```python
import torch

def _softmax(x, axis=-1):
    return torch.softmax(x, dim=axis)

def _gelu(x):
    return torch.nn.functional.gelu(x, approximate='tanh')

def _silu(x):
    return torch.nn.functional.silu(x)

def _sigmoid(x):
    return torch.sigmoid(x)

def _layernorm(x, axis=-1, eps=1e-05):
    m = x.mean(dim=axis, keepdim=True)
    v = x.var(dim=axis, keepdim=True, unbiased=False)
    return (x - m) / torch.sqrt(v + eps)

def _scatter_add(tgt, idx, src, axis=0):
    return tgt.clone().index_add_(axis, idx, src)

def _segment_sum(src, seg, n):
    out = torch.zeros((n,) + src.shape[1:], dtype=src.dtype)
    return out.index_add_(0, seg, src)

def _pad(x, pw):
    flat = tuple((v for pair in reversed(pw) for v in pair))
    return torch.nn.functional.pad(x, flat)
kernel_name = 'gated_mix__memory_aug_recurrent_mem_tr__moe_arch_mod__prompt'

def setup_inputs():

    _w = lambda a: (lambda t: t.to(torch.bfloat16) if t.is_floating_point() else t)(torch.as_tensor(a))

    def _A_setup():
        B, S, Dm = (1, 2048, 512)
        H, Dh = (32, 128)
        M, seg = (8, 32)
        seg = min(seg, S)
        S = S // seg * seg
        return {'x': _w((lambda *s: torch.randn(*s, dtype=torch.bfloat16) * 0.05)(B, S, Dm)), 'mem0': _w((lambda *s: torch.randn(*s, dtype=torch.bfloat16) * 0.8)(B, M, Dm)), 'Wq': _w((lambda *s: torch.randn(*s, dtype=torch.bfloat16) * 3.2)(Dm, H, Dh) * Dm ** (-0.5)), 'Wk': _w((lambda *s: torch.randn(*s, dtype=torch.bfloat16) * 3.2)(Dm, H, Dh) * Dm ** (-0.5)), 'Wv': _w((lambda *s: torch.randn(*s, dtype=torch.bfloat16) * 0.8)(Dm, H, Dh) * Dm ** (-0.5)), 'Wo': _w((lambda *s: torch.randn(*s, dtype=torch.bfloat16) * 0.8)(H, Dh, Dm) * (H * Dh) ** (-0.5)), 'seg_len': seg}
    _A_in = _A_setup()

    def _B_setup():
        B, S, D, F, C = (1, 2048, 512, 1792, 8)
        return {'x': _w((lambda *s: torch.randn(*s, dtype=torch.bfloat16) * 0.05)(B, S, D)), 'w_r': _w((lambda *s: torch.randn(*s, dtype=torch.bfloat16) * 1.6)(D)), 'w_gate': _w((lambda *s: torch.randn(*s, dtype=torch.bfloat16) * 0.2)(D, F)), 'w_up': _w((lambda *s: torch.randn(*s, dtype=torch.bfloat16) * 0.2)(D, F)), 'w_down': _w((lambda *s: torch.randn(*s, dtype=torch.bfloat16) * 0.2)(F, D))}
    _B_in = _B_setup()
    return {'A_x': _A_in['x'], 'A_mem0': _A_in['mem0'], 'A_Wq': _A_in['Wq'], 'A_Wk': _A_in['Wk'], 'A_Wv': _A_in['Wv'], 'A_Wo': _A_in['Wo'], 'A_seg_len': _A_in['seg_len'], 'B_x': _B_in['x'], 'B_w_r': _B_in['w_r'], 'B_w_gate': _B_in['w_gate'], 'B_w_up': _B_in['w_up'], 'B_w_down': _B_in['w_down'], 'gate_w': _w((lambda *s: torch.randn(*s, dtype=torch.bfloat16) * 0.05)(512) * 16.0)}

def reference(A_x, A_mem0, A_Wq, A_Wk, A_Wv, A_Wo, A_seg_len, B_x, B_w_r, B_w_gate, B_w_up, B_w_down, gate_w):

    def _A_ref(x, mem0, Wq, Wk, Wv, Wo, seg_len):
        B, S, Dm = x.shape
        H, Dh = (Wq.shape[1], Wq.shape[2])
        M = mem0.shape[1]
        scale = Dh ** (-0.5)
        n_seg = S // seg_len
        L = M + seg_len
        idx = torch.arange(L)
        mask = (idx[:, None] < M) | (idx[:, None] >= idx[None, :])
        mem = mem0
        outs = []
        for s in range(n_seg):
            xs = x[:, s * seg_len:(s + 1) * seg_len, :].clone()
            h = torch.concatenate([mem, xs], axis=1)
            q = torch.einsum('btd,dhe->bhte', h, Wq)
            k = torch.einsum('btd,dhe->bhte', h, Wk)
            v = torch.einsum('btd,dhe->bhte', h, Wv)
            scores = torch.einsum('bhqe,bhke->bhqk', q, k) * scale
            scores = torch.where(mask[None, None], scores, -1000000000.0)
            p = _softmax(scores, axis=-1)
            o = torch.einsum('bhqk,bhke->bhqe', p, v)
            o = torch.einsum('bhte,hed->btd', o, Wo)
            mem = o[:, :M, :].clone()
            outs.append(o[:, M:, :])
        return torch.concatenate(outs, axis=1)

    def _B_ref(x, w_r, w_gate, w_up, w_down):
        B, S, D = x.shape
        C = 8
        r = x @ w_r
        idx = torch.argsort(-r, axis=-1)[:, :C]
        idx_e = (lambda x, n, axis: torch.repeat_interleave(x, n, dim=axis))(idx.reshape(B, C, 1), D, axis=2)
        x_sel = (lambda x, i, axis: torch.take_along_dim(x, i, dim=axis))(x, idx_e, axis=1)
        g = _silu(x_sel @ w_gate)
        u = x_sel @ w_up
        y = g * u @ w_down
        r_sel = _sigmoid((lambda x, i, axis: torch.take_along_dim(x, i, dim=axis))(r, idx, axis=1))
        y = y * r_sel.reshape(B, C, 1)
        b_off = (torch.arange(B) * S).reshape(B, 1)
        flat_idx = (idx + b_off).reshape(B * C)
        zero = (x * 0.0).reshape(B * S, D)
        upd = _scatter_add(zero, flat_idx, y.reshape(B * C, D), axis=0)
        return x + upd.reshape(B, S, D)
    x = A_x
    g = _sigmoid((x * gate_w).sum(-1, keepdims=True))
    a = _A_ref(x, A_mem0, A_Wq, A_Wk, A_Wv, A_Wo, A_seg_len)
    b = _B_ref(x, B_w_r, B_w_gate, B_w_up, B_w_down)
    return g * a + (1 - g) * b
```

```asm
; @launch grid=(256,1,1) block=(256,1,1) lds=163840
.amdgcn_target "amdgcn-amd-amdhsa--gfx950"
.text
.globl gated_mix__memory_aug_recurrent_mem_tr__moe_arch_mod__prompt_kernel
.p2align 8
.type gated_mix__memory_aug_recurrent_mem_tr__moe_arch_mod__prompt_kernel,@function
gated_mix__memory_aug_recurrent_mem_tr__moe_arch_mod__prompt_kernel:
  s_cmp_ge_u32 s2, 256
  s_cbranch_scc1 L_end
  s_load_dwordx4 s[4:7], s[0:1], 0
  s_load_dwordx4 s[8:11], s[0:1], 16
  s_load_dwordx4 s[12:15], s[0:1], 32
  s_load_dwordx2 s[18:19], s[0:1], 112
  s_load_dwordx2 s[16:17], s[0:1], 120
  s_getreg_b32 s3, hwreg(HW_REG_XCC_ID)
  s_and_b32 s3, s3, 7
  s_lshl_b32 s54, s3, 2
  s_cmp_eq_u32 s3, 0
  s_cselect_b32 s54, 128, s54
  v_mov_b32 v2, s54
  v_mov_b32 v3, 1
  v_mov_b32 v5, 0
  s_waitcnt lgkmcnt(0)
  v_cmp_eq_u32 vcc, 0, v0
  s_nop 0
  s_and_saveexec_b64 s[64:65], vcc
  s_cbranch_execz L_tk
  global_atomic_add v4, v2, v3, s[18:19] sc0
  s_waitcnt vmcnt(0)
  ds_write_b32 v5, v4
  s_waitcnt lgkmcnt(0)
L_tk:
  s_mov_b64 exec, -1
  s_barrier
  ds_read_b32 v4, v5
  s_waitcnt lgkmcnt(0)
  v_readfirstlane_b32 s55, v4
  s_barrier
  s_cmp_lt_u32 s55, 32
  s_cbranch_scc1 L_roles
  v_mov_b32 v2, 32
  v_cmp_eq_u32 vcc, 0, v0
  s_nop 0
  s_and_saveexec_b64 s[64:65], vcc
  s_cbranch_execz L_tk2
  global_atomic_add v4, v2, v3, s[18:19] sc0
  s_waitcnt vmcnt(0)
  ds_write_b32 v5, v4
  s_waitcnt lgkmcnt(0)
L_tk2:
  s_mov_b64 exec, -1
  s_barrier
  ds_read_b32 v4, v5
  s_waitcnt lgkmcnt(0)
  v_readfirstlane_b32 s56, v4
  s_barrier
  s_mov_b32 s27, 0
L_ovf_w:
  s_add_u32 s27, s27, 1
  s_cmp_gt_u32 s27, 0x400000
  s_cbranch_scc1 L_end
  v_mbcnt_lo_u32_b32 v6, -1, 0
  v_mbcnt_hi_u32_b32 v6, -1, v6
  v_and_b32 v6, 7, v6
  v_lshlrev_b32 v6, 2, v6
  v_mov_b32 v7, 128
  v_cmp_eq_u32 vcc, 0, v6
  s_nop 1
  v_cndmask_b32 v6, v6, v7, vcc
  global_load_dword v7, v6, s[18:19] sc1
  s_waitcnt vmcnt(0)
  v_readlane_b32 s70, v7, 0
  v_readlane_b32 s71, v7, 1
  v_readlane_b32 s72, v7, 2
  v_readlane_b32 s73, v7, 3
  v_readlane_b32 s74, v7, 4
  v_readlane_b32 s75, v7, 5
  v_readlane_b32 s76, v7, 6
  v_readlane_b32 s77, v7, 7
  s_add_u32 s54, s70, s71
  s_add_u32 s54, s54, s72
  s_add_u32 s54, s54, s73
  s_add_u32 s54, s54, s74
  s_add_u32 s54, s54, s75
  s_add_u32 s54, s54, s76
  s_add_u32 s54, s54, s77
  s_cmp_ge_u32 s54, 256
  s_cbranch_scc0 L_ovf_w
  s_min_u32 s54, s70, 32
  s_sub_u32 s57, 32, s54
  s_mov_b32 s3, 0
  s_add_u32 s55, s54, s56
  s_cmp_lt_u32 s56, s57
  s_cbranch_scc1 L_roles
  s_sub_u32 s56, s56, s57
  s_min_u32 s54, s71, 32
  s_sub_u32 s57, 32, s54
  s_mov_b32 s3, 1
  s_add_u32 s55, s54, s56
  s_cmp_lt_u32 s56, s57
  s_cbranch_scc1 L_roles
  s_sub_u32 s56, s56, s57
  s_min_u32 s54, s72, 32
  s_sub_u32 s57, 32, s54
  s_mov_b32 s3, 2
  s_add_u32 s55, s54, s56
  s_cmp_lt_u32 s56, s57
  s_cbranch_scc1 L_roles
  s_sub_u32 s56, s56, s57
  s_min_u32 s54, s73, 32
  s_sub_u32 s57, 32, s54
  s_mov_b32 s3, 3
  s_add_u32 s55, s54, s56
  s_cmp_lt_u32 s56, s57
  s_cbranch_scc1 L_roles
  s_sub_u32 s56, s56, s57
  s_min_u32 s54, s74, 32
  s_sub_u32 s57, 32, s54
  s_mov_b32 s3, 4
  s_add_u32 s55, s54, s56
  s_cmp_lt_u32 s56, s57
  s_cbranch_scc1 L_roles
  s_sub_u32 s56, s56, s57
  s_min_u32 s54, s75, 32
  s_sub_u32 s57, 32, s54
  s_mov_b32 s3, 5
  s_add_u32 s55, s54, s56
  s_cmp_lt_u32 s56, s57
  s_cbranch_scc1 L_roles
  s_sub_u32 s56, s56, s57
  s_min_u32 s54, s76, 32
  s_sub_u32 s57, 32, s54
  s_mov_b32 s3, 6
  s_add_u32 s55, s54, s56
  s_cmp_lt_u32 s56, s57
  s_cbranch_scc1 L_roles
  s_sub_u32 s56, s56, s57
  s_min_u32 s54, s77, 32
  s_sub_u32 s57, 32, s54
  s_mov_b32 s3, 7
  s_add_u32 s55, s54, s56
  s_cmp_lt_u32 s56, s57
  s_cbranch_scc1 L_roles
  s_sub_u32 s56, s56, s57
  s_branch L_end
L_roles:
  s_cmp_eq_u32 s3, 0
  s_cbranch_scc1 L_role_rec
  s_cmp_le_u32 s3, 4
  s_cbranch_scc1 L_role_p1
  s_branch L_role_p2
L_role_p1:
  s_sub_u32 s54, s3, 1
  s_lshl_b32 s54, s54, 3
  s_and_b32 s20, s55, 7
  s_add_u32 s20, s20, s54
  s_lshr_b32 s22, s55, 3
L_p1:
  v_lshrrev_b32 v1, 6, v0
  v_lshlrev_b32 v2, 4, v0
  s_nop 0
  v_readfirstlane_b32 s21, v1
  s_getpc_b64 s[62:63]
  s_add_u32 s62, s62, L_tables@rel32@lo+4
  s_addc_u32 s63, s63, L_tables@rel32@hi+12
  s_add_u32 s64, s62, 0
  s_addc_u32 s65, s63, 0
  global_load_dwordx4 v[4:7], v2, s[64:65]
  s_add_u32 s64, s62, 4096
  s_addc_u32 s65, s63, 0
  global_load_dwordx4 v[8:11], v2, s[64:65]
  s_add_u32 s64, s62, 8192
  s_addc_u32 s65, s63, 0
  global_load_dwordx4 v[12:15], v2, s[64:65]
  s_mov_b32 s24, 0x3e0293ee
  s_mov_b32 s23, 0
  s_lshl_b32 s54, s20, 8
  s_add_u32 s8, s8, s54
  s_addc_u32 s9, s9, 0
  s_add_u32 s10, s10, s54
  s_addc_u32 s11, s11, 0
  s_add_u32 s12, s12, s54
  s_addc_u32 s13, s13, 0
  s_getpc_b64 s[64:65]
Lpc_1:
  s_add_u32 s64, s64, L_p1_task-Lpc_1
  s_addc_u32 s65, s65, 0
  v_lshlrev_b32 v21, 6, v0
  global_load_dword v26, v21, s[64:65]
  s_waitcnt vmcnt(1)
  s_add_u32 s64, s62, 12288
  s_addc_u32 s65, s63, 0
  global_load_dwordx4 v[20:23], v2, s[64:65]
  s_and_b32 s54, s22, 1
  s_lshl_b32 s54, s54, 7
  s_cmp_lt_u32 s22, 2
  s_cselect_b32 s40, s10, s12
  s_cselect_b32 s41, s11, s13
  s_add_u32 s40, s40, s54
  s_addc_u32 s41, s41, 0
  s_lshl_b32 s56, s21, 14
  s_waitcnt vmcnt(0)
  s_add_u32 m0, s56, 0
  s_nop 0
  global_load_lds_dwordx4 v20, s[40:41]
  s_add_u32 s40, s40, 65536
  s_addc_u32 s41, s41, 0
  s_add_u32 m0, s56, 1024
  s_nop 0
  global_load_lds_dwordx4 v20, s[40:41]
  s_add_u32 s40, s40, 65536
  s_addc_u32 s41, s41, 0
  s_add_u32 m0, s56, 2048
  s_nop 0
  global_load_lds_dwordx4 v20, s[40:41]
  s_add_u32 s40, s40, 65536
  s_addc_u32 s41, s41, 0
  s_add_u32 m0, s56, 3072
  s_nop 0
  global_load_lds_dwordx4 v20, s[40:41]
  s_add_u32 s40, s40, 65536
  s_addc_u32 s41, s41, 0
  s_add_u32 m0, s56, 4096
  s_nop 0
  global_load_lds_dwordx4 v20, s[40:41]
  s_add_u32 s40, s40, 65536
  s_addc_u32 s41, s41, 0
  s_add_u32 m0, s56, 5120
  s_nop 0
  global_load_lds_dwordx4 v20, s[40:41]
  s_add_u32 s40, s40, 65536
  s_addc_u32 s41, s41, 0
  s_add_u32 m0, s56, 6144
  s_nop 0
  global_load_lds_dwordx4 v20, s[40:41]
  s_add_u32 s40, s40, 65536
  s_addc_u32 s41, s41, 0
  s_add_u32 m0, s56, 7168
  s_nop 0
  global_load_lds_dwordx4 v20, s[40:41]
  s_add_u32 s40, s40, 65536
  s_addc_u32 s41, s41, 0
  s_add_u32 m0, s56, 8192
  s_nop 0
  global_load_lds_dwordx4 v20, s[40:41]
  s_add_u32 s40, s40, 65536
  s_addc_u32 s41, s41, 0
  s_add_u32 m0, s56, 9216
  s_nop 0
  global_load_lds_dwordx4 v20, s[40:41]
  s_add_u32 s40, s40, 65536
  s_addc_u32 s41, s41, 0
  s_add_u32 m0, s56, 10240
  s_nop 0
  global_load_lds_dwordx4 v20, s[40:41]
  s_add_u32 s40, s40, 65536
  s_addc_u32 s41, s41, 0
  s_add_u32 m0, s56, 11264
  s_nop 0
  global_load_lds_dwordx4 v20, s[40:41]
  s_add_u32 s40, s40, 65536
  s_addc_u32 s41, s41, 0
  s_add_u32 m0, s56, 12288
  s_nop 0
  global_load_lds_dwordx4 v20, s[40:41]
  s_add_u32 s40, s40, 65536
  s_addc_u32 s41, s41, 0
  s_add_u32 m0, s56, 13312
  s_nop 0
  global_load_lds_dwordx4 v20, s[40:41]
  s_add_u32 s40, s40, 65536
  s_addc_u32 s41, s41, 0
  s_add_u32 m0, s56, 14336
  s_nop 0
  global_load_lds_dwordx4 v20, s[40:41]
  s_add_u32 s40, s40, 65536
  s_addc_u32 s41, s41, 0
  s_add_u32 m0, s56, 15360
  s_nop 0
  global_load_lds_dwordx4 v20, s[40:41]
  s_add_u32 s40, s40, 65536
  s_addc_u32 s41, s41, 0
  global_load_dwordx4 a[0:3], v4, s[4:5] offset:0
  global_load_dwordx4 a[4:7], v4, s[4:5] offset:32
  global_load_dwordx4 a[8:11], v4, s[4:5] offset:64
  global_load_dwordx4 a[12:15], v4, s[4:5] offset:96
  global_load_dwordx4 a[16:19], v4, s[4:5] offset:128
  global_load_dwordx4 a[20:23], v4, s[4:5] offset:160
  global_load_dwordx4 a[24:27], v4, s[4:5] offset:192
  global_load_dwordx4 a[28:31], v4, s[4:5] offset:224
  global_load_dwordx4 a[32:35], v4, s[4:5] offset:256
  global_load_dwordx4 a[36:39], v4, s[4:5] offset:288
  global_load_dwordx4 a[40:43], v4, s[4:5] offset:320
  global_load_dwordx4 a[44:47], v4, s[4:5] offset:352
  global_load_dwordx4 a[48:51], v4, s[4:5] offset:384
  global_load_dwordx4 a[52:55], v4, s[4:5] offset:416
  global_load_dwordx4 a[56:59], v4, s[4:5] offset:448
  global_load_dwordx4 a[60:63], v4, s[4:5] offset:480
  global_load_dwordx4 a[64:67], v4, s[4:5] offset:512
  global_load_dwordx4 a[68:71], v4, s[4:5] offset:544
  global_load_dwordx4 a[72:75], v4, s[4:5] offset:576
  global_load_dwordx4 a[76:79], v4, s[4:5] offset:608
  global_load_dwordx4 a[80:83], v4, s[4:5] offset:640
  global_load_dwordx4 a[84:87], v4, s[4:5] offset:672
  global_load_dwordx4 a[88:91], v4, s[4:5] offset:704
  global_load_dwordx4 a[92:95], v4, s[4:5] offset:736
  global_load_dwordx4 a[96:99], v4, s[4:5] offset:768
  global_load_dwordx4 a[100:103], v4, s[4:5] offset:800
  global_load_dwordx4 a[104:107], v4, s[4:5] offset:832
  global_load_dwordx4 a[108:111], v4, s[4:5] offset:864
  global_load_dwordx4 a[112:115], v4, s[4:5] offset:896
  global_load_dwordx4 a[116:119], v4, s[4:5] offset:928
  global_load_dwordx4 a[120:123], v4, s[4:5] offset:960
  global_load_dwordx4 a[124:127], v4, s[4:5] offset:992
  s_add_u32 s40, s4, 131072
  s_addc_u32 s41, s5, 0
  s_waitcnt vmcnt(32)
  s_barrier
L_mini_loop:
  s_cmp_lt_u32 s22, 2
  s_cbranch_scc0 L_mini_v
  ds_read_b64_tr_b16 v[32:33], v21 offset:0
  ds_read_b64_tr_b16 v[34:35], v21 offset:512
  ds_read_b64_tr_b16 v[36:37], v21 offset:64
  ds_read_b64_tr_b16 v[38:39], v21 offset:576
  ds_read_b64_tr_b16 v[40:41], v21 offset:2048
  ds_read_b64_tr_b16 v[42:43], v21 offset:2560
  ds_read_b64_tr_b16 v[44:45], v21 offset:2112
  ds_read_b64_tr_b16 v[46:47], v21 offset:2624
  ds_read_b64_tr_b16 v[48:49], v21 offset:4096
  ds_read_b64_tr_b16 v[50:51], v21 offset:4608
  ds_read_b64_tr_b16 v[52:53], v21 offset:4160
  ds_read_b64_tr_b16 v[54:55], v21 offset:4672
  ds_read_b64_tr_b16 v[56:57], v21 offset:6144
  ds_read_b64_tr_b16 v[58:59], v21 offset:6656
  s_waitcnt lgkmcnt(12)
  s_waitcnt vmcnt(28)
  v_mfma_f32_32x32x16_bf16 v[64:79], v[32:35], a[0:3], 0
  ds_read_b64_tr_b16 v[60:61], v21 offset:6208
  ds_read_b64_tr_b16 v[62:63], v21 offset:6720
  s_waitcnt lgkmcnt(12)
  v_mfma_f32_32x32x16_bf16 v[80:95], v[36:39], a[0:3], 0
  ds_read_b64_tr_b16 v[32:33], v21 offset:8192
  ds_read_b64_tr_b16 v[34:35], v21 offset:8704
  s_waitcnt lgkmcnt(12)
  v_mfma_f32_32x32x16_bf16 v[64:79], v[40:43], a[4:7], v[64:79]
  ds_read_b64_tr_b16 v[36:37], v21 offset:8256
  ds_read_b64_tr_b16 v[38:39], v21 offset:8768
  s_waitcnt lgkmcnt(12)
  v_mfma_f32_32x32x16_bf16 v[80:95], v[44:47], a[4:7], v[80:95]
  ds_read_b64_tr_b16 v[40:41], v21 offset:10240
  ds_read_b64_tr_b16 v[42:43], v21 offset:10752
  s_waitcnt lgkmcnt(12)
  v_mfma_f32_32x32x16_bf16 v[64:79], v[48:51], a[8:11], v[64:79]
  ds_read_b64_tr_b16 v[44:45], v21 offset:10304
  ds_read_b64_tr_b16 v[46:47], v21 offset:10816
  s_waitcnt lgkmcnt(12)
  v_mfma_f32_32x32x16_bf16 v[80:95], v[52:55], a[8:11], v[80:95]
  ds_read_b64_tr_b16 v[48:49], v21 offset:12288
  ds_read_b64_tr_b16 v[50:51], v21 offset:12800
  s_waitcnt lgkmcnt(12)
  v_mfma_f32_32x32x16_bf16 v[64:79], v[56:59], a[12:15], v[64:79]
  ds_read_b64_tr_b16 v[52:53], v21 offset:12352
  ds_read_b64_tr_b16 v[54:55], v21 offset:12864
  s_waitcnt lgkmcnt(12)
  v_mfma_f32_32x32x16_bf16 v[80:95], v[60:63], a[12:15], v[80:95]
  ds_read_b64_tr_b16 v[56:57], v21 offset:14336
  ds_read_b64_tr_b16 v[58:59], v21 offset:14848
  s_waitcnt lgkmcnt(12)
  s_waitcnt vmcnt(24)
  v_mfma_f32_32x32x16_bf16 v[64:79], v[32:35], a[16:19], v[64:79]
  ds_read_b64_tr_b16 v[60:61], v21 offset:14400
  ds_read_b64_tr_b16 v[62:63], v21 offset:14912
  s_waitcnt lgkmcnt(12)
  v_mfma_f32_32x32x16_bf16 v[80:95], v[36:39], a[16:19], v[80:95]
  ds_read_b64_tr_b16 v[32:33], v21 offset:16384
  ds_read_b64_tr_b16 v[34:35], v21 offset:16896
  s_waitcnt lgkmcnt(12)
  v_mfma_f32_32x32x16_bf16 v[64:79], v[40:43], a[20:23], v[64:79]
  ds_read_b64_tr_b16 v[36:37], v21 offset:16448
  ds_read_b64_tr_b16 v[38:39], v21 offset:16960
  s_waitcnt lgkmcnt(12)
  v_mfma_f32_32x32x16_bf16 v[80:95], v[44:47], a[20:23], v[80:95]
  ds_read_b64_tr_b16 v[40:41], v21 offset:18432
  ds_read_b64_tr_b16 v[42:43], v21 offset:18944
  s_waitcnt lgkmcnt(12)
  v_mfma_f32_32x32x16_bf16 v[64:79], v[48:51], a[24:27], v[64:79]
  ds_read_b64_tr_b16 v[44:45], v21 offset:18496
  ds_read_b64_tr_b16 v[46:47], v21 offset:19008
  s_waitcnt lgkmcnt(12)
  v_mfma_f32_32x32x16_bf16 v[80:95], v[52:55], a[24:27], v[80:95]
  ds_read_b64_tr_b16 v[48:49], v21 offset:20480
  ds_read_b64_tr_b16 v[50:51], v21 offset:20992
  s_waitcnt lgkmcnt(12)
  v_mfma_f32_32x32x16_bf16 v[64:79], v[56:59], a[28:31], v[64:79]
  ds_read_b64_tr_b16 v[52:53], v21 offset:20544
  ds_read_b64_tr_b16 v[54:55], v21 offset:21056
  s_waitcnt lgkmcnt(12)
  v_mfma_f32_32x32x16_bf16 v[80:95], v[60:63], a[28:31], v[80:95]
  ds_read_b64_tr_b16 v[56:57], v21 offset:22528
  ds_read_b64_tr_b16 v[58:59], v21 offset:23040
  s_waitcnt lgkmcnt(12)
  s_waitcnt vmcnt(20)
  v_mfma_f32_32x32x16_bf16 v[64:79], v[32:35], a[32:35], v[64:79]
  ds_read_b64_tr_b16 v[60:61], v21 offset:22592
  ds_read_b64_tr_b16 v[62:63], v21 offset:23104
  s_waitcnt lgkmcnt(12)
  v_mfma_f32_32x32x16_bf16 v[80:95], v[36:39], a[32:35], v[80:95]
  ds_read_b64_tr_b16 v[32:33], v21 offset:24576
  ds_read_b64_tr_b16 v[34:35], v21 offset:25088
  s_waitcnt lgkmcnt(12)
  v_mfma_f32_32x32x16_bf16 v[64:79], v[40:43], a[36:39], v[64:79]
  ds_read_b64_tr_b16 v[36:37], v21 offset:24640
  ds_read_b64_tr_b16 v[38:39], v21 offset:25152
  s_waitcnt lgkmcnt(12)
  v_mfma_f32_32x32x16_bf16 v[80:95], v[44:47], a[36:39], v[80:95]
  ds_read_b64_tr_b16 v[40:41], v21 offset:26624
  ds_read_b64_tr_b16 v[42:43], v21 offset:27136
  s_waitcnt lgkmcnt(12)
  v_mfma_f32_32x32x16_bf16 v[64:79], v[48:51], a[40:43], v[64:79]
  ds_read_b64_tr_b16 v[44:45], v21 offset:26688
  ds_read_b64_tr_b16 v[46:47], v21 offset:27200
  s_waitcnt lgkmcnt(12)
  v_mfma_f32_32x32x16_bf16 v[80:95], v[52:55], a[40:43], v[80:95]
  ds_read_b64_tr_b16 v[48:49], v21 offset:28672
  ds_read_b64_tr_b16 v[50:51], v21 offset:29184
  s_waitcnt lgkmcnt(12)
  v_mfma_f32_32x32x16_bf16 v[64:79], v[56:59], a[44:47], v[64:79]
  ds_read_b64_tr_b16 v[52:53], v21 offset:28736
  ds_read_b64_tr_b16 v[54:55], v21 offset:29248
  s_waitcnt lgkmcnt(12)
  v_mfma_f32_32x32x16_bf16 v[80:95], v[60:63], a[44:47], v[80:95]
  ds_read_b64_tr_b16 v[56:57], v21 offset:30720
  ds_read_b64_tr_b16 v[58:59], v21 offset:31232
  s_waitcnt lgkmcnt(12)
  s_waitcnt vmcnt(16)
  v_mfma_f32_32x32x16_bf16 v[64:79], v[32:35], a[48:51], v[64:79]
  ds_read_b64_tr_b16 v[60:61], v21 offset:30784
  ds_read_b64_tr_b16 v[62:63], v21 offset:31296
  s_waitcnt lgkmcnt(12)
  v_mfma_f32_32x32x16_bf16 v[80:95], v[36:39], a[48:51], v[80:95]
  ds_read_b64_tr_b16 v[32:33], v21 offset:32768
  ds_read_b64_tr_b16 v[34:35], v21 offset:33280
  s_waitcnt lgkmcnt(12)
  v_mfma_f32_32x32x16_bf16 v[64:79], v[40:43], a[52:55], v[64:79]
  ds_read_b64_tr_b16 v[36:37], v21 offset:32832
  ds_read_b64_tr_b16 v[38:39], v21 offset:33344
  s_waitcnt lgkmcnt(12)
  v_mfma_f32_32x32x16_bf16 v[80:95], v[44:47], a[52:55], v[80:95]
  ds_read_b64_tr_b16 v[40:41], v21 offset:34816
  ds_read_b64_tr_b16 v[42:43], v21 offset:35328
  s_waitcnt lgkmcnt(12)
  v_mfma_f32_32x32x16_bf16 v[64:79], v[48:51], a[56:59], v[64:79]
  ds_read_b64_tr_b16 v[44:45], v21 offset:34880
  ds_read_b64_tr_b16 v[46:47], v21 offset:35392
  s_waitcnt lgkmcnt(12)
  v_mfma_f32_32x32x16_bf16 v[80:95], v[52:55], a[56:59], v[80:95]
  ds_read_b64_tr_b16 v[48:49], v21 offset:36864
  ds_read_b64_tr_b16 v[50:51], v21 offset:37376
  s_waitcnt lgkmcnt(12)
  v_mfma_f32_32x32x16_bf16 v[64:79], v[56:59], a[60:63], v[64:79]
  ds_read_b64_tr_b16 v[52:53], v21 offset:36928
  ds_read_b64_tr_b16 v[54:55], v21 offset:37440
  s_waitcnt lgkmcnt(12)
  v_mfma_f32_32x32x16_bf16 v[80:95], v[60:63], a[60:63], v[80:95]
  ds_read_b64_tr_b16 v[56:57], v21 offset:38912
  ds_read_b64_tr_b16 v[58:59], v21 offset:39424
  s_waitcnt lgkmcnt(12)
  s_waitcnt vmcnt(12)
  v_mfma_f32_32x32x16_bf16 v[64:79], v[32:35], a[64:67], v[64:79]
  ds_read_b64_tr_b16 v[60:61], v21 offset:38976
  ds_read_b64_tr_b16 v[62:63], v21 offset:39488
  s_waitcnt lgkmcnt(12)
  v_mfma_f32_32x32x16_bf16 v[80:95], v[36:39], a[64:67], v[80:95]
  ds_read_b64_tr_b16 v[32:33], v21 offset:40960
  ds_read_b64_tr_b16 v[34:35], v21 offset:41472
  s_waitcnt lgkmcnt(12)
  v_mfma_f32_32x32x16_bf16 v[64:79], v[40:43], a[68:71], v[64:79]
  ds_read_b64_tr_b16 v[36:37], v21 offset:41024
  ds_read_b64_tr_b16 v[38:39], v21 offset:41536
  s_waitcnt lgkmcnt(12)
  v_mfma_f32_32x32x16_bf16 v[80:95], v[44:47], a[68:71], v[80:95]
  ds_read_b64_tr_b16 v[40:41], v21 offset:43008
  ds_read_b64_tr_b16 v[42:43], v21 offset:43520
  s_waitcnt lgkmcnt(12)
  v_mfma_f32_32x32x16_bf16 v[64:79], v[48:51], a[72:75], v[64:79]
  ds_read_b64_tr_b16 v[44:45], v21 offset:43072
  ds_read_b64_tr_b16 v[46:47], v21 offset:43584
  s_waitcnt lgkmcnt(12)
  v_mfma_f32_32x32x16_bf16 v[80:95], v[52:55], a[72:75], v[80:95]
  ds_read_b64_tr_b16 v[48:49], v21 offset:45056
  ds_read_b64_tr_b16 v[50:51], v21 offset:45568
  s_waitcnt lgkmcnt(12)
  v_mfma_f32_32x32x16_bf16 v[64:79], v[56:59], a[76:79], v[64:79]
  ds_read_b64_tr_b16 v[52:53], v21 offset:45120
  ds_read_b64_tr_b16 v[54:55], v21 offset:45632
  s_waitcnt lgkmcnt(12)
  v_mfma_f32_32x32x16_bf16 v[80:95], v[60:63], a[76:79], v[80:95]
  ds_read_b64_tr_b16 v[56:57], v21 offset:47104
  ds_read_b64_tr_b16 v[58:59], v21 offset:47616
  s_waitcnt lgkmcnt(12)
  s_waitcnt vmcnt(8)
  v_mfma_f32_32x32x16_bf16 v[64:79], v[32:35], a[80:83], v[64:79]
  ds_read_b64_tr_b16 v[60:61], v21 offset:47168
  ds_read_b64_tr_b16 v[62:63], v21 offset:47680
  s_waitcnt lgkmcnt(12)
  v_mfma_f32_32x32x16_bf16 v[80:95], v[36:39], a[80:83], v[80:95]
  ds_read_b64_tr_b16 v[32:33], v21 offset:49152
  ds_read_b64_tr_b16 v[34:35], v21 offset:49664
  s_waitcnt lgkmcnt(12)
  v_mfma_f32_32x32x16_bf16 v[64:79], v[40:43], a[84:87], v[64:79]
  ds_read_b64_tr_b16 v[36:37], v21 offset:49216
  ds_read_b64_tr_b16 v[38:39], v21 offset:49728
  s_waitcnt lgkmcnt(12)
  v_mfma_f32_32x32x16_bf16 v[80:95], v[44:47], a[84:87], v[80:95]
  ds_read_b64_tr_b16 v[40:41], v21 offset:51200
  ds_read_b64_tr_b16 v[42:43], v21 offset:51712
  s_waitcnt lgkmcnt(12)
  v_mfma_f32_32x32x16_bf16 v[64:79], v[48:51], a[88:91], v[64:79]
  ds_read_b64_tr_b16 v[44:45], v21 offset:51264
  ds_read_b64_tr_b16 v[46:47], v21 offset:51776
  s_waitcnt lgkmcnt(12)
  v_mfma_f32_32x32x16_bf16 v[80:95], v[52:55], a[88:91], v[80:95]
  ds_read_b64_tr_b16 v[48:49], v21 offset:53248
  ds_read_b64_tr_b16 v[50:51], v21 offset:53760
  s_waitcnt lgkmcnt(12)
  v_mfma_f32_32x32x16_bf16 v[64:79], v[56:59], a[92:95], v[64:79]
  ds_read_b64_tr_b16 v[52:53], v21 offset:53312
  ds_read_b64_tr_b16 v[54:55], v21 offset:53824
  s_waitcnt lgkmcnt(12)
  v_mfma_f32_32x32x16_bf16 v[80:95], v[60:63], a[92:95], v[80:95]
  ds_read_b64_tr_b16 v[56:57], v21 offset:55296
  ds_read_b64_tr_b16 v[58:59], v21 offset:55808
  s_waitcnt lgkmcnt(12)
  s_waitcnt vmcnt(4)
  v_mfma_f32_32x32x16_bf16 v[64:79], v[32:35], a[96:99], v[64:79]
  ds_read_b64_tr_b16 v[60:61], v21 offset:55360
  ds_read_b64_tr_b16 v[62:63], v21 offset:55872
  s_waitcnt lgkmcnt(12)
  v_mfma_f32_32x32x16_bf16 v[80:95], v[36:39], a[96:99], v[80:95]
  ds_read_b64_tr_b16 v[32:33], v21 offset:57344
  ds_read_b64_tr_b16 v[34:35], v21 offset:57856
  s_waitcnt lgkmcnt(12)
  v_mfma_f32_32x32x16_bf16 v[64:79], v[40:43], a[100:103], v[64:79]
  ds_read_b64_tr_b16 v[36:37], v21 offset:57408
  ds_read_b64_tr_b16 v[38:39], v21 offset:57920
  s_waitcnt lgkmcnt(12)
  v_mfma_f32_32x32x16_bf16 v[80:95], v[44:47], a[100:103], v[80:95]
  ds_read_b64_tr_b16 v[40:41], v21 offset:59392
  ds_read_b64_tr_b16 v[42:43], v21 offset:59904
  s_waitcnt lgkmcnt(12)
  v_mfma_f32_32x32x16_bf16 v[64:79], v[48:51], a[104:107], v[64:79]
  ds_read_b64_tr_b16 v[44:45], v21 offset:59456
  ds_read_b64_tr_b16 v[46:47], v21 offset:59968
  s_waitcnt lgkmcnt(12)
  v_mfma_f32_32x32x16_bf16 v[80:95], v[52:55], a[104:107], v[80:95]
  ds_read_b64_tr_b16 v[48:49], v21 offset:61440
  ds_read_b64_tr_b16 v[50:51], v21 offset:61952
  s_waitcnt lgkmcnt(12)
  v_mfma_f32_32x32x16_bf16 v[64:79], v[56:59], a[108:111], v[64:79]
  ds_read_b64_tr_b16 v[52:53], v21 offset:61504
  ds_read_b64_tr_b16 v[54:55], v21 offset:62016
  s_waitcnt lgkmcnt(12)
  v_mfma_f32_32x32x16_bf16 v[80:95], v[60:63], a[108:111], v[80:95]
  ds_read_b64_tr_b16 v[56:57], v21 offset:63488
  ds_read_b64_tr_b16 v[58:59], v21 offset:64000
  s_waitcnt lgkmcnt(12)
  s_waitcnt vmcnt(0)
  v_mfma_f32_32x32x16_bf16 v[64:79], v[32:35], a[112:115], v[64:79]
  ds_read_b64_tr_b16 v[60:61], v21 offset:63552
  ds_read_b64_tr_b16 v[62:63], v21 offset:64064
  s_waitcnt lgkmcnt(12)
  v_mfma_f32_32x32x16_bf16 v[80:95], v[36:39], a[112:115], v[80:95]
  s_waitcnt lgkmcnt(10)
  v_mfma_f32_32x32x16_bf16 v[64:79], v[40:43], a[116:119], v[64:79]
  s_waitcnt lgkmcnt(8)
  v_mfma_f32_32x32x16_bf16 v[80:95], v[44:47], a[116:119], v[80:95]
  s_waitcnt lgkmcnt(6)
  v_mfma_f32_32x32x16_bf16 v[64:79], v[48:51], a[120:123], v[64:79]
  s_waitcnt lgkmcnt(4)
  v_mfma_f32_32x32x16_bf16 v[80:95], v[52:55], a[120:123], v[80:95]
  s_waitcnt lgkmcnt(2)
  v_mfma_f32_32x32x16_bf16 v[64:79], v[56:59], a[124:127], v[64:79]
  s_waitcnt lgkmcnt(0)
  v_mfma_f32_32x32x16_bf16 v[80:95], v[60:63], a[124:127], v[80:95]
  s_nop 7
  s_nop 3
  s_lshl_b32 s54, s23, 7
  s_add_u32 s54, s54, s20
  s_add_u32 s54, s54, 0
  s_lshl_b32 s54, s54, 13
  s_and_b32 s55, s22, 1
  s_lshl_b32 s55, s55, 11
  s_add_u32 s54, s54, s55
  s_add_u32 s54, s54, 0
  s_add_u32 s40, s16, s54
  s_addc_u32 s41, s17, 0
  v_mul_f32 v64, s24, v64
  v_mul_f32 v65, s24, v65
  v_mul_f32 v66, s24, v66
  v_mul_f32 v67, s24, v67
  v_mul_f32 v68, s24, v68
  v_mul_f32 v69, s24, v69
  v_mul_f32 v70, s24, v70
  v_mul_f32 v71, s24, v71
  v_mul_f32 v72, s24, v72
  v_mul_f32 v73, s24, v73
  v_mul_f32 v74, s24, v74
  v_mul_f32 v75, s24, v75
  v_mul_f32 v76, s24, v76
  v_mul_f32 v77, s24, v77
  v_mul_f32 v78, s24, v78
  v_mul_f32 v79, s24, v79
  v_cvt_pk_bf16_f32 v64, v64, v65
  v_cvt_pk_bf16_f32 v65, v66, v67
  v_cvt_pk_bf16_f32 v66, v68, v69
  v_cvt_pk_bf16_f32 v67, v70, v71
  v_cvt_pk_bf16_f32 v68, v72, v73
  v_cvt_pk_bf16_f32 v69, v74, v75
  v_cvt_pk_bf16_f32 v70, v76, v77
  v_cvt_pk_bf16_f32 v71, v78, v79
  global_store_dwordx4 v6, v[64:67], s[40:41] offset:0 sc1
  global_store_dwordx4 v6, v[68:71], s[40:41] offset:512 sc1
  v_mul_f32 v80, s24, v80
  v_mul_f32 v81, s24, v81
  v_mul_f32 v82, s24, v82
  v_mul_f32 v83, s24, v83
  v_mul_f32 v84, s24, v84
  v_mul_f32 v85, s24, v85
  v_mul_f32 v86, s24, v86
  v_mul_f32 v87, s24, v87
  v_mul_f32 v88, s24, v88
  v_mul_f32 v89, s24, v89
  v_mul_f32 v90, s24, v90
  v_mul_f32 v91, s24, v91
  v_mul_f32 v92, s24, v92
  v_mul_f32 v93, s24, v93
  v_mul_f32 v94, s24, v94
  v_mul_f32 v95, s24, v95
  v_cvt_pk_bf16_f32 v80, v80, v81
  v_cvt_pk_bf16_f32 v81, v82, v83
  v_cvt_pk_bf16_f32 v82, v84, v85
  v_cvt_pk_bf16_f32 v83, v86, v87
  v_cvt_pk_bf16_f32 v84, v88, v89
  v_cvt_pk_bf16_f32 v85, v90, v91
  v_cvt_pk_bf16_f32 v86, v92, v93
  v_cvt_pk_bf16_f32 v87, v94, v95
  global_store_dwordx4 v6, v[80:83], s[40:41] offset:1024 sc1
  global_store_dwordx4 v6, v[84:87], s[40:41] offset:1536 sc1
  s_branch L_mini_done
L_mini_v:
  ds_read_b64_tr_b16 v[32:33], v21 offset:0
  ds_read_b64_tr_b16 v[34:35], v21 offset:512
  ds_read_b64_tr_b16 v[36:37], v21 offset:64
  ds_read_b64_tr_b16 v[38:39], v21 offset:576
  ds_read_b64_tr_b16 v[40:41], v21 offset:2048
  ds_read_b64_tr_b16 v[42:43], v21 offset:2560
  ds_read_b64_tr_b16 v[44:45], v21 offset:2112
  ds_read_b64_tr_b16 v[46:47], v21 offset:2624
  ds_read_b64_tr_b16 v[48:49], v21 offset:4096
  ds_read_b64_tr_b16 v[50:51], v21 offset:4608
  ds_read_b64_tr_b16 v[52:53], v21 offset:4160
  ds_read_b64_tr_b16 v[54:55], v21 offset:4672
  ds_read_b64_tr_b16 v[56:57], v21 offset:6144
  ds_read_b64_tr_b16 v[58:59], v21 offset:6656
  s_waitcnt lgkmcnt(12)
  s_waitcnt vmcnt(28)
  v_mfma_f32_32x32x16_bf16 v[64:79], a[0:3], v[32:35], 0
  ds_read_b64_tr_b16 v[60:61], v21 offset:6208
  ds_read_b64_tr_b16 v[62:63], v21 offset:6720
  s_waitcnt lgkmcnt(12)
  v_mfma_f32_32x32x16_bf16 v[80:95], a[0:3], v[36:39], 0
  ds_read_b64_tr_b16 v[32:33], v21 offset:8192
  ds_read_b64_tr_b16 v[34:35], v21 offset:8704
  s_waitcnt lgkmcnt(12)
  v_mfma_f32_32x32x16_bf16 v[64:79], a[4:7], v[40:43], v[64:79]
  ds_read_b64_tr_b16 v[36:37], v21 offset:8256
  ds_read_b64_tr_b16 v[38:39], v21 offset:8768
  s_waitcnt lgkmcnt(12)
  v_mfma_f32_32x32x16_bf16 v[80:95], a[4:7], v[44:47], v[80:95]
  ds_read_b64_tr_b16 v[40:41], v21 offset:10240
  ds_read_b64_tr_b16 v[42:43], v21 offset:10752
  s_waitcnt lgkmcnt(12)
  v_mfma_f32_32x32x16_bf16 v[64:79], a[8:11], v[48:51], v[64:79]
  ds_read_b64_tr_b16 v[44:45], v21 offset:10304
  ds_read_b64_tr_b16 v[46:47], v21 offset:10816
  s_waitcnt lgkmcnt(12)
  v_mfma_f32_32x32x16_bf16 v[80:95], a[8:11], v[52:55], v[80:95]
  ds_read_b64_tr_b16 v[48:49], v21 offset:12288
  ds_read_b64_tr_b16 v[50:51], v21 offset:12800
  s_waitcnt lgkmcnt(12)
  v_mfma_f32_32x32x16_bf16 v[64:79], a[12:15], v[56:59], v[64:79]
  ds_read_b64_tr_b16 v[52:53], v21 offset:12352
  ds_read_b64_tr_b16 v[54:55], v21 offset:12864
  s_waitcnt lgkmcnt(12)
  v_mfma_f32_32x32x16_bf16 v[80:95], a[12:15], v[60:63], v[80:95]
  ds_read_b64_tr_b16 v[56:57], v21 offset:14336
  ds_read_b64_tr_b16 v[58:59], v21 offset:14848
  s_waitcnt lgkmcnt(12)
  s_waitcnt vmcnt(24)
  v_mfma_f32_32x32x16_bf16 v[64:79], a[16:19], v[32:35], v[64:79]
  ds_read_b64_tr_b16 v[60:61], v21 offset:14400
  ds_read_b64_tr_b16 v[62:63], v21 offset:14912
  s_waitcnt lgkmcnt(12)
  v_mfma_f32_32x32x16_bf16 v[80:95], a[16:19], v[36:39], v[80:95]
  ds_read_b64_tr_b16 v[32:33], v21 offset:16384
  ds_read_b64_tr_b16 v[34:35], v21 offset:16896
  s_waitcnt lgkmcnt(12)
  v_mfma_f32_32x32x16_bf16 v[64:79], a[20:23], v[40:43], v[64:79]
  ds_read_b64_tr_b16 v[36:37], v21 offset:16448
  ds_read_b64_tr_b16 v[38:39], v21 offset:16960
  s_waitcnt lgkmcnt(12)
  v_mfma_f32_32x32x16_bf16 v[80:95], a[20:23], v[44:47], v[80:95]
  ds_read_b64_tr_b16 v[40:41], v21 offset:18432
  ds_read_b64_tr_b16 v[42:43], v21 offset:18944
  s_waitcnt lgkmcnt(12)
  v_mfma_f32_32x32x16_bf16 v[64:79], a[24:27], v[48:51], v[64:79]
  ds_read_b64_tr_b16 v[44:45], v21 offset:18496
  ds_read_b64_tr_b16 v[46:47], v21 offset:19008
  s_waitcnt lgkmcnt(12)
  v_mfma_f32_32x32x16_bf16 v[80:95], a[24:27], v[52:55], v[80:95]
  ds_read_b64_tr_b16 v[48:49], v21 offset:20480
  ds_read_b64_tr_b16 v[50:51], v21 offset:20992
  s_waitcnt lgkmcnt(12)
  v_mfma_f32_32x32x16_bf16 v[64:79], a[28:31], v[56:59], v[64:79]
  ds_read_b64_tr_b16 v[52:53], v21 offset:20544
  ds_read_b64_tr_b16 v[54:55], v21 offset:21056
  s_waitcnt lgkmcnt(12)
  v_mfma_f32_32x32x16_bf16 v[80:95], a[28:31], v[60:63], v[80:95]
  ds_read_b64_tr_b16 v[56:57], v21 offset:22528
  ds_read_b64_tr_b16 v[58:59], v21 offset:23040
  s_waitcnt lgkmcnt(12)
  s_waitcnt vmcnt(20)
  v_mfma_f32_32x32x16_bf16 v[64:79], a[32:35], v[32:35], v[64:79]
  ds_read_b64_tr_b16 v[60:61], v21 offset:22592
  ds_read_b64_tr_b16 v[62:63], v21 offset:23104
  s_waitcnt lgkmcnt(12)
  v_mfma_f32_32x32x16_bf16 v[80:95], a[32:35], v[36:39], v[80:95]
  ds_read_b64_tr_b16 v[32:33], v21 offset:24576
  ds_read_b64_tr_b16 v[34:35], v21 offset:25088
  s_waitcnt lgkmcnt(12)
  v_mfma_f32_32x32x16_bf16 v[64:79], a[36:39], v[40:43], v[64:79]
  ds_read_b64_tr_b16 v[36:37], v21 offset:24640
  ds_read_b64_tr_b16 v[38:39], v21 offset:25152
  s_waitcnt lgkmcnt(12)
  v_mfma_f32_32x32x16_bf16 v[80:95], a[36:39], v[44:47], v[80:95]
  ds_read_b64_tr_b16 v[40:41], v21 offset:26624
  ds_read_b64_tr_b16 v[42:43], v21 offset:27136
  s_waitcnt lgkmcnt(12)
  v_mfma_f32_32x32x16_bf16 v[64:79], a[40:43], v[48:51], v[64:79]
  ds_read_b64_tr_b16 v[44:45], v21 offset:26688
  ds_read_b64_tr_b16 v[46:47], v21 offset:27200
  s_waitcnt lgkmcnt(12)
  v_mfma_f32_32x32x16_bf16 v[80:95], a[40:43], v[52:55], v[80:95]
  ds_read_b64_tr_b16 v[48:49], v21 offset:28672
  ds_read_b64_tr_b16 v[50:51], v21 offset:29184
  s_waitcnt lgkmcnt(12)
  v_mfma_f32_32x32x16_bf16 v[64:79], a[44:47], v[56:59], v[64:79]
  ds_read_b64_tr_b16 v[52:53], v21 offset:28736
  ds_read_b64_tr_b16 v[54:55], v21 offset:29248
  s_waitcnt lgkmcnt(12)
  v_mfma_f32_32x32x16_bf16 v[80:95], a[44:47], v[60:63], v[80:95]
  ds_read_b64_tr_b16 v[56:57], v21 offset:30720
  ds_read_b64_tr_b16 v[58:59], v21 offset:31232
  s_waitcnt lgkmcnt(12)
  s_waitcnt vmcnt(16)
  v_mfma_f32_32x32x16_bf16 v[64:79], a[48:51], v[32:35], v[64:79]
  ds_read_b64_tr_b16 v[60:61], v21 offset:30784
  ds_read_b64_tr_b16 v[62:63], v21 offset:31296
  s_waitcnt lgkmcnt(12)
  v_mfma_f32_32x32x16_bf16 v[80:95], a[48:51], v[36:39], v[80:95]
  ds_read_b64_tr_b16 v[32:33], v21 offset:32768
  ds_read_b64_tr_b16 v[34:35], v21 offset:33280
  s_waitcnt lgkmcnt(12)
  v_mfma_f32_32x32x16_bf16 v[64:79], a[52:55], v[40:43], v[64:79]
  ds_read_b64_tr_b16 v[36:37], v21 offset:32832
  ds_read_b64_tr_b16 v[38:39], v21 offset:33344
  s_waitcnt lgkmcnt(12)
  v_mfma_f32_32x32x16_bf16 v[80:95], a[52:55], v[44:47], v[80:95]
  ds_read_b64_tr_b16 v[40:41], v21 offset:34816
  ds_read_b64_tr_b16 v[42:43], v21 offset:35328
  s_waitcnt lgkmcnt(12)
  v_mfma_f32_32x32x16_bf16 v[64:79], a[56:59], v[48:51], v[64:79]
  ds_read_b64_tr_b16 v[44:45], v21 offset:34880
  ds_read_b64_tr_b16 v[46:47], v21 offset:35392
  s_waitcnt lgkmcnt(12)
  v_mfma_f32_32x32x16_bf16 v[80:95], a[56:59], v[52:55], v[80:95]
  ds_read_b64_tr_b16 v[48:49], v21 offset:36864
  ds_read_b64_tr_b16 v[50:51], v21 offset:37376
  s_waitcnt lgkmcnt(12)
  v_mfma_f32_32x32x16_bf16 v[64:79], a[60:63], v[56:59], v[64:79]
  ds_read_b64_tr_b16 v[52:53], v21 offset:36928
  ds_read_b64_tr_b16 v[54:55], v21 offset:37440
  s_waitcnt lgkmcnt(12)
  v_mfma_f32_32x32x16_bf16 v[80:95], a[60:63], v[60:63], v[80:95]
  ds_read_b64_tr_b16 v[56:57], v21 offset:38912
  ds_read_b64_tr_b16 v[58:59], v21 offset:39424
  s_waitcnt lgkmcnt(12)
  s_waitcnt vmcnt(12)
  v_mfma_f32_32x32x16_bf16 v[64:79], a[64:67], v[32:35], v[64:79]
  ds_read_b64_tr_b16 v[60:61], v21 offset:38976
  ds_read_b64_tr_b16 v[62:63], v21 offset:39488
  s_waitcnt lgkmcnt(12)
  v_mfma_f32_32x32x16_bf16 v[80:95], a[64:67], v[36:39], v[80:95]
  ds_read_b64_tr_b16 v[32:33], v21 offset:40960
  ds_read_b64_tr_b16 v[34:35], v21 offset:41472
  s_waitcnt lgkmcnt(12)
  v_mfma_f32_32x32x16_bf16 v[64:79], a[68:71], v[40:43], v[64:79]
  ds_read_b64_tr_b16 v[36:37], v21 offset:41024
  ds_read_b64_tr_b16 v[38:39], v21 offset:41536
  s_waitcnt lgkmcnt(12)
  v_mfma_f32_32x32x16_bf16 v[80:95], a[68:71], v[44:47], v[80:95]
  ds_read_b64_tr_b16 v[40:41], v21 offset:43008
  ds_read_b64_tr_b16 v[42:43], v21 offset:43520
  s_waitcnt lgkmcnt(12)
  v_mfma_f32_32x32x16_bf16 v[64:79], a[72:75], v[48:51], v[64:79]
  ds_read_b64_tr_b16 v[44:45], v21 offset:43072
  ds_read_b64_tr_b16 v[46:47], v21 offset:43584
  s_waitcnt lgkmcnt(12)
  v_mfma_f32_32x32x16_bf16 v[80:95], a[72:75], v[52:55], v[80:95]
  ds_read_b64_tr_b16 v[48:49], v21 offset:45056
  ds_read_b64_tr_b16 v[50:51], v21 offset:45568
  s_waitcnt lgkmcnt(12)
  v_mfma_f32_32x32x16_bf16 v[64:79], a[76:79], v[56:59], v[64:79]
  ds_read_b64_tr_b16 v[52:53], v21 offset:45120
  ds_read_b64_tr_b16 v[54:55], v21 offset:45632
  s_waitcnt lgkmcnt(12)
  v_mfma_f32_32x32x16_bf16 v[80:95], a[76:79], v[60:63], v[80:95]
  ds_read_b64_tr_b16 v[56:57], v21 offset:47104
  ds_read_b64_tr_b16 v[58:59], v21 offset:47616
  s_waitcnt lgkmcnt(12)
  s_waitcnt vmcnt(8)
  v_mfma_f32_32x32x16_bf16 v[64:79], a[80:83], v[32:35], v[64:79]
  ds_read_b64_tr_b16 v[60:61], v21 offset:47168
  ds_read_b64_tr_b16 v[62:63], v21 offset:47680
  s_waitcnt lgkmcnt(12)
  v_mfma_f32_32x32x16_bf16 v[80:95], a[80:83], v[36:39], v[80:95]
  ds_read_b64_tr_b16 v[32:33], v21 offset:49152
  ds_read_b64_tr_b16 v[34:35], v21 offset:49664
  s_waitcnt lgkmcnt(12)
  v_mfma_f32_32x32x16_bf16 v[64:79], a[84:87], v[40:43], v[64:79]
  ds_read_b64_tr_b16 v[36:37], v21 offset:49216
  ds_read_b64_tr_b16 v[38:39], v21 offset:49728
  s_waitcnt lgkmcnt(12)
  v_mfma_f32_32x32x16_bf16 v[80:95], a[84:87], v[44:47], v[80:95]
  ds_read_b64_tr_b16 v[40:41], v21 offset:51200
  ds_read_b64_tr_b16 v[42:43], v21 offset:51712
  s_waitcnt lgkmcnt(12)
  v_mfma_f32_32x32x16_bf16 v[64:79], a[88:91], v[48:51], v[64:79]
  ds_read_b64_tr_b16 v[44:45], v21 offset:51264
  ds_read_b64_tr_b16 v[46:47], v21 offset:51776
  s_waitcnt lgkmcnt(12)
  v_mfma_f32_32x32x16_bf16 v[80:95], a[88:91], v[52:55], v[80:95]
  ds_read_b64_tr_b16 v[48:49], v21 offset:53248
  ds_read_b64_tr_b16 v[50:51], v21 offset:53760
  s_waitcnt lgkmcnt(12)
  v_mfma_f32_32x32x16_bf16 v[64:79], a[92:95], v[56:59], v[64:79]
  ds_read_b64_tr_b16 v[52:53], v21 offset:53312
  ds_read_b64_tr_b16 v[54:55], v21 offset:53824
  s_waitcnt lgkmcnt(12)
  v_mfma_f32_32x32x16_bf16 v[80:95], a[92:95], v[60:63], v[80:95]
  ds_read_b64_tr_b16 v[56:57], v21 offset:55296
  ds_read_b64_tr_b16 v[58:59], v21 offset:55808
  s_waitcnt lgkmcnt(12)
  s_waitcnt vmcnt(4)
  v_mfma_f32_32x32x16_bf16 v[64:79], a[96:99], v[32:35], v[64:79]
  ds_read_b64_tr_b16 v[60:61], v21 offset:55360
  ds_read_b64_tr_b16 v[62:63], v21 offset:55872
  s_waitcnt lgkmcnt(12)
  v_mfma_f32_32x32x16_bf16 v[80:95], a[96:99], v[36:39], v[80:95]
  ds_read_b64_tr_b16 v[32:33], v21 offset:57344
  ds_read_b64_tr_b16 v[34:35], v21 offset:57856
  s_waitcnt lgkmcnt(12)
  v_mfma_f32_32x32x16_bf16 v[64:79], a[100:103], v[40:43], v[64:79]
  ds_read_b64_tr_b16 v[36:37], v21 offset:57408
  ds_read_b64_tr_b16 v[38:39], v21 offset:57920
  s_waitcnt lgkmcnt(12)
  v_mfma_f32_32x32x16_bf16 v[80:95], a[100:103], v[44:47], v[80:95]
  ds_read_b64_tr_b16 v[40:41], v21 offset:59392
  ds_read_b64_tr_b16 v[42:43], v21 offset:59904
  s_waitcnt lgkmcnt(12)
  v_mfma_f32_32x32x16_bf16 v[64:79], a[104:107], v[48:51], v[64:79]
  ds_read_b64_tr_b16 v[44:45], v21 offset:59456
  ds_read_b64_tr_b16 v[46:47], v21 offset:59968
  s_waitcnt lgkmcnt(12)
  v_mfma_f32_32x32x16_bf16 v[80:95], a[104:107], v[52:55], v[80:95]
  ds_read_b64_tr_b16 v[48:49], v21 offset:61440
  ds_read_b64_tr_b16 v[50:51], v21 offset:61952
  s_waitcnt lgkmcnt(12)
  v_mfma_f32_32x32x16_bf16 v[64:79], a[108:111], v[56:59], v[64:79]
  ds_read_b64_tr_b16 v[52:53], v21 offset:61504
  ds_read_b64_tr_b16 v[54:55], v21 offset:62016
  s_waitcnt lgkmcnt(12)
  v_mfma_f32_32x32x16_bf16 v[80:95], a[108:111], v[60:63], v[80:95]
  ds_read_b64_tr_b16 v[56:57], v21 offset:63488
  ds_read_b64_tr_b16 v[58:59], v21 offset:64000
  s_waitcnt lgkmcnt(12)
  s_waitcnt vmcnt(0)
  v_mfma_f32_32x32x16_bf16 v[64:79], a[112:115], v[32:35], v[64:79]
  ds_read_b64_tr_b16 v[60:61], v21 offset:63552
  ds_read_b64_tr_b16 v[62:63], v21 offset:64064
  s_waitcnt lgkmcnt(12)
  v_mfma_f32_32x32x16_bf16 v[80:95], a[112:115], v[36:39], v[80:95]
  s_waitcnt lgkmcnt(10)
  v_mfma_f32_32x32x16_bf16 v[64:79], a[116:119], v[40:43], v[64:79]
  s_waitcnt lgkmcnt(8)
  v_mfma_f32_32x32x16_bf16 v[80:95], a[116:119], v[44:47], v[80:95]
  s_waitcnt lgkmcnt(6)
  v_mfma_f32_32x32x16_bf16 v[64:79], a[120:123], v[48:51], v[64:79]
  s_waitcnt lgkmcnt(4)
  v_mfma_f32_32x32x16_bf16 v[80:95], a[120:123], v[52:55], v[80:95]
  s_waitcnt lgkmcnt(2)
  v_mfma_f32_32x32x16_bf16 v[64:79], a[124:127], v[56:59], v[64:79]
  s_waitcnt lgkmcnt(0)
  v_mfma_f32_32x32x16_bf16 v[80:95], a[124:127], v[60:63], v[80:95]
  s_nop 7
  s_nop 3
  s_lshl_b32 s54, s23, 7
  s_add_u32 s54, s54, s20
  s_add_u32 s54, s54, 0
  s_lshl_b32 s54, s54, 13
  s_and_b32 s55, s22, 1
  s_lshl_b32 s55, s55, 12
  s_add_u32 s54, s54, s55
  s_add_u32 s54, s54, 16777216
  s_add_u32 s40, s16, s54
  s_addc_u32 s41, s17, 0
  v_cvt_pk_bf16_f32 v64, v64, v65
  v_cvt_pk_bf16_f32 v65, v66, v67
  v_cvt_pk_bf16_f32 v66, v72, v73
  v_cvt_pk_bf16_f32 v67, v74, v75
  v_cvt_pk_bf16_f32 v68, v68, v69
  v_cvt_pk_bf16_f32 v69, v70, v71
  v_cvt_pk_bf16_f32 v70, v76, v77
  v_cvt_pk_bf16_f32 v71, v78, v79
  global_store_dwordx4 v7, v[64:67], s[40:41] offset:0 sc1
  global_store_dwordx4 v7, v[68:71], s[40:41] offset:512 sc1
  v_cvt_pk_bf16_f32 v80, v80, v81
  v_cvt_pk_bf16_f32 v81, v82, v83
  v_cvt_pk_bf16_f32 v82, v88, v89
  v_cvt_pk_bf16_f32 v83, v90, v91
  v_cvt_pk_bf16_f32 v84, v84, v85
  v_cvt_pk_bf16_f32 v85, v86, v87
  v_cvt_pk_bf16_f32 v86, v92, v93
  v_cvt_pk_bf16_f32 v87, v94, v95
  global_store_dwordx4 v7, v[80:83], s[40:41] offset:2048 sc1
  global_store_dwordx4 v7, v[84:87], s[40:41] offset:2560 sc1
L_mini_done:
  v_mov_b32 v32, -1
  v_mov_b32 v33, -1
  v_mov_b32 v34, -1
  v_mov_b32 v35, -1
  v_and_b32 v36, 0x3ff, v12
  s_lshl_b32 s54, s21, 5
  s_add_u32 s54, s54, s20
  s_lshl_b32 s55, s23, 7
  s_add_u32 s54, s54, s55
  s_lshl_b32 s54, s54, 12
  s_lshl_b32 s55, s22, 10
  s_add_u32 s54, s54, s55
  s_add_u32 s54, s54, 68157440
  s_add_u32 s40, s16, s54
  s_addc_u32 s41, s17, 0
  global_store_dwordx4 v36, v[32:35], s[40:41] sc1
  s_waitcnt vmcnt(0)
  s_barrier
  s_cmp_eq_u32 s21, 0
  s_cbranch_scc0 L_mini_nf
  s_mov_b32 s27, 0
  s_branch Lwc_5
Lwc_4:
  s_sleep 8
Lwc_5:
  global_load_dword v60, v15, s[18:19] offset:68 sc1
  s_add_u32 s27, s27, 1
  s_cmp_gt_u32 s27, 0x400000
  s_cbranch_scc1 L_end
  s_waitcnt vmcnt(0)
  v_readfirstlane_b32 s54, v60
  s_nop 0
  s_cmp_ge_u32 s54, 96
  s_cbranch_scc0 Lwc_4
  s_lshl_b32 s54, s20, 2
  s_add_u32 s54, s54, s22
  s_lshl_b32 s54, s54, 7
  s_add_u32 s54, s54, 78790656
  s_lshl_b32 s55, s23, 6
  s_add_u32 s54, s54, s55
  v_mov_b32 v60, s54
  v_mov_b32 v61, 1
  global_store_dword v60, v61, s[16:17] sc1
L_mini_nf:
  s_cmp_eq_u32 s23, 0
  s_cbranch_scc0 L_mini_end
  s_mov_b32 s23, 1
  s_add_u32 s40, s4, 131072
  s_addc_u32 s41, s5, 0
  global_load_dwordx4 a[0:3], v4, s[40:41] offset:0
  global_load_dwordx4 a[4:7], v4, s[40:41] offset:32
  global_load_dwordx4 a[8:11], v4, s[40:41] offset:64
  global_load_dwordx4 a[12:15], v4, s[40:41] offset:96
  global_load_dwordx4 a[16:19], v4, s[40:41] offset:128
  global_load_dwordx4 a[20:23], v4, s[40:41] offset:160
  global_load_dwordx4 a[24:27], v4, s[40:41] offset:192
  global_load_dwordx4 a[28:31], v4, s[40:41] offset:224
  global_load_dwordx4 a[32:35], v4, s[40:41] offset:256
  global_load_dwordx4 a[36:39], v4, s[40:41] offset:288
  global_load_dwordx4 a[40:43], v4, s[40:41] offset:320
  global_load_dwordx4 a[44:47], v4, s[40:41] offset:352
  global_load_dwordx4 a[48:51], v4, s[40:41] offset:384
  global_load_dwordx4 a[52:55], v4, s[40:41] offset:416
  global_load_dwordx4 a[56:59], v4, s[40:41] offset:448
  global_load_dwordx4 a[60:63], v4, s[40:41] offset:480
  global_load_dwordx4 a[64:67], v4, s[40:41] offset:512
  global_load_dwordx4 a[68:71], v4, s[40:41] offset:544
  global_load_dwordx4 a[72:75], v4, s[40:41] offset:576
  global_load_dwordx4 a[76:79], v4, s[40:41] offset:608
  global_load_dwordx4 a[80:83], v4, s[40:41] offset:640
  global_load_dwordx4 a[84:87], v4, s[40:41] offset:672
  global_load_dwordx4 a[88:91], v4, s[40:41] offset:704
  global_load_dwordx4 a[92:95], v4, s[40:41] offset:736
  global_load_dwordx4 a[96:99], v4, s[40:41] offset:768
  global_load_dwordx4 a[100:103], v4, s[40:41] offset:800
  global_load_dwordx4 a[104:107], v4, s[40:41] offset:832
  global_load_dwordx4 a[108:111], v4, s[40:41] offset:864
  global_load_dwordx4 a[112:115], v4, s[40:41] offset:896
  global_load_dwordx4 a[116:119], v4, s[40:41] offset:928
  global_load_dwordx4 a[120:123], v4, s[40:41] offset:960
  global_load_dwordx4 a[124:127], v4, s[40:41] offset:992
  s_branch L_mini_loop
L_mini_end:
  s_mov_b32 s23, 0
L_p1_task:
  s_lshl_b32 s54, s22, 17
  s_add_u32 s38, s4, s54
  s_addc_u32 s39, s5, 0
  global_load_dwordx4 a[0:3], v4, s[38:39] offset:0
  global_load_dwordx4 a[4:7], v4, s[38:39] offset:32
  global_load_dwordx4 a[8:11], v4, s[38:39] offset:64
  global_load_dwordx4 a[12:15], v4, s[38:39] offset:96
  s_lshl_b32 s56, s21, 12
  s_add_u32 s56, s56, 0
  s_add_u32 s64, s8, 0
  s_addc_u32 s65, s9, 0
  s_add_u32 m0, s56, 0
  s_nop 0
  global_load_lds_dwordx4 v5, s[64:65]
  s_add_u32 s64, s8, 32768
  s_addc_u32 s65, s9, 0
  s_add_u32 m0, s56, 1024
  s_nop 0
  global_load_lds_dwordx4 v5, s[64:65]
  s_add_u32 s64, s8, 65536
  s_addc_u32 s65, s9, 0
  s_add_u32 m0, s56, 2048
  s_nop 0
  global_load_lds_dwordx4 v5, s[64:65]
  s_add_u32 s64, s8, 98304
  s_addc_u32 s65, s9, 0
  s_add_u32 m0, s56, 3072
  s_nop 0
  global_load_lds_dwordx4 v5, s[64:65]
  s_add_u32 s64, s10, 0
  s_addc_u32 s65, s11, 0
  s_add_u32 m0, s56, 16384
  s_nop 0
  global_load_lds_dwordx4 v5, s[64:65]
  s_add_u32 s64, s10, 32768
  s_addc_u32 s65, s11, 0
  s_add_u32 m0, s56, 17408
  s_nop 0
  global_load_lds_dwordx4 v5, s[64:65]
  s_add_u32 s64, s10, 65536
  s_addc_u32 s65, s11, 0
  s_add_u32 m0, s56, 18432
  s_nop 0
  global_load_lds_dwordx4 v5, s[64:65]
  s_add_u32 s64, s10, 98304
  s_addc_u32 s65, s11, 0
  s_add_u32 m0, s56, 19456
  s_nop 0
  global_load_lds_dwordx4 v5, s[64:65]
  s_add_u32 s64, s12, 0
  s_addc_u32 s65, s13, 0
  s_add_u32 m0, s56, 32768
  s_nop 0
  global_load_lds_dwordx4 v5, s[64:65]
  s_add_u32 s64, s12, 32768
  s_addc_u32 s65, s13, 0
  s_add_u32 m0, s56, 33792
  s_nop 0
  global_load_lds_dwordx4 v5, s[64:65]
  s_add_u32 s64, s12, 65536
  s_addc_u32 s65, s13, 0
  s_add_u32 m0, s56, 34816
  s_nop 0
  global_load_lds_dwordx4 v5, s[64:65]
  s_add_u32 s64, s12, 98304
  s_addc_u32 s65, s13, 0
  s_add_u32 m0, s56, 35840
  s_nop 0
  global_load_lds_dwordx4 v5, s[64:65]
  global_load_dwordx4 a[16:19], v4, s[38:39] offset:128
  global_load_dwordx4 a[20:23], v4, s[38:39] offset:160
  global_load_dwordx4 a[24:27], v4, s[38:39] offset:192
  global_load_dwordx4 a[28:31], v4, s[38:39] offset:224
  s_lshl_b32 s56, s21, 12
  s_add_u32 s56, s56, 49152
  s_add_u32 s64, s8, 524288
  s_addc_u32 s65, s9, 0
  s_add_u32 m0, s56, 0
  s_nop 0
  global_load_lds_dwordx4 v5, s[64:65]
  s_add_u32 s64, s8, 557056
  s_addc_u32 s65, s9, 0
  s_add_u32 m0, s56, 1024
  s_nop 0
  global_load_lds_dwordx4 v5, s[64:65]
  s_add_u32 s64, s8, 589824
  s_addc_u32 s65, s9, 0
  s_add_u32 m0, s56, 2048
  s_nop 0
  global_load_lds_dwordx4 v5, s[64:65]
  s_add_u32 s64, s8, 622592
  s_addc_u32 s65, s9, 0
  s_add_u32 m0, s56, 3072
  s_nop 0
  global_load_lds_dwordx4 v5, s[64:65]
  s_add_u32 s64, s10, 524288
  s_addc_u32 s65, s11, 0
  s_add_u32 m0, s56, 16384
  s_nop 0
  global_load_lds_dwordx4 v5, s[64:65]
  s_add_u32 s64, s10, 557056
  s_addc_u32 s65, s11, 0
  s_add_u32 m0, s56, 17408
  s_nop 0
  global_load_lds_dwordx4 v5, s[64:65]
  s_add_u32 s64, s10, 589824
  s_addc_u32 s65, s11, 0
  s_add_u32 m0, s56, 18432
  s_nop 0
  global_load_lds_dwordx4 v5, s[64:65]
  s_add_u32 s64, s10, 622592
  s_addc_u32 s65, s11, 0
  s_add_u32 m0, s56, 19456
  s_nop 0
  global_load_lds_dwordx4 v5, s[64:65]
  s_add_u32 s64, s12, 524288
  s_addc_u32 s65, s13, 0
  s_add_u32 m0, s56, 32768
  s_nop 0
  global_load_lds_dwordx4 v5, s[64:65]
  s_add_u32 s64, s12, 557056
  s_addc_u32 s65, s13, 0
  s_add_u32 m0, s56, 33792
  s_nop 0
  global_load_lds_dwordx4 v5, s[64:65]
  s_add_u32 s64, s12, 589824
  s_addc_u32 s65, s13, 0
  s_add_u32 m0, s56, 34816
  s_nop 0
  global_load_lds_dwordx4 v5, s[64:65]
  s_add_u32 s64, s12, 622592
  s_addc_u32 s65, s13, 0
  s_add_u32 m0, s56, 35840
  s_nop 0
  global_load_lds_dwordx4 v5, s[64:65]
  s_lshl_b32 s54, s22, 7
  s_add_u32 s54, s54, s20
  s_lshl_b32 s55, s54, 13
  s_add_u32 s28, s16, s55
  s_addc_u32 s29, s17, 0
  s_add_u32 s30, s28, 16781312
  s_addc_u32 s31, s29, 0
  s_add_u32 s32, s28, 33558528
  s_addc_u32 s33, s29, 0
  s_add_u32 s34, s28, 50335744
  s_addc_u32 s35, s29, 0
  s_lshl_b32 s55, s54, 7
  s_add_u32 s55, s55, 67108864
  s_add_u32 s36, s16, s55
  s_addc_u32 s37, s17, 0
  s_lshl_b32 s55, s21, 5
  s_add_u32 s55, s55, s54
  s_lshl_b32 s55, s55, 12
  s_add_u32 s55, s55, 68157440
  s_add_u32 s40, s16, s55
  s_addc_u32 s41, s17, 0
  v_add_u32 v16, 0, v8
  v_add_u32 v17, 0, v9
  v_add_u32 v18, 0, v10
  v_add_u32 v19, 0, v11
  s_waitcnt vmcnt(16)
  s_barrier
  ds_read_b64_tr_b16 a[128:129], v16 offset:0
  ds_read_b64_tr_b16 a[130:131], v16 offset:1024
  ds_read_b64_tr_b16 a[132:133], v17 offset:0
  ds_read_b64_tr_b16 a[134:135], v17 offset:1024
  ds_read_b64_tr_b16 a[136:137], v18 offset:0
  ds_read_b64_tr_b16 a[138:139], v18 offset:1024
  ds_read_b64_tr_b16 a[140:141], v19 offset:0
  ds_read_b64_tr_b16 a[142:143], v19 offset:1024
  ds_read_b64_tr_b16 a[144:145], v16 offset:16384
  ds_read_b64_tr_b16 a[146:147], v16 offset:17408
  ds_read_b64_tr_b16 a[148:149], v17 offset:16384
  ds_read_b64_tr_b16 a[150:151], v17 offset:17408
  ds_read_b64_tr_b16 a[152:153], v18 offset:16384
  ds_read_b64_tr_b16 a[154:155], v18 offset:17408
  s_waitcnt lgkmcnt(12)
  v_mfma_f32_32x32x16_bf16 v[64:79], a[128:131], a[0:3], 0
  ds_read_b64_tr_b16 a[156:157], v19 offset:16384
  ds_read_b64_tr_b16 a[158:159], v19 offset:17408
  s_waitcnt lgkmcnt(12)
  v_mfma_f32_32x32x16_bf16 v[80:95], a[132:135], a[0:3], 0
  global_load_dwordx4 a[32:35], v4, s[38:39] offset:256
  global_load_dwordx4 a[36:39], v4, s[38:39] offset:288
  global_load_dwordx4 a[40:43], v4, s[38:39] offset:320
  global_load_dwordx4 a[44:47], v4, s[38:39] offset:352
  s_lshl_b32 s56, s21, 12
  s_add_u32 s56, s56, 98304
  s_add_u32 s64, s8, 1048576
  s_addc_u32 s65, s9, 0
  s_add_u32 m0, s56, 0
  s_nop 0
  global_load_lds_dwordx4 v5, s[64:65]
  ds_read_b64_tr_b16 a[128:129], v16 offset:32768
  ds_read_b64_tr_b16 a[130:131], v16 offset:33792
  s_waitcnt lgkmcnt(12)
  v_mfma_f32_32x32x16_bf16 v[96:111], a[136:139], a[0:3], 0
  ds_read_b64_tr_b16 a[132:133], v17 offset:32768
  ds_read_b64_tr_b16 a[134:135], v17 offset:33792
  s_waitcnt lgkmcnt(12)
  v_mfma_f32_32x32x16_bf16 v[112:127], a[140:143], a[0:3], 0
  ds_read_b64_tr_b16 a[136:137], v18 offset:32768
  ds_read_b64_tr_b16 a[138:139], v18 offset:33792
  s_waitcnt lgkmcnt(12)
  v_mfma_f32_32x32x16_bf16 v[128:143], a[144:147], a[0:3], 0
  ds_read_b64_tr_b16 a[140:141], v19 offset:32768
  ds_read_b64_tr_b16 a[142:143], v19 offset:33792
  s_waitcnt lgkmcnt(12)
  v_mfma_f32_32x32x16_bf16 v[144:159], a[148:151], a[0:3], 0
  s_add_u32 s64, s8, 1081344
  s_addc_u32 s65, s9, 0
  s_add_u32 m0, s56, 1024
  s_nop 0
  global_load_lds_dwordx4 v5, s[64:65]
  ds_read_b64_tr_b16 a[144:145], v16 offset:4096
  ds_read_b64_tr_b16 a[146:147], v16 offset:5120
  s_waitcnt lgkmcnt(12)
  v_mfma_f32_32x32x16_bf16 v[160:175], a[152:155], a[0:3], 0
  ds_read_b64_tr_b16 a[148:149], v17 offset:4096
  ds_read_b64_tr_b16 a[150:151], v17 offset:5120
  s_waitcnt lgkmcnt(12)
  v_mfma_f32_32x32x16_bf16 v[176:191], a[156:159], a[0:3], 0
  ds_read_b64_tr_b16 a[152:153], v18 offset:4096
  ds_read_b64_tr_b16 a[154:155], v18 offset:5120
  s_waitcnt lgkmcnt(12)
  v_mfma_f32_32x32x16_bf16 v[192:207], a[0:3], a[128:131], 0
  ds_read_b64_tr_b16 a[156:157], v19 offset:4096
  ds_read_b64_tr_b16 a[158:159], v19 offset:5120
  s_waitcnt lgkmcnt(12)
  v_mfma_f32_32x32x16_bf16 v[208:223], a[0:3], a[132:135], 0
  s_add_u32 s64, s8, 1114112
  s_addc_u32 s65, s9, 0
  s_add_u32 m0, s56, 2048
  s_nop 0
  global_load_lds_dwordx4 v5, s[64:65]
  ds_read_b64_tr_b16 a[128:129], v16 offset:20480
  ds_read_b64_tr_b16 a[130:131], v16 offset:21504
  s_waitcnt lgkmcnt(12)
  v_mfma_f32_32x32x16_bf16 v[224:239], a[0:3], a[136:139], 0
  ds_read_b64_tr_b16 a[132:133], v17 offset:20480
  ds_read_b64_tr_b16 a[134:135], v17 offset:21504
  s_waitcnt lgkmcnt(12)
  v_mfma_f32_32x32x16_bf16 v[240:255], a[0:3], a[140:143], 0
  ds_read_b64_tr_b16 a[136:137], v18 offset:20480
  ds_read_b64_tr_b16 a[138:139], v18 offset:21504
  s_waitcnt lgkmcnt(12)
  v_mfma_f32_32x32x16_bf16 v[64:79], a[144:147], a[4:7], v[64:79]
  ds_read_b64_tr_b16 a[140:141], v19 offset:20480
  ds_read_b64_tr_b16 a[142:143], v19 offset:21504
  s_waitcnt lgkmcnt(12)
  v_mfma_f32_32x32x16_bf16 v[80:95], a[148:151], a[4:7], v[80:95]
  s_add_u32 s64, s8, 1146880
  s_addc_u32 s65, s9, 0
  s_add_u32 m0, s56, 3072
  s_nop 0
  global_load_lds_dwordx4 v5, s[64:65]
  ds_read_b64_tr_b16 a[144:145], v16 offset:36864
  ds_read_b64_tr_b16 a[146:147], v16 offset:37888
  s_waitcnt lgkmcnt(12)
  v_mfma_f32_32x32x16_bf16 v[96:111], a[152:155], a[4:7], v[96:111]
  ds_read_b64_tr_b16 a[148:149], v17 offset:36864
  ds_read_b64_tr_b16 a[150:151], v17 offset:37888
  s_waitcnt lgkmcnt(12)
  v_mfma_f32_32x32x16_bf16 v[112:127], a[156:159], a[4:7], v[112:127]
  ds_read_b64_tr_b16 a[152:153], v18 offset:36864
  ds_read_b64_tr_b16 a[154:155], v18 offset:37888
  s_waitcnt lgkmcnt(12)
  v_mfma_f32_32x32x16_bf16 v[128:143], a[128:131], a[4:7], v[128:143]
  ds_read_b64_tr_b16 a[156:157], v19 offset:36864
  ds_read_b64_tr_b16 a[158:159], v19 offset:37888
  s_waitcnt lgkmcnt(12)
  v_mfma_f32_32x32x16_bf16 v[144:159], a[132:135], a[4:7], v[144:159]
  s_add_u32 s64, s10, 1048576
  s_addc_u32 s65, s11, 0
  s_add_u32 m0, s56, 16384
  s_nop 0
  global_load_lds_dwordx4 v5, s[64:65]
  ds_read_b64_tr_b16 a[128:129], v16 offset:8192
  ds_read_b64_tr_b16 a[130:131], v16 offset:9216
  s_waitcnt lgkmcnt(12)
  v_mfma_f32_32x32x16_bf16 v[160:175], a[136:139], a[4:7], v[160:175]
  ds_read_b64_tr_b16 a[132:133], v17 offset:8192
  ds_read_b64_tr_b16 a[134:135], v17 offset:9216
  s_waitcnt lgkmcnt(12)
  v_mfma_f32_32x32x16_bf16 v[176:191], a[140:143], a[4:7], v[176:191]
  ds_read_b64_tr_b16 a[136:137], v18 offset:8192
  ds_read_b64_tr_b16 a[138:139], v18 offset:9216
  s_waitcnt lgkmcnt(12)
  v_mfma_f32_32x32x16_bf16 v[192:207], a[4:7], a[144:147], v[192:207]
  ds_read_b64_tr_b16 a[140:141], v19 offset:8192
  ds_read_b64_tr_b16 a[142:143], v19 offset:9216
  s_waitcnt lgkmcnt(12)
  v_mfma_f32_32x32x16_bf16 v[208:223], a[4:7], a[148:151], v[208:223]
  s_add_u32 s64, s10, 1081344
  s_addc_u32 s65, s11, 0
  s_add_u32 m0, s56, 17408
  s_nop 0
  global_load_lds_dwordx4 v5, s[64:65]
  ds_read_b64_tr_b16 a[144:145], v16 offset:24576
  ds_read_b64_tr_b16 a[146:147], v16 offset:25600
  s_waitcnt lgkmcnt(12)
  v_mfma_f32_32x32x16_bf16 v[224:239], a[4:7], a[152:155], v[224:239]
  ds_read_b64_tr_b16 a[148:149], v17 offset:24576
  ds_read_b64_tr_b16 a[150:151], v17 offset:25600
  s_waitcnt lgkmcnt(12)
  v_mfma_f32_32x32x16_bf16 v[240:255], a[4:7], a[156:159], v[240:255]
  ds_read_b64_tr_b16 a[152:153], v18 offset:24576
  ds_read_b64_tr_b16 a[154:155], v18 offset:25600
  s_waitcnt lgkmcnt(12)
  v_mfma_f32_32x32x16_bf16 v[64:79], a[128:131], a[8:11], v[64:79]
  ds_read_b64_tr_b16 a[156:157], v19 offset:24576
  ds_read_b64_tr_b16 a[158:159], v19 offset:25600
  s_waitcnt lgkmcnt(12)
  v_mfma_f32_32x32x16_bf16 v[80:95], a[132:135], a[8:11], v[80:95]
  s_add_u32 s64, s10, 1114112
  s_addc_u32 s65, s11, 0
  s_add_u32 m0, s56, 18432
  s_nop 0
  global_load_lds_dwordx4 v5, s[64:65]
  ds_read_b64_tr_b16 a[128:129], v16 offset:40960
  ds_read_b64_tr_b16 a[130:131], v16 offset:41984
  s_waitcnt lgkmcnt(12)
  v_mfma_f32_32x32x16_bf16 v[96:111], a[136:139], a[8:11], v[96:111]
  ds_read_b64_tr_b16 a[132:133], v17 offset:40960
  ds_read_b64_tr_b16 a[134:135], v17 offset:41984
  s_waitcnt lgkmcnt(12)
  v_mfma_f32_32x32x16_bf16 v[112:127], a[140:143], a[8:11], v[112:127]
  ds_read_b64_tr_b16 a[136:137], v18 offset:40960
  ds_read_b64_tr_b16 a[138:139], v18 offset:41984
  s_waitcnt lgkmcnt(12)
  v_mfma_f32_32x32x16_bf16 v[128:143], a[144:147], a[8:11], v[128:143]
  ds_read_b64_tr_b16 a[140:141], v19 offset:40960
  ds_read_b64_tr_b16 a[142:143], v19 offset:41984
  s_waitcnt lgkmcnt(12)
  v_mfma_f32_32x32x16_bf16 v[144:159], a[148:151], a[8:11], v[144:159]
  s_add_u32 s64, s10, 1146880
  s_addc_u32 s65, s11, 0
  s_add_u32 m0, s56, 19456
  s_nop 0
  global_load_lds_dwordx4 v5, s[64:65]
  ds_read_b64_tr_b16 a[144:145], v16 offset:12288
  ds_read_b64_tr_b16 a[146:147], v16 offset:13312
  s_waitcnt lgkmcnt(12)
  v_mfma_f32_32x32x16_bf16 v[160:175], a[152:155], a[8:11], v[160:175]
  ds_read_b64_tr_b16 a[148:149], v17 offset:12288
  ds_read_b64_tr_b16 a[150:151], v17 offset:13312
  s_waitcnt lgkmcnt(12)
  v_mfma_f32_32x32x16_bf16 v[176:191], a[156:159], a[8:11], v[176:191]
  ds_read_b64_tr_b16 a[152:153], v18 offset:12288
  ds_read_b64_tr_b16 a[154:155], v18 offset:13312
  s_waitcnt lgkmcnt(12)
  v_mfma_f32_32x32x16_bf16 v[192:207], a[8:11], a[128:131], v[192:207]
  ds_read_b64_tr_b16 a[156:157], v19 offset:12288
  ds_read_b64_tr_b16 a[158:159], v19 offset:13312
  s_waitcnt lgkmcnt(12)
  v_mfma_f32_32x32x16_bf16 v[208:223], a[8:11], a[132:135], v[208:223]
  s_add_u32 s64, s12, 1048576
  s_addc_u32 s65, s13, 0
  s_add_u32 m0, s56, 32768
  s_nop 0
  global_load_lds_dwordx4 v5, s[64:65]
  ds_read_b64_tr_b16 a[128:129], v16 offset:28672
  ds_read_b64_tr_b16 a[130:131], v16 offset:29696
  s_waitcnt lgkmcnt(12)
  v_mfma_f32_32x32x16_bf16 v[224:239], a[8:11], a[136:139], v[224:239]
  ds_read_b64_tr_b16 a[132:133], v17 offset:28672
  ds_read_b64_tr_b16 a[134:135], v17 offset:29696
  s_waitcnt lgkmcnt(12)
  v_mfma_f32_32x32x16_bf16 v[240:255], a[8:11], a[140:143], v[240:255]
  ds_read_b64_tr_b16 a[136:137], v18 offset:28672
  ds_read_b64_tr_b16 a[138:139], v18 offset:29696
  s_waitcnt lgkmcnt(12)
  v_mfma_f32_32x32x16_bf16 v[64:79], a[144:147], a[12:15], v[64:79]
  ds_read_b64_tr_b16 a[140:141], v19 offset:28672
  ds_read_b64_tr_b16 a[142:143], v19 offset:29696
  s_waitcnt lgkmcnt(12)
  v_mfma_f32_32x32x16_bf16 v[80:95], a[148:151], a[12:15], v[80:95]
  s_add_u32 s64, s12, 1081344
  s_addc_u32 s65, s13, 0
  s_add_u32 m0, s56, 33792
  s_nop 0
  global_load_lds_dwordx4 v5, s[64:65]
  ds_read_b64_tr_b16 a[144:145], v16 offset:45056
  ds_read_b64_tr_b16 a[146:147], v16 offset:46080
  s_waitcnt lgkmcnt(12)
  v_mfma_f32_32x32x16_bf16 v[96:111], a[152:155], a[12:15], v[96:111]
  ds_read_b64_tr_b16 a[148:149], v17 offset:45056
  ds_read_b64_tr_b16 a[150:151], v17 offset:46080
  s_waitcnt lgkmcnt(12)
  v_mfma_f32_32x32x16_bf16 v[112:127], a[156:159], a[12:15], v[112:127]
  ds_read_b64_tr_b16 a[152:153], v18 offset:45056
  ds_read_b64_tr_b16 a[154:155], v18 offset:46080
  s_waitcnt lgkmcnt(12)
  v_mfma_f32_32x32x16_bf16 v[128:143], a[128:131], a[12:15], v[128:143]
  ds_read_b64_tr_b16 a[156:157], v19 offset:45056
  ds_read_b64_tr_b16 a[158:159], v19 offset:46080
  s_waitcnt lgkmcnt(12)
  v_mfma_f32_32x32x16_bf16 v[144:159], a[132:135], a[12:15], v[144:159]
  s_add_u32 s64, s12, 1114112
  s_addc_u32 s65, s13, 0
  s_add_u32 m0, s56, 34816
  s_nop 0
  global_load_lds_dwordx4 v5, s[64:65]
  s_waitcnt lgkmcnt(10)
  v_mfma_f32_32x32x16_bf16 v[160:175], a[136:139], a[12:15], v[160:175]
  s_waitcnt lgkmcnt(8)
  v_mfma_f32_32x32x16_bf16 v[176:191], a[140:143], a[12:15], v[176:191]
  s_waitcnt lgkmcnt(6)
  v_mfma_f32_32x32x16_bf16 v[192:207], a[12:15], a[144:147], v[192:207]
  s_waitcnt lgkmcnt(4)
  v_mfma_f32_32x32x16_bf16 v[208:223], a[12:15], a[148:151], v[208:223]
  s_add_u32 s64, s12, 1146880
  s_addc_u32 s65, s13, 0
  s_add_u32 m0, s56, 35840
  s_nop 0
  global_load_lds_dwordx4 v5, s[64:65]
  s_waitcnt lgkmcnt(2)
  v_mfma_f32_32x32x16_bf16 v[224:239], a[12:15], a[152:155], v[224:239]
  s_waitcnt lgkmcnt(0)
  v_mfma_f32_32x32x16_bf16 v[240:255], a[12:15], a[156:159], v[240:255]
  v_add_u32 v16, 49152, v8
  v_add_u32 v17, 49152, v9
  v_add_u32 v18, 49152, v10
  v_add_u32 v19, 49152, v11
  s_waitcnt vmcnt(16)
  s_barrier
  ds_read_b64_tr_b16 a[128:129], v16 offset:0
  ds_read_b64_tr_b16 a[130:131], v16 offset:1024
  ds_read_b64_tr_b16 a[132:133], v17 offset:0
  ds_read_b64_tr_b16 a[134:135], v17 offset:1024
  ds_read_b64_tr_b16 a[136:137], v18 offset:0
  ds_read_b64_tr_b16 a[138:139], v18 offset:1024
  ds_read_b64_tr_b16 a[140:141], v19 offset:0
  ds_read_b64_tr_b16 a[142:143], v19 offset:1024
  ds_read_b64_tr_b16 a[144:145], v16 offset:16384
  ds_read_b64_tr_b16 a[146:147], v16 offset:17408
  ds_read_b64_tr_b16 a[148:149], v17 offset:16384
  ds_read_b64_tr_b16 a[150:151], v17 offset:17408
  ds_read_b64_tr_b16 a[152:153], v18 offset:16384
  ds_read_b64_tr_b16 a[154:155], v18 offset:17408
  s_waitcnt lgkmcnt(12)
  v_mfma_f32_32x32x16_bf16 v[64:79], a[128:131], a[16:19], v[64:79]
  ds_read_b64_tr_b16 a[156:157], v19 offset:16384
  ds_read_b64_tr_b16 a[158:159], v19 offset:17408
  s_waitcnt lgkmcnt(12)
  v_mfma_f32_32x32x16_bf16 v[80:95], a[132:135], a[16:19], v[80:95]
  global_load_dwordx4 a[48:51], v4, s[38:39] offset:384
  global_load_dwordx4 a[52:55], v4, s[38:39] offset:416
  global_load_dwordx4 a[56:59], v4, s[38:39] offset:448
  global_load_dwordx4 a[60:63], v4, s[38:39] offset:480
  s_lshl_b32 s56, s21, 12
  s_add_u32 s56, s56, 0
  s_add_u32 s64, s8, 1572864
  s_addc_u32 s65, s9, 0
  s_add_u32 m0, s56, 0
  s_nop 0
  global_load_lds_dwordx4 v5, s[64:65]
  ds_read_b64_tr_b16 a[128:129], v16 offset:32768
  ds_read_b64_tr_b16 a[130:131], v16 offset:33792
  s_waitcnt lgkmcnt(12)
  v_mfma_f32_32x32x16_bf16 v[96:111], a[136:139], a[16:19], v[96:111]
  ds_read_b64_tr_b16 a[132:133], v17 offset:32768
  ds_read_b64_tr_b16 a[134:135], v17 offset:33792
  s_waitcnt lgkmcnt(12)
  v_mfma_f32_32x32x16_bf16 v[112:127], a[140:143], a[16:19], v[112:127]
  ds_read_b64_tr_b16 a[136:137], v18 offset:32768
  ds_read_b64_tr_b16 a[138:139], v18 offset:33792
  s_waitcnt lgkmcnt(12)
  v_mfma_f32_32x32x16_bf16 v[128:143], a[144:147], a[16:19], v[128:143]
  ds_read_b64_tr_b16 a[140:141], v19 offset:32768
  ds_read_b64_tr_b16 a[142:143], v19 offset:33792
  s_waitcnt lgkmcnt(12)
  v_mfma_f32_32x32x16_bf16 v[144:159], a[148:151], a[16:19], v[144:159]
  s_add_u32 s64, s8, 1605632
  s_addc_u32 s65, s9, 0
  s_add_u32 m0, s56, 1024
  s_nop 0
  global_load_lds_dwordx4 v5, s[64:65]
  ds_read_b64_tr_b16 a[144:145], v16 offset:4096
  ds_read_b64_tr_b16 a[146:147], v16 offset:5120
  s_waitcnt lgkmcnt(12)
  v_mfma_f32_32x32x16_bf16 v[160:175], a[152:155], a[16:19], v[160:175]
  ds_read_b64_tr_b16 a[148:149], v17 offset:4096
  ds_read_b64_tr_b16 a[150:151], v17 offset:5120
  s_waitcnt lgkmcnt(12)
  v_mfma_f32_32x32x16_bf16 v[176:191], a[156:159], a[16:19], v[176:191]
  ds_read_b64_tr_b16 a[152:153], v18 offset:4096
  ds_read_b64_tr_b16 a[154:155], v18 offset:5120
  s_waitcnt lgkmcnt(12)
  v_mfma_f32_32x32x16_bf16 v[192:207], a[16:19], a[128:131], v[192:207]
  ds_read_b64_tr_b16 a[156:157], v19 offset:4096
  ds_read_b64_tr_b16 a[158:159], v19 offset:5120
  s_waitcnt lgkmcnt(12)
  v_mfma_f32_32x32x16_bf16 v[208:223], a[16:19], a[132:135], v[208:223]
  s_add_u32 s64, s8, 1638400
  s_addc_u32 s65, s9, 0
  s_add_u32 m0, s56, 2048
  s_nop 0
  global_load_lds_dwordx4 v5, s[64:65]
  ds_read_b64_tr_b16 a[128:129], v16 offset:20480
  ds_read_b64_tr_b16 a[130:131], v16 offset:21504
  s_waitcnt lgkmcnt(12)
  v_mfma_f32_32x32x16_bf16 v[224:239], a[16:19], a[136:139], v[224:239]
  ds_read_b64_tr_b16 a[132:133], v17 offset:20480
  ds_read_b64_tr_b16 a[134:135], v17 offset:21504
  s_waitcnt lgkmcnt(12)
  v_mfma_f32_32x32x16_bf16 v[240:255], a[16:19], a[140:143], v[240:255]
  ds_read_b64_tr_b16 a[136:137], v18 offset:20480
  ds_read_b64_tr_b16 a[138:139], v18 offset:21504
  s_waitcnt lgkmcnt(12)
  v_mfma_f32_32x32x16_bf16 v[64:79], a[144:147], a[20:23], v[64:79]
  ds_read_b64_tr_b16 a[140:141], v19 offset:20480
  ds_read_b64_tr_b16 a[142:143], v19 offset:21504
  s_waitcnt lgkmcnt(12)
  v_mfma_f32_32x32x16_bf16 v[80:95], a[148:151], a[20:23], v[80:95]
  s_add_u32 s64, s8, 1671168
  s_addc_u32 s65, s9, 0
  s_add_u32 m0, s56, 3072
  s_nop 0
  global_load_lds_dwordx4 v5, s[64:65]
  ds_read_b64_tr_b16 a[144:145], v16 offset:36864
  ds_read_b64_tr_b16 a[146:147], v16 offset:37888
  s_waitcnt lgkmcnt(12)
  v_mfma_f32_32x32x16_bf16 v[96:111], a[152:155], a[20:23], v[96:111]
  ds_read_b64_tr_b16 a[148:149], v17 offset:36864
  ds_read_b64_tr_b16 a[150:151], v17 offset:37888
  s_waitcnt lgkmcnt(12)
  v_mfma_f32_32x32x16_bf16 v[112:127], a[156:159], a[20:23], v[112:127]
  ds_read_b64_tr_b16 a[152:153], v18 offset:36864
  ds_read_b64_tr_b16 a[154:155], v18 offset:37888
  s_waitcnt lgkmcnt(12)
  v_mfma_f32_32x32x16_bf16 v[128:143], a[128:131], a[20:23], v[128:143]
  ds_read_b64_tr_b16 a[156:157], v19 offset:36864
  ds_read_b64_tr_b16 a[158:159], v19 offset:37888
  s_waitcnt lgkmcnt(12)
  v_mfma_f32_32x32x16_bf16 v[144:159], a[132:135], a[20:23], v[144:159]
  s_add_u32 s64, s10, 1572864
  s_addc_u32 s65, s11, 0
  s_add_u32 m0, s56, 16384
  s_nop 0
  global_load_lds_dwordx4 v5, s[64:65]
  ds_read_b64_tr_b16 a[128:129], v16 offset:8192
  ds_read_b64_tr_b16 a[130:131], v16 offset:9216
  s_waitcnt lgkmcnt(12)
  v_mfma_f32_32x32x16_bf16 v[160:175], a[136:139], a[20:23], v[160:175]
  ds_read_b64_tr_b16 a[132:133], v17 offset:8192
  ds_read_b64_tr_b16 a[134:135], v17 offset:9216
  s_waitcnt lgkmcnt(12)
  v_mfma_f32_32x32x16_bf16 v[176:191], a[140:143], a[20:23], v[176:191]
  ds_read_b64_tr_b16 a[136:137], v18 offset:8192
  ds_read_b64_tr_b16 a[138:139], v18 offset:9216
  s_waitcnt lgkmcnt(12)
  v_mfma_f32_32x32x16_bf16 v[192:207], a[20:23], a[144:147], v[192:207]
  ds_read_b64_tr_b16 a[140:141], v19 offset:8192
  ds_read_b64_tr_b16 a[142:143], v19 offset:9216
  s_waitcnt lgkmcnt(12)
  v_mfma_f32_32x32x16_bf16 v[208:223], a[20:23], a[148:151], v[208:223]
  s_add_u32 s64, s10, 1605632
  s_addc_u32 s65, s11, 0
  s_add_u32 m0, s56, 17408
  s_nop 0
  global_load_lds_dwordx4 v5, s[64:65]
  ds_read_b64_tr_b16 a[144:145], v16 offset:24576
  ds_read_b64_tr_b16 a[146:147], v16 offset:25600
  s_waitcnt lgkmcnt(12)
  v_mfma_f32_32x32x16_bf16 v[224:239], a[20:23], a[152:155], v[224:239]
  ds_read_b64_tr_b16 a[148:149], v17 offset:24576
  ds_read_b64_tr_b16 a[150:151], v17 offset:25600
  s_waitcnt lgkmcnt(12)
  v_mfma_f32_32x32x16_bf16 v[240:255], a[20:23], a[156:159], v[240:255]
  ds_read_b64_tr_b16 a[152:153], v18 offset:24576
  ds_read_b64_tr_b16 a[154:155], v18 offset:25600
  s_waitcnt lgkmcnt(12)
  v_mfma_f32_32x32x16_bf16 v[64:79], a[128:131], a[24:27], v[64:79]
  ds_read_b64_tr_b16 a[156:157], v19 offset:24576
  ds_read_b64_tr_b16 a[158:159], v19 offset:25600
  s_waitcnt lgkmcnt(12)
  v_mfma_f32_32x32x16_bf16 v[80:95], a[132:135], a[24:27], v[80:95]
  s_add_u32 s64, s10, 1638400
  s_addc_u32 s65, s11, 0
  s_add_u32 m0, s56, 18432
  s_nop 0
  global_load_lds_dwordx4 v5, s[64:65]
  ds_read_b64_tr_b16 a[128:129], v16 offset:40960
  ds_read_b64_tr_b16 a[130:131], v16 offset:41984
  s_waitcnt lgkmcnt(12)
  v_mfma_f32_32x32x16_bf16 v[96:111], a[136:139], a[24:27], v[96:111]
  ds_read_b64_tr_b16 a[132:133], v17 offset:40960
  ds_read_b64_tr_b16 a[134:135], v17 offset:41984
  s_waitcnt lgkmcnt(12)
  v_mfma_f32_32x32x16_bf16 v[112:127], a[140:143], a[24:27], v[112:127]
  ds_read_b64_tr_b16 a[136:137], v18 offset:40960
  ds_read_b64_tr_b16 a[138:139], v18 offset:41984
  s_waitcnt lgkmcnt(12)
  v_mfma_f32_32x32x16_bf16 v[128:143], a[144:147], a[24:27], v[128:143]
  ds_read_b64_tr_b16 a[140:141], v19 offset:40960
  ds_read_b64_tr_b16 a[142:143], v19 offset:41984
  s_waitcnt lgkmcnt(12)
  v_mfma_f32_32x32x16_bf16 v[144:159], a[148:151], a[24:27], v[144:159]
  s_add_u32 s64, s10, 1671168
  s_addc_u32 s65, s11, 0
  s_add_u32 m0, s56, 19456
  s_nop 0
  global_load_lds_dwordx4 v5, s[64:65]
  ds_read_b64_tr_b16 a[144:145], v16 offset:12288
  ds_read_b64_tr_b16 a[146:147], v16 offset:13312
  s_waitcnt lgkmcnt(12)
  v_mfma_f32_32x32x16_bf16 v[160:175], a[152:155], a[24:27], v[160:175]
  ds_read_b64_tr_b16 a[148:149], v17 offset:12288
  ds_read_b64_tr_b16 a[150:151], v17 offset:13312
  s_waitcnt lgkmcnt(12)
  v_mfma_f32_32x32x16_bf16 v[176:191], a[156:159], a[24:27], v[176:191]
  ds_read_b64_tr_b16 a[152:153], v18 offset:12288
  ds_read_b64_tr_b16 a[154:155], v18 offset:13312
  s_waitcnt lgkmcnt(12)
  v_mfma_f32_32x32x16_bf16 v[192:207], a[24:27], a[128:131], v[192:207]
  ds_read_b64_tr_b16 a[156:157], v19 offset:12288
  ds_read_b64_tr_b16 a[158:159], v19 offset:13312
  s_waitcnt lgkmcnt(12)
  v_mfma_f32_32x32x16_bf16 v[208:223], a[24:27], a[132:135], v[208:223]
  s_add_u32 s64, s12, 1572864
  s_addc_u32 s65, s13, 0
  s_add_u32 m0, s56, 32768
  s_nop 0
  global_load_lds_dwordx4 v5, s[64:65]
  ds_read_b64_tr_b16 a[128:129], v16 offset:28672
  ds_read_b64_tr_b16 a[130:131], v16 offset:29696
  s_waitcnt lgkmcnt(12)
  v_mfma_f32_32x32x16_bf16 v[224:239], a[24:27], a[136:139], v[224:239]
  ds_read_b64_tr_b16 a[132:133], v17 offset:28672
  ds_read_b64_tr_b16 a[134:135], v17 offset:29696
  s_waitcnt lgkmcnt(12)
  v_mfma_f32_32x32x16_bf16 v[240:255], a[24:27], a[140:143], v[240:255]
  ds_read_b64_tr_b16 a[136:137], v18 offset:28672
  ds_read_b64_tr_b16 a[138:139], v18 offset:29696
  s_waitcnt lgkmcnt(12)
  v_mfma_f32_32x32x16_bf16 v[64:79], a[144:147], a[28:31], v[64:79]
  ds_read_b64_tr_b16 a[140:141], v19 offset:28672
  ds_read_b64_tr_b16 a[142:143], v19 offset:29696
  s_waitcnt lgkmcnt(12)
  v_mfma_f32_32x32x16_bf16 v[80:95], a[148:151], a[28:31], v[80:95]
  s_add_u32 s64, s12, 1605632
  s_addc_u32 s65, s13, 0
  s_add_u32 m0, s56, 33792
  s_nop 0
  global_load_lds_dwordx4 v5, s[64:65]
  ds_read_b64_tr_b16 a[144:145], v16 offset:45056
  ds_read_b64_tr_b16 a[146:147], v16 offset:46080
  s_waitcnt lgkmcnt(12)
  v_mfma_f32_32x32x16_bf16 v[96:111], a[152:155], a[28:31], v[96:111]
  ds_read_b64_tr_b16 a[148:149], v17 offset:45056
  ds_read_b64_tr_b16 a[150:151], v17 offset:46080
  s_waitcnt lgkmcnt(12)
  v_mfma_f32_32x32x16_bf16 v[112:127], a[156:159], a[28:31], v[112:127]
  ds_read_b64_tr_b16 a[152:153], v18 offset:45056
  ds_read_b64_tr_b16 a[154:155], v18 offset:46080
  s_waitcnt lgkmcnt(12)
  v_mfma_f32_32x32x16_bf16 v[128:143], a[128:131], a[28:31], v[128:143]
  ds_read_b64_tr_b16 a[156:157], v19 offset:45056
  ds_read_b64_tr_b16 a[158:159], v19 offset:46080
  s_waitcnt lgkmcnt(12)
  v_mfma_f32_32x32x16_bf16 v[144:159], a[132:135], a[28:31], v[144:159]
  s_add_u32 s64, s12, 1638400
  s_addc_u32 s65, s13, 0
  s_add_u32 m0, s56, 34816
  s_nop 0
  global_load_lds_dwordx4 v5, s[64:65]
  s_waitcnt lgkmcnt(10)
  v_mfma_f32_32x32x16_bf16 v[160:175], a[136:139], a[28:31], v[160:175]
  s_waitcnt lgkmcnt(8)
  v_mfma_f32_32x32x16_bf16 v[176:191], a[140:143], a[28:31], v[176:191]
  s_waitcnt lgkmcnt(6)
  v_mfma_f32_32x32x16_bf16 v[192:207], a[28:31], a[144:147], v[192:207]
  s_waitcnt lgkmcnt(4)
  v_mfma_f32_32x32x16_bf16 v[208:223], a[28:31], a[148:151], v[208:223]
  s_add_u32 s64, s12, 1671168
  s_addc_u32 s65, s13, 0
  s_add_u32 m0, s56, 35840
  s_nop 0
  global_load_lds_dwordx4 v5, s[64:65]
  s_waitcnt lgkmcnt(2)
  v_mfma_f32_32x32x16_bf16 v[224:239], a[28:31], a[152:155], v[224:239]
  s_waitcnt lgkmcnt(0)
  v_mfma_f32_32x32x16_bf16 v[240:255], a[28:31], a[156:159], v[240:255]
  v_add_u32 v16, 98304, v8
  v_add_u32 v17, 98304, v9
  v_add_u32 v18, 98304, v10
  v_add_u32 v19, 98304, v11
  s_waitcnt vmcnt(16)
  s_barrier
  ds_read_b64_tr_b16 a[128:129], v16 offset:0
  ds_read_b64_tr_b16 a[130:131], v16 offset:1024
  ds_read_b64_tr_b16 a[132:133], v17 offset:0
  ds_read_b64_tr_b16 a[134:135], v17 offset:1024
  ds_read_b64_tr_b16 a[136:137], v18 offset:0
  ds_read_b64_tr_b16 a[138:139], v18 offset:1024
  ds_read_b64_tr_b16 a[140:141], v19 offset:0
  ds_read_b64_tr_b16 a[142:143], v19 offset:1024
  ds_read_b64_tr_b16 a[144:145], v16 offset:16384
  ds_read_b64_tr_b16 a[146:147], v16 offset:17408
  ds_read_b64_tr_b16 a[148:149], v17 offset:16384
  ds_read_b64_tr_b16 a[150:151], v17 offset:17408
  ds_read_b64_tr_b16 a[152:153], v18 offset:16384
  ds_read_b64_tr_b16 a[154:155], v18 offset:17408
  s_waitcnt lgkmcnt(12)
  v_mfma_f32_32x32x16_bf16 v[64:79], a[128:131], a[32:35], v[64:79]
  ds_read_b64_tr_b16 a[156:157], v19 offset:16384
  ds_read_b64_tr_b16 a[158:159], v19 offset:17408
  s_waitcnt lgkmcnt(12)
  v_mfma_f32_32x32x16_bf16 v[80:95], a[132:135], a[32:35], v[80:95]
  global_load_dwordx4 a[64:67], v4, s[38:39] offset:512
  global_load_dwordx4 a[68:71], v4, s[38:39] offset:544
  global_load_dwordx4 a[72:75], v4, s[38:39] offset:576
  global_load_dwordx4 a[76:79], v4, s[38:39] offset:608
  s_lshl_b32 s56, s21, 12
  s_add_u32 s56, s56, 49152
  s_add_u32 s64, s8, 2097152
  s_addc_u32 s65, s9, 0
  s_add_u32 m0, s56, 0
  s_nop 0
  global_load_lds_dwordx4 v5, s[64:65]
  ds_read_b64_tr_b16 a[128:129], v16 offset:32768
  ds_read_b64_tr_b16 a[130:131], v16 offset:33792
  s_waitcnt lgkmcnt(12)
  v_mfma_f32_32x32x16_bf16 v[96:111], a[136:139], a[32:35], v[96:111]
  ds_read_b64_tr_b16 a[132:133], v17 offset:32768
  ds_read_b64_tr_b16 a[134:135], v17 offset:33792
  s_waitcnt lgkmcnt(12)
  v_mfma_f32_32x32x16_bf16 v[112:127], a[140:143], a[32:35], v[112:127]
  ds_read_b64_tr_b16 a[136:137], v18 offset:32768
  ds_read_b64_tr_b16 a[138:139], v18 offset:33792
  s_waitcnt lgkmcnt(12)
  v_mfma_f32_32x32x16_bf16 v[128:143], a[144:147], a[32:35], v[128:143]
  ds_read_b64_tr_b16 a[140:141], v19 offset:32768
  ds_read_b64_tr_b16 a[142:143], v19 offset:33792
  s_waitcnt lgkmcnt(12)
  v_mfma_f32_32x32x16_bf16 v[144:159], a[148:151], a[32:35], v[144:159]
  s_add_u32 s64, s8, 2129920
  s_addc_u32 s65, s9, 0
  s_add_u32 m0, s56, 1024
  s_nop 0
  global_load_lds_dwordx4 v5, s[64:65]
  ds_read_b64_tr_b16 a[144:145], v16 offset:4096
  ds_read_b64_tr_b16 a[146:147], v16 offset:5120
  s_waitcnt lgkmcnt(12)
  v_mfma_f32_32x32x16_bf16 v[160:175], a[152:155], a[32:35], v[160:175]
  ds_read_b64_tr_b16 a[148:149], v17 offset:4096
  ds_read_b64_tr_b16 a[150:151], v17 offset:5120
  s_waitcnt lgkmcnt(12)
  v_mfma_f32_32x32x16_bf16 v[176:191], a[156:159], a[32:35], v[176:191]
  ds_read_b64_tr_b16 a[152:153], v18 offset:4096
  ds_read_b64_tr_b16 a[154:155], v18 offset:5120
  s_waitcnt lgkmcnt(12)
  v_mfma_f32_32x32x16_bf16 v[192:207], a[32:35], a[128:131], v[192:207]
  ds_read_b64_tr_b16 a[156:157], v19 offset:4096
  ds_read_b64_tr_b16 a[158:159], v19 offset:5120
  s_waitcnt lgkmcnt(12)
  v_mfma_f32_32x32x16_bf16 v[208:223], a[32:35], a[132:135], v[208:223]
  s_add_u32 s64, s8, 2162688
  s_addc_u32 s65, s9, 0
  s_add_u32 m0, s56, 2048
  s_nop 0
  global_load_lds_dwordx4 v5, s[64:65]
  ds_read_b64_tr_b16 a[128:129], v16 offset:20480
  ds_read_b64_tr_b16 a[130:131], v16 offset:21504
  s_waitcnt lgkmcnt(12)
  v_mfma_f32_32x32x16_bf16 v[224:239], a[32:35], a[136:139], v[224:239]
  ds_read_b64_tr_b16 a[132:133], v17 offset:20480
  ds_read_b64_tr_b16 a[134:135], v17 offset:21504
  s_waitcnt lgkmcnt(12)
  v_mfma_f32_32x32x16_bf16 v[240:255], a[32:35], a[140:143], v[240:255]
  ds_read_b64_tr_b16 a[136:137], v18 offset:20480
  ds_read_b64_tr_b16 a[138:139], v18 offset:21504
  s_waitcnt lgkmcnt(12)
  v_mfma_f32_32x32x16_bf16 v[64:79], a[144:147], a[36:39], v[64:79]
  ds_read_b64_tr_b16 a[140:141], v19 offset:20480
  ds_read_b64_tr_b16 a[142:143], v19 offset:21504
  s_waitcnt lgkmcnt(12)
  v_mfma_f32_32x32x16_bf16 v[80:95], a[148:151], a[36:39], v[80:95]
  s_add_u32 s64, s8, 2195456
  s_addc_u32 s65, s9, 0
  s_add_u32 m0, s56, 3072
  s_nop 0
  global_load_lds_dwordx4 v5, s[64:65]
  ds_read_b64_tr_b16 a[144:145], v16 offset:36864
  ds_read_b64_tr_b16 a[146:147], v16 offset:37888
  s_waitcnt lgkmcnt(12)
  v_mfma_f32_32x32x16_bf16 v[96:111], a[152:155], a[36:39], v[96:111]
  ds_read_b64_tr_b16 a[148:149], v17 offset:36864
  ds_read_b64_tr_b16 a[150:151], v17 offset:37888
  s_waitcnt lgkmcnt(12)
  v_mfma_f32_32x32x16_bf16 v[112:127], a[156:159], a[36:39], v[112:127]
  ds_read_b64_tr_b16 a[152:153], v18 offset:36864
  ds_read_b64_tr_b16 a[154:155], v18 offset:37888
  s_waitcnt lgkmcnt(12)
  v_mfma_f32_32x32x16_bf16 v[128:143], a[128:131], a[36:39], v[128:143]
  ds_read_b64_tr_b16 a[156:157], v19 offset:36864
  ds_read_b64_tr_b16 a[158:159], v19 offset:37888
  s_waitcnt lgkmcnt(12)
  v_mfma_f32_32x32x16_bf16 v[144:159], a[132:135], a[36:39], v[144:159]
  s_add_u32 s64, s10, 2097152
  s_addc_u32 s65, s11, 0
  s_add_u32 m0, s56, 16384
  s_nop 0
  global_load_lds_dwordx4 v5, s[64:65]
  ds_read_b64_tr_b16 a[128:129], v16 offset:8192
  ds_read_b64_tr_b16 a[130:131], v16 offset:9216
  s_waitcnt lgkmcnt(12)
  v_mfma_f32_32x32x16_bf16 v[160:175], a[136:139], a[36:39], v[160:175]
  ds_read_b64_tr_b16 a[132:133], v17 offset:8192
  ds_read_b64_tr_b16 a[134:135], v17 offset:9216
  s_waitcnt lgkmcnt(12)
  v_mfma_f32_32x32x16_bf16 v[176:191], a[140:143], a[36:39], v[176:191]
  ds_read_b64_tr_b16 a[136:137], v18 offset:8192
  ds_read_b64_tr_b16 a[138:139], v18 offset:9216
  s_waitcnt lgkmcnt(12)
  v_mfma_f32_32x32x16_bf16 v[192:207], a[36:39], a[144:147], v[192:207]
  ds_read_b64_tr_b16 a[140:141], v19 offset:8192
  ds_read_b64_tr_b16 a[142:143], v19 offset:9216
  s_waitcnt lgkmcnt(12)
  v_mfma_f32_32x32x16_bf16 v[208:223], a[36:39], a[148:151], v[208:223]
  s_add_u32 s64, s10, 2129920
  s_addc_u32 s65, s11, 0
  s_add_u32 m0, s56, 17408
  s_nop 0
  global_load_lds_dwordx4 v5, s[64:65]
  ds_read_b64_tr_b16 a[144:145], v16 offset:24576
  ds_read_b64_tr_b16 a[146:147], v16 offset:25600
  s_waitcnt lgkmcnt(12)
  v_mfma_f32_32x32x16_bf16 v[224:239], a[36:39], a[152:155], v[224:239]
  ds_read_b64_tr_b16 a[148:149], v17 offset:24576
  ds_read_b64_tr_b16 a[150:151], v17 offset:25600
  s_waitcnt lgkmcnt(12)
  v_mfma_f32_32x32x16_bf16 v[240:255], a[36:39], a[156:159], v[240:255]
  ds_read_b64_tr_b16 a[152:153], v18 offset:24576
  ds_read_b64_tr_b16 a[154:155], v18 offset:25600
  s_waitcnt lgkmcnt(12)
  v_mfma_f32_32x32x16_bf16 v[64:79], a[128:131], a[40:43], v[64:79]
  ds_read_b64_tr_b16 a[156:157], v19 offset:24576
  ds_read_b64_tr_b16 a[158:159], v19 offset:25600
  s_waitcnt lgkmcnt(12)
  v_mfma_f32_32x32x16_bf16 v[80:95], a[132:135], a[40:43], v[80:95]
  s_add_u32 s64, s10, 2162688
  s_addc_u32 s65, s11, 0
  s_add_u32 m0, s56, 18432
  s_nop 0
  global_load_lds_dwordx4 v5, s[64:65]
  ds_read_b64_tr_b16 a[128:129], v16 offset:40960
  ds_read_b64_tr_b16 a[130:131], v16 offset:41984
  s_waitcnt lgkmcnt(12)
  v_mfma_f32_32x32x16_bf16 v[96:111], a[136:139], a[40:43], v[96:111]
  ds_read_b64_tr_b16 a[132:133], v17 offset:40960
  ds_read_b64_tr_b16 a[134:135], v17 offset:41984
  s_waitcnt lgkmcnt(12)
  v_mfma_f32_32x32x16_bf16 v[112:127], a[140:143], a[40:43], v[112:127]
  ds_read_b64_tr_b16 a[136:137], v18 offset:40960
  ds_read_b64_tr_b16 a[138:139], v18 offset:41984
  s_waitcnt lgkmcnt(12)
  v_mfma_f32_32x32x16_bf16 v[128:143], a[144:147], a[40:43], v[128:143]
  ds_read_b64_tr_b16 a[140:141], v19 offset:40960
  ds_read_b64_tr_b16 a[142:143], v19 offset:41984
  s_waitcnt lgkmcnt(12)
  v_mfma_f32_32x32x16_bf16 v[144:159], a[148:151], a[40:43], v[144:159]
  s_add_u32 s64, s10, 2195456
  s_addc_u32 s65, s11, 0
  s_add_u32 m0, s56, 19456
  s_nop 0
  global_load_lds_dwordx4 v5, s[64:65]
  ds_read_b64_tr_b16 a[144:145], v16 offset:12288
  ds_read_b64_tr_b16 a[146:147], v16 offset:13312
  s_waitcnt lgkmcnt(12)
  v_mfma_f32_32x32x16_bf16 v[160:175], a[152:155], a[40:43], v[160:175]
  ds_read_b64_tr_b16 a[148:149], v17 offset:12288
  ds_read_b64_tr_b16 a[150:151], v17 offset:13312
  s_waitcnt lgkmcnt(12)
  v_mfma_f32_32x32x16_bf16 v[176:191], a[156:159], a[40:43], v[176:191]
  ds_read_b64_tr_b16 a[152:153], v18 offset:12288
  ds_read_b64_tr_b16 a[154:155], v18 offset:13312
  s_waitcnt lgkmcnt(12)
  v_mfma_f32_32x32x16_bf16 v[192:207], a[40:43], a[128:131], v[192:207]
  ds_read_b64_tr_b16 a[156:157], v19 offset:12288
  ds_read_b64_tr_b16 a[158:159], v19 offset:13312
  s_waitcnt lgkmcnt(12)
  v_mfma_f32_32x32x16_bf16 v[208:223], a[40:43], a[132:135], v[208:223]
  s_add_u32 s64, s12, 2097152
  s_addc_u32 s65, s13, 0
  s_add_u32 m0, s56, 32768
  s_nop 0
  global_load_lds_dwordx4 v5, s[64:65]
  ds_read_b64_tr_b16 a[128:129], v16 offset:28672
  ds_read_b64_tr_b16 a[130:131], v16 offset:29696
  s_waitcnt lgkmcnt(12)
  v_mfma_f32_32x32x16_bf16 v[224:239], a[40:43], a[136:139], v[224:239]
  ds_read_b64_tr_b16 a[132:133], v17 offset:28672
  ds_read_b64_tr_b16 a[134:135], v17 offset:29696
  s_waitcnt lgkmcnt(12)
  v_mfma_f32_32x32x16_bf16 v[240:255], a[40:43], a[140:143], v[240:255]
  ds_read_b64_tr_b16 a[136:137], v18 offset:28672
  ds_read_b64_tr_b16 a[138:139], v18 offset:29696
  s_waitcnt lgkmcnt(12)
  v_mfma_f32_32x32x16_bf16 v[64:79], a[144:147], a[44:47], v[64:79]
  ds_read_b64_tr_b16 a[140:141], v19 offset:28672
  ds_read_b64_tr_b16 a[142:143], v19 offset:29696
  s_waitcnt lgkmcnt(12)
  v_mfma_f32_32x32x16_bf16 v[80:95], a[148:151], a[44:47], v[80:95]
  s_add_u32 s64, s12, 2129920
  s_addc_u32 s65, s13, 0
  s_add_u32 m0, s56, 33792
  s_nop 0
  global_load_lds_dwordx4 v5, s[64:65]
  ds_read_b64_tr_b16 a[144:145], v16 offset:45056
  ds_read_b64_tr_b16 a[146:147], v16 offset:46080
  s_waitcnt lgkmcnt(12)
  v_mfma_f32_32x32x16_bf16 v[96:111], a[152:155], a[44:47], v[96:111]
  ds_read_b64_tr_b16 a[148:149], v17 offset:45056
  ds_read_b64_tr_b16 a[150:151], v17 offset:46080
  s_waitcnt lgkmcnt(12)
  v_mfma_f32_32x32x16_bf16 v[112:127], a[156:159], a[44:47], v[112:127]
  ds_read_b64_tr_b16 a[152:153], v18 offset:45056
  ds_read_b64_tr_b16 a[154:155], v18 offset:46080
  s_waitcnt lgkmcnt(12)
  v_mfma_f32_32x32x16_bf16 v[128:143], a[128:131], a[44:47], v[128:143]
  ds_read_b64_tr_b16 a[156:157], v19 offset:45056
  ds_read_b64_tr_b16 a[158:159], v19 offset:46080
  s_waitcnt lgkmcnt(12)
  v_mfma_f32_32x32x16_bf16 v[144:159], a[132:135], a[44:47], v[144:159]
  s_add_u32 s64, s12, 2162688
  s_addc_u32 s65, s13, 0
  s_add_u32 m0, s56, 34816
  s_nop 0
  global_load_lds_dwordx4 v5, s[64:65]
  s_waitcnt lgkmcnt(10)
  v_mfma_f32_32x32x16_bf16 v[160:175], a[136:139], a[44:47], v[160:175]
  s_waitcnt lgkmcnt(8)
  v_mfma_f32_32x32x16_bf16 v[176:191], a[140:143], a[44:47], v[176:191]
  s_waitcnt lgkmcnt(6)
  v_mfma_f32_32x32x16_bf16 v[192:207], a[44:47], a[144:147], v[192:207]
  s_waitcnt lgkmcnt(4)
  v_mfma_f32_32x32x16_bf16 v[208:223], a[44:47], a[148:151], v[208:223]
  s_add_u32 s64, s12, 2195456
  s_addc_u32 s65, s13, 0
  s_add_u32 m0, s56, 35840
  s_nop 0
  global_load_lds_dwordx4 v5, s[64:65]
  s_waitcnt lgkmcnt(2)
  v_mfma_f32_32x32x16_bf16 v[224:239], a[44:47], a[152:155], v[224:239]
  s_waitcnt lgkmcnt(0)
  v_mfma_f32_32x32x16_bf16 v[240:255], a[44:47], a[156:159], v[240:255]
  v_add_u32 v16, 0, v8
  v_add_u32 v17, 0, v9
  v_add_u32 v18, 0, v10
  v_add_u32 v19, 0, v11
  s_waitcnt vmcnt(16)
  s_barrier
  ds_read_b64_tr_b16 a[128:129], v16 offset:0
  ds_read_b64_tr_b16 a[130:131], v16 offset:1024
  ds_read_b64_tr_b16 a[132:133], v17 offset:0
  ds_read_b64_tr_b16 a[134:135], v17 offset:1024
  ds_read_b64_tr_b16 a[136:137], v18 offset:0
  ds_read_b64_tr_b16 a[138:139], v18 offset:1024
  ds_read_b64_tr_b16 a[140:141], v19 offset:0
  ds_read_b64_tr_b16 a[142:143], v19 offset:1024
  ds_read_b64_tr_b16 a[144:145], v16 offset:16384
  ds_read_b64_tr_b16 a[146:147], v16 offset:17408
  ds_read_b64_tr_b16 a[148:149], v17 offset:16384
  ds_read_b64_tr_b16 a[150:151], v17 offset:17408
  ds_read_b64_tr_b16 a[152:153], v18 offset:16384
  ds_read_b64_tr_b16 a[154:155], v18 offset:17408
  s_waitcnt lgkmcnt(12)
  v_mfma_f32_32x32x16_bf16 v[64:79], a[128:131], a[48:51], v[64:79]
  ds_read_b64_tr_b16 a[156:157], v19 offset:16384
  ds_read_b64_tr_b16 a[158:159], v19 offset:17408
  s_waitcnt lgkmcnt(12)
  v_mfma_f32_32x32x16_bf16 v[80:95], a[132:135], a[48:51], v[80:95]
  global_load_dwordx4 a[80:83], v4, s[38:39] offset:640
  global_load_dwordx4 a[84:87], v4, s[38:39] offset:672
  global_load_dwordx4 a[88:91], v4, s[38:39] offset:704
  global_load_dwordx4 a[92:95], v4, s[38:39] offset:736
  s_lshl_b32 s56, s21, 12
  s_add_u32 s56, s56, 98304
  s_add_u32 s64, s8, 2621440
  s_addc_u32 s65, s9, 0
  s_add_u32 m0, s56, 0
  s_nop 0
  global_load_lds_dwordx4 v5, s[64:65]
  ds_read_b64_tr_b16 a[128:129], v16 offset:32768
  ds_read_b64_tr_b16 a[130:131], v16 offset:33792
  s_waitcnt lgkmcnt(12)
  v_mfma_f32_32x32x16_bf16 v[96:111], a[136:139], a[48:51], v[96:111]
  ds_read_b64_tr_b16 a[132:133], v17 offset:32768
  ds_read_b64_tr_b16 a[134:135], v17 offset:33792
  s_waitcnt lgkmcnt(12)
  v_mfma_f32_32x32x16_bf16 v[112:127], a[140:143], a[48:51], v[112:127]
  ds_read_b64_tr_b16 a[136:137], v18 offset:32768
  ds_read_b64_tr_b16 a[138:139], v18 offset:33792
  s_waitcnt lgkmcnt(12)
  v_mfma_f32_32x32x16_bf16 v[128:143], a[144:147], a[48:51], v[128:143]
  ds_read_b64_tr_b16 a[140:141], v19 offset:32768
  ds_read_b64_tr_b16 a[142:143], v19 offset:33792
  s_waitcnt lgkmcnt(12)
  v_mfma_f32_32x32x16_bf16 v[144:159], a[148:151], a[48:51], v[144:159]
  s_add_u32 s64, s8, 2654208
  s_addc_u32 s65, s9, 0
  s_add_u32 m0, s56, 1024
  s_nop 0
  global_load_lds_dwordx4 v5, s[64:65]
  ds_read_b64_tr_b16 a[144:145], v16 offset:4096
  ds_read_b64_tr_b16 a[146:147], v16 offset:5120
  s_waitcnt lgkmcnt(12)
  v_mfma_f32_32x32x16_bf16 v[160:175], a[152:155], a[48:51], v[160:175]
  ds_read_b64_tr_b16 a[148:149], v17 offset:4096
  ds_read_b64_tr_b16 a[150:151], v17 offset:5120
  s_waitcnt lgkmcnt(12)
  v_mfma_f32_32x32x16_bf16 v[176:191], a[156:159], a[48:51], v[176:191]
  ds_read_b64_tr_b16 a[152:153], v18 offset:4096
  ds_read_b64_tr_b16 a[154:155], v18 offset:5120
  s_waitcnt lgkmcnt(12)
  v_mfma_f32_32x32x16_bf16 v[192:207], a[48:51], a[128:131], v[192:207]
  ds_read_b64_tr_b16 a[156:157], v19 offset:4096
  ds_read_b64_tr_b16 a[158:159], v19 offset:5120
  s_waitcnt lgkmcnt(12)
  v_mfma_f32_32x32x16_bf16 v[208:223], a[48:51], a[132:135], v[208:223]
  s_add_u32 s64, s8, 2686976
  s_addc_u32 s65, s9, 0
  s_add_u32 m0, s56, 2048
  s_nop 0
  global_load_lds_dwordx4 v5, s[64:65]
  ds_read_b64_tr_b16 a[128:129], v16 offset:20480
  ds_read_b64_tr_b16 a[130:131], v16 offset:21504
  s_waitcnt lgkmcnt(12)
  v_mfma_f32_32x32x16_bf16 v[224:239], a[48:51], a[136:139], v[224:239]
  ds_read_b64_tr_b16 a[132:133], v17 offset:20480
  ds_read_b64_tr_b16 a[134:135], v17 offset:21504
  s_waitcnt lgkmcnt(12)
  v_mfma_f32_32x32x16_bf16 v[240:255], a[48:51], a[140:143], v[240:255]
  ds_read_b64_tr_b16 a[136:137], v18 offset:20480
  ds_read_b64_tr_b16 a[138:139], v18 offset:21504
  s_waitcnt lgkmcnt(12)
  v_mfma_f32_32x32x16_bf16 v[64:79], a[144:147], a[52:55], v[64:79]
  ds_read_b64_tr_b16 a[140:141], v19 offset:20480
  ds_read_b64_tr_b16 a[142:143], v19 offset:21504
  s_waitcnt lgkmcnt(12)
  v_mfma_f32_32x32x16_bf16 v[80:95], a[148:151], a[52:55], v[80:95]
  s_add_u32 s64, s8, 2719744
  s_addc_u32 s65, s9, 0
  s_add_u32 m0, s56, 3072
  s_nop 0
  global_load_lds_dwordx4 v5, s[64:65]
  ds_read_b64_tr_b16 a[144:145], v16 offset:36864
  ds_read_b64_tr_b16 a[146:147], v16 offset:37888
  s_waitcnt lgkmcnt(12)
  v_mfma_f32_32x32x16_bf16 v[96:111], a[152:155], a[52:55], v[96:111]
  ds_read_b64_tr_b16 a[148:149], v17 offset:36864
  ds_read_b64_tr_b16 a[150:151], v17 offset:37888
  s_waitcnt lgkmcnt(12)
  v_mfma_f32_32x32x16_bf16 v[112:127], a[156:159], a[52:55], v[112:127]
  ds_read_b64_tr_b16 a[152:153], v18 offset:36864
  ds_read_b64_tr_b16 a[154:155], v18 offset:37888
  s_waitcnt lgkmcnt(12)
  v_mfma_f32_32x32x16_bf16 v[128:143], a[128:131], a[52:55], v[128:143]
  ds_read_b64_tr_b16 a[156:157], v19 offset:36864
  ds_read_b64_tr_b16 a[158:159], v19 offset:37888
  s_waitcnt lgkmcnt(12)
  v_mfma_f32_32x32x16_bf16 v[144:159], a[132:135], a[52:55], v[144:159]
  s_add_u32 s64, s10, 2621440
  s_addc_u32 s65, s11, 0
  s_add_u32 m0, s56, 16384
  s_nop 0
  global_load_lds_dwordx4 v5, s[64:65]
  ds_read_b64_tr_b16 a[128:129], v16 offset:8192
  ds_read_b64_tr_b16 a[130:131], v16 offset:9216
  s_waitcnt lgkmcnt(12)
  v_mfma_f32_32x32x16_bf16 v[160:175], a[136:139], a[52:55], v[160:175]
  ds_read_b64_tr_b16 a[132:133], v17 offset:8192
  ds_read_b64_tr_b16 a[134:135], v17 offset:9216
  s_waitcnt lgkmcnt(12)
  v_mfma_f32_32x32x16_bf16 v[176:191], a[140:143], a[52:55], v[176:191]
  ds_read_b64_tr_b16 a[136:137], v18 offset:8192
  ds_read_b64_tr_b16 a[138:139], v18 offset:9216
  s_waitcnt lgkmcnt(12)
  v_mfma_f32_32x32x16_bf16 v[192:207], a[52:55], a[144:147], v[192:207]
  ds_read_b64_tr_b16 a[140:141], v19 offset:8192
  ds_read_b64_tr_b16 a[142:143], v19 offset:9216
  s_waitcnt lgkmcnt(12)
  v_mfma_f32_32x32x16_bf16 v[208:223], a[52:55], a[148:151], v[208:223]
  s_add_u32 s64, s10, 2654208
  s_addc_u32 s65, s11, 0
  s_add_u32 m0, s56, 17408
  s_nop 0
  global_load_lds_dwordx4 v5, s[64:65]
  ds_read_b64_tr_b16 a[144:145], v16 offset:24576
  ds_read_b64_tr_b16 a[146:147], v16 offset:25600
  s_waitcnt lgkmcnt(12)
  v_mfma_f32_32x32x16_bf16 v[224:239], a[52:55], a[152:155], v[224:239]
  ds_read_b64_tr_b16 a[148:149], v17 offset:24576
  ds_read_b64_tr_b16 a[150:151], v17 offset:25600
  s_waitcnt lgkmcnt(12)
  v_mfma_f32_32x32x16_bf16 v[240:255], a[52:55], a[156:159], v[240:255]
  ds_read_b64_tr_b16 a[152:153], v18 offset:24576
  ds_read_b64_tr_b16 a[154:155], v18 offset:25600
  s_waitcnt lgkmcnt(12)
  v_mfma_f32_32x32x16_bf16 v[64:79], a[128:131], a[56:59], v[64:79]
  ds_read_b64_tr_b16 a[156:157], v19 offset:24576
  ds_read_b64_tr_b16 a[158:159], v19 offset:25600
  s_waitcnt lgkmcnt(12)
  v_mfma_f32_32x32x16_bf16 v[80:95], a[132:135], a[56:59], v[80:95]
  s_add_u32 s64, s10, 2686976
  s_addc_u32 s65, s11, 0
  s_add_u32 m0, s56, 18432
  s_nop 0
  global_load_lds_dwordx4 v5, s[64:65]
  ds_read_b64_tr_b16 a[128:129], v16 offset:40960
  ds_read_b64_tr_b16 a[130:131], v16 offset:41984
  s_waitcnt lgkmcnt(12)
  v_mfma_f32_32x32x16_bf16 v[96:111], a[136:139], a[56:59], v[96:111]
  ds_read_b64_tr_b16 a[132:133], v17 offset:40960
  ds_read_b64_tr_b16 a[134:135], v17 offset:41984
  s_waitcnt lgkmcnt(12)
  v_mfma_f32_32x32x16_bf16 v[112:127], a[140:143], a[56:59], v[112:127]
  ds_read_b64_tr_b16 a[136:137], v18 offset:40960
  ds_read_b64_tr_b16 a[138:139], v18 offset:41984
  s_waitcnt lgkmcnt(12)
  v_mfma_f32_32x32x16_bf16 v[128:143], a[144:147], a[56:59], v[128:143]
  ds_read_b64_tr_b16 a[140:141], v19 offset:40960
  ds_read_b64_tr_b16 a[142:143], v19 offset:41984
  s_waitcnt lgkmcnt(12)
  v_mfma_f32_32x32x16_bf16 v[144:159], a[148:151], a[56:59], v[144:159]
  s_add_u32 s64, s10, 2719744
  s_addc_u32 s65, s11, 0
  s_add_u32 m0, s56, 19456
  s_nop 0
  global_load_lds_dwordx4 v5, s[64:65]
  ds_read_b64_tr_b16 a[144:145], v16 offset:12288
  ds_read_b64_tr_b16 a[146:147], v16 offset:13312
  s_waitcnt lgkmcnt(12)
  v_mfma_f32_32x32x16_bf16 v[160:175], a[152:155], a[56:59], v[160:175]
  ds_read_b64_tr_b16 a[148:149], v17 offset:12288
  ds_read_b64_tr_b16 a[150:151], v17 offset:13312
  s_waitcnt lgkmcnt(12)
  v_mfma_f32_32x32x16_bf16 v[176:191], a[156:159], a[56:59], v[176:191]
  ds_read_b64_tr_b16 a[152:153], v18 offset:12288
  ds_read_b64_tr_b16 a[154:155], v18 offset:13312
  s_waitcnt lgkmcnt(12)
  v_mfma_f32_32x32x16_bf16 v[192:207], a[56:59], a[128:131], v[192:207]
  ds_read_b64_tr_b16 a[156:157], v19 offset:12288
  ds_read_b64_tr_b16 a[158:159], v19 offset:13312
  s_waitcnt lgkmcnt(12)
  v_mfma_f32_32x32x16_bf16 v[208:223], a[56:59], a[132:135], v[208:223]
  s_add_u32 s64, s12, 2621440
  s_addc_u32 s65, s13, 0
  s_add_u32 m0, s56, 32768
  s_nop 0
  global_load_lds_dwordx4 v5, s[64:65]
  ds_read_b64_tr_b16 a[128:129], v16 offset:28672
  ds_read_b64_tr_b16 a[130:131], v16 offset:29696
  s_waitcnt lgkmcnt(12)
  v_mfma_f32_32x32x16_bf16 v[224:239], a[56:59], a[136:139], v[224:239]
  ds_read_b64_tr_b16 a[132:133], v17 offset:28672
  ds_read_b64_tr_b16 a[134:135], v17 offset:29696
  s_waitcnt lgkmcnt(12)
  v_mfma_f32_32x32x16_bf16 v[240:255], a[56:59], a[140:143], v[240:255]
  ds_read_b64_tr_b16 a[136:137], v18 offset:28672
  ds_read_b64_tr_b16 a[138:139], v18 offset:29696
  s_waitcnt lgkmcnt(12)
  v_mfma_f32_32x32x16_bf16 v[64:79], a[144:147], a[60:63], v[64:79]
  ds_read_b64_tr_b16 a[140:141], v19 offset:28672
  ds_read_b64_tr_b16 a[142:143], v19 offset:29696
  s_waitcnt lgkmcnt(12)
  v_mfma_f32_32x32x16_bf16 v[80:95], a[148:151], a[60:63], v[80:95]
  s_add_u32 s64, s12, 2654208
  s_addc_u32 s65, s13, 0
  s_add_u32 m0, s56, 33792
  s_nop 0
  global_load_lds_dwordx4 v5, s[64:65]
  ds_read_b64_tr_b16 a[144:145], v16 offset:45056
  ds_read_b64_tr_b16 a[146:147], v16 offset:46080
  s_waitcnt lgkmcnt(12)
  v_mfma_f32_32x32x16_bf16 v[96:111], a[152:155], a[60:63], v[96:111]
  ds_read_b64_tr_b16 a[148:149], v17 offset:45056
  ds_read_b64_tr_b16 a[150:151], v17 offset:46080
  s_waitcnt lgkmcnt(12)
  v_mfma_f32_32x32x16_bf16 v[112:127], a[156:159], a[60:63], v[112:127]
  ds_read_b64_tr_b16 a[152:153], v18 offset:45056
  ds_read_b64_tr_b16 a[154:155], v18 offset:46080
  s_waitcnt lgkmcnt(12)
  v_mfma_f32_32x32x16_bf16 v[128:143], a[128:131], a[60:63], v[128:143]
  ds_read_b64_tr_b16 a[156:157], v19 offset:45056
  ds_read_b64_tr_b16 a[158:159], v19 offset:46080
  s_waitcnt lgkmcnt(12)
  v_mfma_f32_32x32x16_bf16 v[144:159], a[132:135], a[60:63], v[144:159]
  s_add_u32 s64, s12, 2686976
  s_addc_u32 s65, s13, 0
  s_add_u32 m0, s56, 34816
  s_nop 0
  global_load_lds_dwordx4 v5, s[64:65]
  s_waitcnt lgkmcnt(10)
  v_mfma_f32_32x32x16_bf16 v[160:175], a[136:139], a[60:63], v[160:175]
  s_waitcnt lgkmcnt(8)
  v_mfma_f32_32x32x16_bf16 v[176:191], a[140:143], a[60:63], v[176:191]
  s_waitcnt lgkmcnt(6)
  v_mfma_f32_32x32x16_bf16 v[192:207], a[60:63], a[144:147], v[192:207]
  s_waitcnt lgkmcnt(4)
  v_mfma_f32_32x32x16_bf16 v[208:223], a[60:63], a[148:151], v[208:223]
  s_add_u32 s64, s12, 2719744
  s_addc_u32 s65, s13, 0
  s_add_u32 m0, s56, 35840
  s_nop 0
  global_load_lds_dwordx4 v5, s[64:65]
  s_waitcnt lgkmcnt(2)
  v_mfma_f32_32x32x16_bf16 v[224:239], a[60:63], a[152:155], v[224:239]
  s_waitcnt lgkmcnt(0)
  v_mfma_f32_32x32x16_bf16 v[240:255], a[60:63], a[156:159], v[240:255]
  v_add_u32 v16, 49152, v8
  v_add_u32 v17, 49152, v9
  v_add_u32 v18, 49152, v10
  v_add_u32 v19, 49152, v11
  s_waitcnt vmcnt(16)
  s_barrier
  ds_read_b64_tr_b16 a[128:129], v16 offset:0
  ds_read_b64_tr_b16 a[130:131], v16 offset:1024
  ds_read_b64_tr_b16 a[132:133], v17 offset:0
  ds_read_b64_tr_b16 a[134:135], v17 offset:1024
  ds_read_b64_tr_b16 a[136:137], v18 offset:0
  ds_read_b64_tr_b16 a[138:139], v18 offset:1024
  ds_read_b64_tr_b16 a[140:141], v19 offset:0
  ds_read_b64_tr_b16 a[142:143], v19 offset:1024
  ds_read_b64_tr_b16 a[144:145], v16 offset:16384
  ds_read_b64_tr_b16 a[146:147], v16 offset:17408
  ds_read_b64_tr_b16 a[148:149], v17 offset:16384
  ds_read_b64_tr_b16 a[150:151], v17 offset:17408
  ds_read_b64_tr_b16 a[152:153], v18 offset:16384
  ds_read_b64_tr_b16 a[154:155], v18 offset:17408
  s_waitcnt lgkmcnt(12)
  v_mfma_f32_32x32x16_bf16 v[64:79], a[128:131], a[64:67], v[64:79]
  ds_read_b64_tr_b16 a[156:157], v19 offset:16384
  ds_read_b64_tr_b16 a[158:159], v19 offset:17408
  s_waitcnt lgkmcnt(12)
  v_mfma_f32_32x32x16_bf16 v[80:95], a[132:135], a[64:67], v[80:95]
  global_load_dwordx4 a[96:99], v4, s[38:39] offset:768
  global_load_dwordx4 a[100:103], v4, s[38:39] offset:800
  global_load_dwordx4 a[104:107], v4, s[38:39] offset:832
  global_load_dwordx4 a[108:111], v4, s[38:39] offset:864
  s_lshl_b32 s56, s21, 12
  s_add_u32 s56, s56, 0
  s_add_u32 s64, s8, 3145728
  s_addc_u32 s65, s9, 0
  s_add_u32 m0, s56, 0
  s_nop 0
  global_load_lds_dwordx4 v5, s[64:65]
  ds_read_b64_tr_b16 a[128:129], v16 offset:32768
  ds_read_b64_tr_b16 a[130:131], v16 offset:33792
  s_waitcnt lgkmcnt(12)
  v_mfma_f32_32x32x16_bf16 v[96:111], a[136:139], a[64:67], v[96:111]
  ds_read_b64_tr_b16 a[132:133], v17 offset:32768
  ds_read_b64_tr_b16 a[134:135], v17 offset:33792
  s_waitcnt lgkmcnt(12)
  v_mfma_f32_32x32x16_bf16 v[112:127], a[140:143], a[64:67], v[112:127]
  ds_read_b64_tr_b16 a[136:137], v18 offset:32768
  ds_read_b64_tr_b16 a[138:139], v18 offset:33792
  s_waitcnt lgkmcnt(12)
  v_mfma_f32_32x32x16_bf16 v[128:143], a[144:147], a[64:67], v[128:143]
  ds_read_b64_tr_b16 a[140:141], v19 offset:32768
  ds_read_b64_tr_b16 a[142:143], v19 offset:33792
  s_waitcnt lgkmcnt(12)
  v_mfma_f32_32x32x16_bf16 v[144:159], a[148:151], a[64:67], v[144:159]
  s_add_u32 s64, s8, 3178496
  s_addc_u32 s65, s9, 0
  s_add_u32 m0, s56, 1024
  s_nop 0
  global_load_lds_dwordx4 v5, s[64:65]
  ds_read_b64_tr_b16 a[144:145], v16 offset:4096
  ds_read_b64_tr_b16 a[146:147], v16 offset:5120
  s_waitcnt lgkmcnt(12)
  v_mfma_f32_32x32x16_bf16 v[160:175], a[152:155], a[64:67], v[160:175]
  ds_read_b64_tr_b16 a[148:149], v17 offset:4096
  ds_read_b64_tr_b16 a[150:151], v17 offset:5120
  s_waitcnt lgkmcnt(12)
  v_mfma_f32_32x32x16_bf16 v[176:191], a[156:159], a[64:67], v[176:191]
  ds_read_b64_tr_b16 a[152:153], v18 offset:4096
  ds_read_b64_tr_b16 a[154:155], v18 offset:5120
  s_waitcnt lgkmcnt(12)
  v_mfma_f32_32x32x16_bf16 v[192:207], a[64:67], a[128:131], v[192:207]
  ds_read_b64_tr_b16 a[156:157], v19 offset:4096
  ds_read_b64_tr_b16 a[158:159], v19 offset:5120
  s_waitcnt lgkmcnt(12)
  v_mfma_f32_32x32x16_bf16 v[208:223], a[64:67], a[132:135], v[208:223]
  s_add_u32 s64, s8, 3211264
  s_addc_u32 s65, s9, 0
  s_add_u32 m0, s56, 2048
  s_nop 0
  global_load_lds_dwordx4 v5, s[64:65]
  ds_read_b64_tr_b16 a[128:129], v16 offset:20480
  ds_read_b64_tr_b16 a[130:131], v16 offset:21504
  s_waitcnt lgkmcnt(12)
  v_mfma_f32_32x32x16_bf16 v[224:239], a[64:67], a[136:139], v[224:239]
  ds_read_b64_tr_b16 a[132:133], v17 offset:20480
  ds_read_b64_tr_b16 a[134:135], v17 offset:21504
  s_waitcnt lgkmcnt(12)
  v_mfma_f32_32x32x16_bf16 v[240:255], a[64:67], a[140:143], v[240:255]
  ds_read_b64_tr_b16 a[136:137], v18 offset:20480
  ds_read_b64_tr_b16 a[138:139], v18 offset:21504
  s_waitcnt lgkmcnt(12)
  v_mfma_f32_32x32x16_bf16 v[64:79], a[144:147], a[68:71], v[64:79]
  ds_read_b64_tr_b16 a[140:141], v19 offset:20480
  ds_read_b64_tr_b16 a[142:143], v19 offset:21504
  s_waitcnt lgkmcnt(12)
  v_mfma_f32_32x32x16_bf16 v[80:95], a[148:151], a[68:71], v[80:95]
  s_add_u32 s64, s8, 3244032
  s_addc_u32 s65, s9, 0
  s_add_u32 m0, s56, 3072
  s_nop 0
  global_load_lds_dwordx4 v5, s[64:65]
  ds_read_b64_tr_b16 a[144:145], v16 offset:36864
  ds_read_b64_tr_b16 a[146:147], v16 offset:37888
  s_waitcnt lgkmcnt(12)
  v_mfma_f32_32x32x16_bf16 v[96:111], a[152:155], a[68:71], v[96:111]
  ds_read_b64_tr_b16 a[148:149], v17 offset:36864
  ds_read_b64_tr_b16 a[150:151], v17 offset:37888
  s_waitcnt lgkmcnt(12)
  v_mfma_f32_32x32x16_bf16 v[112:127], a[156:159], a[68:71], v[112:127]
  ds_read_b64_tr_b16 a[152:153], v18 offset:36864
  ds_read_b64_tr_b16 a[154:155], v18 offset:37888
  s_waitcnt lgkmcnt(12)
  v_mfma_f32_32x32x16_bf16 v[128:143], a[128:131], a[68:71], v[128:143]
  ds_read_b64_tr_b16 a[156:157], v19 offset:36864
  ds_read_b64_tr_b16 a[158:159], v19 offset:37888
  s_waitcnt lgkmcnt(12)
  v_mfma_f32_32x32x16_bf16 v[144:159], a[132:135], a[68:71], v[144:159]
  s_add_u32 s64, s10, 3145728
  s_addc_u32 s65, s11, 0
  s_add_u32 m0, s56, 16384
  s_nop 0
  global_load_lds_dwordx4 v5, s[64:65]
  ds_read_b64_tr_b16 a[128:129], v16 offset:8192
  ds_read_b64_tr_b16 a[130:131], v16 offset:9216
  s_waitcnt lgkmcnt(12)
  v_mfma_f32_32x32x16_bf16 v[160:175], a[136:139], a[68:71], v[160:175]
  ds_read_b64_tr_b16 a[132:133], v17 offset:8192
  ds_read_b64_tr_b16 a[134:135], v17 offset:9216
  s_waitcnt lgkmcnt(12)
  v_mfma_f32_32x32x16_bf16 v[176:191], a[140:143], a[68:71], v[176:191]
  ds_read_b64_tr_b16 a[136:137], v18 offset:8192
  ds_read_b64_tr_b16 a[138:139], v18 offset:9216
  s_waitcnt lgkmcnt(12)
  v_mfma_f32_32x32x16_bf16 v[192:207], a[68:71], a[144:147], v[192:207]
  ds_read_b64_tr_b16 a[140:141], v19 offset:8192
  ds_read_b64_tr_b16 a[142:143], v19 offset:9216
  s_waitcnt lgkmcnt(12)
  v_mfma_f32_32x32x16_bf16 v[208:223], a[68:71], a[148:151], v[208:223]
  s_add_u32 s64, s10, 3178496
  s_addc_u32 s65, s11, 0
  s_add_u32 m0, s56, 17408
  s_nop 0
  global_load_lds_dwordx4 v5, s[64:65]
  ds_read_b64_tr_b16 a[144:145], v16 offset:24576
  ds_read_b64_tr_b16 a[146:147], v16 offset:25600
  s_waitcnt lgkmcnt(12)
  v_mfma_f32_32x32x16_bf16 v[224:239], a[68:71], a[152:155], v[224:239]
  ds_read_b64_tr_b16 a[148:149], v17 offset:24576
  ds_read_b64_tr_b16 a[150:151], v17 offset:25600
  s_waitcnt lgkmcnt(12)
  v_mfma_f32_32x32x16_bf16 v[240:255], a[68:71], a[156:159], v[240:255]
  ds_read_b64_tr_b16 a[152:153], v18 offset:24576
  ds_read_b64_tr_b16 a[154:155], v18 offset:25600
  s_waitcnt lgkmcnt(12)
  v_mfma_f32_32x32x16_bf16 v[64:79], a[128:131], a[72:75], v[64:79]
  ds_read_b64_tr_b16 a[156:157], v19 offset:24576
  ds_read_b64_tr_b16 a[158:159], v19 offset:25600
  s_waitcnt lgkmcnt(12)
  v_mfma_f32_32x32x16_bf16 v[80:95], a[132:135], a[72:75], v[80:95]
  s_add_u32 s64, s10, 3211264
  s_addc_u32 s65, s11, 0
  s_add_u32 m0, s56, 18432
  s_nop 0
  global_load_lds_dwordx4 v5, s[64:65]
  ds_read_b64_tr_b16 a[128:129], v16 offset:40960
  ds_read_b64_tr_b16 a[130:131], v16 offset:41984
  s_waitcnt lgkmcnt(12)
  v_mfma_f32_32x32x16_bf16 v[96:111], a[136:139], a[72:75], v[96:111]
  ds_read_b64_tr_b16 a[132:133], v17 offset:40960
  ds_read_b64_tr_b16 a[134:135], v17 offset:41984
  s_waitcnt lgkmcnt(12)
  v_mfma_f32_32x32x16_bf16 v[112:127], a[140:143], a[72:75], v[112:127]
  ds_read_b64_tr_b16 a[136:137], v18 offset:40960
  ds_read_b64_tr_b16 a[138:139], v18 offset:41984
  s_waitcnt lgkmcnt(12)
  v_mfma_f32_32x32x16_bf16 v[128:143], a[144:147], a[72:75], v[128:143]
  ds_read_b64_tr_b16 a[140:141], v19 offset:40960
  ds_read_b64_tr_b16 a[142:143], v19 offset:41984
  s_waitcnt lgkmcnt(12)
  v_mfma_f32_32x32x16_bf16 v[144:159], a[148:151], a[72:75], v[144:159]
  s_add_u32 s64, s10, 3244032
  s_addc_u32 s65, s11, 0
  s_add_u32 m0, s56, 19456
  s_nop 0
  global_load_lds_dwordx4 v5, s[64:65]
  ds_read_b64_tr_b16 a[144:145], v16 offset:12288
  ds_read_b64_tr_b16 a[146:147], v16 offset:13312
  s_waitcnt lgkmcnt(12)
  v_mfma_f32_32x32x16_bf16 v[160:175], a[152:155], a[72:75], v[160:175]
  ds_read_b64_tr_b16 a[148:149], v17 offset:12288
  ds_read_b64_tr_b16 a[150:151], v17 offset:13312
  s_waitcnt lgkmcnt(12)
  v_mfma_f32_32x32x16_bf16 v[176:191], a[156:159], a[72:75], v[176:191]
  ds_read_b64_tr_b16 a[152:153], v18 offset:12288
  ds_read_b64_tr_b16 a[154:155], v18 offset:13312
  s_waitcnt lgkmcnt(12)
  v_mfma_f32_32x32x16_bf16 v[192:207], a[72:75], a[128:131], v[192:207]
  ds_read_b64_tr_b16 a[156:157], v19 offset:12288
  ds_read_b64_tr_b16 a[158:159], v19 offset:13312
  s_waitcnt lgkmcnt(12)
  v_mfma_f32_32x32x16_bf16 v[208:223], a[72:75], a[132:135], v[208:223]
  s_add_u32 s64, s12, 3145728
  s_addc_u32 s65, s13, 0
  s_add_u32 m0, s56, 32768
  s_nop 0
  global_load_lds_dwordx4 v5, s[64:65]
  ds_read_b64_tr_b16 a[128:129], v16 offset:28672
  ds_read_b64_tr_b16 a[130:131], v16 offset:29696
  s_waitcnt lgkmcnt(12)
  v_mfma_f32_32x32x16_bf16 v[224:239], a[72:75], a[136:139], v[224:239]
  ds_read_b64_tr_b16 a[132:133], v17 offset:28672
  ds_read_b64_tr_b16 a[134:135], v17 offset:29696
  s_waitcnt lgkmcnt(12)
  v_mfma_f32_32x32x16_bf16 v[240:255], a[72:75], a[140:143], v[240:255]
  ds_read_b64_tr_b16 a[136:137], v18 offset:28672
  ds_read_b64_tr_b16 a[138:139], v18 offset:29696
  s_waitcnt lgkmcnt(12)
  v_mfma_f32_32x32x16_bf16 v[64:79], a[144:147], a[76:79], v[64:79]
  ds_read_b64_tr_b16 a[140:141], v19 offset:28672
  ds_read_b64_tr_b16 a[142:143], v19 offset:29696
  s_waitcnt lgkmcnt(12)
  v_mfma_f32_32x32x16_bf16 v[80:95], a[148:151], a[76:79], v[80:95]
  s_add_u32 s64, s12, 3178496
  s_addc_u32 s65, s13, 0
  s_add_u32 m0, s56, 33792
  s_nop 0
  global_load_lds_dwordx4 v5, s[64:65]
  ds_read_b64_tr_b16 a[144:145], v16 offset:45056
  ds_read_b64_tr_b16 a[146:147], v16 offset:46080
  s_waitcnt lgkmcnt(12)
  v_mfma_f32_32x32x16_bf16 v[96:111], a[152:155], a[76:79], v[96:111]
  ds_read_b64_tr_b16 a[148:149], v17 offset:45056
  ds_read_b64_tr_b16 a[150:151], v17 offset:46080
  s_waitcnt lgkmcnt(12)
  v_mfma_f32_32x32x16_bf16 v[112:127], a[156:159], a[76:79], v[112:127]
  ds_read_b64_tr_b16 a[152:153], v18 offset:45056
  ds_read_b64_tr_b16 a[154:155], v18 offset:46080
  s_waitcnt lgkmcnt(12)
  v_mfma_f32_32x32x16_bf16 v[128:143], a[128:131], a[76:79], v[128:143]
  ds_read_b64_tr_b16 a[156:157], v19 offset:45056
  ds_read_b64_tr_b16 a[158:159], v19 offset:46080
  s_waitcnt lgkmcnt(12)
  v_mfma_f32_32x32x16_bf16 v[144:159], a[132:135], a[76:79], v[144:159]
  s_add_u32 s64, s12, 3211264
  s_addc_u32 s65, s13, 0
  s_add_u32 m0, s56, 34816
  s_nop 0
  global_load_lds_dwordx4 v5, s[64:65]
  s_waitcnt lgkmcnt(10)
  v_mfma_f32_32x32x16_bf16 v[160:175], a[136:139], a[76:79], v[160:175]
  s_waitcnt lgkmcnt(8)
  v_mfma_f32_32x32x16_bf16 v[176:191], a[140:143], a[76:79], v[176:191]
  s_waitcnt lgkmcnt(6)
  v_mfma_f32_32x32x16_bf16 v[192:207], a[76:79], a[144:147], v[192:207]
  s_waitcnt lgkmcnt(4)
  v_mfma_f32_32x32x16_bf16 v[208:223], a[76:79], a[148:151], v[208:223]
  s_add_u32 s64, s12, 3244032
  s_addc_u32 s65, s13, 0
  s_add_u32 m0, s56, 35840
  s_nop 0
  global_load_lds_dwordx4 v5, s[64:65]
  s_waitcnt lgkmcnt(2)
  v_mfma_f32_32x32x16_bf16 v[224:239], a[76:79], a[152:155], v[224:239]
  s_waitcnt lgkmcnt(0)
  v_mfma_f32_32x32x16_bf16 v[240:255], a[76:79], a[156:159], v[240:255]
  v_add_u32 v16, 98304, v8
  v_add_u32 v17, 98304, v9
  v_add_u32 v18, 98304, v10
  v_add_u32 v19, 98304, v11
  s_waitcnt vmcnt(16)
  s_barrier
  ds_read_b64_tr_b16 a[128:129], v16 offset:0
  ds_read_b64_tr_b16 a[130:131], v16 offset:1024
  ds_read_b64_tr_b16 a[132:133], v17 offset:0
  ds_read_b64_tr_b16 a[134:135], v17 offset:1024
  ds_read_b64_tr_b16 a[136:137], v18 offset:0
  ds_read_b64_tr_b16 a[138:139], v18 offset:1024
  ds_read_b64_tr_b16 a[140:141], v19 offset:0
  ds_read_b64_tr_b16 a[142:143], v19 offset:1024
  ds_read_b64_tr_b16 a[144:145], v16 offset:16384
  ds_read_b64_tr_b16 a[146:147], v16 offset:17408
  ds_read_b64_tr_b16 a[148:149], v17 offset:16384
  ds_read_b64_tr_b16 a[150:151], v17 offset:17408
  ds_read_b64_tr_b16 a[152:153], v18 offset:16384
  ds_read_b64_tr_b16 a[154:155], v18 offset:17408
  s_waitcnt lgkmcnt(12)
  v_mfma_f32_32x32x16_bf16 v[64:79], a[128:131], a[80:83], v[64:79]
  ds_read_b64_tr_b16 a[156:157], v19 offset:16384
  ds_read_b64_tr_b16 a[158:159], v19 offset:17408
  s_waitcnt lgkmcnt(12)
  v_mfma_f32_32x32x16_bf16 v[80:95], a[132:135], a[80:83], v[80:95]
  global_load_dwordx4 a[112:115], v4, s[38:39] offset:896
  global_load_dwordx4 a[116:119], v4, s[38:39] offset:928
  global_load_dwordx4 a[120:123], v4, s[38:39] offset:960
  global_load_dwordx4 a[124:127], v4, s[38:39] offset:992
  s_lshl_b32 s56, s21, 12
  s_add_u32 s56, s56, 49152
  s_add_u32 s64, s8, 3670016
  s_addc_u32 s65, s9, 0
  s_add_u32 m0, s56, 0
  s_nop 0
  global_load_lds_dwordx4 v5, s[64:65]
  ds_read_b64_tr_b16 a[128:129], v16 offset:32768
  ds_read_b64_tr_b16 a[130:131], v16 offset:33792
  s_waitcnt lgkmcnt(12)
  v_mfma_f32_32x32x16_bf16 v[96:111], a[136:139], a[80:83], v[96:111]
  ds_read_b64_tr_b16 a[132:133], v17 offset:32768
  ds_read_b64_tr_b16 a[134:135], v17 offset:33792
  s_waitcnt lgkmcnt(12)
  v_mfma_f32_32x32x16_bf16 v[112:127], a[140:143], a[80:83], v[112:127]
  ds_read_b64_tr_b16 a[136:137], v18 offset:32768
  ds_read_b64_tr_b16 a[138:139], v18 offset:33792
  s_waitcnt lgkmcnt(12)
  v_mfma_f32_32x32x16_bf16 v[128:143], a[144:147], a[80:83], v[128:143]
  ds_read_b64_tr_b16 a[140:141], v19 offset:32768
  ds_read_b64_tr_b16 a[142:143], v19 offset:33792
  s_waitcnt lgkmcnt(12)
  v_mfma_f32_32x32x16_bf16 v[144:159], a[148:151], a[80:83], v[144:159]
  s_add_u32 s64, s8, 3702784
  s_addc_u32 s65, s9, 0
  s_add_u32 m0, s56, 1024
  s_nop 0
  global_load_lds_dwordx4 v5, s[64:65]
  ds_read_b64_tr_b16 a[144:145], v16 offset:4096
  ds_read_b64_tr_b16 a[146:147], v16 offset:5120
  s_waitcnt lgkmcnt(12)
  v_mfma_f32_32x32x16_bf16 v[160:175], a[152:155], a[80:83], v[160:175]
  ds_read_b64_tr_b16 a[148:149], v17 offset:4096
  ds_read_b64_tr_b16 a[150:151], v17 offset:5120
  s_waitcnt lgkmcnt(12)
  v_mfma_f32_32x32x16_bf16 v[176:191], a[156:159], a[80:83], v[176:191]
  ds_read_b64_tr_b16 a[152:153], v18 offset:4096
  ds_read_b64_tr_b16 a[154:155], v18 offset:5120
  s_waitcnt lgkmcnt(12)
  v_mfma_f32_32x32x16_bf16 v[192:207], a[80:83], a[128:131], v[192:207]
  ds_read_b64_tr_b16 a[156:157], v19 offset:4096
  ds_read_b64_tr_b16 a[158:159], v19 offset:5120
  s_waitcnt lgkmcnt(12)
  v_mfma_f32_32x32x16_bf16 v[208:223], a[80:83], a[132:135], v[208:223]
  s_add_u32 s64, s8, 3735552
  s_addc_u32 s65, s9, 0
  s_add_u32 m0, s56, 2048
  s_nop 0
  global_load_lds_dwordx4 v5, s[64:65]
  ds_read_b64_tr_b16 a[128:129], v16 offset:20480
  ds_read_b64_tr_b16 a[130:131], v16 offset:21504
  s_waitcnt lgkmcnt(12)
  v_mfma_f32_32x32x16_bf16 v[224:239], a[80:83], a[136:139], v[224:239]
  ds_read_b64_tr_b16 a[132:133], v17 offset:20480
  ds_read_b64_tr_b16 a[134:135], v17 offset:21504
  s_waitcnt lgkmcnt(12)
  v_mfma_f32_32x32x16_bf16 v[240:255], a[80:83], a[140:143], v[240:255]
  ds_read_b64_tr_b16 a[136:137], v18 offset:20480
  ds_read_b64_tr_b16 a[138:139], v18 offset:21504
  s_waitcnt lgkmcnt(12)
  v_mfma_f32_32x32x16_bf16 v[64:79], a[144:147], a[84:87], v[64:79]
  ds_read_b64_tr_b16 a[140:141], v19 offset:20480
  ds_read_b64_tr_b16 a[142:143], v19 offset:21504
  s_waitcnt lgkmcnt(12)
  v_mfma_f32_32x32x16_bf16 v[80:95], a[148:151], a[84:87], v[80:95]
  s_add_u32 s64, s8, 3768320
  s_addc_u32 s65, s9, 0
  s_add_u32 m0, s56, 3072
  s_nop 0
  global_load_lds_dwordx4 v5, s[64:65]
  ds_read_b64_tr_b16 a[144:145], v16 offset:36864
  ds_read_b64_tr_b16 a[146:147], v16 offset:37888
  s_waitcnt lgkmcnt(12)
  v_mfma_f32_32x32x16_bf16 v[96:111], a[152:155], a[84:87], v[96:111]
  ds_read_b64_tr_b16 a[148:149], v17 offset:36864
  ds_read_b64_tr_b16 a[150:151], v17 offset:37888
  s_waitcnt lgkmcnt(12)
  v_mfma_f32_32x32x16_bf16 v[112:127], a[156:159], a[84:87], v[112:127]
  ds_read_b64_tr_b16 a[152:153], v18 offset:36864
  ds_read_b64_tr_b16 a[154:155], v18 offset:37888
  s_waitcnt lgkmcnt(12)
  v_mfma_f32_32x32x16_bf16 v[128:143], a[128:131], a[84:87], v[128:143]
  ds_read_b64_tr_b16 a[156:157], v19 offset:36864
  ds_read_b64_tr_b16 a[158:159], v19 offset:37888
  s_waitcnt lgkmcnt(12)
  v_mfma_f32_32x32x16_bf16 v[144:159], a[132:135], a[84:87], v[144:159]
  s_add_u32 s64, s10, 3670016
  s_addc_u32 s65, s11, 0
  s_add_u32 m0, s56, 16384
  s_nop 0
  global_load_lds_dwordx4 v5, s[64:65]
  ds_read_b64_tr_b16 a[128:129], v16 offset:8192
  ds_read_b64_tr_b16 a[130:131], v16 offset:9216
  s_waitcnt lgkmcnt(12)
  v_mfma_f32_32x32x16_bf16 v[160:175], a[136:139], a[84:87], v[160:175]
  ds_read_b64_tr_b16 a[132:133], v17 offset:8192
  ds_read_b64_tr_b16 a[134:135], v17 offset:9216
  s_waitcnt lgkmcnt(12)
  v_mfma_f32_32x32x16_bf16 v[176:191], a[140:143], a[84:87], v[176:191]
  ds_read_b64_tr_b16 a[136:137], v18 offset:8192
  ds_read_b64_tr_b16 a[138:139], v18 offset:9216
  s_waitcnt lgkmcnt(12)
  v_mfma_f32_32x32x16_bf16 v[192:207], a[84:87], a[144:147], v[192:207]
  ds_read_b64_tr_b16 a[140:141], v19 offset:8192
  ds_read_b64_tr_b16 a[142:143], v19 offset:9216
  s_waitcnt lgkmcnt(12)
  v_mfma_f32_32x32x16_bf16 v[208:223], a[84:87], a[148:151], v[208:223]
  s_add_u32 s64, s10, 3702784
  s_addc_u32 s65, s11, 0
  s_add_u32 m0, s56, 17408
  s_nop 0
  global_load_lds_dwordx4 v5, s[64:65]
  ds_read_b64_tr_b16 a[144:145], v16 offset:24576
  ds_read_b64_tr_b16 a[146:147], v16 offset:25600
  s_waitcnt lgkmcnt(12)
  v_mfma_f32_32x32x16_bf16 v[224:239], a[84:87], a[152:155], v[224:239]
  ds_read_b64_tr_b16 a[148:149], v17 offset:24576
  ds_read_b64_tr_b16 a[150:151], v17 offset:25600
  s_waitcnt lgkmcnt(12)
  v_mfma_f32_32x32x16_bf16 v[240:255], a[84:87], a[156:159], v[240:255]
  ds_read_b64_tr_b16 a[152:153], v18 offset:24576
  ds_read_b64_tr_b16 a[154:155], v18 offset:25600
  s_waitcnt lgkmcnt(12)
  v_mfma_f32_32x32x16_bf16 v[64:79], a[128:131], a[88:91], v[64:79]
  ds_read_b64_tr_b16 a[156:157], v19 offset:24576
  ds_read_b64_tr_b16 a[158:159], v19 offset:25600
  s_waitcnt lgkmcnt(12)
  v_mfma_f32_32x32x16_bf16 v[80:95], a[132:135], a[88:91], v[80:95]
  s_add_u32 s64, s10, 3735552
  s_addc_u32 s65, s11, 0
  s_add_u32 m0, s56, 18432
  s_nop 0
  global_load_lds_dwordx4 v5, s[64:65]
  ds_read_b64_tr_b16 a[128:129], v16 offset:40960
  ds_read_b64_tr_b16 a[130:131], v16 offset:41984
  s_waitcnt lgkmcnt(12)
  v_mfma_f32_32x32x16_bf16 v[96:111], a[136:139], a[88:91], v[96:111]
  ds_read_b64_tr_b16 a[132:133], v17 offset:40960
  ds_read_b64_tr_b16 a[134:135], v17 offset:41984
  s_waitcnt lgkmcnt(12)
  v_mfma_f32_32x32x16_bf16 v[112:127], a[140:143], a[88:91], v[112:127]
  ds_read_b64_tr_b16 a[136:137], v18 offset:40960
  ds_read_b64_tr_b16 a[138:139], v18 offset:41984
  s_waitcnt lgkmcnt(12)
  v_mfma_f32_32x32x16_bf16 v[128:143], a[144:147], a[88:91], v[128:143]
  ds_read_b64_tr_b16 a[140:141], v19 offset:40960
  ds_read_b64_tr_b16 a[142:143], v19 offset:41984
  s_waitcnt lgkmcnt(12)
  v_mfma_f32_32x32x16_bf16 v[144:159], a[148:151], a[88:91], v[144:159]
  s_add_u32 s64, s10, 3768320
  s_addc_u32 s65, s11, 0
  s_add_u32 m0, s56, 19456
  s_nop 0
  global_load_lds_dwordx4 v5, s[64:65]
  ds_read_b64_tr_b16 a[144:145], v16 offset:12288
  ds_read_b64_tr_b16 a[146:147], v16 offset:13312
  s_waitcnt lgkmcnt(12)
  v_mfma_f32_32x32x16_bf16 v[160:175], a[152:155], a[88:91], v[160:175]
  ds_read_b64_tr_b16 a[148:149], v17 offset:12288
  ds_read_b64_tr_b16 a[150:151], v17 offset:13312
  s_waitcnt lgkmcnt(12)
  v_mfma_f32_32x32x16_bf16 v[176:191], a[156:159], a[88:91], v[176:191]
  ds_read_b64_tr_b16 a[152:153], v18 offset:12288
  ds_read_b64_tr_b16 a[154:155], v18 offset:13312
  s_waitcnt lgkmcnt(12)
  v_mfma_f32_32x32x16_bf16 v[192:207], a[88:91], a[128:131], v[192:207]
  ds_read_b64_tr_b16 a[156:157], v19 offset:12288
  ds_read_b64_tr_b16 a[158:159], v19 offset:13312
  s_waitcnt lgkmcnt(12)
  v_mfma_f32_32x32x16_bf16 v[208:223], a[88:91], a[132:135], v[208:223]
  s_add_u32 s64, s12, 3670016
  s_addc_u32 s65, s13, 0
  s_add_u32 m0, s56, 32768
  s_nop 0
  global_load_lds_dwordx4 v5, s[64:65]
  ds_read_b64_tr_b16 a[128:129], v16 offset:28672
  ds_read_b64_tr_b16 a[130:131], v16 offset:29696
  s_waitcnt lgkmcnt(12)
  v_mfma_f32_32x32x16_bf16 v[224:239], a[88:91], a[136:139], v[224:239]
  ds_read_b64_tr_b16 a[132:133], v17 offset:28672
  ds_read_b64_tr_b16 a[134:135], v17 offset:29696
  s_waitcnt lgkmcnt(12)
  v_mfma_f32_32x32x16_bf16 v[240:255], a[88:91], a[140:143], v[240:255]
  ds_read_b64_tr_b16 a[136:137], v18 offset:28672
  ds_read_b64_tr_b16 a[138:139], v18 offset:29696
  s_waitcnt lgkmcnt(12)
  v_mfma_f32_32x32x16_bf16 v[64:79], a[144:147], a[92:95], v[64:79]
  ds_read_b64_tr_b16 a[140:141], v19 offset:28672
  ds_read_b64_tr_b16 a[142:143], v19 offset:29696
  s_waitcnt lgkmcnt(12)
  v_mfma_f32_32x32x16_bf16 v[80:95], a[148:151], a[92:95], v[80:95]
  s_add_u32 s64, s12, 3702784
  s_addc_u32 s65, s13, 0
  s_add_u32 m0, s56, 33792
  s_nop 0
  global_load_lds_dwordx4 v5, s[64:65]
  ds_read_b64_tr_b16 a[144:145], v16 offset:45056
  ds_read_b64_tr_b16 a[146:147], v16 offset:46080
  s_waitcnt lgkmcnt(12)
  v_mfma_f32_32x32x16_bf16 v[96:111], a[152:155], a[92:95], v[96:111]
  ds_read_b64_tr_b16 a[148:149], v17 offset:45056
  ds_read_b64_tr_b16 a[150:151], v17 offset:46080
  s_waitcnt lgkmcnt(12)
  v_mfma_f32_32x32x16_bf16 v[112:127], a[156:159], a[92:95], v[112:127]
  ds_read_b64_tr_b16 a[152:153], v18 offset:45056
  ds_read_b64_tr_b16 a[154:155], v18 offset:46080
  s_waitcnt lgkmcnt(12)
  v_mfma_f32_32x32x16_bf16 v[128:143], a[128:131], a[92:95], v[128:143]
  ds_read_b64_tr_b16 a[156:157], v19 offset:45056
  ds_read_b64_tr_b16 a[158:159], v19 offset:46080
  s_waitcnt lgkmcnt(12)
  v_mfma_f32_32x32x16_bf16 v[144:159], a[132:135], a[92:95], v[144:159]
  s_add_u32 s64, s12, 3735552
  s_addc_u32 s65, s13, 0
  s_add_u32 m0, s56, 34816
  s_nop 0
  global_load_lds_dwordx4 v5, s[64:65]
  s_waitcnt lgkmcnt(10)
  v_mfma_f32_32x32x16_bf16 v[160:175], a[136:139], a[92:95], v[160:175]
  s_waitcnt lgkmcnt(8)
  v_mfma_f32_32x32x16_bf16 v[176:191], a[140:143], a[92:95], v[176:191]
  s_waitcnt lgkmcnt(6)
  v_mfma_f32_32x32x16_bf16 v[192:207], a[92:95], a[144:147], v[192:207]
  s_waitcnt lgkmcnt(4)
  v_mfma_f32_32x32x16_bf16 v[208:223], a[92:95], a[148:151], v[208:223]
  s_add_u32 s64, s12, 3768320
  s_addc_u32 s65, s13, 0
  s_add_u32 m0, s56, 35840
  s_nop 0
  global_load_lds_dwordx4 v5, s[64:65]
  s_waitcnt lgkmcnt(2)
  v_mfma_f32_32x32x16_bf16 v[224:239], a[92:95], a[152:155], v[224:239]
  s_waitcnt lgkmcnt(0)
  v_mfma_f32_32x32x16_bf16 v[240:255], a[92:95], a[156:159], v[240:255]
  v_add_u32 v16, 0, v8
  v_add_u32 v17, 0, v9
  v_add_u32 v18, 0, v10
  v_add_u32 v19, 0, v11
  s_waitcnt vmcnt(16)
  s_barrier
  ds_read_b64_tr_b16 a[128:129], v16 offset:0
  ds_read_b64_tr_b16 a[130:131], v16 offset:1024
  ds_read_b64_tr_b16 a[132:133], v17 offset:0
  ds_read_b64_tr_b16 a[134:135], v17 offset:1024
  ds_read_b64_tr_b16 a[136:137], v18 offset:0
  ds_read_b64_tr_b16 a[138:139], v18 offset:1024
  ds_read_b64_tr_b16 a[140:141], v19 offset:0
  ds_read_b64_tr_b16 a[142:143], v19 offset:1024
  ds_read_b64_tr_b16 a[144:145], v16 offset:16384
  ds_read_b64_tr_b16 a[146:147], v16 offset:17408
  ds_read_b64_tr_b16 a[148:149], v17 offset:16384
  ds_read_b64_tr_b16 a[150:151], v17 offset:17408
  ds_read_b64_tr_b16 a[152:153], v18 offset:16384
  ds_read_b64_tr_b16 a[154:155], v18 offset:17408
  s_waitcnt lgkmcnt(12)
  v_mfma_f32_32x32x16_bf16 v[64:79], a[128:131], a[96:99], v[64:79]
  ds_read_b64_tr_b16 a[156:157], v19 offset:16384
  ds_read_b64_tr_b16 a[158:159], v19 offset:17408
  s_waitcnt lgkmcnt(12)
  v_mfma_f32_32x32x16_bf16 v[80:95], a[132:135], a[96:99], v[80:95]
  ds_read_b64_tr_b16 a[128:129], v16 offset:32768
  ds_read_b64_tr_b16 a[130:131], v16 offset:33792
  s_waitcnt lgkmcnt(12)
  v_mfma_f32_32x32x16_bf16 v[96:111], a[136:139], a[96:99], v[96:111]
  ds_read_b64_tr_b16 a[132:133], v17 offset:32768
  ds_read_b64_tr_b16 a[134:135], v17 offset:33792
  s_waitcnt lgkmcnt(12)
  v_mfma_f32_32x32x16_bf16 v[112:127], a[140:143], a[96:99], v[112:127]
  ds_read_b64_tr_b16 a[136:137], v18 offset:32768
  ds_read_b64_tr_b16 a[138:139], v18 offset:33792
  s_waitcnt lgkmcnt(12)
  v_mfma_f32_32x32x16_bf16 v[128:143], a[144:147], a[96:99], v[128:143]
  ds_read_b64_tr_b16 a[140:141], v19 offset:32768
  ds_read_b64_tr_b16 a[142:143], v19 offset:33792
  s_waitcnt lgkmcnt(12)
  v_mfma_f32_32x32x16_bf16 v[144:159], a[148:151], a[96:99], v[144:159]
  ds_read_b64_tr_b16 a[144:145], v16 offset:4096
  ds_read_b64_tr_b16 a[146:147], v16 offset:5120
  s_waitcnt lgkmcnt(12)
  v_mfma_f32_32x32x16_bf16 v[160:175], a[152:155], a[96:99], v[160:175]
  ds_read_b64_tr_b16 a[148:149], v17 offset:4096
  ds_read_b64_tr_b16 a[150:151], v17 offset:5120
  s_waitcnt lgkmcnt(12)
  v_mfma_f32_32x32x16_bf16 v[176:191], a[156:159], a[96:99], v[176:191]
  ds_read_b64_tr_b16 a[152:153], v18 offset:4096
  ds_read_b64_tr_b16 a[154:155], v18 offset:5120
  s_waitcnt lgkmcnt(12)
  v_mfma_f32_32x32x16_bf16 v[192:207], a[96:99], a[128:131], v[192:207]
  ds_read_b64_tr_b16 a[156:157], v19 offset:4096
  ds_read_b64_tr_b16 a[158:159], v19 offset:5120
  s_waitcnt lgkmcnt(12)
  v_mfma_f32_32x32x16_bf16 v[208:223], a[96:99], a[132:135], v[208:223]
  ds_read_b64_tr_b16 a[128:129], v16 offset:20480
  ds_read_b64_tr_b16 a[130:131], v16 offset:21504
  s_waitcnt lgkmcnt(12)
  v_mfma_f32_32x32x16_bf16 v[224:239], a[96:99], a[136:139], v[224:239]
  ds_read_b64_tr_b16 a[132:133], v17 offset:20480
  ds_read_b64_tr_b16 a[134:135], v17 offset:21504
  s_waitcnt lgkmcnt(12)
  v_mfma_f32_32x32x16_bf16 v[240:255], a[96:99], a[140:143], v[240:255]
  ds_read_b64_tr_b16 a[136:137], v18 offset:20480
  ds_read_b64_tr_b16 a[138:139], v18 offset:21504
  s_waitcnt lgkmcnt(12)
  v_mfma_f32_32x32x16_bf16 v[64:79], a[144:147], a[100:103], v[64:79]
  ds_read_b64_tr_b16 a[140:141], v19 offset:20480
  ds_read_b64_tr_b16 a[142:143], v19 offset:21504
  s_waitcnt lgkmcnt(12)
  v_mfma_f32_32x32x16_bf16 v[80:95], a[148:151], a[100:103], v[80:95]
  ds_read_b64_tr_b16 a[144:145], v16 offset:36864
  ds_read_b64_tr_b16 a[146:147], v16 offset:37888
  s_waitcnt lgkmcnt(12)
  v_mfma_f32_32x32x16_bf16 v[96:111], a[152:155], a[100:103], v[96:111]
  ds_read_b64_tr_b16 a[148:149], v17 offset:36864
  ds_read_b64_tr_b16 a[150:151], v17 offset:37888
  s_waitcnt lgkmcnt(12)
  v_mfma_f32_32x32x16_bf16 v[112:127], a[156:159], a[100:103], v[112:127]
  ds_read_b64_tr_b16 a[152:153], v18 offset:36864
  ds_read_b64_tr_b16 a[154:155], v18 offset:37888
  s_waitcnt lgkmcnt(12)
  v_mfma_f32_32x32x16_bf16 v[128:143], a[128:131], a[100:103], v[128:143]
  ds_read_b64_tr_b16 a[156:157], v19 offset:36864
  ds_read_b64_tr_b16 a[158:159], v19 offset:37888
  s_waitcnt lgkmcnt(12)
  v_mfma_f32_32x32x16_bf16 v[144:159], a[132:135], a[100:103], v[144:159]
  ds_read_b64_tr_b16 a[128:129], v16 offset:8192
  ds_read_b64_tr_b16 a[130:131], v16 offset:9216
  s_waitcnt lgkmcnt(12)
  v_mfma_f32_32x32x16_bf16 v[160:175], a[136:139], a[100:103], v[160:175]
  ds_read_b64_tr_b16 a[132:133], v17 offset:8192
  ds_read_b64_tr_b16 a[134:135], v17 offset:9216
  s_waitcnt lgkmcnt(12)
  v_mfma_f32_32x32x16_bf16 v[176:191], a[140:143], a[100:103], v[176:191]
  ds_read_b64_tr_b16 a[136:137], v18 offset:8192
  ds_read_b64_tr_b16 a[138:139], v18 offset:9216
  s_waitcnt lgkmcnt(12)
  v_mfma_f32_32x32x16_bf16 v[192:207], a[100:103], a[144:147], v[192:207]
  ds_read_b64_tr_b16 a[140:141], v19 offset:8192
  ds_read_b64_tr_b16 a[142:143], v19 offset:9216
  s_waitcnt lgkmcnt(12)
  v_mfma_f32_32x32x16_bf16 v[208:223], a[100:103], a[148:151], v[208:223]
  ds_read_b64_tr_b16 a[144:145], v16 offset:24576
  ds_read_b64_tr_b16 a[146:147], v16 offset:25600
  s_waitcnt lgkmcnt(12)
  v_mfma_f32_32x32x16_bf16 v[224:239], a[100:103], a[152:155], v[224:239]
  ds_read_b64_tr_b16 a[148:149], v17 offset:24576
  ds_read_b64_tr_b16 a[150:151], v17 offset:25600
  s_waitcnt lgkmcnt(12)
  v_mfma_f32_32x32x16_bf16 v[240:255], a[100:103], a[156:159], v[240:255]
  ds_read_b64_tr_b16 a[152:153], v18 offset:24576
  ds_read_b64_tr_b16 a[154:155], v18 offset:25600
  s_waitcnt lgkmcnt(12)
  v_mfma_f32_32x32x16_bf16 v[64:79], a[128:131], a[104:107], v[64:79]
  ds_read_b64_tr_b16 a[156:157], v19 offset:24576
  ds_read_b64_tr_b16 a[158:159], v19 offset:25600
  s_waitcnt lgkmcnt(12)
  v_mfma_f32_32x32x16_bf16 v[80:95], a[132:135], a[104:107], v[80:95]
  ds_read_b64_tr_b16 a[128:129], v16 offset:40960
  ds_read_b64_tr_b16 a[130:131], v16 offset:41984
  s_waitcnt lgkmcnt(12)
  v_mfma_f32_32x32x16_bf16 v[96:111], a[136:139], a[104:107], v[96:111]
  ds_read_b64_tr_b16 a[132:133], v17 offset:40960
  ds_read_b64_tr_b16 a[134:135], v17 offset:41984
  s_waitcnt lgkmcnt(12)
  v_mfma_f32_32x32x16_bf16 v[112:127], a[140:143], a[104:107], v[112:127]
  ds_read_b64_tr_b16 a[136:137], v18 offset:40960
  ds_read_b64_tr_b16 a[138:139], v18 offset:41984
  s_waitcnt lgkmcnt(12)
  v_mfma_f32_32x32x16_bf16 v[128:143], a[144:147], a[104:107], v[128:143]
  ds_read_b64_tr_b16 a[140:141], v19 offset:40960
  ds_read_b64_tr_b16 a[142:143], v19 offset:41984
  s_waitcnt lgkmcnt(12)
  v_mfma_f32_32x32x16_bf16 v[144:159], a[148:151], a[104:107], v[144:159]
  ds_read_b64_tr_b16 a[144:145], v16 offset:12288
  ds_read_b64_tr_b16 a[146:147], v16 offset:13312
  s_waitcnt lgkmcnt(12)
  v_mfma_f32_32x32x16_bf16 v[160:175], a[152:155], a[104:107], v[160:175]
  ds_read_b64_tr_b16 a[148:149], v17 offset:12288
  ds_read_b64_tr_b16 a[150:151], v17 offset:13312
  s_waitcnt lgkmcnt(12)
  v_mfma_f32_32x32x16_bf16 v[176:191], a[156:159], a[104:107], v[176:191]
  ds_read_b64_tr_b16 a[152:153], v18 offset:12288
  ds_read_b64_tr_b16 a[154:155], v18 offset:13312
  s_waitcnt lgkmcnt(12)
  v_mfma_f32_32x32x16_bf16 v[192:207], a[104:107], a[128:131], v[192:207]
  ds_read_b64_tr_b16 a[156:157], v19 offset:12288
  ds_read_b64_tr_b16 a[158:159], v19 offset:13312
  s_waitcnt lgkmcnt(12)
  v_mfma_f32_32x32x16_bf16 v[208:223], a[104:107], a[132:135], v[208:223]
  ds_read_b64_tr_b16 a[128:129], v16 offset:28672
  ds_read_b64_tr_b16 a[130:131], v16 offset:29696
  s_waitcnt lgkmcnt(12)
  v_mfma_f32_32x32x16_bf16 v[224:239], a[104:107], a[136:139], v[224:239]
  ds_read_b64_tr_b16 a[132:133], v17 offset:28672
  ds_read_b64_tr_b16 a[134:135], v17 offset:29696
  s_waitcnt lgkmcnt(12)
  v_mfma_f32_32x32x16_bf16 v[240:255], a[104:107], a[140:143], v[240:255]
  ds_read_b64_tr_b16 a[136:137], v18 offset:28672
  ds_read_b64_tr_b16 a[138:139], v18 offset:29696
  s_waitcnt lgkmcnt(12)
  v_mfma_f32_32x32x16_bf16 v[64:79], a[144:147], a[108:111], v[64:79]
  ds_read_b64_tr_b16 a[140:141], v19 offset:28672
  ds_read_b64_tr_b16 a[142:143], v19 offset:29696
  s_waitcnt lgkmcnt(12)
  v_mfma_f32_32x32x16_bf16 v[80:95], a[148:151], a[108:111], v[80:95]
  ds_read_b64_tr_b16 a[144:145], v16 offset:45056
  ds_read_b64_tr_b16 a[146:147], v16 offset:46080
  s_waitcnt lgkmcnt(12)
  v_mfma_f32_32x32x16_bf16 v[96:111], a[152:155], a[108:111], v[96:111]
  ds_read_b64_tr_b16 a[148:149], v17 offset:45056
  ds_read_b64_tr_b16 a[150:151], v17 offset:46080
  s_waitcnt lgkmcnt(12)
  v_mfma_f32_32x32x16_bf16 v[112:127], a[156:159], a[108:111], v[112:127]
  ds_read_b64_tr_b16 a[152:153], v18 offset:45056
  ds_read_b64_tr_b16 a[154:155], v18 offset:46080
  s_waitcnt lgkmcnt(12)
  v_mfma_f32_32x32x16_bf16 v[128:143], a[128:131], a[108:111], v[128:143]
  ds_read_b64_tr_b16 a[156:157], v19 offset:45056
  ds_read_b64_tr_b16 a[158:159], v19 offset:46080
  s_waitcnt lgkmcnt(12)
  v_mfma_f32_32x32x16_bf16 v[144:159], a[132:135], a[108:111], v[144:159]
  s_waitcnt lgkmcnt(10)
  v_mfma_f32_32x32x16_bf16 v[160:175], a[136:139], a[108:111], v[160:175]
  s_waitcnt lgkmcnt(8)
  v_mfma_f32_32x32x16_bf16 v[176:191], a[140:143], a[108:111], v[176:191]
  s_waitcnt lgkmcnt(6)
  v_mfma_f32_32x32x16_bf16 v[192:207], a[108:111], a[144:147], v[192:207]
  s_waitcnt lgkmcnt(4)
  v_mfma_f32_32x32x16_bf16 v[208:223], a[108:111], a[148:151], v[208:223]
  s_waitcnt lgkmcnt(2)
  v_mfma_f32_32x32x16_bf16 v[224:239], a[108:111], a[152:155], v[224:239]
  s_waitcnt lgkmcnt(0)
  v_mfma_f32_32x32x16_bf16 v[240:255], a[108:111], a[156:159], v[240:255]
  v_add_u32 v16, 49152, v8
  v_add_u32 v17, 49152, v9
  v_add_u32 v18, 49152, v10
  v_add_u32 v19, 49152, v11
  s_waitcnt vmcnt(0)
  s_barrier
  ds_read_b64_tr_b16 a[128:129], v16 offset:0
  ds_read_b64_tr_b16 a[130:131], v16 offset:1024
  ds_read_b64_tr_b16 a[132:133], v17 offset:0
  ds_read_b64_tr_b16 a[134:135], v17 offset:1024
  ds_read_b64_tr_b16 a[136:137], v18 offset:0
  ds_read_b64_tr_b16 a[138:139], v18 offset:1024
  ds_read_b64_tr_b16 a[140:141], v19 offset:0
  ds_read_b64_tr_b16 a[142:143], v19 offset:1024
  ds_read_b64_tr_b16 a[144:145], v16 offset:16384
  ds_read_b64_tr_b16 a[146:147], v16 offset:17408
  ds_read_b64_tr_b16 a[148:149], v17 offset:16384
  ds_read_b64_tr_b16 a[150:151], v17 offset:17408
  ds_read_b64_tr_b16 a[152:153], v18 offset:16384
  ds_read_b64_tr_b16 a[154:155], v18 offset:17408
  s_waitcnt lgkmcnt(12)
  v_mfma_f32_32x32x16_bf16 v[64:79], a[128:131], a[112:115], v[64:79]
  ds_read_b64_tr_b16 a[156:157], v19 offset:16384
  ds_read_b64_tr_b16 a[158:159], v19 offset:17408
  s_waitcnt lgkmcnt(12)
  v_mfma_f32_32x32x16_bf16 v[80:95], a[132:135], a[112:115], v[80:95]
  ds_read_b64_tr_b16 a[128:129], v16 offset:32768
  ds_read_b64_tr_b16 a[130:131], v16 offset:33792
  s_waitcnt lgkmcnt(12)
  v_mfma_f32_32x32x16_bf16 v[96:111], a[136:139], a[112:115], v[96:111]
  ds_read_b64_tr_b16 a[132:133], v17 offset:32768
  ds_read_b64_tr_b16 a[134:135], v17 offset:33792
  s_waitcnt lgkmcnt(12)
  v_mfma_f32_32x32x16_bf16 v[112:127], a[140:143], a[112:115], v[112:127]
  ds_read_b64_tr_b16 a[136:137], v18 offset:32768
  ds_read_b64_tr_b16 a[138:139], v18 offset:33792
  s_waitcnt lgkmcnt(12)
  v_mfma_f32_32x32x16_bf16 v[128:143], a[144:147], a[112:115], v[128:143]
  ds_read_b64_tr_b16 a[140:141], v19 offset:32768
  ds_read_b64_tr_b16 a[142:143], v19 offset:33792
  s_waitcnt lgkmcnt(12)
  v_mfma_f32_32x32x16_bf16 v[144:159], a[148:151], a[112:115], v[144:159]
  ds_read_b64_tr_b16 a[144:145], v16 offset:4096
  ds_read_b64_tr_b16 a[146:147], v16 offset:5120
  s_waitcnt lgkmcnt(12)
  v_mfma_f32_32x32x16_bf16 v[160:175], a[152:155], a[112:115], v[160:175]
  ds_read_b64_tr_b16 a[148:149], v17 offset:4096
  ds_read_b64_tr_b16 a[150:151], v17 offset:5120
  s_waitcnt lgkmcnt(12)
  v_mfma_f32_32x32x16_bf16 v[176:191], a[156:159], a[112:115], v[176:191]
  ds_read_b64_tr_b16 a[152:153], v18 offset:4096
  ds_read_b64_tr_b16 a[154:155], v18 offset:5120
  s_waitcnt lgkmcnt(12)
  v_mfma_f32_32x32x16_bf16 v[192:207], a[112:115], a[128:131], v[192:207]
  ds_read_b64_tr_b16 a[156:157], v19 offset:4096
  ds_read_b64_tr_b16 a[158:159], v19 offset:5120
  s_waitcnt lgkmcnt(12)
  v_mfma_f32_32x32x16_bf16 v[208:223], a[112:115], a[132:135], v[208:223]
  ds_read_b64_tr_b16 a[128:129], v16 offset:20480
  ds_read_b64_tr_b16 a[130:131], v16 offset:21504
  s_waitcnt lgkmcnt(12)
  v_mfma_f32_32x32x16_bf16 v[224:239], a[112:115], a[136:139], v[224:239]
  ds_read_b64_tr_b16 a[132:133], v17 offset:20480
  ds_read_b64_tr_b16 a[134:135], v17 offset:21504
  s_waitcnt lgkmcnt(12)
  v_mfma_f32_32x32x16_bf16 v[240:255], a[112:115], a[140:143], v[240:255]
  ds_read_b64_tr_b16 a[136:137], v18 offset:20480
  ds_read_b64_tr_b16 a[138:139], v18 offset:21504
  s_waitcnt lgkmcnt(12)
  v_mfma_f32_32x32x16_bf16 v[64:79], a[144:147], a[116:119], v[64:79]
  ds_read_b64_tr_b16 a[140:141], v19 offset:20480
  ds_read_b64_tr_b16 a[142:143], v19 offset:21504
  s_waitcnt lgkmcnt(12)
  v_mfma_f32_32x32x16_bf16 v[80:95], a[148:151], a[116:119], v[80:95]
  ds_read_b64_tr_b16 a[144:145], v16 offset:36864
  ds_read_b64_tr_b16 a[146:147], v16 offset:37888
  s_waitcnt lgkmcnt(12)
  v_mfma_f32_32x32x16_bf16 v[96:111], a[152:155], a[116:119], v[96:111]
  ds_read_b64_tr_b16 a[148:149], v17 offset:36864
  ds_read_b64_tr_b16 a[150:151], v17 offset:37888
  s_waitcnt lgkmcnt(12)
  v_mfma_f32_32x32x16_bf16 v[112:127], a[156:159], a[116:119], v[112:127]
  ds_read_b64_tr_b16 a[152:153], v18 offset:36864
  ds_read_b64_tr_b16 a[154:155], v18 offset:37888
  s_waitcnt lgkmcnt(12)
  v_mfma_f32_32x32x16_bf16 v[128:143], a[128:131], a[116:119], v[128:143]
  ds_read_b64_tr_b16 a[156:157], v19 offset:36864
  ds_read_b64_tr_b16 a[158:159], v19 offset:37888
  s_waitcnt lgkmcnt(12)
  v_mfma_f32_32x32x16_bf16 v[144:159], a[132:135], a[116:119], v[144:159]
  ds_read_b64_tr_b16 a[128:129], v16 offset:8192
  ds_read_b64_tr_b16 a[130:131], v16 offset:9216
  s_waitcnt lgkmcnt(12)
  v_mfma_f32_32x32x16_bf16 v[160:175], a[136:139], a[116:119], v[160:175]
  ds_read_b64_tr_b16 a[132:133], v17 offset:8192
  ds_read_b64_tr_b16 a[134:135], v17 offset:9216
  s_waitcnt lgkmcnt(12)
  v_mfma_f32_32x32x16_bf16 v[176:191], a[140:143], a[116:119], v[176:191]
  ds_read_b64_tr_b16 a[136:137], v18 offset:8192
  ds_read_b64_tr_b16 a[138:139], v18 offset:9216
  s_waitcnt lgkmcnt(12)
  v_mfma_f32_32x32x16_bf16 v[192:207], a[116:119], a[144:147], v[192:207]
  ds_read_b64_tr_b16 a[140:141], v19 offset:8192
  ds_read_b64_tr_b16 a[142:143], v19 offset:9216
  s_waitcnt lgkmcnt(12)
  v_mfma_f32_32x32x16_bf16 v[208:223], a[116:119], a[148:151], v[208:223]
  ds_read_b64_tr_b16 a[144:145], v16 offset:24576
  ds_read_b64_tr_b16 a[146:147], v16 offset:25600
  s_waitcnt lgkmcnt(12)
  v_mfma_f32_32x32x16_bf16 v[224:239], a[116:119], a[152:155], v[224:239]
  ds_read_b64_tr_b16 a[148:149], v17 offset:24576
  ds_read_b64_tr_b16 a[150:151], v17 offset:25600
  s_waitcnt lgkmcnt(12)
  v_mfma_f32_32x32x16_bf16 v[240:255], a[116:119], a[156:159], v[240:255]
  ds_read_b64_tr_b16 a[152:153], v18 offset:24576
  ds_read_b64_tr_b16 a[154:155], v18 offset:25600
  s_waitcnt lgkmcnt(12)
  v_mfma_f32_32x32x16_bf16 v[64:79], a[128:131], a[120:123], v[64:79]
  ds_read_b64_tr_b16 a[156:157], v19 offset:24576
  ds_read_b64_tr_b16 a[158:159], v19 offset:25600
  s_waitcnt lgkmcnt(12)
  v_mfma_f32_32x32x16_bf16 v[80:95], a[132:135], a[120:123], v[80:95]
  ds_read_b64_tr_b16 a[128:129], v16 offset:40960
  ds_read_b64_tr_b16 a[130:131], v16 offset:41984
  s_waitcnt lgkmcnt(12)
  v_mfma_f32_32x32x16_bf16 v[96:111], a[136:139], a[120:123], v[96:111]
  ds_read_b64_tr_b16 a[132:133], v17 offset:40960
  ds_read_b64_tr_b16 a[134:135], v17 offset:41984
  s_waitcnt lgkmcnt(12)
  v_mfma_f32_32x32x16_bf16 v[112:127], a[140:143], a[120:123], v[112:127]
  ds_read_b64_tr_b16 a[136:137], v18 offset:40960
  ds_read_b64_tr_b16 a[138:139], v18 offset:41984
  s_waitcnt lgkmcnt(12)
  v_mfma_f32_32x32x16_bf16 v[128:143], a[144:147], a[120:123], v[128:143]
  ds_read_b64_tr_b16 a[140:141], v19 offset:40960
  ds_read_b64_tr_b16 a[142:143], v19 offset:41984
  s_waitcnt lgkmcnt(12)
  v_mfma_f32_32x32x16_bf16 v[144:159], a[148:151], a[120:123], v[144:159]
  ds_read_b64_tr_b16 a[144:145], v16 offset:12288
  ds_read_b64_tr_b16 a[146:147], v16 offset:13312
  s_waitcnt lgkmcnt(12)
  v_mfma_f32_32x32x16_bf16 v[160:175], a[152:155], a[120:123], v[160:175]
  ds_read_b64_tr_b16 a[148:149], v17 offset:12288
  ds_read_b64_tr_b16 a[150:151], v17 offset:13312
  s_waitcnt lgkmcnt(12)
  v_mfma_f32_32x32x16_bf16 v[176:191], a[156:159], a[120:123], v[176:191]
  ds_read_b64_tr_b16 a[152:153], v18 offset:12288
  ds_read_b64_tr_b16 a[154:155], v18 offset:13312
  s_waitcnt lgkmcnt(12)
  v_mfma_f32_32x32x16_bf16 v[192:207], a[120:123], a[128:131], v[192:207]
  ds_read_b64_tr_b16 a[156:157], v19 offset:12288
  ds_read_b64_tr_b16 a[158:159], v19 offset:13312
  s_waitcnt lgkmcnt(12)
  v_mfma_f32_32x32x16_bf16 v[208:223], a[120:123], a[132:135], v[208:223]
  ds_read_b64_tr_b16 a[128:129], v16 offset:28672
  ds_read_b64_tr_b16 a[130:131], v16 offset:29696
  s_waitcnt lgkmcnt(12)
  v_mfma_f32_32x32x16_bf16 v[224:239], a[120:123], a[136:139], v[224:239]
  ds_read_b64_tr_b16 a[132:133], v17 offset:28672
  ds_read_b64_tr_b16 a[134:135], v17 offset:29696
  s_waitcnt lgkmcnt(12)
  v_mfma_f32_32x32x16_bf16 v[240:255], a[120:123], a[140:143], v[240:255]
  ds_read_b64_tr_b16 a[136:137], v18 offset:28672
  ds_read_b64_tr_b16 a[138:139], v18 offset:29696
  s_waitcnt lgkmcnt(12)
  v_mfma_f32_32x32x16_bf16 v[64:79], a[144:147], a[124:127], v[64:79]
  ds_read_b64_tr_b16 a[140:141], v19 offset:28672
  ds_read_b64_tr_b16 a[142:143], v19 offset:29696
  s_waitcnt lgkmcnt(12)
  v_mfma_f32_32x32x16_bf16 v[80:95], a[148:151], a[124:127], v[80:95]
  ds_read_b64_tr_b16 a[144:145], v16 offset:45056
  ds_read_b64_tr_b16 a[146:147], v16 offset:46080
  s_waitcnt lgkmcnt(12)
  v_mfma_f32_32x32x16_bf16 v[96:111], a[152:155], a[124:127], v[96:111]
  ds_read_b64_tr_b16 a[148:149], v17 offset:45056
  ds_read_b64_tr_b16 a[150:151], v17 offset:46080
  s_waitcnt lgkmcnt(12)
  v_mfma_f32_32x32x16_bf16 v[112:127], a[156:159], a[124:127], v[112:127]
  ds_read_b64_tr_b16 a[152:153], v18 offset:45056
  ds_read_b64_tr_b16 a[154:155], v18 offset:46080
  s_waitcnt lgkmcnt(12)
  v_mfma_f32_32x32x16_bf16 v[128:143], a[128:131], a[124:127], v[128:143]
  ds_read_b64_tr_b16 a[156:157], v19 offset:45056
  ds_read_b64_tr_b16 a[158:159], v19 offset:46080
  s_waitcnt lgkmcnt(12)
  v_mfma_f32_32x32x16_bf16 v[144:159], a[132:135], a[124:127], v[144:159]
  s_waitcnt lgkmcnt(10)
  v_mfma_f32_32x32x16_bf16 v[160:175], a[136:139], a[124:127], v[160:175]
  s_waitcnt lgkmcnt(8)
  v_mfma_f32_32x32x16_bf16 v[176:191], a[140:143], a[124:127], v[176:191]
  s_waitcnt lgkmcnt(6)
  v_mfma_f32_32x32x16_bf16 v[192:207], a[124:127], a[144:147], v[192:207]
  s_waitcnt lgkmcnt(4)
  v_mfma_f32_32x32x16_bf16 v[208:223], a[124:127], a[148:151], v[208:223]
  s_waitcnt lgkmcnt(2)
  v_mfma_f32_32x32x16_bf16 v[224:239], a[124:127], a[152:155], v[224:239]
  s_waitcnt lgkmcnt(0)
  v_mfma_f32_32x32x16_bf16 v[240:255], a[124:127], a[156:159], v[240:255]
  s_add_u32 s57, s23, 8
  s_nop 7
  s_nop 3
  v_mov_b32 v32, -1
  v_mov_b32 v33, -1
  v_mov_b32 v34, -1
  v_mov_b32 v35, -1
  v_and_b32 v36, 0x3ff, v12
  s_cmp_lt_u32 s22, 2
  s_cbranch_scc1 L_p1_nosent
  global_store_dwordx4 v36, v[32:35], s[40:41] offset:0 sc1
  global_store_dwordx4 v36, v[32:35], s[40:41] offset:1024 sc1
  global_store_dwordx4 v36, v[32:35], s[40:41] offset:2048 sc1
  global_store_dwordx4 v36, v[32:35], s[40:41] offset:3072 sc1
L_p1_nosent:
  v_mul_f32 v128, s24, v128
  v_mul_f32 v129, s24, v129
  v_mul_f32 v130, s24, v130
  v_mul_f32 v131, s24, v131
  v_mul_f32 v132, s24, v132
  v_mul_f32 v133, s24, v133
  v_mul_f32 v134, s24, v134
  v_mul_f32 v135, s24, v135
  v_mul_f32 v136, s24, v136
  v_mul_f32 v137, s24, v137
  v_mul_f32 v138, s24, v138
  v_mul_f32 v139, s24, v139
  v_mul_f32 v140, s24, v140
  v_mul_f32 v141, s24, v141
  v_mul_f32 v142, s24, v142
  v_mul_f32 v143, s24, v143
  v_cvt_pk_bf16_f32 v128, v128, v129
  v_cvt_pk_bf16_f32 v129, v130, v131
  v_cvt_pk_bf16_f32 v130, v132, v133
  v_cvt_pk_bf16_f32 v131, v134, v135
  v_cvt_pk_bf16_f32 v132, v136, v137
  v_cvt_pk_bf16_f32 v133, v138, v139
  v_cvt_pk_bf16_f32 v134, v140, v141
  v_cvt_pk_bf16_f32 v135, v142, v143
  global_store_dwordx4 v6, v[128:131], s[28:29] offset:0 sc1
  global_store_dwordx4 v6, v[132:135], s[28:29] offset:512 sc1
  v_mul_f32 v144, s24, v144
  v_mul_f32 v145, s24, v145
  v_mul_f32 v146, s24, v146
  v_mul_f32 v147, s24, v147
  v_mul_f32 v148, s24, v148
  v_mul_f32 v149, s24, v149
  v_mul_f32 v150, s24, v150
  v_mul_f32 v151, s24, v151
  v_mul_f32 v152, s24, v152
  v_mul_f32 v153, s24, v153
  v_mul_f32 v154, s24, v154
  v_mul_f32 v155, s24, v155
  v_mul_f32 v156, s24, v156
  v_mul_f32 v157, s24, v157
  v_mul_f32 v158, s24, v158
  v_mul_f32 v159, s24, v159
  v_cvt_pk_bf16_f32 v144, v144, v145
  v_cvt_pk_bf16_f32 v145, v146, v147
  v_cvt_pk_bf16_f32 v146, v148, v149
  v_cvt_pk_bf16_f32 v147, v150, v151
  v_cvt_pk_bf16_f32 v148, v152, v153
  v_cvt_pk_bf16_f32 v149, v154, v155
  v_cvt_pk_bf16_f32 v150, v156, v157
  v_cvt_pk_bf16_f32 v151, v158, v159
  global_store_dwordx4 v6, v[144:147], s[28:29] offset:1024 sc1
  global_store_dwordx4 v6, v[148:151], s[28:29] offset:1536 sc1
  v_mul_f32 v160, s24, v160
  v_mul_f32 v161, s24, v161
  v_mul_f32 v162, s24, v162
  v_mul_f32 v163, s24, v163
  v_mul_f32 v164, s24, v164
  v_mul_f32 v165, s24, v165
  v_mul_f32 v166, s24, v166
  v_mul_f32 v167, s24, v167
  v_mul_f32 v168, s24, v168
  v_mul_f32 v169, s24, v169
  v_mul_f32 v170, s24, v170
  v_mul_f32 v171, s24, v171
  v_mul_f32 v172, s24, v172
  v_mul_f32 v173, s24, v173
  v_mul_f32 v174, s24, v174
  v_mul_f32 v175, s24, v175
  v_cvt_pk_bf16_f32 v160, v160, v161
  v_cvt_pk_bf16_f32 v161, v162, v163
  v_cvt_pk_bf16_f32 v162, v164, v165
  v_cvt_pk_bf16_f32 v163, v166, v167
  v_cvt_pk_bf16_f32 v164, v168, v169
  v_cvt_pk_bf16_f32 v165, v170, v171
  v_cvt_pk_bf16_f32 v166, v172, v173
  v_cvt_pk_bf16_f32 v167, v174, v175
  global_store_dwordx4 v6, v[160:163], s[28:29] offset:2048 sc1
  global_store_dwordx4 v6, v[164:167], s[28:29] offset:2560 sc1
  v_mul_f32 v176, s24, v176
  v_mul_f32 v177, s24, v177
  v_mul_f32 v178, s24, v178
  v_mul_f32 v179, s24, v179
  v_mul_f32 v180, s24, v180
  v_mul_f32 v181, s24, v181
  v_mul_f32 v182, s24, v182
  v_mul_f32 v183, s24, v183
  v_mul_f32 v184, s24, v184
  v_mul_f32 v185, s24, v185
  v_mul_f32 v186, s24, v186
  v_mul_f32 v187, s24, v187
  v_mul_f32 v188, s24, v188
  v_mul_f32 v189, s24, v189
  v_mul_f32 v190, s24, v190
  v_mul_f32 v191, s24, v191
  v_cvt_pk_bf16_f32 v176, v176, v177
  v_cvt_pk_bf16_f32 v177, v178, v179
  v_cvt_pk_bf16_f32 v178, v180, v181
  v_cvt_pk_bf16_f32 v179, v182, v183
  v_cvt_pk_bf16_f32 v180, v184, v185
  v_cvt_pk_bf16_f32 v181, v186, v187
  v_cvt_pk_bf16_f32 v182, v188, v189
  v_cvt_pk_bf16_f32 v183, v190, v191
  global_store_dwordx4 v6, v[176:179], s[28:29] offset:3072 sc1
  global_store_dwordx4 v6, v[180:183], s[28:29] offset:3584 sc1
  v_cvt_pk_bf16_f32 v192, v192, v193
  v_cvt_pk_bf16_f32 v193, v194, v195
  v_cvt_pk_bf16_f32 v194, v200, v201
  v_cvt_pk_bf16_f32 v195, v202, v203
  v_cvt_pk_bf16_f32 v196, v196, v197
  v_cvt_pk_bf16_f32 v197, v198, v199
  v_cvt_pk_bf16_f32 v198, v204, v205
  v_cvt_pk_bf16_f32 v199, v206, v207
  global_store_dwordx4 v7, v[192:195], s[30:31] offset:-4096 sc1
  global_store_dwordx4 v7, v[196:199], s[30:31] offset:-3584 sc1
  v_cvt_pk_bf16_f32 v208, v208, v209
  v_cvt_pk_bf16_f32 v209, v210, v211
  v_cvt_pk_bf16_f32 v210, v216, v217
  v_cvt_pk_bf16_f32 v211, v218, v219
  v_cvt_pk_bf16_f32 v212, v212, v213
  v_cvt_pk_bf16_f32 v213, v214, v215
  v_cvt_pk_bf16_f32 v214, v220, v221
  v_cvt_pk_bf16_f32 v215, v222, v223
  global_store_dwordx4 v7, v[208:211], s[30:31] offset:-2048 sc1
  global_store_dwordx4 v7, v[212:215], s[30:31] offset:-1536 sc1
  v_cvt_pk_bf16_f32 v224, v224, v225
  v_cvt_pk_bf16_f32 v225, v226, v227
  v_cvt_pk_bf16_f32 v226, v232, v233
  v_cvt_pk_bf16_f32 v227, v234, v235
  v_cvt_pk_bf16_f32 v228, v228, v229
  v_cvt_pk_bf16_f32 v229, v230, v231
  v_cvt_pk_bf16_f32 v230, v236, v237
  v_cvt_pk_bf16_f32 v231, v238, v239
  global_store_dwordx4 v7, v[224:227], s[30:31] offset:0 sc1
  global_store_dwordx4 v7, v[228:231], s[30:31] offset:512 sc1
  v_cvt_pk_bf16_f32 v240, v240, v241
  v_cvt_pk_bf16_f32 v241, v242, v243
  v_cvt_pk_bf16_f32 v242, v248, v249
  v_cvt_pk_bf16_f32 v243, v250, v251
  v_cvt_pk_bf16_f32 v244, v244, v245
  v_cvt_pk_bf16_f32 v245, v246, v247
  v_cvt_pk_bf16_f32 v246, v252, v253
  v_cvt_pk_bf16_f32 v247, v254, v255
  global_store_dwordx4 v7, v[240:243], s[30:31] offset:2048 sc1
  global_store_dwordx4 v7, v[244:247], s[30:31] offset:2560 sc1
  v_cvt_pk_bf16_f32 v64, v64, v65
  v_cvt_pk_bf16_f32 v65, v66, v67
  v_cvt_pk_bf16_f32 v66, v68, v69
  v_cvt_pk_bf16_f32 v67, v70, v71
  v_cvt_pk_bf16_f32 v68, v72, v73
  v_cvt_pk_bf16_f32 v69, v74, v75
  v_cvt_pk_bf16_f32 v70, v76, v77
  v_cvt_pk_bf16_f32 v71, v78, v79
  v_mfma_f32_32x32x16_bf16 v[32:47], v[128:131], v[64:67], 0
  s_nop 0
  v_mfma_f32_32x32x16_bf16 v[32:47], v[132:135], v[68:71], v[32:47]
  v_cvt_pk_bf16_f32 v80, v80, v81
  v_cvt_pk_bf16_f32 v81, v82, v83
  v_cvt_pk_bf16_f32 v82, v84, v85
  v_cvt_pk_bf16_f32 v83, v86, v87
  v_cvt_pk_bf16_f32 v84, v88, v89
  v_cvt_pk_bf16_f32 v85, v90, v91
  v_cvt_pk_bf16_f32 v86, v92, v93
  v_cvt_pk_bf16_f32 v87, v94, v95
  v_mfma_f32_32x32x16_bf16 v[32:47], v[144:147], v[80:83], v[32:47]
  s_nop 0
  v_mfma_f32_32x32x16_bf16 v[32:47], v[148:151], v[84:87], v[32:47]
  v_cvt_pk_bf16_f32 v96, v96, v97
  v_cvt_pk_bf16_f32 v97, v98, v99
  v_cvt_pk_bf16_f32 v98, v100, v101
  v_cvt_pk_bf16_f32 v99, v102, v103
  v_cvt_pk_bf16_f32 v100, v104, v105
  v_cvt_pk_bf16_f32 v101, v106, v107
  v_cvt_pk_bf16_f32 v102, v108, v109
  v_cvt_pk_bf16_f32 v103, v110, v111
  v_mfma_f32_32x32x16_bf16 v[32:47], v[160:163], v[96:99], v[32:47]
  s_nop 0
  v_mfma_f32_32x32x16_bf16 v[32:47], v[164:167], v[100:103], v[32:47]
  v_cvt_pk_bf16_f32 v112, v112, v113
  v_cvt_pk_bf16_f32 v113, v114, v115
  v_cvt_pk_bf16_f32 v114, v116, v117
  v_cvt_pk_bf16_f32 v115, v118, v119
  v_cvt_pk_bf16_f32 v116, v120, v121
  v_cvt_pk_bf16_f32 v117, v122, v123
  v_cvt_pk_bf16_f32 v118, v124, v125
  v_cvt_pk_bf16_f32 v119, v126, v127
  v_mfma_f32_32x32x16_bf16 v[32:47], v[176:179], v[112:115], v[32:47]
  s_nop 0
  v_mfma_f32_32x32x16_bf16 v[32:47], v[180:183], v[116:119], v[32:47]
  s_waitcnt vmcnt(0)
  s_barrier
  s_cmp_eq_u32 s21, 0
  s_cbranch_scc0 Lp1n_6
  s_cmp_eq_u32 s23, 0
  s_cbranch_scc0 L_p1_fl
  s_mov_b32 s27, 0
L_p1_iw:
  global_load_dword v60, v15, s[18:19] offset:68 sc1
  s_add_u32 s27, s27, 1
  s_cmp_gt_u32 s27, 0x400000
  s_cbranch_scc1 L_end
  s_waitcnt vmcnt(0)
  v_readfirstlane_b32 s54, v60
  s_nop 0
  s_cmp_ge_u32 s54, 96
  s_cbranch_scc0 L_p1_iw
L_p1_fl:
  s_lshl_b32 s54, s22, 5
  s_add_u32 s54, s54, s20
  s_lshl_b32 s54, s54, 7
  s_add_u32 s54, s54, 78643200
  v_mov_b32 v60, s54
  v_mov_b32 v61, 1
  global_store_dword v60, v61, s[16:17] sc1
Lp1n_6:
  s_add_u32 s57, s23, 12
  global_store_dwordx4 v12, v[64:67], s[32:33] offset:-4096 sc1
  global_store_dwordx4 v12, v[68:71], s[32:33] offset:-3072 sc1
  global_store_dwordx4 v12, v[80:83], s[32:33] offset:-2048 sc1
  global_store_dwordx4 v12, v[84:87], s[32:33] offset:-1024 sc1
  global_store_dwordx4 v12, v[96:99], s[32:33] offset:0 sc1
  global_store_dwordx4 v12, v[100:103], s[32:33] offset:1024 sc1
  global_store_dwordx4 v12, v[112:115], s[32:33] offset:2048 sc1
  global_store_dwordx4 v12, v[116:119], s[32:33] offset:3072 sc1
  v_mov_b32 v56, 0xf149f2ca
  v_cmp_le_i32 vcc, 0, v13
  s_nop 1
  v_cndmask_b32 v32, v56, v32, vcc
  v_cmp_le_i32 vcc, 1, v13
  s_nop 1
  v_cndmask_b32 v33, v56, v33, vcc
  v_cmp_le_i32 vcc, 2, v13
  s_nop 1
  v_cndmask_b32 v34, v56, v34, vcc
  v_cmp_le_i32 vcc, 3, v13
  s_nop 1
  v_cndmask_b32 v35, v56, v35, vcc
  v_cmp_le_i32 vcc, 8, v13
  s_nop 1
  v_cndmask_b32 v36, v56, v36, vcc
  v_cmp_le_i32 vcc, 9, v13
  s_nop 1
  v_cndmask_b32 v37, v56, v37, vcc
  v_cmp_le_i32 vcc, 10, v13
  s_nop 1
  v_cndmask_b32 v38, v56, v38, vcc
  v_cmp_le_i32 vcc, 11, v13
  s_nop 1
  v_cndmask_b32 v39, v56, v39, vcc
  v_cmp_le_i32 vcc, 16, v13
  s_nop 1
  v_cndmask_b32 v40, v56, v40, vcc
  v_cmp_le_i32 vcc, 17, v13
  s_nop 1
  v_cndmask_b32 v41, v56, v41, vcc
  v_cmp_le_i32 vcc, 18, v13
  s_nop 1
  v_cndmask_b32 v42, v56, v42, vcc
  v_cmp_le_i32 vcc, 19, v13
  s_nop 1
  v_cndmask_b32 v43, v56, v43, vcc
  v_cmp_le_i32 vcc, 24, v13
  s_nop 1
  v_cndmask_b32 v44, v56, v44, vcc
  v_cmp_le_i32 vcc, 25, v13
  s_nop 1
  v_cndmask_b32 v45, v56, v45, vcc
  v_cmp_le_i32 vcc, 26, v13
  s_nop 1
  v_cndmask_b32 v46, v56, v46, vcc
  v_cmp_le_i32 vcc, 27, v13
  s_nop 1
  v_cndmask_b32 v47, v56, v47, vcc
  v_max3_f32 v57, v32, v33, v34
  v_max3_f32 v57, v57, v35, v36
  v_max3_f32 v57, v57, v37, v38
  v_max3_f32 v57, v57, v39, v40
  v_max3_f32 v57, v57, v41, v42
  v_max3_f32 v57, v57, v43, v44
  v_max3_f32 v57, v57, v45, v46
  v_max_f32 v57, v57, v47
  v_mov_b32 v58, v57
  s_nop 1
  v_permlane32_swap_b32 v57, v58
  v_max_f32 v57, v57, v58
  v_sub_f32 v32, v32, v57
  v_sub_f32 v33, v33, v57
  v_sub_f32 v34, v34, v57
  v_sub_f32 v35, v35, v57
  v_sub_f32 v36, v36, v57
  v_sub_f32 v37, v37, v57
  v_sub_f32 v38, v38, v57
  v_sub_f32 v39, v39, v57
  v_sub_f32 v40, v40, v57
  v_sub_f32 v41, v41, v57
  v_sub_f32 v42, v42, v57
  v_sub_f32 v43, v43, v57
  v_sub_f32 v44, v44, v57
  v_sub_f32 v45, v45, v57
  v_sub_f32 v46, v46, v57
  v_sub_f32 v47, v47, v57
  v_exp_f32 v32, v32
  v_exp_f32 v33, v33
  v_exp_f32 v34, v34
  v_exp_f32 v35, v35
  v_exp_f32 v36, v36
  v_exp_f32 v37, v37
  v_exp_f32 v38, v38
  v_exp_f32 v39, v39
  v_exp_f32 v40, v40
  v_exp_f32 v41, v41
  v_exp_f32 v42, v42
  v_exp_f32 v43, v43
  v_exp_f32 v44, v44
  v_exp_f32 v45, v45
  v_exp_f32 v46, v46
  v_exp_f32 v47, v47
  v_cvt_pk_bf16_f32 v48, v32, v33
  v_cvt_pk_bf16_f32 v49, v34, v35
  v_cvt_pk_bf16_f32 v50, v40, v41
  v_cvt_pk_bf16_f32 v51, v42, v43
  v_cvt_pk_bf16_f32 v52, v36, v37
  v_cvt_pk_bf16_f32 v53, v38, v39
  v_cvt_pk_bf16_f32 v54, v44, v45
  v_cvt_pk_bf16_f32 v55, v46, v47
  v_mfma_f32_32x32x16_bf16 v[64:79], v[192:195], v[48:51], 0
  s_nop 0
  v_mfma_f32_32x32x16_bf16 v[64:79], v[196:199], v[52:55], v[64:79]
  v_mfma_f32_32x32x16_bf16 v[80:95], v[208:211], v[48:51], 0
  v_mfma_f32_32x32x16_bf16 v[80:95], v[212:215], v[52:55], v[80:95]
  v_mfma_f32_32x32x16_bf16 v[96:111], v[224:227], v[48:51], 0
  v_mfma_f32_32x32x16_bf16 v[96:111], v[228:231], v[52:55], v[96:111]
  v_mfma_f32_32x32x16_bf16 v[112:127], v[240:243], v[48:51], 0
  v_mfma_f32_32x32x16_bf16 v[112:127], v[244:247], v[52:55], v[112:127]
  v_add_f32 v59, v32, v33
  v_add_f32 v59, v59, v34
  v_add_f32 v59, v59, v35
  v_add_f32 v59, v59, v36
  v_add_f32 v59, v59, v37
  v_add_f32 v59, v59, v38
  v_add_f32 v59, v59, v39
  v_add_f32 v59, v59, v40
  v_add_f32 v59, v59, v41
  v_add_f32 v59, v59, v42
  v_add_f32 v59, v59, v43
  v_add_f32 v59, v59, v44
  v_add_f32 v59, v59, v45
  v_add_f32 v59, v59, v46
  v_add_f32 v59, v59, v47
  v_mov_b32 v58, v59
  s_nop 1
  v_permlane32_swap_b32 v59, v58
  v_add_f32 v59, v59, v58
  v_log_f32 v58, v59
  v_rcp_f32 v59, v59
  v_add_f32 v58, v58, v57
  global_store_dword v14, v58, s[36:37] sc1
  v_mul_f32 v64, v64, v59
  v_mul_f32 v65, v65, v59
  v_mul_f32 v66, v66, v59
  v_mul_f32 v67, v67, v59
  v_mul_f32 v68, v68, v59
  v_mul_f32 v69, v69, v59
  v_mul_f32 v70, v70, v59
  v_mul_f32 v71, v71, v59
  v_mul_f32 v72, v72, v59
  v_mul_f32 v73, v73, v59
  v_mul_f32 v74, v74, v59
  v_mul_f32 v75, v75, v59
  v_mul_f32 v76, v76, v59
  v_mul_f32 v77, v77, v59
  v_mul_f32 v78, v78, v59
  v_mul_f32 v79, v79, v59
  v_cvt_pk_bf16_f32 v64, v64, v65
  v_cvt_pk_bf16_f32 v65, v66, v67
  v_cvt_pk_bf16_f32 v66, v68, v69
  v_cvt_pk_bf16_f32 v67, v70, v71
  v_cvt_pk_bf16_f32 v68, v72, v73
  v_cvt_pk_bf16_f32 v69, v74, v75
  v_cvt_pk_bf16_f32 v70, v76, v77
  v_cvt_pk_bf16_f32 v71, v78, v79
  global_store_dwordx4 v12, v[64:67], s[34:35] offset:-4096 sc1
  global_store_dwordx4 v12, v[68:71], s[34:35] offset:-3072 sc1
  v_mul_f32 v80, v80, v59
  v_mul_f32 v81, v81, v59
  v_mul_f32 v82, v82, v59
  v_mul_f32 v83, v83, v59
  v_mul_f32 v84, v84, v59
  v_mul_f32 v85, v85, v59
  v_mul_f32 v86, v86, v59
  v_mul_f32 v87, v87, v59
  v_mul_f32 v88, v88, v59
  v_mul_f32 v89, v89, v59
  v_mul_f32 v90, v90, v59
  v_mul_f32 v91, v91, v59
  v_mul_f32 v92, v92, v59
  v_mul_f32 v93, v93, v59
  v_mul_f32 v94, v94, v59
  v_mul_f32 v95, v95, v59
  v_cvt_pk_bf16_f32 v80, v80, v81
  v_cvt_pk_bf16_f32 v81, v82, v83
  v_cvt_pk_bf16_f32 v82, v84, v85
  v_cvt_pk_bf16_f32 v83, v86, v87
  v_cvt_pk_bf16_f32 v84, v88, v89
  v_cvt_pk_bf16_f32 v85, v90, v91
  v_cvt_pk_bf16_f32 v86, v92, v93
  v_cvt_pk_bf16_f32 v87, v94, v95
  global_store_dwordx4 v12, v[80:83], s[34:35] offset:-2048 sc1
  global_store_dwordx4 v12, v[84:87], s[34:35] offset:-1024 sc1
  v_mul_f32 v96, v96, v59
  v_mul_f32 v97, v97, v59
  v_mul_f32 v98, v98, v59
  v_mul_f32 v99, v99, v59
  v_mul_f32 v100, v100, v59
  v_mul_f32 v101, v101, v59
  v_mul_f32 v102, v102, v59
  v_mul_f32 v103, v103, v59
  v_mul_f32 v104, v104, v59
  v_mul_f32 v105, v105, v59
  v_mul_f32 v106, v106, v59
  v_mul_f32 v107, v107, v59
  v_mul_f32 v108, v108, v59
  v_mul_f32 v109, v109, v59
  v_mul_f32 v110, v110, v59
  v_mul_f32 v111, v111, v59
  v_cvt_pk_bf16_f32 v96, v96, v97
  v_cvt_pk_bf16_f32 v97, v98, v99
  v_cvt_pk_bf16_f32 v98, v100, v101
  v_cvt_pk_bf16_f32 v99, v102, v103
  v_cvt_pk_bf16_f32 v100, v104, v105
  v_cvt_pk_bf16_f32 v101, v106, v107
  v_cvt_pk_bf16_f32 v102, v108, v109
  v_cvt_pk_bf16_f32 v103, v110, v111
  global_store_dwordx4 v12, v[96:99], s[34:35] offset:0 sc1
  global_store_dwordx4 v12, v[100:103], s[34:35] offset:1024 sc1
  v_mul_f32 v112, v112, v59
  v_mul_f32 v113, v113, v59
  v_mul_f32 v114, v114, v59
  v_mul_f32 v115, v115, v59
  v_mul_f32 v116, v116, v59
  v_mul_f32 v117, v117, v59
  v_mul_f32 v118, v118, v59
  v_mul_f32 v119, v119, v59
  v_mul_f32 v120, v120, v59
  v_mul_f32 v121, v121, v59
  v_mul_f32 v122, v122, v59
  v_mul_f32 v123, v123, v59
  v_mul_f32 v124, v124, v59
  v_mul_f32 v125, v125, v59
  v_mul_f32 v126, v126, v59
  v_mul_f32 v127, v127, v59
  v_cvt_pk_bf16_f32 v112, v112, v113
  v_cvt_pk_bf16_f32 v113, v114, v115
  v_cvt_pk_bf16_f32 v114, v116, v117
  v_cvt_pk_bf16_f32 v115, v118, v119
  v_cvt_pk_bf16_f32 v116, v120, v121
  v_cvt_pk_bf16_f32 v117, v122, v123
  v_cvt_pk_bf16_f32 v118, v124, v125
  v_cvt_pk_bf16_f32 v119, v126, v127
  global_store_dwordx4 v12, v[112:115], s[34:35] offset:2048 sc1
  global_store_dwordx4 v12, v[116:119], s[34:35] offset:3072 sc1
  s_waitcnt vmcnt(0)
  s_barrier
  s_cmp_eq_u32 s21, 0
  s_cbranch_scc0 Lp1n_7
  s_lshl_b32 s54, s22, 5
  s_add_u32 s54, s54, s20
  s_lshl_b32 s54, s54, 7
  s_add_u32 s54, s54, 78708736
  v_mov_b32 v60, s54
  v_mov_b32 v61, 1
  global_store_dword v60, v61, s[16:17] sc1
Lp1n_7:
L_p1_next:
  s_add_u32 s57, s23, 4
  s_add_u32 s22, s22, 4
  s_add_u32 s23, s23, 1
  s_cmp_lt_u32 s23, 4
  s_cbranch_scc1 L_p1_task
  s_branch L_end
L_role_p2:
  s_sub_u32 s22, s3, 5
  s_mov_b32 s25, s55
  s_load_dwordx2 s[30:31], s[0:1], 104
  s_load_dwordx4 s[32:35], s[0:1], 64
  s_load_dwordx4 s[36:39], s[0:1], 80
  s_load_dwordx2 s[40:41], s[0:1], 96
  v_lshrrev_b32 v4, 6, v0
  v_and_b32 v1, 63, v0
  v_lshlrev_b32 v2, 4, v1
  v_mov_b32 v3, 0
  v_readfirstlane_b32 s21, v4
  s_lshr_b32 s23, s25, 2
  s_and_b32 s24, s25, 3
  s_mov_b32 s26, 0x3e0293ee
  s_getpc_b64 s[62:63]
  s_add_u32 s62, s62, L_tables@rel32@lo+4
  s_addc_u32 s63, s63, L_tables@rel32@hi+12
  s_lshl_b32 s57, s22, 5
  s_add_u32 s57, s57, s25
  v_lshlrev_b32 v8, 4, v0
  v_mov_b32 v12, 0
  v_mov_b32 v13, 0
  v_mov_b32 v14, 0
  v_mov_b32 v15, 0
  v_mov_b32 v16, -1
  v_mov_b32 v17, -1
  v_mov_b32 v18, -1
  v_mov_b32 v19, -1
  s_mov_b32 s54, s57
Lin_8:
  s_cmp_ge_u32 s54, 40
  s_cbranch_scc1 Lin_9
  s_lshl_b32 s55, s54, 12
  s_add_u32 s55, s55, 78643200
  s_add_u32 s64, s16, s55
  s_addc_u32 s65, s17, 0
  global_store_dwordx4 v8, v[12:15], s[64:65] sc1
  s_add_u32 s54, s54, 96
  s_branch Lin_8
Lin_9:
  s_mov_b32 s54, s57
Lin_10:
  s_cmp_ge_u32 s54, 768
  s_cbranch_scc1 Lin_11
  s_lshl_b32 s55, s54, 12
  s_add_u32 s55, s55, 80740352
  s_add_u32 s64, s16, s55
  s_addc_u32 s65, s17, 0
  global_store_dwordx4 v8, v[12:15], s[64:65] sc1
  s_add_u32 s54, s54, 96
  s_branch Lin_10
Lin_11:
  s_waitcnt vmcnt(0)
  s_barrier
  v_cmp_eq_u32 vcc, 0, v0
  s_nop 0
  s_and_saveexec_b64 s[64:65], vcc
  s_cbranch_execz Lin_12
  v_mov_b32 v16, 1
  global_atomic_add v12, v16, s[18:19] offset:68
Lin_12:
  s_mov_b64 exec, -1
  s_waitcnt lgkmcnt(0)
  s_cmp_eq_u32 s22, 2
  s_cbranch_scc1 L_p2_moe
  s_lshl_b32 s57, s22, 5
  s_add_u32 s57, s57, s25
  s_lshl_b32 s54, s57, 15
  s_lshl_b32 s55, s21, 13
  s_add_u32 s54, s54, s55
  s_add_u32 s54, s54, 4096
  s_add_u32 s74, s4, s54
  s_addc_u32 s75, s5, 0
  global_load_dwordx4 v[8:11], v2, s[32:33]
  global_load_dwordx4 v[12:15], v2, s[40:41]
  global_load_dwordx4 v[64:67], v2, s[74:75] offset:-4096
  global_load_dwordx4 v[68:71], v2, s[74:75] offset:-3072
  global_load_dwordx4 v[72:75], v2, s[74:75] offset:-2048
  global_load_dwordx4 v[76:79], v2, s[74:75] offset:-1024
  global_load_dwordx4 v[80:83], v2, s[74:75] offset:0
  global_load_dwordx4 v[84:87], v2, s[74:75] offset:1024
  global_load_dwordx4 v[88:91], v2, s[74:75] offset:2048
  global_load_dwordx4 v[92:95], v2, s[74:75] offset:3072
  s_waitcnt vmcnt(8)
  v_lshlrev_b32 v16, 16, v8
  v_and_b32 v17, 0xffff0000, v8
  v_lshlrev_b32 v24, 16, v12
  v_and_b32 v25, 0xffff0000, v12
  v_lshlrev_b32 v18, 16, v9
  v_and_b32 v19, 0xffff0000, v9
  v_lshlrev_b32 v26, 16, v13
  v_and_b32 v27, 0xffff0000, v13
  v_lshlrev_b32 v20, 16, v10
  v_and_b32 v21, 0xffff0000, v10
  v_lshlrev_b32 v28, 16, v14
  v_and_b32 v29, 0xffff0000, v14
  v_lshlrev_b32 v22, 16, v11
  v_and_b32 v23, 0xffff0000, v11
  v_lshlrev_b32 v30, 16, v15
  v_and_b32 v31, 0xffff0000, v15
  s_waitcnt vmcnt(7)
  v_lshlrev_b32 v32, 16, v64
  v_and_b32 v33, 0xffff0000, v64
  v_lshlrev_b32 v34, 16, v65
  v_and_b32 v35, 0xffff0000, v65
  v_lshlrev_b32 v36, 16, v66
  v_and_b32 v37, 0xffff0000, v66
  v_lshlrev_b32 v38, 16, v67
  v_and_b32 v39, 0xffff0000, v67
  v_mul_f32 v40, v32, v16
  v_fmac_f32 v40, v33, v17
  v_fmac_f32 v40, v34, v18
  v_fmac_f32 v40, v35, v19
  v_fmac_f32 v40, v36, v20
  v_fmac_f32 v40, v37, v21
  v_fmac_f32 v40, v38, v22
  v_fmac_f32 v40, v39, v23
  v_mul_f32 v32, v32, v24
  v_mul_f32 v33, v33, v25
  v_mul_f32 v34, v34, v26
  v_mul_f32 v35, v35, v27
  v_mul_f32 v36, v36, v28
  v_mul_f32 v37, v37, v29
  v_mul_f32 v38, v38, v30
  v_mul_f32 v39, v39, v31
  v_cvt_pk_bf16_f32 v32, v32, v33
  v_cvt_pk_bf16_f32 v33, v34, v35
  v_cvt_pk_bf16_f32 v34, v36, v37
  v_cvt_pk_bf16_f32 v35, v38, v39
  v_mov_b32 v42, 0x3f803f80
  v_dot2_f32_bf16 v41, v32, v42, 0
  v_dot2_f32_bf16 v41, v33, v42, v41
  v_dot2_f32_bf16 v41, v34, v42, v41
  v_dot2_f32_bf16 v41, v35, v42, v41
  v_add_f32_dpp v43, v40, v40 quad_perm:[1,0,3,2] row_mask:0xf bank_mask:0xf
  v_mov_b32 v40, v43
  s_nop 1
  v_add_f32_dpp v43, v40, v40 quad_perm:[2,3,0,1] row_mask:0xf bank_mask:0xf
  v_mov_b32 v40, v43
  s_nop 1
  v_add_f32_dpp v43, v40, v40 row_ror:4 row_mask:0xf bank_mask:0xf
  v_mov_b32 v40, v43
  s_nop 1
  v_add_f32_dpp v43, v40, v40 row_ror:8 row_mask:0xf bank_mask:0xf
  v_mov_b32 v40, v43
  v_mov_b32 v43, v40
  s_nop 1
  v_permlane16_swap_b32 v40, v43
  v_add_f32 v40, v40, v43
  v_mov_b32 v43, v40
  s_nop 1
  v_permlane32_swap_b32 v40, v43
  v_add_f32 v40, v40, v43
  s_nop 0
  v_add_f32_dpp v43, v41, v41 quad_perm:[1,0,3,2] row_mask:0xf bank_mask:0xf
  v_mov_b32 v41, v43
  s_nop 1
  v_add_f32_dpp v43, v41, v41 quad_perm:[2,3,0,1] row_mask:0xf bank_mask:0xf
  v_mov_b32 v41, v43
  s_nop 1
  v_add_f32_dpp v43, v41, v41 row_ror:4 row_mask:0xf bank_mask:0xf
  v_mov_b32 v41, v43
  s_nop 1
  v_add_f32_dpp v43, v41, v41 row_ror:8 row_mask:0xf bank_mask:0xf
  v_mov_b32 v41, v43
  v_mov_b32 v43, v41
  s_nop 1
  v_permlane16_swap_b32 v41, v43
  v_add_f32 v41, v41, v43
  v_mov_b32 v43, v41
  s_nop 1
  v_permlane32_swap_b32 v41, v43
  v_add_f32 v41, v41, v43
  v_cmp_eq_u32 vcc, 0, v1
  s_nop 1
  v_cndmask_b32 v48, v48, v40, vcc
  v_cndmask_b32 v49, v49, v41, vcc
  s_waitcnt vmcnt(6)
  v_lshlrev_b32 v32, 16, v68
  v_and_b32 v33, 0xffff0000, v68
  v_lshlrev_b32 v34, 16, v69
  v_and_b32 v35, 0xffff0000, v69
  v_lshlrev_b32 v36, 16, v70
  v_and_b32 v37, 0xffff0000, v70
  v_lshlrev_b32 v38, 16, v71
  v_and_b32 v39, 0xffff0000, v71
  v_mul_f32 v40, v32, v16
  v_fmac_f32 v40, v33, v17
  v_fmac_f32 v40, v34, v18
  v_fmac_f32 v40, v35, v19
  v_fmac_f32 v40, v36, v20
  v_fmac_f32 v40, v37, v21
  v_fmac_f32 v40, v38, v22
  v_fmac_f32 v40, v39, v23
  v_mul_f32 v32, v32, v24
  v_mul_f32 v33, v33, v25
  v_mul_f32 v34, v34, v26
  v_mul_f32 v35, v35, v27
  v_mul_f32 v36, v36, v28
  v_mul_f32 v37, v37, v29
  v_mul_f32 v38, v38, v30
  v_mul_f32 v39, v39, v31
  v_cvt_pk_bf16_f32 v32, v32, v33
  v_cvt_pk_bf16_f32 v33, v34, v35
  v_cvt_pk_bf16_f32 v34, v36, v37
  v_cvt_pk_bf16_f32 v35, v38, v39
  v_mov_b32 v42, 0x3f803f80
  v_dot2_f32_bf16 v41, v32, v42, 0
  v_dot2_f32_bf16 v41, v33, v42, v41
  v_dot2_f32_bf16 v41, v34, v42, v41
  v_dot2_f32_bf16 v41, v35, v42, v41
  v_add_f32_dpp v43, v40, v40 quad_perm:[1,0,3,2] row_mask:0xf bank_mask:0xf
  v_mov_b32 v40, v43
  s_nop 1
  v_add_f32_dpp v43, v40, v40 quad_perm:[2,3,0,1] row_mask:0xf bank_mask:0xf
  v_mov_b32 v40, v43
  s_nop 1
  v_add_f32_dpp v43, v40, v40 row_ror:4 row_mask:0xf bank_mask:0xf
  v_mov_b32 v40, v43
  s_nop 1
  v_add_f32_dpp v43, v40, v40 row_ror:8 row_mask:0xf bank_mask:0xf
  v_mov_b32 v40, v43
  v_mov_b32 v43, v40
  s_nop 1
  v_permlane16_swap_b32 v40, v43
  v_add_f32 v40, v40, v43
  v_mov_b32 v43, v40
  s_nop 1
  v_permlane32_swap_b32 v40, v43
  v_add_f32 v40, v40, v43
  s_nop 0
  v_add_f32_dpp v43, v41, v41 quad_perm:[1,0,3,2] row_mask:0xf bank_mask:0xf
  v_mov_b32 v41, v43
  s_nop 1
  v_add_f32_dpp v43, v41, v41 quad_perm:[2,3,0,1] row_mask:0xf bank_mask:0xf
  v_mov_b32 v41, v43
  s_nop 1
  v_add_f32_dpp v43, v41, v41 row_ror:4 row_mask:0xf bank_mask:0xf
  v_mov_b32 v41, v43
  s_nop 1
  v_add_f32_dpp v43, v41, v41 row_ror:8 row_mask:0xf bank_mask:0xf
  v_mov_b32 v41, v43
  v_mov_b32 v43, v41
  s_nop 1
  v_permlane16_swap_b32 v41, v43
  v_add_f32 v41, v41, v43
  v_mov_b32 v43, v41
  s_nop 1
  v_permlane32_swap_b32 v41, v43
  v_add_f32 v41, v41, v43
  v_cmp_eq_u32 vcc, 1, v1
  s_nop 1
  v_cndmask_b32 v48, v48, v40, vcc
  v_cndmask_b32 v49, v49, v41, vcc
  s_waitcnt vmcnt(5)
  v_lshlrev_b32 v32, 16, v72
  v_and_b32 v33, 0xffff0000, v72
  v_lshlrev_b32 v34, 16, v73
  v_and_b32 v35, 0xffff0000, v73
  v_lshlrev_b32 v36, 16, v74
  v_and_b32 v37, 0xffff0000, v74
  v_lshlrev_b32 v38, 16, v75
  v_and_b32 v39, 0xffff0000, v75
  v_mul_f32 v40, v32, v16
  v_fmac_f32 v40, v33, v17
  v_fmac_f32 v40, v34, v18
  v_fmac_f32 v40, v35, v19
  v_fmac_f32 v40, v36, v20
  v_fmac_f32 v40, v37, v21
  v_fmac_f32 v40, v38, v22
  v_fmac_f32 v40, v39, v23
  v_mul_f32 v32, v32, v24
  v_mul_f32 v33, v33, v25
  v_mul_f32 v34, v34, v26
  v_mul_f32 v35, v35, v27
  v_mul_f32 v36, v36, v28
  v_mul_f32 v37, v37, v29
  v_mul_f32 v38, v38, v30
  v_mul_f32 v39, v39, v31
  v_cvt_pk_bf16_f32 v32, v32, v33
  v_cvt_pk_bf16_f32 v33, v34, v35
  v_cvt_pk_bf16_f32 v34, v36, v37
  v_cvt_pk_bf16_f32 v35, v38, v39
  v_mov_b32 v42, 0x3f803f80
  v_dot2_f32_bf16 v41, v32, v42, 0
  v_dot2_f32_bf16 v41, v33, v42, v41
  v_dot2_f32_bf16 v41, v34, v42, v41
  v_dot2_f32_bf16 v41, v35, v42, v41
  v_add_f32_dpp v43, v40, v40 quad_perm:[1,0,3,2] row_mask:0xf bank_mask:0xf
  v_mov_b32 v40, v43
  s_nop 1
  v_add_f32_dpp v43, v40, v40 quad_perm:[2,3,0,1] row_mask:0xf bank_mask:0xf
  v_mov_b32 v40, v43
  s_nop 1
  v_add_f32_dpp v43, v40, v40 row_ror:4 row_mask:0xf bank_mask:0xf
  v_mov_b32 v40, v43
  s_nop 1
  v_add_f32_dpp v43, v40, v40 row_ror:8 row_mask:0xf bank_mask:0xf
  v_mov_b32 v40, v43
  v_mov_b32 v43, v40
  s_nop 1
  v_permlane16_swap_b32 v40, v43
  v_add_f32 v40, v40, v43
  v_mov_b32 v43, v40
  s_nop 1
  v_permlane32_swap_b32 v40, v43
  v_add_f32 v40, v40, v43
  s_nop 0
  v_add_f32_dpp v43, v41, v41 quad_perm:[1,0,3,2] row_mask:0xf bank_mask:0xf
  v_mov_b32 v41, v43
  s_nop 1
  v_add_f32_dpp v43, v41, v41 quad_perm:[2,3,0,1] row_mask:0xf bank_mask:0xf
  v_mov_b32 v41, v43
  s_nop 1
  v_add_f32_dpp v43, v41, v41 row_ror:4 row_mask:0xf bank_mask:0xf
  v_mov_b32 v41, v43
  s_nop 1
  v_add_f32_dpp v43, v41, v41 row_ror:8 row_mask:0xf bank_mask:0xf
  v_mov_b32 v41, v43
  v_mov_b32 v43, v41
  s_nop 1
  v_permlane16_swap_b32 v41, v43
  v_add_f32 v41, v41, v43
  v_mov_b32 v43, v41
  s_nop 1
  v_permlane32_swap_b32 v41, v43
  v_add_f32 v41, v41, v43
  v_cmp_eq_u32 vcc, 2, v1
  s_nop 1
  v_cndmask_b32 v48, v48, v40, vcc
  v_cndmask_b32 v49, v49, v41, vcc
  s_waitcnt vmcnt(4)
  v_lshlrev_b32 v32, 16, v76
  v_and_b32 v33, 0xffff0000, v76
  v_lshlrev_b32 v34, 16, v77
  v_and_b32 v35, 0xffff0000, v77
  v_lshlrev_b32 v36, 16, v78
  v_and_b32 v37, 0xffff0000, v78
  v_lshlrev_b32 v38, 16, v79
  v_and_b32 v39, 0xffff0000, v79
  v_mul_f32 v40, v32, v16
  v_fmac_f32 v40, v33, v17
  v_fmac_f32 v40, v34, v18
  v_fmac_f32 v40, v35, v19
  v_fmac_f32 v40, v36, v20
  v_fmac_f32 v40, v37, v21
  v_fmac_f32 v40, v38, v22
  v_fmac_f32 v40, v39, v23
  v_mul_f32 v32, v32, v24
  v_mul_f32 v33, v33, v25
  v_mul_f32 v34, v34, v26
  v_mul_f32 v35, v35, v27
  v_mul_f32 v36, v36, v28
  v_mul_f32 v37, v37, v29
  v_mul_f32 v38, v38, v30
  v_mul_f32 v39, v39, v31
  v_cvt_pk_bf16_f32 v32, v32, v33
  v_cvt_pk_bf16_f32 v33, v34, v35
  v_cvt_pk_bf16_f32 v34, v36, v37
  v_cvt_pk_bf16_f32 v35, v38, v39
  v_mov_b32 v42, 0x3f803f80
  v_dot2_f32_bf16 v41, v32, v42, 0
  v_dot2_f32_bf16 v41, v33, v42, v41
  v_dot2_f32_bf16 v41, v34, v42, v41
  v_dot2_f32_bf16 v41, v35, v42, v41
  v_add_f32_dpp v43, v40, v40 quad_perm:[1,0,3,2] row_mask:0xf bank_mask:0xf
  v_mov_b32 v40, v43
  s_nop 1
  v_add_f32_dpp v43, v40, v40 quad_perm:[2,3,0,1] row_mask:0xf bank_mask:0xf
  v_mov_b32 v40, v43
  s_nop 1
  v_add_f32_dpp v43, v40, v40 row_ror:4 row_mask:0xf bank_mask:0xf
  v_mov_b32 v40, v43
  s_nop 1
  v_add_f32_dpp v43, v40, v40 row_ror:8 row_mask:0xf bank_mask:0xf
  v_mov_b32 v40, v43
  v_mov_b32 v43, v40
  s_nop 1
  v_permlane16_swap_b32 v40, v43
  v_add_f32 v40, v40, v43
  v_mov_b32 v43, v40
  s_nop 1
  v_permlane32_swap_b32 v40, v43
  v_add_f32 v40, v40, v43
  s_nop 0
  v_add_f32_dpp v43, v41, v41 quad_perm:[1,0,3,2] row_mask:0xf bank_mask:0xf
  v_mov_b32 v41, v43
  s_nop 1
  v_add_f32_dpp v43, v41, v41 quad_perm:[2,3,0,1] row_mask:0xf bank_mask:0xf
  v_mov_b32 v41, v43
  s_nop 1
  v_add_f32_dpp v43, v41, v41 row_ror:4 row_mask:0xf bank_mask:0xf
  v_mov_b32 v41, v43
  s_nop 1
  v_add_f32_dpp v43, v41, v41 row_ror:8 row_mask:0xf bank_mask:0xf
  v_mov_b32 v41, v43
  v_mov_b32 v43, v41
  s_nop 1
  v_permlane16_swap_b32 v41, v43
  v_add_f32 v41, v41, v43
  v_mov_b32 v43, v41
  s_nop 1
  v_permlane32_swap_b32 v41, v43
  v_add_f32 v41, v41, v43
  v_cmp_eq_u32 vcc, 3, v1
  s_nop 1
  v_cndmask_b32 v48, v48, v40, vcc
  v_cndmask_b32 v49, v49, v41, vcc
  s_waitcnt vmcnt(3)
  v_lshlrev_b32 v32, 16, v80
  v_and_b32 v33, 0xffff0000, v80
  v_lshlrev_b32 v34, 16, v81
  v_and_b32 v35, 0xffff0000, v81
  v_lshlrev_b32 v36, 16, v82
  v_and_b32 v37, 0xffff0000, v82
  v_lshlrev_b32 v38, 16, v83
  v_and_b32 v39, 0xffff0000, v83
  v_mul_f32 v40, v32, v16
  v_fmac_f32 v40, v33, v17
  v_fmac_f32 v40, v34, v18
  v_fmac_f32 v40, v35, v19
  v_fmac_f32 v40, v36, v20
  v_fmac_f32 v40, v37, v21
  v_fmac_f32 v40, v38, v22
  v_fmac_f32 v40, v39, v23
  v_mul_f32 v32, v32, v24
  v_mul_f32 v33, v33, v25
  v_mul_f32 v34, v34, v26
  v_mul_f32 v35, v35, v27
  v_mul_f32 v36, v36, v28
  v_mul_f32 v37, v37, v29
  v_mul_f32 v38, v38, v30
  v_mul_f32 v39, v39, v31
  v_cvt_pk_bf16_f32 v32, v32, v33
  v_cvt_pk_bf16_f32 v33, v34, v35
  v_cvt_pk_bf16_f32 v34, v36, v37
  v_cvt_pk_bf16_f32 v35, v38, v39
  v_mov_b32 v42, 0x3f803f80
  v_dot2_f32_bf16 v41, v32, v42, 0
  v_dot2_f32_bf16 v41, v33, v42, v41
  v_dot2_f32_bf16 v41, v34, v42, v41
  v_dot2_f32_bf16 v41, v35, v42, v41
  v_add_f32_dpp v43, v40, v40 quad_perm:[1,0,3,2] row_mask:0xf bank_mask:0xf
  v_mov_b32 v40, v43
  s_nop 1
  v_add_f32_dpp v43, v40, v40 quad_perm:[2,3,0,1] row_mask:0xf bank_mask:0xf
  v_mov_b32 v40, v43
  s_nop 1
  v_add_f32_dpp v43, v40, v40 row_ror:4 row_mask:0xf bank_mask:0xf
  v_mov_b32 v40, v43
  s_nop 1
  v_add_f32_dpp v43, v40, v40 row_ror:8 row_mask:0xf bank_mask:0xf
  v_mov_b32 v40, v43
  v_mov_b32 v43, v40
  s_nop 1
  v_permlane16_swap_b32 v40, v43
  v_add_f32 v40, v40, v43
  v_mov_b32 v43, v40
  s_nop 1
  v_permlane32_swap_b32 v40, v43
  v_add_f32 v40, v40, v43
  s_nop 0
  v_add_f32_dpp v43, v41, v41 quad_perm:[1,0,3,2] row_mask:0xf bank_mask:0xf
  v_mov_b32 v41, v43
  s_nop 1
  v_add_f32_dpp v43, v41, v41 quad_perm:[2,3,0,1] row_mask:0xf bank_mask:0xf
  v_mov_b32 v41, v43
  s_nop 1
  v_add_f32_dpp v43, v41, v41 row_ror:4 row_mask:0xf bank_mask:0xf
  v_mov_b32 v41, v43
  s_nop 1
  v_add_f32_dpp v43, v41, v41 row_ror:8 row_mask:0xf bank_mask:0xf
  v_mov_b32 v41, v43
  v_mov_b32 v43, v41
  s_nop 1
  v_permlane16_swap_b32 v41, v43
  v_add_f32 v41, v41, v43
  v_mov_b32 v43, v41
  s_nop 1
  v_permlane32_swap_b32 v41, v43
  v_add_f32 v41, v41, v43
  v_cmp_eq_u32 vcc, 4, v1
  s_nop 1
  v_cndmask_b32 v48, v48, v40, vcc
  v_cndmask_b32 v49, v49, v41, vcc
  s_waitcnt vmcnt(2)
  v_lshlrev_b32 v32, 16, v84
  v_and_b32 v33, 0xffff0000, v84
  v_lshlrev_b32 v34, 16, v85
  v_and_b32 v35, 0xffff0000, v85
  v_lshlrev_b32 v36, 16, v86
  v_and_b32 v37, 0xffff0000, v86
  v_lshlrev_b32 v38, 16, v87
  v_and_b32 v39, 0xffff0000, v87
  v_mul_f32 v40, v32, v16
  v_fmac_f32 v40, v33, v17
  v_fmac_f32 v40, v34, v18
  v_fmac_f32 v40, v35, v19
  v_fmac_f32 v40, v36, v20
  v_fmac_f32 v40, v37, v21
  v_fmac_f32 v40, v38, v22
  v_fmac_f32 v40, v39, v23
  v_mul_f32 v32, v32, v24
  v_mul_f32 v33, v33, v25
  v_mul_f32 v34, v34, v26
  v_mul_f32 v35, v35, v27
  v_mul_f32 v36, v36, v28
  v_mul_f32 v37, v37, v29
  v_mul_f32 v38, v38, v30
  v_mul_f32 v39, v39, v31
  v_cvt_pk_bf16_f32 v32, v32, v33
  v_cvt_pk_bf16_f32 v33, v34, v35
  v_cvt_pk_bf16_f32 v34, v36, v37
  v_cvt_pk_bf16_f32 v35, v38, v39
  v_mov_b32 v42, 0x3f803f80
  v_dot2_f32_bf16 v41, v32, v42, 0
  v_dot2_f32_bf16 v41, v33, v42, v41
  v_dot2_f32_bf16 v41, v34, v42, v41
  v_dot2_f32_bf16 v41, v35, v42, v41
  v_add_f32_dpp v43, v40, v40 quad_perm:[1,0,3,2] row_mask:0xf bank_mask:0xf
  v_mov_b32 v40, v43
  s_nop 1
  v_add_f32_dpp v43, v40, v40 quad_perm:[2,3,0,1] row_mask:0xf bank_mask:0xf
  v_mov_b32 v40, v43
  s_nop 1
  v_add_f32_dpp v43, v40, v40 row_ror:4 row_mask:0xf bank_mask:0xf
  v_mov_b32 v40, v43
  s_nop 1
  v_add_f32_dpp v43, v40, v40 row_ror:8 row_mask:0xf bank_mask:0xf
  v_mov_b32 v40, v43
  v_mov_b32 v43, v40
  s_nop 1
  v_permlane16_swap_b32 v40, v43
  v_add_f32 v40, v40, v43
  v_mov_b32 v43, v40
  s_nop 1
  v_permlane32_swap_b32 v40, v43
  v_add_f32 v40, v40, v43
  s_nop 0
  v_add_f32_dpp v43, v41, v41 quad_perm:[1,0,3,2] row_mask:0xf bank_mask:0xf
  v_mov_b32 v41, v43
  s_nop 1
  v_add_f32_dpp v43, v41, v41 quad_perm:[2,3,0,1] row_mask:0xf bank_mask:0xf
  v_mov_b32 v41, v43
  s_nop 1
  v_add_f32_dpp v43, v41, v41 row_ror:4 row_mask:0xf bank_mask:0xf
  v_mov_b32 v41, v43
  s_nop 1
  v_add_f32_dpp v43, v41, v41 row_ror:8 row_mask:0xf bank_mask:0xf
  v_mov_b32 v41, v43
  v_mov_b32 v43, v41
  s_nop 1
  v_permlane16_swap_b32 v41, v43
  v_add_f32 v41, v41, v43
  v_mov_b32 v43, v41
  s_nop 1
  v_permlane32_swap_b32 v41, v43
  v_add_f32 v41, v41, v43
  v_cmp_eq_u32 vcc, 5, v1
  s_nop 1
  v_cndmask_b32 v48, v48, v40, vcc
  v_cndmask_b32 v49, v49, v41, vcc
  s_waitcnt vmcnt(1)
  v_lshlrev_b32 v32, 16, v88
  v_and_b32 v33, 0xffff0000, v88
  v_lshlrev_b32 v34, 16, v89
  v_and_b32 v35, 0xffff0000, v89
  v_lshlrev_b32 v36, 16, v90
  v_and_b32 v37, 0xffff0000, v90
  v_lshlrev_b32 v38, 16, v91
  v_and_b32 v39, 0xffff0000, v91
  v_mul_f32 v40, v32, v16
  v_fmac_f32 v40, v33, v17
  v_fmac_f32 v40, v34, v18
  v_fmac_f32 v40, v35, v19
  v_fmac_f32 v40, v36, v20
  v_fmac_f32 v40, v37, v21
  v_fmac_f32 v40, v38, v22
  v_fmac_f32 v40, v39, v23
  v_mul_f32 v32, v32, v24
  v_mul_f32 v33, v33, v25
  v_mul_f32 v34, v34, v26
  v_mul_f32 v35, v35, v27
  v_mul_f32 v36, v36, v28
  v_mul_f32 v37, v37, v29
  v_mul_f32 v38, v38, v30
  v_mul_f32 v39, v39, v31
  v_cvt_pk_bf16_f32 v32, v32, v33
  v_cvt_pk_bf16_f32 v33, v34, v35
  v_cvt_pk_bf16_f32 v34, v36, v37
  v_cvt_pk_bf16_f32 v35, v38, v39
  v_mov_b32 v42, 0x3f803f80
  v_dot2_f32_bf16 v41, v32, v42, 0
  v_dot2_f32_bf16 v41, v33, v42, v41
  v_dot2_f32_bf16 v41, v34, v42, v41
  v_dot2_f32_bf16 v41, v35, v42, v41
  v_add_f32_dpp v43, v40, v40 quad_perm:[1,0,3,2] row_mask:0xf bank_mask:0xf
  v_mov_b32 v40, v43
  s_nop 1
  v_add_f32_dpp v43, v40, v40 quad_perm:[2,3,0,1] row_mask:0xf bank_mask:0xf
  v_mov_b32 v40, v43
  s_nop 1
  v_add_f32_dpp v43, v40, v40 row_ror:4 row_mask:0xf bank_mask:0xf
  v_mov_b32 v40, v43
  s_nop 1
  v_add_f32_dpp v43, v40, v40 row_ror:8 row_mask:0xf bank_mask:0xf
  v_mov_b32 v40, v43
  v_mov_b32 v43, v40
  s_nop 1
  v_permlane16_swap_b32 v40, v43
  v_add_f32 v40, v40, v43
  v_mov_b32 v43, v40
  s_nop 1
  v_permlane32_swap_b32 v40, v43
  v_add_f32 v40, v40, v43
  s_nop 0
  v_add_f32_dpp v43, v41, v41 quad_perm:[1,0,3,2] row_mask:0xf bank_mask:0xf
  v_mov_b32 v41, v43
  s_nop 1
  v_add_f32_dpp v43, v41, v41 quad_perm:[2,3,0,1] row_mask:0xf bank_mask:0xf
  v_mov_b32 v41, v43
  s_nop 1
  v_add_f32_dpp v43, v41, v41 row_ror:4 row_mask:0xf bank_mask:0xf
  v_mov_b32 v41, v43
  s_nop 1
  v_add_f32_dpp v43, v41, v41 row_ror:8 row_mask:0xf bank_mask:0xf
  v_mov_b32 v41, v43
  v_mov_b32 v43, v41
  s_nop 1
  v_permlane16_swap_b32 v41, v43
  v_add_f32 v41, v41, v43
  v_mov_b32 v43, v41
  s_nop 1
  v_permlane32_swap_b32 v41, v43
  v_add_f32 v41, v41, v43
  v_cmp_eq_u32 vcc, 6, v1
  s_nop 1
  v_cndmask_b32 v48, v48, v40, vcc
  v_cndmask_b32 v49, v49, v41, vcc
  s_waitcnt vmcnt(0)
  v_lshlrev_b32 v32, 16, v92
  v_and_b32 v33, 0xffff0000, v92
  v_lshlrev_b32 v34, 16, v93
  v_and_b32 v35, 0xffff0000, v93
  v_lshlrev_b32 v36, 16, v94
  v_and_b32 v37, 0xffff0000, v94
  v_lshlrev_b32 v38, 16, v95
  v_and_b32 v39, 0xffff0000, v95
  v_mul_f32 v40, v32, v16
  v_fmac_f32 v40, v33, v17
  v_fmac_f32 v40, v34, v18
  v_fmac_f32 v40, v35, v19
  v_fmac_f32 v40, v36, v20
  v_fmac_f32 v40, v37, v21
  v_fmac_f32 v40, v38, v22
  v_fmac_f32 v40, v39, v23
  v_mul_f32 v32, v32, v24
  v_mul_f32 v33, v33, v25
  v_mul_f32 v34, v34, v26
  v_mul_f32 v35, v35, v27
  v_mul_f32 v36, v36, v28
  v_mul_f32 v37, v37, v29
  v_mul_f32 v38, v38, v30
  v_mul_f32 v39, v39, v31
  v_cvt_pk_bf16_f32 v32, v32, v33
  v_cvt_pk_bf16_f32 v33, v34, v35
  v_cvt_pk_bf16_f32 v34, v36, v37
  v_cvt_pk_bf16_f32 v35, v38, v39
  v_mov_b32 v42, 0x3f803f80
  v_dot2_f32_bf16 v41, v32, v42, 0
  v_dot2_f32_bf16 v41, v33, v42, v41
  v_dot2_f32_bf16 v41, v34, v42, v41
  v_dot2_f32_bf16 v41, v35, v42, v41
  v_add_f32_dpp v43, v40, v40 quad_perm:[1,0,3,2] row_mask:0xf bank_mask:0xf
  v_mov_b32 v40, v43
  s_nop 1
  v_add_f32_dpp v43, v40, v40 quad_perm:[2,3,0,1] row_mask:0xf bank_mask:0xf
  v_mov_b32 v40, v43
  s_nop 1
  v_add_f32_dpp v43, v40, v40 row_ror:4 row_mask:0xf bank_mask:0xf
  v_mov_b32 v40, v43
  s_nop 1
  v_add_f32_dpp v43, v40, v40 row_ror:8 row_mask:0xf bank_mask:0xf
  v_mov_b32 v40, v43
  v_mov_b32 v43, v40
  s_nop 1
  v_permlane16_swap_b32 v40, v43
  v_add_f32 v40, v40, v43
  v_mov_b32 v43, v40
  s_nop 1
  v_permlane32_swap_b32 v40, v43
  v_add_f32 v40, v40, v43
  s_nop 0
  v_add_f32_dpp v43, v41, v41 quad_perm:[1,0,3,2] row_mask:0xf bank_mask:0xf
  v_mov_b32 v41, v43
  s_nop 1
  v_add_f32_dpp v43, v41, v41 quad_perm:[2,3,0,1] row_mask:0xf bank_mask:0xf
  v_mov_b32 v41, v43
  s_nop 1
  v_add_f32_dpp v43, v41, v41 row_ror:4 row_mask:0xf bank_mask:0xf
  v_mov_b32 v41, v43
  s_nop 1
  v_add_f32_dpp v43, v41, v41 row_ror:8 row_mask:0xf bank_mask:0xf
  v_mov_b32 v41, v43
  v_mov_b32 v43, v41
  s_nop 1
  v_permlane16_swap_b32 v41, v43
  v_add_f32 v41, v41, v43
  v_mov_b32 v43, v41
  s_nop 1
  v_permlane32_swap_b32 v41, v43
  v_add_f32 v41, v41, v43
  v_cmp_eq_u32 vcc, 7, v1
  s_nop 1
  v_cndmask_b32 v48, v48, v40, vcc
  v_cndmask_b32 v49, v49, v41, vcc
  v_cvt_pk_bf16_f32 v50, v48, v48
  v_and_b32 v50, 0xffff0000, v50
  v_ashrrev_i32 v51, 31, v50
  v_or_b32 v51, 0x80000000, v51
  v_xor_b32 v50, v50, v51
  v_and_b32 v50, 0xffff0000, v50
  s_lshl_b32 s54, s57, 5
  s_lshl_b32 s55, s21, 3
  s_add_u32 s54, s54, s55
  v_add_u32 v52, s54, v1
  v_sub_u32 v53, 0xffff, v52
  v_or_b32 v50, v50, v53
  v_cvt_pk_bf16_f32 v54, v49, v49
  v_and_b32 v54, 0xffff0000, v54
  v_mul_f32 v55, 0xbfb8aa3b, v54
  v_exp_f32 v55, v55
  s_nop 0
  v_add_f32 v55, 1.0, v55
  v_rcp_f32 v55, v55
  s_nop 0
  v_cvt_pk_bf16_f32 v54, v55, v55
  v_and_b32 v54, 0xffff0000, v54
  v_sub_f32 v55, 1.0, v54
  v_cvt_pk_bf16_f32 v55, v55, v55
  v_and_b32 v55, 0xffff0000, v55
  v_lshlrev_b32 v56, 2, v52
  v_add_u32 v56, 79691776, v56
  v_lshlrev_b32 v57, 3, v52
  v_add_u32 v57, 79699968, v57
  s_mov_b64 exec, 0xff
  global_store_dword v56, v50, s[16:17] sc1
  global_store_dwordx2 v57, v[54:55], s[16:17] sc1
  s_mov_b64 exec, -1
  s_mov_b32 s27, 0
  s_branch Lwc_14
Lwc_13:
  s_sleep 8
Lwc_14:
  global_load_dword v58, v3, s[18:19] offset:68 sc1
  s_add_u32 s27, s27, 1
  s_cmp_gt_u32 s27, 0x400000
  s_cbranch_scc1 L_end
  s_waitcnt vmcnt(0)
  v_readfirstlane_b32 s54, v58
  s_nop 0
  s_cmp_ge_u32 s54, 96
  s_cbranch_scc0 Lwc_13
  s_lshl_b32 s55, s57, 7
  s_add_u32 s55, s55, 78774272
  s_waitcnt vmcnt(0)
  s_barrier
  s_cmp_eq_u32 s21, 0
  s_cbranch_scc0 Lsf_15
  v_mov_b32 v58, s55
  v_mov_b32 v59, 1
  global_store_dword v58, v59, s[16:17] sc1
Lsf_15:
  s_branch L_p2_main
L_p2_moe:
  s_cmp_ge_u32 s25, 28
  s_cbranch_scc1 L_p2_m3
  v_lshlrev_b32 v4, 4, v0
  s_add_u32 s64, s62, 16384
  s_addc_u32 s65, s63, 0
  global_load_dwordx4 v[16:19], v4, s[64:65]
  s_add_u32 s64, s62, 20480
  s_addc_u32 s65, s63, 0
  global_load_dwordx4 v[20:23], v4, s[64:65]
  s_lshl_b32 s54, s25, 7
  s_add_u32 s74, s34, s54
  s_addc_u32 s75, s35, 0
  s_add_u32 s76, s36, s54
  s_addc_u32 s77, s37, 0
  s_lshl_b32 s56, s21, 14
  s_waitcnt vmcnt(0)
  s_add_u32 m0, s56, 0
  s_nop 0
  global_load_lds_dwordx4 v16, s[74:75]
  s_add_u32 s74, s74, 28672
  s_addc_u32 s75, s75, 0
  s_add_u32 m0, s56, 1024
  s_nop 0
  global_load_lds_dwordx4 v16, s[74:75]
  s_add_u32 s74, s74, 28672
  s_addc_u32 s75, s75, 0
  s_add_u32 m0, s56, 2048
  s_nop 0
  global_load_lds_dwordx4 v16, s[74:75]
  s_add_u32 s74, s74, 28672
  s_addc_u32 s75, s75, 0
  s_add_u32 m0, s56, 3072
  s_nop 0
  global_load_lds_dwordx4 v16, s[74:75]
  s_add_u32 s74, s74, 28672
  s_addc_u32 s75, s75, 0
  s_add_u32 m0, s56, 4096
  s_nop 0
  global_load_lds_dwordx4 v16, s[74:75]
  s_add_u32 s74, s74, 28672
  s_addc_u32 s75, s75, 0
  s_add_u32 m0, s56, 5120
  s_nop 0
  global_load_lds_dwordx4 v16, s[74:75]
  s_add_u32 s74, s74, 28672
  s_addc_u32 s75, s75, 0
  s_add_u32 m0, s56, 6144
  s_nop 0
  global_load_lds_dwordx4 v16, s[74:75]
  s_add_u32 s74, s74, 28672
  s_addc_u32 s75, s75, 0
  s_add_u32 m0, s56, 7168
  s_nop 0
  global_load_lds_dwordx4 v16, s[74:75]
  s_add_u32 s74, s74, 28672
  s_addc_u32 s75, s75, 0
  s_add_u32 m0, s56, 8192
  s_nop 0
  global_load_lds_dwordx4 v16, s[74:75]
  s_add_u32 s74, s74, 28672
  s_addc_u32 s75, s75, 0
  s_add_u32 m0, s56, 9216
  s_nop 0
  global_load_lds_dwordx4 v16, s[74:75]
  s_add_u32 s74, s74, 28672
  s_addc_u32 s75, s75, 0
  s_add_u32 m0, s56, 10240
  s_nop 0
  global_load_lds_dwordx4 v16, s[74:75]
  s_add_u32 s74, s74, 28672
  s_addc_u32 s75, s75, 0
  s_add_u32 m0, s56, 11264
  s_nop 0
  global_load_lds_dwordx4 v16, s[74:75]
  s_add_u32 s74, s74, 28672
  s_addc_u32 s75, s75, 0
  s_add_u32 m0, s56, 12288
  s_nop 0
  global_load_lds_dwordx4 v16, s[74:75]
  s_add_u32 s74, s74, 28672
  s_addc_u32 s75, s75, 0
  s_add_u32 m0, s56, 13312
  s_nop 0
  global_load_lds_dwordx4 v16, s[74:75]
  s_add_u32 s74, s74, 28672
  s_addc_u32 s75, s75, 0
  s_add_u32 m0, s56, 14336
  s_nop 0
  global_load_lds_dwordx4 v16, s[74:75]
  s_add_u32 s74, s74, 28672
  s_addc_u32 s75, s75, 0
  s_add_u32 m0, s56, 15360
  s_nop 0
  global_load_lds_dwordx4 v16, s[74:75]
  s_add_u32 s74, s74, 28672
  s_addc_u32 s75, s75, 0
  s_add_u32 m0, s56, 65536
  s_nop 0
  global_load_lds_dwordx4 v16, s[76:77]
  s_add_u32 s76, s76, 28672
  s_addc_u32 s77, s77, 0
  s_add_u32 m0, s56, 66560
  s_nop 0
  global_load_lds_dwordx4 v16, s[76:77]
  s_add_u32 s76, s76, 28672
  s_addc_u32 s77, s77, 0
  s_add_u32 m0, s56, 67584
  s_nop 0
  global_load_lds_dwordx4 v16, s[76:77]
  s_add_u32 s76, s76, 28672
  s_addc_u32 s77, s77, 0
  s_add_u32 m0, s56, 68608
  s_nop 0
  global_load_lds_dwordx4 v16, s[76:77]
  s_add_u32 s76, s76, 28672
  s_addc_u32 s77, s77, 0
  s_add_u32 m0, s56, 69632
  s_nop 0
  global_load_lds_dwordx4 v16, s[76:77]
  s_add_u32 s76, s76, 28672
  s_addc_u32 s77, s77, 0
  s_add_u32 m0, s56, 70656
  s_nop 0
  global_load_lds_dwordx4 v16, s[76:77]
  s_add_u32 s76, s76, 28672
  s_addc_u32 s77, s77, 0
  s_add_u32 m0, s56, 71680
  s_nop 0
  global_load_lds_dwordx4 v16, s[76:77]
  s_add_u32 s76, s76, 28672
  s_addc_u32 s77, s77, 0
  s_add_u32 m0, s56, 72704
  s_nop 0
  global_load_lds_dwordx4 v16, s[76:77]
  s_add_u32 s76, s76, 28672
  s_addc_u32 s77, s77, 0
  s_add_u32 m0, s56, 73728
  s_nop 0
  global_load_lds_dwordx4 v16, s[76:77]
  s_add_u32 s76, s76, 28672
  s_addc_u32 s77, s77, 0
  s_add_u32 m0, s56, 74752
  s_nop 0
  global_load_lds_dwordx4 v16, s[76:77]
  s_add_u32 s76, s76, 28672
  s_addc_u32 s77, s77, 0
  s_add_u32 m0, s56, 75776
  s_nop 0
  global_load_lds_dwordx4 v16, s[76:77]
  s_add_u32 s76, s76, 28672
  s_addc_u32 s77, s77, 0
  s_add_u32 m0, s56, 76800
  s_nop 0
  global_load_lds_dwordx4 v16, s[76:77]
  s_add_u32 s76, s76, 28672
  s_addc_u32 s77, s77, 0
  s_add_u32 m0, s56, 77824
  s_nop 0
  global_load_lds_dwordx4 v16, s[76:77]
  s_add_u32 s76, s76, 28672
  s_addc_u32 s77, s77, 0
  s_add_u32 m0, s56, 78848
  s_nop 0
  global_load_lds_dwordx4 v16, s[76:77]
  s_add_u32 s76, s76, 28672
  s_addc_u32 s77, s77, 0
  s_add_u32 m0, s56, 79872
  s_nop 0
  global_load_lds_dwordx4 v16, s[76:77]
  s_add_u32 s76, s76, 28672
  s_addc_u32 s77, s77, 0
  s_add_u32 m0, s56, 80896
  s_nop 0
  global_load_lds_dwordx4 v16, s[76:77]
  s_add_u32 s76, s76, 28672
  s_addc_u32 s77, s77, 0
  s_mov_b32 s27, 0
  s_branch Lwc_17
Lwc_16:
  s_sleep 8
Lwc_17:
  global_load_dword v58, v3, s[18:19] offset:68 sc1
  s_add_u32 s27, s27, 1
  s_cmp_gt_u32 s27, 0x400000
  s_cbranch_scc1 L_end
  s_waitcnt vmcnt(0)
  v_readfirstlane_b32 s54, v58
  s_nop 0
  s_cmp_ge_u32 s54, 96
  s_cbranch_scc0 Lwc_16
  v_lshlrev_b32 v8, 7, v1
  v_add_u32 v8, 78774272, v8
  s_mov_b32 s27, 0
  s_branch Lwf_19
Lwf_18:
  s_sleep 2
Lwf_19:
  global_load_dword v9, v8, s[16:17] sc1
  s_add_u32 s27, s27, 1
  s_cmp_gt_u32 s27, 0x400000
  s_cbranch_scc1 L_end
  s_waitcnt vmcnt(0)
  v_cmp_ne_u32 vcc, 1, v9
  s_cbranch_vccnz Lwf_18
  s_add_u32 s74, s16, 79695872
  s_addc_u32 s75, s17, 0
  global_load_dwordx4 v[64:67], v2, s[74:75] offset:-4096 sc1
  global_load_dwordx4 v[68:71], v2, s[74:75] offset:-3072 sc1
  global_load_dwordx4 v[72:75], v2, s[74:75] offset:-2048 sc1
  global_load_dwordx4 v[76:79], v2, s[74:75] offset:-1024 sc1
  global_load_dwordx4 v[80:83], v2, s[74:75] offset:0 sc1
  global_load_dwordx4 v[84:87], v2, s[74:75] offset:1024 sc1
  global_load_dwordx4 v[88:91], v2, s[74:75] offset:2048 sc1
  global_load_dwordx4 v[92:95], v2, s[74:75] offset:3072 sc1
  s_waitcnt vmcnt(0)
  s_mov_b32 s55, 0
  v_max3_u32 v8, v64, v65, v66
  v_max3_u32 v8, v8, v67, v68
  v_max3_u32 v8, v8, v69, v70
  v_max3_u32 v8, v8, v71, v72
  v_max3_u32 v8, v8, v73, v74
  v_max3_u32 v8, v8, v75, v76
  v_max3_u32 v8, v8, v77, v78
  v_max3_u32 v8, v8, v79, v80
  v_max3_u32 v8, v8, v81, v82
  v_max3_u32 v8, v8, v83, v84
  v_max3_u32 v8, v8, v85, v86
  v_max3_u32 v8, v8, v87, v88
  v_max3_u32 v8, v8, v89, v90
  v_max3_u32 v8, v8, v91, v92
  v_max3_u32 v8, v8, v93, v94
  v_max_u32 v8, v8, v95
  s_nop 1
  v_max_u32_dpp v9, v8, v8 quad_perm:[1,0,3,2] row_mask:0xf bank_mask:0xf
  v_mov_b32 v8, v9
  s_nop 1
  v_max_u32_dpp v9, v8, v8 quad_perm:[2,3,0,1] row_mask:0xf bank_mask:0xf
  v_mov_b32 v8, v9
  s_nop 1
  v_max_u32_dpp v9, v8, v8 row_ror:4 row_mask:0xf bank_mask:0xf
  v_mov_b32 v8, v9
  s_nop 1
  v_max_u32_dpp v9, v8, v8 row_ror:8 row_mask:0xf bank_mask:0xf
  v_mov_b32 v8, v9
  v_mov_b32 v9, v8
  s_nop 1
  v_permlane16_swap_b32 v8, v9
  v_max_u32 v8, v8, v9
  v_mov_b32 v9, v8
  s_nop 1
  v_permlane32_swap_b32 v8, v9
  v_max_u32 v8, v8, v9
  s_nop 0
  v_readfirstlane_b32 s54, v8
  s_nop 0
  s_add_u32 s55, s55, s54
  s_mov_b32 s66, s55
  s_and_b32 s56, s55, 0xffff
  s_sub_u32 s56, 0xffff, s56
  s_and_b32 s42, s56, 2047
  v_subrev_u32 v64, s54, v64
  v_subrev_u32 v65, s54, v65
  v_subrev_u32 v66, s54, v66
  v_subrev_u32 v67, s54, v67
  v_subrev_u32 v68, s54, v68
  v_subrev_u32 v69, s54, v69
  v_subrev_u32 v70, s54, v70
  v_subrev_u32 v71, s54, v71
  v_subrev_u32 v72, s54, v72
  v_subrev_u32 v73, s54, v73
  v_subrev_u32 v74, s54, v74
  v_subrev_u32 v75, s54, v75
  v_subrev_u32 v76, s54, v76
  v_subrev_u32 v77, s54, v77
  v_subrev_u32 v78, s54, v78
  v_subrev_u32 v79, s54, v79
  v_subrev_u32 v80, s54, v80
  v_subrev_u32 v81, s54, v81
  v_subrev_u32 v82, s54, v82
  v_subrev_u32 v83, s54, v83
  v_subrev_u32 v84, s54, v84
  v_subrev_u32 v85, s54, v85
  v_subrev_u32 v86, s54, v86
  v_subrev_u32 v87, s54, v87
  v_subrev_u32 v88, s54, v88
  v_subrev_u32 v89, s54, v89
  v_subrev_u32 v90, s54, v90
  v_subrev_u32 v91, s54, v91
  v_subrev_u32 v92, s54, v92
  v_subrev_u32 v93, s54, v93
  v_subrev_u32 v94, s54, v94
  v_subrev_u32 v95, s54, v95
  v_max3_u32 v8, v64, v65, v66
  v_max3_u32 v8, v8, v67, v68
  v_max3_u32 v8, v8, v69, v70
  v_max3_u32 v8, v8, v71, v72
  v_max3_u32 v8, v8, v73, v74
  v_max3_u32 v8, v8, v75, v76
  v_max3_u32 v8, v8, v77, v78
  v_max3_u32 v8, v8, v79, v80
  v_max3_u32 v8, v8, v81, v82
  v_max3_u32 v8, v8, v83, v84
  v_max3_u32 v8, v8, v85, v86
  v_max3_u32 v8, v8, v87, v88
  v_max3_u32 v8, v8, v89, v90
  v_max3_u32 v8, v8, v91, v92
  v_max3_u32 v8, v8, v93, v94
  v_max_u32 v8, v8, v95
  s_nop 1
  v_max_u32_dpp v9, v8, v8 quad_perm:[1,0,3,2] row_mask:0xf bank_mask:0xf
  v_mov_b32 v8, v9
  s_nop 1
  v_max_u32_dpp v9, v8, v8 quad_perm:[2,3,0,1] row_mask:0xf bank_mask:0xf
  v_mov_b32 v8, v9
  s_nop 1
  v_max_u32_dpp v9, v8, v8 row_ror:4 row_mask:0xf bank_mask:0xf
  v_mov_b32 v8, v9
  s_nop 1
  v_max_u32_dpp v9, v8, v8 row_ror:8 row_mask:0xf bank_mask:0xf
  v_mov_b32 v8, v9
  v_mov_b32 v9, v8
  s_nop 1
  v_permlane16_swap_b32 v8, v9
  v_max_u32 v8, v8, v9
  v_mov_b32 v9, v8
  s_nop 1
  v_permlane32_swap_b32 v8, v9
  v_max_u32 v8, v8, v9
  s_nop 0
  v_readfirstlane_b32 s54, v8
  s_nop 0
  s_add_u32 s55, s55, s54
  s_mov_b32 s67, s55
  s_and_b32 s56, s55, 0xffff
  s_sub_u32 s56, 0xffff, s56
  s_and_b32 s43, s56, 2047
  v_subrev_u32 v64, s54, v64
  v_subrev_u32 v65, s54, v65
  v_subrev_u32 v66, s54, v66
  v_subrev_u32 v67, s54, v67
  v_subrev_u32 v68, s54, v68
  v_subrev_u32 v69, s54, v69
  v_subrev_u32 v70, s54, v70
  v_subrev_u32 v71, s54, v71
  v_subrev_u32 v72, s54, v72
  v_subrev_u32 v73, s54, v73
  v_subrev_u32 v74, s54, v74
  v_subrev_u32 v75, s54, v75
  v_subrev_u32 v76, s54, v76
  v_subrev_u32 v77, s54, v77
  v_subrev_u32 v78, s54, v78
  v_subrev_u32 v79, s54, v79
  v_subrev_u32 v80, s54, v80
  v_subrev_u32 v81, s54, v81
  v_subrev_u32 v82, s54, v82
  v_subrev_u32 v83, s54, v83
  v_subrev_u32 v84, s54, v84
  v_subrev_u32 v85, s54, v85
  v_subrev_u32 v86, s54, v86
  v_subrev_u32 v87, s54, v87
  v_subrev_u32 v88, s54, v88
  v_subrev_u32 v89, s54, v89
  v_subrev_u32 v90, s54, v90
  v_subrev_u32 v91, s54, v91
  v_subrev_u32 v92, s54, v92
  v_subrev_u32 v93, s54, v93
  v_subrev_u32 v94, s54, v94
  v_subrev_u32 v95, s54, v95
  v_max3_u32 v8, v64, v65, v66
  v_max3_u32 v8, v8, v67, v68
  v_max3_u32 v8, v8, v69, v70
  v_max3_u32 v8, v8, v71, v72
  v_max3_u32 v8, v8, v73, v74
  v_max3_u32 v8, v8, v75, v76
  v_max3_u32 v8, v8, v77, v78
  v_max3_u32 v8, v8, v79, v80
  v_max3_u32 v8, v8, v81, v82
  v_max3_u32 v8, v8, v83, v84
  v_max3_u32 v8, v8, v85, v86
  v_max3_u32 v8, v8, v87, v88
  v_max3_u32 v8, v8, v89, v90
  v_max3_u32 v8, v8, v91, v92
  v_max3_u32 v8, v8, v93, v94
  v_max_u32 v8, v8, v95
  s_nop 1
  v_max_u32_dpp v9, v8, v8 quad_perm:[1,0,3,2] row_mask:0xf bank_mask:0xf
  v_mov_b32 v8, v9
  s_nop 1
  v_max_u32_dpp v9, v8, v8 quad_perm:[2,3,0,1] row_mask:0xf bank_mask:0xf
  v_mov_b32 v8, v9
  s_nop 1
  v_max_u32_dpp v9, v8, v8 row_ror:4 row_mask:0xf bank_mask:0xf
  v_mov_b32 v8, v9
  s_nop 1
  v_max_u32_dpp v9, v8, v8 row_ror:8 row_mask:0xf bank_mask:0xf
  v_mov_b32 v8, v9
  v_mov_b32 v9, v8
  s_nop 1
  v_permlane16_swap_b32 v8, v9
  v_max_u32 v8, v8, v9
  v_mov_b32 v9, v8
  s_nop 1
  v_permlane32_swap_b32 v8, v9
  v_max_u32 v8, v8, v9
  s_nop 0
  v_readfirstlane_b32 s54, v8
  s_nop 0
  s_add_u32 s55, s55, s54
  s_mov_b32 s68, s55
  s_and_b32 s56, s55, 0xffff
  s_sub_u32 s56, 0xffff, s56
  s_and_b32 s44, s56, 2047
  v_subrev_u32 v64, s54, v64
  v_subrev_u32 v65, s54, v65
  v_subrev_u32 v66, s54, v66
  v_subrev_u32 v67, s54, v67
  v_subrev_u32 v68, s54, v68
  v_subrev_u32 v69, s54, v69
  v_subrev_u32 v70, s54, v70
  v_subrev_u32 v71, s54, v71
  v_subrev_u32 v72, s54, v72
  v_subrev_u32 v73, s54, v73
  v_subrev_u32 v74, s54, v74
  v_subrev_u32 v75, s54, v75
  v_subrev_u32 v76, s54, v76
  v_subrev_u32 v77, s54, v77
  v_subrev_u32 v78, s54, v78
  v_subrev_u32 v79, s54, v79
  v_subrev_u32 v80, s54, v80
  v_subrev_u32 v81, s54, v81
  v_subrev_u32 v82, s54, v82
  v_subrev_u32 v83, s54, v83
  v_subrev_u32 v84, s54, v84
  v_subrev_u32 v85, s54, v85
  v_subrev_u32 v86, s54, v86
  v_subrev_u32 v87, s54, v87
  v_subrev_u32 v88, s54, v88
  v_subrev_u32 v89, s54, v89
  v_subrev_u32 v90, s54, v90
  v_subrev_u32 v91, s54, v91
  v_subrev_u32 v92, s54, v92
  v_subrev_u32 v93, s54, v93
  v_subrev_u32 v94, s54, v94
  v_subrev_u32 v95, s54, v95
  v_max3_u32 v8, v64, v65, v66
  v_max3_u32 v8, v8, v67, v68
  v_max3_u32 v8, v8, v69, v70
  v_max3_u32 v8, v8, v71, v72
  v_max3_u32 v8, v8, v73, v74
  v_max3_u32 v8, v8, v75, v76
  v_max3_u32 v8, v8, v77, v78
  v_max3_u32 v8, v8, v79, v80
  v_max3_u32 v8, v8, v81, v82
  v_max3_u32 v8, v8, v83, v84
  v_max3_u32 v8, v8, v85, v86
  v_max3_u32 v8, v8, v87, v88
  v_max3_u32 v8, v8, v89, v90
  v_max3_u32 v8, v8, v91, v92
  v_max3_u32 v8, v8, v93, v94
  v_max_u32 v8, v8, v95
  s_nop 1
  v_max_u32_dpp v9, v8, v8 quad_perm:[1,0,3,2] row_mask:0xf bank_mask:0xf
  v_mov_b32 v8, v9
  s_nop 1
  v_max_u32_dpp v9, v8, v8 quad_perm:[2,3,0,1] row_mask:0xf bank_mask:0xf
  v_mov_b32 v8, v9
  s_nop 1
  v_max_u32_dpp v9, v8, v8 row_ror:4 row_mask:0xf bank_mask:0xf
  v_mov_b32 v8, v9
  s_nop 1
  v_max_u32_dpp v9, v8, v8 row_ror:8 row_mask:0xf bank_mask:0xf
  v_mov_b32 v8, v9
  v_mov_b32 v9, v8
  s_nop 1
  v_permlane16_swap_b32 v8, v9
  v_max_u32 v8, v8, v9
  v_mov_b32 v9, v8
  s_nop 1
  v_permlane32_swap_b32 v8, v9
  v_max_u32 v8, v8, v9
  s_nop 0
  v_readfirstlane_b32 s54, v8
  s_nop 0
  s_add_u32 s55, s55, s54
  s_mov_b32 s69, s55
  s_and_b32 s56, s55, 0xffff
  s_sub_u32 s56, 0xffff, s56
  s_and_b32 s45, s56, 2047
  v_subrev_u32 v64, s54, v64
  v_subrev_u32 v65, s54, v65
  v_subrev_u32 v66, s54, v66
  v_subrev_u32 v67, s54, v67
  v_subrev_u32 v68, s54, v68
  v_subrev_u32 v69, s54, v69
  v_subrev_u32 v70, s54, v70
  v_subrev_u32 v71, s54, v71
  v_subrev_u32 v72, s54, v72
  v_subrev_u32 v73, s54, v73
  v_subrev_u32 v74, s54, v74
  v_subrev_u32 v75, s54, v75
  v_subrev_u32 v76, s54, v76
  v_subrev_u32 v77, s54, v77
  v_subrev_u32 v78, s54, v78
  v_subrev_u32 v79, s54, v79
  v_subrev_u32 v80, s54, v80
  v_subrev_u32 v81, s54, v81
  v_subrev_u32 v82, s54, v82
  v_subrev_u32 v83, s54, v83
  v_subrev_u32 v84, s54, v84
  v_subrev_u32 v85, s54, v85
  v_subrev_u32 v86, s54, v86
  v_subrev_u32 v87, s54, v87
  v_subrev_u32 v88, s54, v88
  v_subrev_u32 v89, s54, v89
  v_subrev_u32 v90, s54, v90
  v_subrev_u32 v91, s54, v91
  v_subrev_u32 v92, s54, v92
  v_subrev_u32 v93, s54, v93
  v_subrev_u32 v94, s54, v94
  v_subrev_u32 v95, s54, v95
  v_max3_u32 v8, v64, v65, v66
  v_max3_u32 v8, v8, v67, v68
  v_max3_u32 v8, v8, v69, v70
  v_max3_u32 v8, v8, v71, v72
  v_max3_u32 v8, v8, v73, v74
  v_max3_u32 v8, v8, v75, v76
  v_max3_u32 v8, v8, v77, v78
  v_max3_u32 v8, v8, v79, v80
  v_max3_u32 v8, v8, v81, v82
  v_max3_u32 v8, v8, v83, v84
  v_max3_u32 v8, v8, v85, v86
  v_max3_u32 v8, v8, v87, v88
  v_max3_u32 v8, v8, v89, v90
  v_max3_u32 v8, v8, v91, v92
  v_max3_u32 v8, v8, v93, v94
  v_max_u32 v8, v8, v95
  s_nop 1
  v_max_u32_dpp v9, v8, v8 quad_perm:[1,0,3,2] row_mask:0xf bank_mask:0xf
  v_mov_b32 v8, v9
  s_nop 1
  v_max_u32_dpp v9, v8, v8 quad_perm:[2,3,0,1] row_mask:0xf bank_mask:0xf
  v_mov_b32 v8, v9
  s_nop 1
  v_max_u32_dpp v9, v8, v8 row_ror:4 row_mask:0xf bank_mask:0xf
  v_mov_b32 v8, v9
  s_nop 1
  v_max_u32_dpp v9, v8, v8 row_ror:8 row_mask:0xf bank_mask:0xf
  v_mov_b32 v8, v9
  v_mov_b32 v9, v8
  s_nop 1
  v_permlane16_swap_b32 v8, v9
  v_max_u32 v8, v8, v9
  v_mov_b32 v9, v8
  s_nop 1
  v_permlane32_swap_b32 v8, v9
  v_max_u32 v8, v8, v9
  s_nop 0
  v_readfirstlane_b32 s54, v8
  s_nop 0
  s_add_u32 s55, s55, s54
  s_mov_b32 s70, s55
  s_and_b32 s56, s55, 0xffff
  s_sub_u32 s56, 0xffff, s56
  s_and_b32 s46, s56, 2047
  v_subrev_u32 v64, s54, v64
  v_subrev_u32 v65, s54, v65
  v_subrev_u32 v66, s54, v66
  v_subrev_u32 v67, s54, v67
  v_subrev_u32 v68, s54, v68
  v_subrev_u32 v69, s54, v69
  v_subrev_u32 v70, s54, v70
  v_subrev_u32 v71, s54, v71
  v_subrev_u32 v72, s54, v72
  v_subrev_u32 v73, s54, v73
  v_subrev_u32 v74, s54, v74
  v_subrev_u32 v75, s54, v75
  v_subrev_u32 v76, s54, v76
  v_subrev_u32 v77, s54, v77
  v_subrev_u32 v78, s54, v78
  v_subrev_u32 v79, s54, v79
  v_subrev_u32 v80, s54, v80
  v_subrev_u32 v81, s54, v81
  v_subrev_u32 v82, s54, v82
  v_subrev_u32 v83, s54, v83
  v_subrev_u32 v84, s54, v84
  v_subrev_u32 v85, s54, v85
  v_subrev_u32 v86, s54, v86
  v_subrev_u32 v87, s54, v87
  v_subrev_u32 v88, s54, v88
  v_subrev_u32 v89, s54, v89
  v_subrev_u32 v90, s54, v90
  v_subrev_u32 v91, s54, v91
  v_subrev_u32 v92, s54, v92
  v_subrev_u32 v93, s54, v93
  v_subrev_u32 v94, s54, v94
  v_subrev_u32 v95, s54, v95
  v_max3_u32 v8, v64, v65, v66
  v_max3_u32 v8, v8, v67, v68
  v_max3_u32 v8, v8, v69, v70
  v_max3_u32 v8, v8, v71, v72
  v_max3_u32 v8, v8, v73, v74
  v_max3_u32 v8, v8, v75, v76
  v_max3_u32 v8, v8, v77, v78
  v_max3_u32 v8, v8, v79, v80
  v_max3_u32 v8, v8, v81, v82
  v_max3_u32 v8, v8, v83, v84
  v_max3_u32 v8, v8, v85, v86
  v_max3_u32 v8, v8, v87, v88
  v_max3_u32 v8, v8, v89, v90
  v_max3_u32 v8, v8, v91, v92
  v_max3_u32 v8, v8, v93, v94
  v_max_u32 v8, v8, v95
  s_nop 1
  v_max_u32_dpp v9, v8, v8 quad_perm:[1,0,3,2] row_mask:0xf bank_mask:0xf
  v_mov_b32 v8, v9
  s_nop 1
  v_max_u32_dpp v9, v8, v8 quad_perm:[2,3,0,1] row_mask:0xf bank_mask:0xf
  v_mov_b32 v8, v9
  s_nop 1
  v_max_u32_dpp v9, v8, v8 row_ror:4 row_mask:0xf bank_mask:0xf
  v_mov_b32 v8, v9
  s_nop 1
  v_max_u32_dpp v9, v8, v8 row_ror:8 row_mask:0xf bank_mask:0xf
  v_mov_b32 v8, v9
  v_mov_b32 v9, v8
  s_nop 1
  v_permlane16_swap_b32 v8, v9
  v_max_u32 v8, v8, v9
  v_mov_b32 v9, v8
  s_nop 1
  v_permlane32_swap_b32 v8, v9
  v_max_u32 v8, v8, v9
  s_nop 0
  v_readfirstlane_b32 s54, v8
  s_nop 0
  s_add_u32 s55, s55, s54
  s_mov_b32 s71, s55
  s_and_b32 s56, s55, 0xffff
  s_sub_u32 s56, 0xffff, s56
  s_and_b32 s47, s56, 2047
  v_subrev_u32 v64, s54, v64
  v_subrev_u32 v65, s54, v65
  v_subrev_u32 v66, s54, v66
  v_subrev_u32 v67, s54, v67
  v_subrev_u32 v68, s54, v68
  v_subrev_u32 v69, s54, v69
  v_subrev_u32 v70, s54, v70
  v_subrev_u32 v71, s54, v71
  v_subrev_u32 v72, s54, v72
  v_subrev_u32 v73, s54, v73
  v_subrev_u32 v74, s54, v74
  v_subrev_u32 v75, s54, v75
  v_subrev_u32 v76, s54, v76
  v_subrev_u32 v77, s54, v77
  v_subrev_u32 v78, s54, v78
  v_subrev_u32 v79, s54, v79
  v_subrev_u32 v80, s54, v80
  v_subrev_u32 v81, s54, v81
  v_subrev_u32 v82, s54, v82
  v_subrev_u32 v83, s54, v83
  v_subrev_u32 v84, s54, v84
  v_subrev_u32 v85, s54, v85
  v_subrev_u32 v86, s54, v86
  v_subrev_u32 v87, s54, v87
  v_subrev_u32 v88, s54, v88
  v_subrev_u32 v89, s54, v89
  v_subrev_u32 v90, s54, v90
  v_subrev_u32 v91, s54, v91
  v_subrev_u32 v92, s54, v92
  v_subrev_u32 v93, s54, v93
  v_subrev_u32 v94, s54, v94
  v_subrev_u32 v95, s54, v95
  v_max3_u32 v8, v64, v65, v66
  v_max3_u32 v8, v8, v67, v68
  v_max3_u32 v8, v8, v69, v70
  v_max3_u32 v8, v8, v71, v72
  v_max3_u32 v8, v8, v73, v74
  v_max3_u32 v8, v8, v75, v76
  v_max3_u32 v8, v8, v77, v78
  v_max3_u32 v8, v8, v79, v80
  v_max3_u32 v8, v8, v81, v82
  v_max3_u32 v8, v8, v83, v84
  v_max3_u32 v8, v8, v85, v86
  v_max3_u32 v8, v8, v87, v88
  v_max3_u32 v8, v8, v89, v90
  v_max3_u32 v8, v8, v91, v92
  v_max3_u32 v8, v8, v93, v94
  v_max_u32 v8, v8, v95
  s_nop 1
  v_max_u32_dpp v9, v8, v8 quad_perm:[1,0,3,2] row_mask:0xf bank_mask:0xf
  v_mov_b32 v8, v9
  s_nop 1
  v_max_u32_dpp v9, v8, v8 quad_perm:[2,3,0,1] row_mask:0xf bank_mask:0xf
  v_mov_b32 v8, v9
  s_nop 1
  v_max_u32_dpp v9, v8, v8 row_ror:4 row_mask:0xf bank_mask:0xf
  v_mov_b32 v8, v9
  s_nop 1
  v_max_u32_dpp v9, v8, v8 row_ror:8 row_mask:0xf bank_mask:0xf
  v_mov_b32 v8, v9
  v_mov_b32 v9, v8
  s_nop 1
  v_permlane16_swap_b32 v8, v9
  v_max_u32 v8, v8, v9
  v_mov_b32 v9, v8
  s_nop 1
  v_permlane32_swap_b32 v8, v9
  v_max_u32 v8, v8, v9
  s_nop 0
  v_readfirstlane_b32 s54, v8
  s_nop 0
  s_add_u32 s55, s55, s54
  s_mov_b32 s72, s55
  s_and_b32 s56, s55, 0xffff
  s_sub_u32 s56, 0xffff, s56
  s_and_b32 s48, s56, 2047
  v_subrev_u32 v64, s54, v64
  v_subrev_u32 v65, s54, v65
  v_subrev_u32 v66, s54, v66
  v_subrev_u32 v67, s54, v67
  v_subrev_u32 v68, s54, v68
  v_subrev_u32 v69, s54, v69
  v_subrev_u32 v70, s54, v70
  v_subrev_u32 v71, s54, v71
  v_subrev_u32 v72, s54, v72
  v_subrev_u32 v73, s54, v73
  v_subrev_u32 v74, s54, v74
  v_subrev_u32 v75, s54, v75
  v_subrev_u32 v76, s54, v76
  v_subrev_u32 v77, s54, v77
  v_subrev_u32 v78, s54, v78
  v_subrev_u32 v79, s54, v79
  v_subrev_u32 v80, s54, v80
  v_subrev_u32 v81, s54, v81
  v_subrev_u32 v82, s54, v82
  v_subrev_u32 v83, s54, v83
  v_subrev_u32 v84, s54, v84
  v_subrev_u32 v85, s54, v85
  v_subrev_u32 v86, s54, v86
  v_subrev_u32 v87, s54, v87
  v_subrev_u32 v88, s54, v88
  v_subrev_u32 v89, s54, v89
  v_subrev_u32 v90, s54, v90
  v_subrev_u32 v91, s54, v91
  v_subrev_u32 v92, s54, v92
  v_subrev_u32 v93, s54, v93
  v_subrev_u32 v94, s54, v94
  v_subrev_u32 v95, s54, v95
  v_max3_u32 v8, v64, v65, v66
  v_max3_u32 v8, v8, v67, v68
  v_max3_u32 v8, v8, v69, v70
  v_max3_u32 v8, v8, v71, v72
  v_max3_u32 v8, v8, v73, v74
  v_max3_u32 v8, v8, v75, v76
  v_max3_u32 v8, v8, v77, v78
  v_max3_u32 v8, v8, v79, v80
  v_max3_u32 v8, v8, v81, v82
  v_max3_u32 v8, v8, v83, v84
  v_max3_u32 v8, v8, v85, v86
  v_max3_u32 v8, v8, v87, v88
  v_max3_u32 v8, v8, v89, v90
  v_max3_u32 v8, v8, v91, v92
  v_max3_u32 v8, v8, v93, v94
  v_max_u32 v8, v8, v95
  s_nop 1
  v_max_u32_dpp v9, v8, v8 quad_perm:[1,0,3,2] row_mask:0xf bank_mask:0xf
  v_mov_b32 v8, v9
  s_nop 1
  v_max_u32_dpp v9, v8, v8 quad_perm:[2,3,0,1] row_mask:0xf bank_mask:0xf
  v_mov_b32 v8, v9
  s_nop 1
  v_max_u32_dpp v9, v8, v8 row_ror:4 row_mask:0xf bank_mask:0xf
  v_mov_b32 v8, v9
  s_nop 1
  v_max_u32_dpp v9, v8, v8 row_ror:8 row_mask:0xf bank_mask:0xf
  v_mov_b32 v8, v9
  v_mov_b32 v9, v8
  s_nop 1
  v_permlane16_swap_b32 v8, v9
  v_max_u32 v8, v8, v9
  v_mov_b32 v9, v8
  s_nop 1
  v_permlane32_swap_b32 v8, v9
  v_max_u32 v8, v8, v9
  s_nop 0
  v_readfirstlane_b32 s54, v8
  s_nop 0
  s_add_u32 s55, s55, s54
  s_mov_b32 s73, s55
  s_and_b32 s56, s55, 0xffff
  s_sub_u32 s56, 0xffff, s56
  s_and_b32 s49, s56, 2047
  v_mov_b32 v8, s42
  v_cmp_eq_u32 vcc, 1, v23
  v_mov_b32 v9, s43
  s_nop 0
  v_cndmask_b32 v8, v8, v9, vcc
  v_cmp_eq_u32 vcc, 2, v23
  v_mov_b32 v9, s44
  s_nop 0
  v_cndmask_b32 v8, v8, v9, vcc
  v_cmp_eq_u32 vcc, 3, v23
  v_mov_b32 v9, s45
  s_nop 0
  v_cndmask_b32 v8, v8, v9, vcc
  v_cmp_eq_u32 vcc, 4, v23
  v_mov_b32 v9, s46
  s_nop 0
  v_cndmask_b32 v8, v8, v9, vcc
  v_cmp_eq_u32 vcc, 5, v23
  v_mov_b32 v9, s47
  s_nop 0
  v_cndmask_b32 v8, v8, v9, vcc
  v_cmp_eq_u32 vcc, 6, v23
  v_mov_b32 v9, s48
  s_nop 0
  v_cndmask_b32 v8, v8, v9, vcc
  v_cmp_eq_u32 vcc, 7, v23
  v_mov_b32 v9, s49
  s_nop 0
  v_cndmask_b32 v8, v8, v9, vcc
  v_lshl_add_u32 v8, v8, 10, v22
  global_load_dwordx4 v[64:67], v8, s[4:5] offset:0
  global_load_dwordx4 v[68:71], v8, s[4:5] offset:64
  global_load_dwordx4 v[72:75], v8, s[4:5] offset:128
  global_load_dwordx4 v[76:79], v8, s[4:5] offset:192
  global_load_dwordx4 v[80:83], v8, s[4:5] offset:256
  global_load_dwordx4 v[84:87], v8, s[4:5] offset:320
  global_load_dwordx4 v[88:91], v8, s[4:5] offset:384
  global_load_dwordx4 v[92:95], v8, s[4:5] offset:448
  global_load_dwordx4 v[96:99], v8, s[4:5] offset:512
  global_load_dwordx4 v[100:103], v8, s[4:5] offset:576
  global_load_dwordx4 v[104:107], v8, s[4:5] offset:640
  global_load_dwordx4 v[108:111], v8, s[4:5] offset:704
  global_load_dwordx4 v[112:115], v8, s[4:5] offset:768
  global_load_dwordx4 v[116:119], v8, s[4:5] offset:832
  global_load_dwordx4 v[120:123], v8, s[4:5] offset:896
  global_load_dwordx4 v[124:127], v8, s[4:5] offset:960
  s_waitcnt vmcnt(0)
  s_barrier
  v_add_u32 v9, 0x10000, v17
  ds_read_b64_tr_b16 v[32:33], v17 offset:0
  ds_read_b64_tr_b16 v[34:35], v17 offset:512
  ds_read_b64_tr_b16 v[36:37], v9 offset:0
  ds_read_b64_tr_b16 v[38:39], v9 offset:512
  ds_read_b64_tr_b16 v[40:41], v17 offset:4096
  ds_read_b64_tr_b16 v[42:43], v17 offset:4608
  ds_read_b64_tr_b16 v[44:45], v9 offset:4096
  ds_read_b64_tr_b16 v[46:47], v9 offset:4608
  s_waitcnt lgkmcnt(4)
  v_mfma_f32_16x16x32_bf16 v[24:27], v[32:35], v[64:67], 0
  v_mfma_f32_16x16x32_bf16 v[28:31], v[36:39], v[64:67], 0
  ds_read_b64_tr_b16 v[32:33], v17 offset:8192
  ds_read_b64_tr_b16 v[34:35], v17 offset:8704
  ds_read_b64_tr_b16 v[36:37], v9 offset:8192
  ds_read_b64_tr_b16 v[38:39], v9 offset:8704
  s_waitcnt lgkmcnt(4)
  v_mfma_f32_16x16x32_bf16 v[24:27], v[40:43], v[68:71], v[24:27]
  v_mfma_f32_16x16x32_bf16 v[28:31], v[44:47], v[68:71], v[28:31]
  ds_read_b64_tr_b16 v[40:41], v17 offset:12288
  ds_read_b64_tr_b16 v[42:43], v17 offset:12800
  ds_read_b64_tr_b16 v[44:45], v9 offset:12288
  ds_read_b64_tr_b16 v[46:47], v9 offset:12800
  s_waitcnt lgkmcnt(4)
  v_mfma_f32_16x16x32_bf16 v[24:27], v[32:35], v[72:75], v[24:27]
  v_mfma_f32_16x16x32_bf16 v[28:31], v[36:39], v[72:75], v[28:31]
  ds_read_b64_tr_b16 v[32:33], v17 offset:16384
  ds_read_b64_tr_b16 v[34:35], v17 offset:16896
  ds_read_b64_tr_b16 v[36:37], v9 offset:16384
  ds_read_b64_tr_b16 v[38:39], v9 offset:16896
  s_waitcnt lgkmcnt(4)
  v_mfma_f32_16x16x32_bf16 v[24:27], v[40:43], v[76:79], v[24:27]
  v_mfma_f32_16x16x32_bf16 v[28:31], v[44:47], v[76:79], v[28:31]
  ds_read_b64_tr_b16 v[40:41], v17 offset:20480
  ds_read_b64_tr_b16 v[42:43], v17 offset:20992
  ds_read_b64_tr_b16 v[44:45], v9 offset:20480
  ds_read_b64_tr_b16 v[46:47], v9 offset:20992
  s_waitcnt lgkmcnt(4)
  v_mfma_f32_16x16x32_bf16 v[24:27], v[32:35], v[80:83], v[24:27]
  v_mfma_f32_16x16x32_bf16 v[28:31], v[36:39], v[80:83], v[28:31]
  ds_read_b64_tr_b16 v[32:33], v17 offset:24576
  ds_read_b64_tr_b16 v[34:35], v17 offset:25088
  ds_read_b64_tr_b16 v[36:37], v9 offset:24576
  ds_read_b64_tr_b16 v[38:39], v9 offset:25088
  s_waitcnt lgkmcnt(4)
  v_mfma_f32_16x16x32_bf16 v[24:27], v[40:43], v[84:87], v[24:27]
  v_mfma_f32_16x16x32_bf16 v[28:31], v[44:47], v[84:87], v[28:31]
  ds_read_b64_tr_b16 v[40:41], v17 offset:28672
  ds_read_b64_tr_b16 v[42:43], v17 offset:29184
  ds_read_b64_tr_b16 v[44:45], v9 offset:28672
  ds_read_b64_tr_b16 v[46:47], v9 offset:29184
  s_waitcnt lgkmcnt(4)
  v_mfma_f32_16x16x32_bf16 v[24:27], v[32:35], v[88:91], v[24:27]
  v_mfma_f32_16x16x32_bf16 v[28:31], v[36:39], v[88:91], v[28:31]
  ds_read_b64_tr_b16 v[32:33], v17 offset:32768
  ds_read_b64_tr_b16 v[34:35], v17 offset:33280
  ds_read_b64_tr_b16 v[36:37], v9 offset:32768
  ds_read_b64_tr_b16 v[38:39], v9 offset:33280
  s_waitcnt lgkmcnt(4)
  v_mfma_f32_16x16x32_bf16 v[24:27], v[40:43], v[92:95], v[24:27]
  v_mfma_f32_16x16x32_bf16 v[28:31], v[44:47], v[92:95], v[28:31]
  ds_read_b64_tr_b16 v[40:41], v17 offset:36864
  ds_read_b64_tr_b16 v[42:43], v17 offset:37376
  ds_read_b64_tr_b16 v[44:45], v9 offset:36864
  ds_read_b64_tr_b16 v[46:47], v9 offset:37376
  s_waitcnt lgkmcnt(4)
  v_mfma_f32_16x16x32_bf16 v[24:27], v[32:35], v[96:99], v[24:27]
  v_mfma_f32_16x16x32_bf16 v[28:31], v[36:39], v[96:99], v[28:31]
  ds_read_b64_tr_b16 v[32:33], v17 offset:40960
  ds_read_b64_tr_b16 v[34:35], v17 offset:41472
  ds_read_b64_tr_b16 v[36:37], v9 offset:40960
  ds_read_b64_tr_b16 v[38:39], v9 offset:41472
  s_waitcnt lgkmcnt(4)
  v_mfma_f32_16x16x32_bf16 v[24:27], v[40:43], v[100:103], v[24:27]
  v_mfma_f32_16x16x32_bf16 v[28:31], v[44:47], v[100:103], v[28:31]
  ds_read_b64_tr_b16 v[40:41], v17 offset:45056
  ds_read_b64_tr_b16 v[42:43], v17 offset:45568
  ds_read_b64_tr_b16 v[44:45], v9 offset:45056
  ds_read_b64_tr_b16 v[46:47], v9 offset:45568
  s_waitcnt lgkmcnt(4)
  v_mfma_f32_16x16x32_bf16 v[24:27], v[32:35], v[104:107], v[24:27]
  v_mfma_f32_16x16x32_bf16 v[28:31], v[36:39], v[104:107], v[28:31]
  ds_read_b64_tr_b16 v[32:33], v17 offset:49152
  ds_read_b64_tr_b16 v[34:35], v17 offset:49664
  ds_read_b64_tr_b16 v[36:37], v9 offset:49152
  ds_read_b64_tr_b16 v[38:39], v9 offset:49664
  s_waitcnt lgkmcnt(4)
  v_mfma_f32_16x16x32_bf16 v[24:27], v[40:43], v[108:111], v[24:27]
  v_mfma_f32_16x16x32_bf16 v[28:31], v[44:47], v[108:111], v[28:31]
  ds_read_b64_tr_b16 v[40:41], v17 offset:53248
  ds_read_b64_tr_b16 v[42:43], v17 offset:53760
  ds_read_b64_tr_b16 v[44:45], v9 offset:53248
  ds_read_b64_tr_b16 v[46:47], v9 offset:53760
  s_waitcnt lgkmcnt(4)
  v_mfma_f32_16x16x32_bf16 v[24:27], v[32:35], v[112:115], v[24:27]
  v_mfma_f32_16x16x32_bf16 v[28:31], v[36:39], v[112:115], v[28:31]
  ds_read_b64_tr_b16 v[32:33], v17 offset:57344
  ds_read_b64_tr_b16 v[34:35], v17 offset:57856
  ds_read_b64_tr_b16 v[36:37], v9 offset:57344
  ds_read_b64_tr_b16 v[38:39], v9 offset:57856
  s_waitcnt lgkmcnt(4)
  v_mfma_f32_16x16x32_bf16 v[24:27], v[40:43], v[116:119], v[24:27]
  v_mfma_f32_16x16x32_bf16 v[28:31], v[44:47], v[116:119], v[28:31]
  ds_read_b64_tr_b16 v[40:41], v17 offset:61440
  ds_read_b64_tr_b16 v[42:43], v17 offset:61952
  ds_read_b64_tr_b16 v[44:45], v9 offset:61440
  ds_read_b64_tr_b16 v[46:47], v9 offset:61952
  s_waitcnt lgkmcnt(4)
  v_mfma_f32_16x16x32_bf16 v[24:27], v[32:35], v[120:123], v[24:27]
  v_mfma_f32_16x16x32_bf16 v[28:31], v[36:39], v[120:123], v[28:31]
  s_waitcnt lgkmcnt(0)
  v_mfma_f32_16x16x32_bf16 v[24:27], v[40:43], v[124:127], v[24:27]
  v_mfma_f32_16x16x32_bf16 v[28:31], v[44:47], v[124:127], v[28:31]
  s_barrier
  s_lshl_b32 s54, s25, 16
  s_lshl_b32 s56, s21, 14
  s_add_u32 s54, s54, s56
  s_add_u32 s74, s38, s54
  s_addc_u32 s75, s39, 0
  s_add_u32 m0, s56, 0
  s_nop 0
  global_load_lds_dwordx4 v2, s[74:75]
  s_add_u32 s74, s74, 1024
  s_addc_u32 s75, s75, 0
  s_add_u32 m0, s56, 1024
  s_nop 0
  global_load_lds_dwordx4 v2, s[74:75]
  s_add_u32 s74, s74, 1024
  s_addc_u32 s75, s75, 0
  s_add_u32 m0, s56, 2048
  s_nop 0
  global_load_lds_dwordx4 v2, s[74:75]
  s_add_u32 s74, s74, 1024
  s_addc_u32 s75, s75, 0
  s_add_u32 m0, s56, 3072
  s_nop 0
  global_load_lds_dwordx4 v2, s[74:75]
  s_add_u32 s74, s74, 1024
  s_addc_u32 s75, s75, 0
  s_add_u32 m0, s56, 4096
  s_nop 0
  global_load_lds_dwordx4 v2, s[74:75]
  s_add_u32 s74, s74, 1024
  s_addc_u32 s75, s75, 0
  s_add_u32 m0, s56, 5120
  s_nop 0
  global_load_lds_dwordx4 v2, s[74:75]
  s_add_u32 s74, s74, 1024
  s_addc_u32 s75, s75, 0
  s_add_u32 m0, s56, 6144
  s_nop 0
  global_load_lds_dwordx4 v2, s[74:75]
  s_add_u32 s74, s74, 1024
  s_addc_u32 s75, s75, 0
  s_add_u32 m0, s56, 7168
  s_nop 0
  global_load_lds_dwordx4 v2, s[74:75]
  s_add_u32 s74, s74, 1024
  s_addc_u32 s75, s75, 0
  s_add_u32 m0, s56, 8192
  s_nop 0
  global_load_lds_dwordx4 v2, s[74:75]
  s_add_u32 s74, s74, 1024
  s_addc_u32 s75, s75, 0
  s_add_u32 m0, s56, 9216
  s_nop 0
  global_load_lds_dwordx4 v2, s[74:75]
  s_add_u32 s74, s74, 1024
  s_addc_u32 s75, s75, 0
  s_add_u32 m0, s56, 10240
  s_nop 0
  global_load_lds_dwordx4 v2, s[74:75]
  s_add_u32 s74, s74, 1024
  s_addc_u32 s75, s75, 0
  s_add_u32 m0, s56, 11264
  s_nop 0
  global_load_lds_dwordx4 v2, s[74:75]
  s_add_u32 s74, s74, 1024
  s_addc_u32 s75, s75, 0
  s_add_u32 m0, s56, 12288
  s_nop 0
  global_load_lds_dwordx4 v2, s[74:75]
  s_add_u32 s74, s74, 1024
  s_addc_u32 s75, s75, 0
  s_add_u32 m0, s56, 13312
  s_nop 0
  global_load_lds_dwordx4 v2, s[74:75]
  s_add_u32 s74, s74, 1024
  s_addc_u32 s75, s75, 0
  s_add_u32 m0, s56, 14336
  s_nop 0
  global_load_lds_dwordx4 v2, s[74:75]
  s_add_u32 s74, s74, 1024
  s_addc_u32 s75, s75, 0
  s_add_u32 m0, s56, 15360
  s_nop 0
  global_load_lds_dwordx4 v2, s[74:75]
  s_add_u32 s74, s74, 1024
  s_addc_u32 s75, s75, 0
  v_cvt_pk_bf16_f32 v24, v24, v24
  v_and_b32 v24, 0xffff0000, v24
  v_mul_f32 v48, 0xbfb8aa3b, v24
  v_exp_f32 v48, v48
  s_nop 0
  v_add_f32 v48, 1.0, v48
  v_rcp_f32 v48, v48
  s_nop 0
  v_mul_f32 v24, v24, v48
  v_cvt_pk_bf16_f32 v24, v24, v24
  v_and_b32 v24, 0xffff0000, v24
  v_cvt_pk_bf16_f32 v28, v28, v28
  v_and_b32 v28, 0xffff0000, v28
  v_mul_f32 v24, v24, v28
  v_cvt_pk_bf16_f32 v25, v25, v25
  v_and_b32 v25, 0xffff0000, v25
  v_mul_f32 v48, 0xbfb8aa3b, v25
  v_exp_f32 v48, v48
  s_nop 0
  v_add_f32 v48, 1.0, v48
  v_rcp_f32 v48, v48
  s_nop 0
  v_mul_f32 v25, v25, v48
  v_cvt_pk_bf16_f32 v25, v25, v25
  v_and_b32 v25, 0xffff0000, v25
  v_cvt_pk_bf16_f32 v29, v29, v29
  v_and_b32 v29, 0xffff0000, v29
  v_mul_f32 v25, v25, v29
  v_cvt_pk_bf16_f32 v26, v26, v26
  v_and_b32 v26, 0xffff0000, v26
  v_mul_f32 v48, 0xbfb8aa3b, v26
  v_exp_f32 v48, v48
  s_nop 0
  v_add_f32 v48, 1.0, v48
  v_rcp_f32 v48, v48
  s_nop 0
  v_mul_f32 v26, v26, v48
  v_cvt_pk_bf16_f32 v26, v26, v26
  v_and_b32 v26, 0xffff0000, v26
  v_cvt_pk_bf16_f32 v30, v30, v30
  v_and_b32 v30, 0xffff0000, v30
  v_mul_f32 v26, v26, v30
  v_cvt_pk_bf16_f32 v27, v27, v27
  v_and_b32 v27, 0xffff0000, v27
  v_mul_f32 v48, 0xbfb8aa3b, v27
  v_exp_f32 v48, v48
  s_nop 0
  v_add_f32 v48, 1.0, v48
  v_rcp_f32 v48, v48
  s_nop 0
  v_mul_f32 v27, v27, v48
  v_cvt_pk_bf16_f32 v27, v27, v27
  v_and_b32 v27, 0xffff0000, v27
  v_cvt_pk_bf16_f32 v31, v31, v31
  v_and_b32 v31, 0xffff0000, v31
  v_mul_f32 v27, v27, v31
  v_cvt_pk_bf16_f32 v48, v24, v25
  v_cvt_pk_bf16_f32 v49, v26, v27
  ds_write_b64 v19, v[48:49]
  s_waitcnt vmcnt(0) lgkmcnt(0)
  s_barrier
  ds_read_b128 v[52:55], v20
  ds_read_b128 v[56:59], v20 offset:64
  s_mul_i32 s54, s25, 16384
  s_add_u32 s54, s54, 79725568
  s_add_u32 s74, s16, s54
  s_addc_u32 s75, s17, 0
  ds_read_b64_tr_b16 v[64:65], v18 offset:0
  ds_read_b64_tr_b16 v[66:67], v18 offset:4096
  ds_read_b64_tr_b16 v[68:69], v18 offset:32768
  ds_read_b64_tr_b16 v[70:71], v18 offset:36864
  ds_read_b64_tr_b16 v[72:73], v18 offset:32
  ds_read_b64_tr_b16 v[74:75], v18 offset:4128
  ds_read_b64_tr_b16 v[76:77], v18 offset:32800
  ds_read_b64_tr_b16 v[78:79], v18 offset:36896
  s_waitcnt lgkmcnt(0)
  ds_read_b64_tr_b16 v[80:81], v18 offset:64
  ds_read_b64_tr_b16 v[82:83], v18 offset:4160
  ds_read_b64_tr_b16 v[84:85], v18 offset:32832
  ds_read_b64_tr_b16 v[86:87], v18 offset:36928
  ds_read_b64_tr_b16 v[88:89], v18 offset:96
  ds_read_b64_tr_b16 v[90:91], v18 offset:4192
  ds_read_b64_tr_b16 v[92:93], v18 offset:32864
  ds_read_b64_tr_b16 v[94:95], v18 offset:36960
  s_waitcnt lgkmcnt(0)
  ds_read_b64_tr_b16 v[96:97], v18 offset:128
  ds_read_b64_tr_b16 v[98:99], v18 offset:4224
  ds_read_b64_tr_b16 v[100:101], v18 offset:32896
  ds_read_b64_tr_b16 v[102:103], v18 offset:36992
  ds_read_b64_tr_b16 v[104:105], v18 offset:160
  ds_read_b64_tr_b16 v[106:107], v18 offset:4256
  ds_read_b64_tr_b16 v[108:109], v18 offset:32928
  ds_read_b64_tr_b16 v[110:111], v18 offset:37024
  s_waitcnt lgkmcnt(0)
  ds_read_b64_tr_b16 v[112:113], v18 offset:192
  ds_read_b64_tr_b16 v[114:115], v18 offset:4288
  ds_read_b64_tr_b16 v[116:117], v18 offset:32960
  ds_read_b64_tr_b16 v[118:119], v18 offset:37056
  ds_read_b64_tr_b16 v[120:121], v18 offset:224
  ds_read_b64_tr_b16 v[122:123], v18 offset:4320
  ds_read_b64_tr_b16 v[124:125], v18 offset:32992
  ds_read_b64_tr_b16 v[126:127], v18 offset:37088
  s_waitcnt lgkmcnt(0)
  v_mfma_f32_16x16x32_bf16 v[128:131], v[64:67], v[52:55], 0
  v_mfma_f32_16x16x32_bf16 v[128:131], v[68:71], v[56:59], v[128:131]
  v_mfma_f32_16x16x32_bf16 v[132:135], v[72:75], v[52:55], 0
  v_mfma_f32_16x16x32_bf16 v[132:135], v[76:79], v[56:59], v[132:135]
  v_mfma_f32_16x16x32_bf16 v[136:139], v[80:83], v[52:55], 0
  v_mfma_f32_16x16x32_bf16 v[136:139], v[84:87], v[56:59], v[136:139]
  v_mfma_f32_16x16x32_bf16 v[140:143], v[88:91], v[52:55], 0
  v_mfma_f32_16x16x32_bf16 v[140:143], v[92:95], v[56:59], v[140:143]
  v_mfma_f32_16x16x32_bf16 v[144:147], v[96:99], v[52:55], 0
  v_mfma_f32_16x16x32_bf16 v[144:147], v[100:103], v[56:59], v[144:147]
  v_mfma_f32_16x16x32_bf16 v[148:151], v[104:107], v[52:55], 0
  v_mfma_f32_16x16x32_bf16 v[148:151], v[108:111], v[56:59], v[148:151]
  v_mfma_f32_16x16x32_bf16 v[152:155], v[112:115], v[52:55], 0
  v_mfma_f32_16x16x32_bf16 v[152:155], v[116:119], v[56:59], v[152:155]
  v_mfma_f32_16x16x32_bf16 v[156:159], v[120:123], v[52:55], 0
  v_mfma_f32_16x16x32_bf16 v[156:159], v[124:127], v[56:59], v[156:159]
  global_store_dwordx4 v21, v[128:131], s[74:75] offset:0 sc1
  global_store_dwordx4 v21, v[132:135], s[74:75] offset:64 sc1
  global_store_dwordx4 v21, v[136:139], s[74:75] offset:128 sc1
  global_store_dwordx4 v21, v[140:143], s[74:75] offset:192 sc1
  global_store_dwordx4 v21, v[144:147], s[74:75] offset:256 sc1
  global_store_dwordx4 v21, v[148:151], s[74:75] offset:320 sc1
  global_store_dwordx4 v21, v[152:155], s[74:75] offset:384 sc1
  s_nop 0
  global_store_dwordx4 v21, v[156:159], s[74:75] offset:448 sc1
  s_lshl_b32 s55, s25, 7
  s_add_u32 s55, s55, 78782464
  s_waitcnt vmcnt(0)
  s_barrier
  s_cmp_eq_u32 s21, 0
  s_cbranch_scc0 Lsf_20
  v_mov_b32 v58, s55
  v_mov_b32 v59, 1
  global_store_dword v58, v59, s[16:17] sc1
Lsf_20:
  s_branch L_p2_main
L_p2_m3:
  s_mov_b32 s27, 0
  s_branch Lwc_22
Lwc_21:
  s_sleep 8
Lwc_22:
  global_load_dword v58, v3, s[18:19] offset:68 sc1
  s_add_u32 s27, s27, 1
  s_cmp_gt_u32 s27, 0x400000
  s_cbranch_scc1 L_end
  s_waitcnt vmcnt(0)
  v_readfirstlane_b32 s54, v58
  s_nop 0
  s_cmp_ge_u32 s54, 96
  s_cbranch_scc0 Lwc_21
  v_lshlrev_b32 v8, 7, v1
  v_add_u32 v8, 78774272, v8
  s_mov_b32 s27, 0
  s_branch Lwf_24
Lwf_23:
  s_sleep 2
Lwf_24:
  global_load_dword v9, v8, s[16:17] sc1
  s_add_u32 s27, s27, 1
  s_cmp_gt_u32 s27, 0x400000
  s_cbranch_scc1 L_end
  s_waitcnt vmcnt(0)
  v_cmp_ne_u32 vcc, 1, v9
  s_cbranch_vccnz Lwf_23
  s_add_u32 s74, s16, 79695872
  s_addc_u32 s75, s17, 0
  global_load_dwordx4 v[64:67], v2, s[74:75] offset:-4096 sc1
  global_load_dwordx4 v[68:71], v2, s[74:75] offset:-3072 sc1
  global_load_dwordx4 v[72:75], v2, s[74:75] offset:-2048 sc1
  global_load_dwordx4 v[76:79], v2, s[74:75] offset:-1024 sc1
  global_load_dwordx4 v[80:83], v2, s[74:75] offset:0 sc1
  global_load_dwordx4 v[84:87], v2, s[74:75] offset:1024 sc1
  global_load_dwordx4 v[88:91], v2, s[74:75] offset:2048 sc1
  global_load_dwordx4 v[92:95], v2, s[74:75] offset:3072 sc1
  s_waitcnt vmcnt(0)
  s_mov_b32 s55, 0
  v_max3_u32 v8, v64, v65, v66
  v_max3_u32 v8, v8, v67, v68
  v_max3_u32 v8, v8, v69, v70
  v_max3_u32 v8, v8, v71, v72
  v_max3_u32 v8, v8, v73, v74
  v_max3_u32 v8, v8, v75, v76
  v_max3_u32 v8, v8, v77, v78
  v_max3_u32 v8, v8, v79, v80
  v_max3_u32 v8, v8, v81, v82
  v_max3_u32 v8, v8, v83, v84
  v_max3_u32 v8, v8, v85, v86
  v_max3_u32 v8, v8, v87, v88
  v_max3_u32 v8, v8, v89, v90
  v_max3_u32 v8, v8, v91, v92
  v_max3_u32 v8, v8, v93, v94
  v_max_u32 v8, v8, v95
  s_nop 1
  v_max_u32_dpp v9, v8, v8 quad_perm:[1,0,3,2] row_mask:0xf bank_mask:0xf
  v_mov_b32 v8, v9
  s_nop 1
  v_max_u32_dpp v9, v8, v8 quad_perm:[2,3,0,1] row_mask:0xf bank_mask:0xf
  v_mov_b32 v8, v9
  s_nop 1
  v_max_u32_dpp v9, v8, v8 row_ror:4 row_mask:0xf bank_mask:0xf
  v_mov_b32 v8, v9
  s_nop 1
  v_max_u32_dpp v9, v8, v8 row_ror:8 row_mask:0xf bank_mask:0xf
  v_mov_b32 v8, v9
  v_mov_b32 v9, v8
  s_nop 1
  v_permlane16_swap_b32 v8, v9
  v_max_u32 v8, v8, v9
  v_mov_b32 v9, v8
  s_nop 1
  v_permlane32_swap_b32 v8, v9
  v_max_u32 v8, v8, v9
  s_nop 0
  v_readfirstlane_b32 s54, v8
  s_nop 0
  s_add_u32 s55, s55, s54
  s_mov_b32 s66, s55
  s_and_b32 s56, s55, 0xffff
  s_sub_u32 s56, 0xffff, s56
  s_and_b32 s42, s56, 2047
  v_subrev_u32 v64, s54, v64
  v_subrev_u32 v65, s54, v65
  v_subrev_u32 v66, s54, v66
  v_subrev_u32 v67, s54, v67
  v_subrev_u32 v68, s54, v68
  v_subrev_u32 v69, s54, v69
  v_subrev_u32 v70, s54, v70
  v_subrev_u32 v71, s54, v71
  v_subrev_u32 v72, s54, v72
  v_subrev_u32 v73, s54, v73
  v_subrev_u32 v74, s54, v74
  v_subrev_u32 v75, s54, v75
  v_subrev_u32 v76, s54, v76
  v_subrev_u32 v77, s54, v77
  v_subrev_u32 v78, s54, v78
  v_subrev_u32 v79, s54, v79
  v_subrev_u32 v80, s54, v80
  v_subrev_u32 v81, s54, v81
  v_subrev_u32 v82, s54, v82
  v_subrev_u32 v83, s54, v83
  v_subrev_u32 v84, s54, v84
  v_subrev_u32 v85, s54, v85
  v_subrev_u32 v86, s54, v86
  v_subrev_u32 v87, s54, v87
  v_subrev_u32 v88, s54, v88
  v_subrev_u32 v89, s54, v89
  v_subrev_u32 v90, s54, v90
  v_subrev_u32 v91, s54, v91
  v_subrev_u32 v92, s54, v92
  v_subrev_u32 v93, s54, v93
  v_subrev_u32 v94, s54, v94
  v_subrev_u32 v95, s54, v95
  v_max3_u32 v8, v64, v65, v66
  v_max3_u32 v8, v8, v67, v68
  v_max3_u32 v8, v8, v69, v70
  v_max3_u32 v8, v8, v71, v72
  v_max3_u32 v8, v8, v73, v74
  v_max3_u32 v8, v8, v75, v76
  v_max3_u32 v8, v8, v77, v78
  v_max3_u32 v8, v8, v79, v80
  v_max3_u32 v8, v8, v81, v82
  v_max3_u32 v8, v8, v83, v84
  v_max3_u32 v8, v8, v85, v86
  v_max3_u32 v8, v8, v87, v88
  v_max3_u32 v8, v8, v89, v90
  v_max3_u32 v8, v8, v91, v92
  v_max3_u32 v8, v8, v93, v94
  v_max_u32 v8, v8, v95
  s_nop 1
  v_max_u32_dpp v9, v8, v8 quad_perm:[1,0,3,2] row_mask:0xf bank_mask:0xf
  v_mov_b32 v8, v9
  s_nop 1
  v_max_u32_dpp v9, v8, v8 quad_perm:[2,3,0,1] row_mask:0xf bank_mask:0xf
  v_mov_b32 v8, v9
  s_nop 1
  v_max_u32_dpp v9, v8, v8 row_ror:4 row_mask:0xf bank_mask:0xf
  v_mov_b32 v8, v9
  s_nop 1
  v_max_u32_dpp v9, v8, v8 row_ror:8 row_mask:0xf bank_mask:0xf
  v_mov_b32 v8, v9
  v_mov_b32 v9, v8
  s_nop 1
  v_permlane16_swap_b32 v8, v9
  v_max_u32 v8, v8, v9
  v_mov_b32 v9, v8
  s_nop 1
  v_permlane32_swap_b32 v8, v9
  v_max_u32 v8, v8, v9
  s_nop 0
  v_readfirstlane_b32 s54, v8
  s_nop 0
  s_add_u32 s55, s55, s54
  s_mov_b32 s67, s55
  s_and_b32 s56, s55, 0xffff
  s_sub_u32 s56, 0xffff, s56
  s_and_b32 s43, s56, 2047
  v_subrev_u32 v64, s54, v64
  v_subrev_u32 v65, s54, v65
  v_subrev_u32 v66, s54, v66
  v_subrev_u32 v67, s54, v67
  v_subrev_u32 v68, s54, v68
  v_subrev_u32 v69, s54, v69
  v_subrev_u32 v70, s54, v70
  v_subrev_u32 v71, s54, v71
  v_subrev_u32 v72, s54, v72
  v_subrev_u32 v73, s54, v73
  v_subrev_u32 v74, s54, v74
  v_subrev_u32 v75, s54, v75
  v_subrev_u32 v76, s54, v76
  v_subrev_u32 v77, s54, v77
  v_subrev_u32 v78, s54, v78
  v_subrev_u32 v79, s54, v79
  v_subrev_u32 v80, s54, v80
  v_subrev_u32 v81, s54, v81
  v_subrev_u32 v82, s54, v82
  v_subrev_u32 v83, s54, v83
  v_subrev_u32 v84, s54, v84
  v_subrev_u32 v85, s54, v85
  v_subrev_u32 v86, s54, v86
  v_subrev_u32 v87, s54, v87
  v_subrev_u32 v88, s54, v88
  v_subrev_u32 v89, s54, v89
  v_subrev_u32 v90, s54, v90
  v_subrev_u32 v91, s54, v91
  v_subrev_u32 v92, s54, v92
  v_subrev_u32 v93, s54, v93
  v_subrev_u32 v94, s54, v94
  v_subrev_u32 v95, s54, v95
  v_max3_u32 v8, v64, v65, v66
  v_max3_u32 v8, v8, v67, v68
  v_max3_u32 v8, v8, v69, v70
  v_max3_u32 v8, v8, v71, v72
  v_max3_u32 v8, v8, v73, v74
  v_max3_u32 v8, v8, v75, v76
  v_max3_u32 v8, v8, v77, v78
  v_max3_u32 v8, v8, v79, v80
  v_max3_u32 v8, v8, v81, v82
  v_max3_u32 v8, v8, v83, v84
  v_max3_u32 v8, v8, v85, v86
  v_max3_u32 v8, v8, v87, v88
  v_max3_u32 v8, v8, v89, v90
  v_max3_u32 v8, v8, v91, v92
  v_max3_u32 v8, v8, v93, v94
  v_max_u32 v8, v8, v95
  s_nop 1
  v_max_u32_dpp v9, v8, v8 quad_perm:[1,0,3,2] row_mask:0xf bank_mask:0xf
  v_mov_b32 v8, v9
  s_nop 1
  v_max_u32_dpp v9, v8, v8 quad_perm:[2,3,0,1] row_mask:0xf bank_mask:0xf
  v_mov_b32 v8, v9
  s_nop 1
  v_max_u32_dpp v9, v8, v8 row_ror:4 row_mask:0xf bank_mask:0xf
  v_mov_b32 v8, v9
  s_nop 1
  v_max_u32_dpp v9, v8, v8 row_ror:8 row_mask:0xf bank_mask:0xf
  v_mov_b32 v8, v9
  v_mov_b32 v9, v8
  s_nop 1
  v_permlane16_swap_b32 v8, v9
  v_max_u32 v8, v8, v9
  v_mov_b32 v9, v8
  s_nop 1
  v_permlane32_swap_b32 v8, v9
  v_max_u32 v8, v8, v9
  s_nop 0
  v_readfirstlane_b32 s54, v8
  s_nop 0
  s_add_u32 s55, s55, s54
  s_mov_b32 s68, s55
  s_and_b32 s56, s55, 0xffff
  s_sub_u32 s56, 0xffff, s56
  s_and_b32 s44, s56, 2047
  v_subrev_u32 v64, s54, v64
  v_subrev_u32 v65, s54, v65
  v_subrev_u32 v66, s54, v66
  v_subrev_u32 v67, s54, v67
  v_subrev_u32 v68, s54, v68
  v_subrev_u32 v69, s54, v69
  v_subrev_u32 v70, s54, v70
  v_subrev_u32 v71, s54, v71
  v_subrev_u32 v72, s54, v72
  v_subrev_u32 v73, s54, v73
  v_subrev_u32 v74, s54, v74
  v_subrev_u32 v75, s54, v75
  v_subrev_u32 v76, s54, v76
  v_subrev_u32 v77, s54, v77
  v_subrev_u32 v78, s54, v78
  v_subrev_u32 v79, s54, v79
  v_subrev_u32 v80, s54, v80
  v_subrev_u32 v81, s54, v81
  v_subrev_u32 v82, s54, v82
  v_subrev_u32 v83, s54, v83
  v_subrev_u32 v84, s54, v84
  v_subrev_u32 v85, s54, v85
  v_subrev_u32 v86, s54, v86
  v_subrev_u32 v87, s54, v87
  v_subrev_u32 v88, s54, v88
  v_subrev_u32 v89, s54, v89
  v_subrev_u32 v90, s54, v90
  v_subrev_u32 v91, s54, v91
  v_subrev_u32 v92, s54, v92
  v_subrev_u32 v93, s54, v93
  v_subrev_u32 v94, s54, v94
  v_subrev_u32 v95, s54, v95
  v_max3_u32 v8, v64, v65, v66
  v_max3_u32 v8, v8, v67, v68
  v_max3_u32 v8, v8, v69, v70
  v_max3_u32 v8, v8, v71, v72
  v_max3_u32 v8, v8, v73, v74
  v_max3_u32 v8, v8, v75, v76
  v_max3_u32 v8, v8, v77, v78
  v_max3_u32 v8, v8, v79, v80
  v_max3_u32 v8, v8, v81, v82
  v_max3_u32 v8, v8, v83, v84
  v_max3_u32 v8, v8, v85, v86
  v_max3_u32 v8, v8, v87, v88
  v_max3_u32 v8, v8, v89, v90
  v_max3_u32 v8, v8, v91, v92
  v_max3_u32 v8, v8, v93, v94
  v_max_u32 v8, v8, v95
  s_nop 1
  v_max_u32_dpp v9, v8, v8 quad_perm:[1,0,3,2] row_mask:0xf bank_mask:0xf
  v_mov_b32 v8, v9
  s_nop 1
  v_max_u32_dpp v9, v8, v8 quad_perm:[2,3,0,1] row_mask:0xf bank_mask:0xf
  v_mov_b32 v8, v9
  s_nop 1
  v_max_u32_dpp v9, v8, v8 row_ror:4 row_mask:0xf bank_mask:0xf
  v_mov_b32 v8, v9
  s_nop 1
  v_max_u32_dpp v9, v8, v8 row_ror:8 row_mask:0xf bank_mask:0xf
  v_mov_b32 v8, v9
  v_mov_b32 v9, v8
  s_nop 1
  v_permlane16_swap_b32 v8, v9
  v_max_u32 v8, v8, v9
  v_mov_b32 v9, v8
  s_nop 1
  v_permlane32_swap_b32 v8, v9
  v_max_u32 v8, v8, v9
  s_nop 0
  v_readfirstlane_b32 s54, v8
  s_nop 0
  s_add_u32 s55, s55, s54
  s_mov_b32 s69, s55
  s_and_b32 s56, s55, 0xffff
  s_sub_u32 s56, 0xffff, s56
  s_and_b32 s45, s56, 2047
  v_subrev_u32 v64, s54, v64
  v_subrev_u32 v65, s54, v65
  v_subrev_u32 v66, s54, v66
  v_subrev_u32 v67, s54, v67
  v_subrev_u32 v68, s54, v68
  v_subrev_u32 v69, s54, v69
  v_subrev_u32 v70, s54, v70
  v_subrev_u32 v71, s54, v71
  v_subrev_u32 v72, s54, v72
  v_subrev_u32 v73, s54, v73
  v_subrev_u32 v74, s54, v74
  v_subrev_u32 v75, s54, v75
  v_subrev_u32 v76, s54, v76
  v_subrev_u32 v77, s54, v77
  v_subrev_u32 v78, s54, v78
  v_subrev_u32 v79, s54, v79
  v_subrev_u32 v80, s54, v80
  v_subrev_u32 v81, s54, v81
  v_subrev_u32 v82, s54, v82
  v_subrev_u32 v83, s54, v83
  v_subrev_u32 v84, s54, v84
  v_subrev_u32 v85, s54, v85
  v_subrev_u32 v86, s54, v86
  v_subrev_u32 v87, s54, v87
  v_subrev_u32 v88, s54, v88
  v_subrev_u32 v89, s54, v89
  v_subrev_u32 v90, s54, v90
  v_subrev_u32 v91, s54, v91
  v_subrev_u32 v92, s54, v92
  v_subrev_u32 v93, s54, v93
  v_subrev_u32 v94, s54, v94
  v_subrev_u32 v95, s54, v95
  v_max3_u32 v8, v64, v65, v66
  v_max3_u32 v8, v8, v67, v68
  v_max3_u32 v8, v8, v69, v70
  v_max3_u32 v8, v8, v71, v72
  v_max3_u32 v8, v8, v73, v74
  v_max3_u32 v8, v8, v75, v76
  v_max3_u32 v8, v8, v77, v78
  v_max3_u32 v8, v8, v79, v80
  v_max3_u32 v8, v8, v81, v82
  v_max3_u32 v8, v8, v83, v84
  v_max3_u32 v8, v8, v85, v86
  v_max3_u32 v8, v8, v87, v88
  v_max3_u32 v8, v8, v89, v90
  v_max3_u32 v8, v8, v91, v92
  v_max3_u32 v8, v8, v93, v94
  v_max_u32 v8, v8, v95
  s_nop 1
  v_max_u32_dpp v9, v8, v8 quad_perm:[1,0,3,2] row_mask:0xf bank_mask:0xf
  v_mov_b32 v8, v9
  s_nop 1
  v_max_u32_dpp v9, v8, v8 quad_perm:[2,3,0,1] row_mask:0xf bank_mask:0xf
  v_mov_b32 v8, v9
  s_nop 1
  v_max_u32_dpp v9, v8, v8 row_ror:4 row_mask:0xf bank_mask:0xf
  v_mov_b32 v8, v9
  s_nop 1
  v_max_u32_dpp v9, v8, v8 row_ror:8 row_mask:0xf bank_mask:0xf
  v_mov_b32 v8, v9
  v_mov_b32 v9, v8
  s_nop 1
  v_permlane16_swap_b32 v8, v9
  v_max_u32 v8, v8, v9
  v_mov_b32 v9, v8
  s_nop 1
  v_permlane32_swap_b32 v8, v9
  v_max_u32 v8, v8, v9
  s_nop 0
  v_readfirstlane_b32 s54, v8
  s_nop 0
  s_add_u32 s55, s55, s54
  s_mov_b32 s70, s55
  s_and_b32 s56, s55, 0xffff
  s_sub_u32 s56, 0xffff, s56
  s_and_b32 s46, s56, 2047
  v_subrev_u32 v64, s54, v64
  v_subrev_u32 v65, s54, v65
  v_subrev_u32 v66, s54, v66
  v_subrev_u32 v67, s54, v67
  v_subrev_u32 v68, s54, v68
  v_subrev_u32 v69, s54, v69
  v_subrev_u32 v70, s54, v70
  v_subrev_u32 v71, s54, v71
  v_subrev_u32 v72, s54, v72
  v_subrev_u32 v73, s54, v73
  v_subrev_u32 v74, s54, v74
  v_subrev_u32 v75, s54, v75
  v_subrev_u32 v76, s54, v76
  v_subrev_u32 v77, s54, v77
  v_subrev_u32 v78, s54, v78
  v_subrev_u32 v79, s54, v79
  v_subrev_u32 v80, s54, v80
  v_subrev_u32 v81, s54, v81
  v_subrev_u32 v82, s54, v82
  v_subrev_u32 v83, s54, v83
  v_subrev_u32 v84, s54, v84
  v_subrev_u32 v85, s54, v85
  v_subrev_u32 v86, s54, v86
  v_subrev_u32 v87, s54, v87
  v_subrev_u32 v88, s54, v88
  v_subrev_u32 v89, s54, v89
  v_subrev_u32 v90, s54, v90
  v_subrev_u32 v91, s54, v91
  v_subrev_u32 v92, s54, v92
  v_subrev_u32 v93, s54, v93
  v_subrev_u32 v94, s54, v94
  v_subrev_u32 v95, s54, v95
  v_max3_u32 v8, v64, v65, v66
  v_max3_u32 v8, v8, v67, v68
  v_max3_u32 v8, v8, v69, v70
  v_max3_u32 v8, v8, v71, v72
  v_max3_u32 v8, v8, v73, v74
  v_max3_u32 v8, v8, v75, v76
  v_max3_u32 v8, v8, v77, v78
  v_max3_u32 v8, v8, v79, v80
  v_max3_u32 v8, v8, v81, v82
  v_max3_u32 v8, v8, v83, v84
  v_max3_u32 v8, v8, v85, v86
  v_max3_u32 v8, v8, v87, v88
  v_max3_u32 v8, v8, v89, v90
  v_max3_u32 v8, v8, v91, v92
  v_max3_u32 v8, v8, v93, v94
  v_max_u32 v8, v8, v95
  s_nop 1
  v_max_u32_dpp v9, v8, v8 quad_perm:[1,0,3,2] row_mask:0xf bank_mask:0xf
  v_mov_b32 v8, v9
  s_nop 1
  v_max_u32_dpp v9, v8, v8 quad_perm:[2,3,0,1] row_mask:0xf bank_mask:0xf
  v_mov_b32 v8, v9
  s_nop 1
  v_max_u32_dpp v9, v8, v8 row_ror:4 row_mask:0xf bank_mask:0xf
  v_mov_b32 v8, v9
  s_nop 1
  v_max_u32_dpp v9, v8, v8 row_ror:8 row_mask:0xf bank_mask:0xf
  v_mov_b32 v8, v9
  v_mov_b32 v9, v8
  s_nop 1
  v_permlane16_swap_b32 v8, v9
  v_max_u32 v8, v8, v9
  v_mov_b32 v9, v8
  s_nop 1
  v_permlane32_swap_b32 v8, v9
  v_max_u32 v8, v8, v9
  s_nop 0
  v_readfirstlane_b32 s54, v8
  s_nop 0
  s_add_u32 s55, s55, s54
  s_mov_b32 s71, s55
  s_and_b32 s56, s55, 0xffff
  s_sub_u32 s56, 0xffff, s56
  s_and_b32 s47, s56, 2047
  v_subrev_u32 v64, s54, v64
  v_subrev_u32 v65, s54, v65
  v_subrev_u32 v66, s54, v66
  v_subrev_u32 v67, s54, v67
  v_subrev_u32 v68, s54, v68
  v_subrev_u32 v69, s54, v69
  v_subrev_u32 v70, s54, v70
  v_subrev_u32 v71, s54, v71
  v_subrev_u32 v72, s54, v72
  v_subrev_u32 v73, s54, v73
  v_subrev_u32 v74, s54, v74
  v_subrev_u32 v75, s54, v75
  v_subrev_u32 v76, s54, v76
  v_subrev_u32 v77, s54, v77
  v_subrev_u32 v78, s54, v78
  v_subrev_u32 v79, s54, v79
  v_subrev_u32 v80, s54, v80
  v_subrev_u32 v81, s54, v81
  v_subrev_u32 v82, s54, v82
  v_subrev_u32 v83, s54, v83
  v_subrev_u32 v84, s54, v84
  v_subrev_u32 v85, s54, v85
  v_subrev_u32 v86, s54, v86
  v_subrev_u32 v87, s54, v87
  v_subrev_u32 v88, s54, v88
  v_subrev_u32 v89, s54, v89
  v_subrev_u32 v90, s54, v90
  v_subrev_u32 v91, s54, v91
  v_subrev_u32 v92, s54, v92
  v_subrev_u32 v93, s54, v93
  v_subrev_u32 v94, s54, v94
  v_subrev_u32 v95, s54, v95
  v_max3_u32 v8, v64, v65, v66
  v_max3_u32 v8, v8, v67, v68
  v_max3_u32 v8, v8, v69, v70
  v_max3_u32 v8, v8, v71, v72
  v_max3_u32 v8, v8, v73, v74
  v_max3_u32 v8, v8, v75, v76
  v_max3_u32 v8, v8, v77, v78
  v_max3_u32 v8, v8, v79, v80
  v_max3_u32 v8, v8, v81, v82
  v_max3_u32 v8, v8, v83, v84
  v_max3_u32 v8, v8, v85, v86
  v_max3_u32 v8, v8, v87, v88
  v_max3_u32 v8, v8, v89, v90
  v_max3_u32 v8, v8, v91, v92
  v_max3_u32 v8, v8, v93, v94
  v_max_u32 v8, v8, v95
  s_nop 1
  v_max_u32_dpp v9, v8, v8 quad_perm:[1,0,3,2] row_mask:0xf bank_mask:0xf
  v_mov_b32 v8, v9
  s_nop 1
  v_max_u32_dpp v9, v8, v8 quad_perm:[2,3,0,1] row_mask:0xf bank_mask:0xf
  v_mov_b32 v8, v9
  s_nop 1
  v_max_u32_dpp v9, v8, v8 row_ror:4 row_mask:0xf bank_mask:0xf
  v_mov_b32 v8, v9
  s_nop 1
  v_max_u32_dpp v9, v8, v8 row_ror:8 row_mask:0xf bank_mask:0xf
  v_mov_b32 v8, v9
  v_mov_b32 v9, v8
  s_nop 1
  v_permlane16_swap_b32 v8, v9
  v_max_u32 v8, v8, v9
  v_mov_b32 v9, v8
  s_nop 1
  v_permlane32_swap_b32 v8, v9
  v_max_u32 v8, v8, v9
  s_nop 0
  v_readfirstlane_b32 s54, v8
  s_nop 0
  s_add_u32 s55, s55, s54
  s_mov_b32 s72, s55
  s_and_b32 s56, s55, 0xffff
  s_sub_u32 s56, 0xffff, s56
  s_and_b32 s48, s56, 2047
  v_subrev_u32 v64, s54, v64
  v_subrev_u32 v65, s54, v65
  v_subrev_u32 v66, s54, v66
  v_subrev_u32 v67, s54, v67
  v_subrev_u32 v68, s54, v68
  v_subrev_u32 v69, s54, v69
  v_subrev_u32 v70, s54, v70
  v_subrev_u32 v71, s54, v71
  v_subrev_u32 v72, s54, v72
  v_subrev_u32 v73, s54, v73
  v_subrev_u32 v74, s54, v74
  v_subrev_u32 v75, s54, v75
  v_subrev_u32 v76, s54, v76
  v_subrev_u32 v77, s54, v77
  v_subrev_u32 v78, s54, v78
  v_subrev_u32 v79, s54, v79
  v_subrev_u32 v80, s54, v80
  v_subrev_u32 v81, s54, v81
  v_subrev_u32 v82, s54, v82
  v_subrev_u32 v83, s54, v83
  v_subrev_u32 v84, s54, v84
  v_subrev_u32 v85, s54, v85
  v_subrev_u32 v86, s54, v86
  v_subrev_u32 v87, s54, v87
  v_subrev_u32 v88, s54, v88
  v_subrev_u32 v89, s54, v89
  v_subrev_u32 v90, s54, v90
  v_subrev_u32 v91, s54, v91
  v_subrev_u32 v92, s54, v92
  v_subrev_u32 v93, s54, v93
  v_subrev_u32 v94, s54, v94
  v_subrev_u32 v95, s54, v95
  v_max3_u32 v8, v64, v65, v66
  v_max3_u32 v8, v8, v67, v68
  v_max3_u32 v8, v8, v69, v70
  v_max3_u32 v8, v8, v71, v72
  v_max3_u32 v8, v8, v73, v74
  v_max3_u32 v8, v8, v75, v76
  v_max3_u32 v8, v8, v77, v78
  v_max3_u32 v8, v8, v79, v80
  v_max3_u32 v8, v8, v81, v82
  v_max3_u32 v8, v8, v83, v84
  v_max3_u32 v8, v8, v85, v86
  v_max3_u32 v8, v8, v87, v88
  v_max3_u32 v8, v8, v89, v90
  v_max3_u32 v8, v8, v91, v92
  v_max3_u32 v8, v8, v93, v94
  v_max_u32 v8, v8, v95
  s_nop 1
  v_max_u32_dpp v9, v8, v8 quad_perm:[1,0,3,2] row_mask:0xf bank_mask:0xf
  v_mov_b32 v8, v9
  s_nop 1
  v_max_u32_dpp v9, v8, v8 quad_perm:[2,3,0,1] row_mask:0xf bank_mask:0xf
  v_mov_b32 v8, v9
  s_nop 1
  v_max_u32_dpp v9, v8, v8 row_ror:4 row_mask:0xf bank_mask:0xf
  v_mov_b32 v8, v9
  s_nop 1
  v_max_u32_dpp v9, v8, v8 row_ror:8 row_mask:0xf bank_mask:0xf
  v_mov_b32 v8, v9
  v_mov_b32 v9, v8
  s_nop 1
  v_permlane16_swap_b32 v8, v9
  v_max_u32 v8, v8, v9
  v_mov_b32 v9, v8
  s_nop 1
  v_permlane32_swap_b32 v8, v9
  v_max_u32 v8, v8, v9
  s_nop 0
  v_readfirstlane_b32 s54, v8
  s_nop 0
  s_add_u32 s55, s55, s54
  s_mov_b32 s73, s55
  s_and_b32 s56, s55, 0xffff
  s_sub_u32 s56, 0xffff, s56
  s_and_b32 s49, s56, 2047
  v_min_u32 v8, 27, v1
  v_lshlrev_b32 v8, 7, v8
  v_add_u32 v8, 78782464, v8
  s_mov_b32 s27, 0
  s_branch Lwf_26
Lwf_25:
  s_sleep 2
Lwf_26:
  global_load_dword v9, v8, s[16:17] sc1
  s_add_u32 s27, s27, 1
  s_cmp_gt_u32 s27, 0x400000
  s_cbranch_scc1 L_end
  s_waitcnt vmcnt(0)
  v_cmp_ne_u32 vcc, 1, v9
  s_cbranch_vccnz Lwf_25
  s_sub_u32 s57, s25, 28
  s_lshl_b32 s57, s57, 1
  s_lshr_b32 s54, s21, 1
  s_add_u32 s57, s57, s54
  s_mov_b32 s55, s42
  s_mov_b32 s56, s66
  s_cmp_eq_u32 s57, 1
  s_cselect_b32 s55, s43, s55
  s_cselect_b32 s56, s67, s56
  s_cmp_eq_u32 s57, 2
  s_cselect_b32 s55, s44, s55
  s_cselect_b32 s56, s68, s56
  s_cmp_eq_u32 s57, 3
  s_cselect_b32 s55, s45, s55
  s_cselect_b32 s56, s69, s56
  s_cmp_eq_u32 s57, 4
  s_cselect_b32 s55, s46, s55
  s_cselect_b32 s56, s70, s56
  s_cmp_eq_u32 s57, 5
  s_cselect_b32 s55, s47, s55
  s_cselect_b32 s56, s71, s56
  s_cmp_eq_u32 s57, 6
  s_cselect_b32 s55, s48, s55
  s_cselect_b32 s56, s72, s56
  s_cmp_eq_u32 s57, 7
  s_cselect_b32 s55, s49, s55
  s_cselect_b32 s56, s73, s56
  s_and_b32 s54, s21, 1
  s_lshl_b32 s54, s54, 10
  v_add_u32 v8, s54, v2
  v_lshrrev_b32 v9, 1, v8
  s_lshl_b32 s54, s57, 11
  s_add_u32 s54, s54, 79725568
  s_add_u32 s74, s16, s54
  s_addc_u32 s75, s17, 0
  global_load_dwordx4 v[64:67], v8, s[74:75] sc1
  s_add_u32 s74, s74, 16384
  s_addc_u32 s75, s75, 0
  global_load_dwordx4 v[68:71], v8, s[74:75] sc1
  s_add_u32 s74, s74, 16384
  s_addc_u32 s75, s75, 0
  global_load_dwordx4 v[72:75], v8, s[74:75] sc1
  s_add_u32 s74, s74, 16384
  s_addc_u32 s75, s75, 0
  global_load_dwordx4 v[76:79], v8, s[74:75] sc1
  s_add_u32 s74, s74, 16384
  s_addc_u32 s75, s75, 0
  global_load_dwordx4 v[80:83], v8, s[74:75] sc1
  s_add_u32 s74, s74, 16384
  s_addc_u32 s75, s75, 0
  global_load_dwordx4 v[84:87], v8, s[74:75] sc1
  s_add_u32 s74, s74, 16384
  s_addc_u32 s75, s75, 0
  global_load_dwordx4 v[88:91], v8, s[74:75] sc1
  s_add_u32 s74, s74, 16384
  s_addc_u32 s75, s75, 0
  global_load_dwordx4 v[92:95], v8, s[74:75] sc1
  s_add_u32 s74, s74, 16384
  s_addc_u32 s75, s75, 0
  global_load_dwordx4 v[96:99], v8, s[74:75] sc1
  s_add_u32 s74, s74, 16384
  s_addc_u32 s75, s75, 0
  global_load_dwordx4 v[100:103], v8, s[74:75] sc1
  s_add_u32 s74, s74, 16384
  s_addc_u32 s75, s75, 0
  global_load_dwordx4 v[104:107], v8, s[74:75] sc1
  s_add_u32 s74, s74, 16384
  s_addc_u32 s75, s75, 0
  global_load_dwordx4 v[108:111], v8, s[74:75] sc1
  s_add_u32 s74, s74, 16384
  s_addc_u32 s75, s75, 0
  global_load_dwordx4 v[112:115], v8, s[74:75] sc1
  s_add_u32 s74, s74, 16384
  s_addc_u32 s75, s75, 0
  global_load_dwordx4 v[116:119], v8, s[74:75] sc1
  s_add_u32 s74, s74, 16384
  s_addc_u32 s75, s75, 0
  global_load_dwordx4 v[120:123], v8, s[74:75] sc1
  s_add_u32 s74, s74, 16384
  s_addc_u32 s75, s75, 0
  global_load_dwordx4 v[124:127], v8, s[74:75] sc1
  s_add_u32 s74, s74, 16384
  s_addc_u32 s75, s75, 0
  global_load_dwordx4 v[128:131], v8, s[74:75] sc1
  s_add_u32 s74, s74, 16384
  s_addc_u32 s75, s75, 0
  global_load_dwordx4 v[132:135], v8, s[74:75] sc1
  s_add_u32 s74, s74, 16384
  s_addc_u32 s75, s75, 0
  global_load_dwordx4 v[136:139], v8, s[74:75] sc1
  s_add_u32 s74, s74, 16384
  s_addc_u32 s75, s75, 0
  global_load_dwordx4 v[140:143], v8, s[74:75] sc1
  s_add_u32 s74, s74, 16384
  s_addc_u32 s75, s75, 0
  global_load_dwordx4 v[144:147], v8, s[74:75] sc1
  s_add_u32 s74, s74, 16384
  s_addc_u32 s75, s75, 0
  global_load_dwordx4 v[148:151], v8, s[74:75] sc1
  s_add_u32 s74, s74, 16384
  s_addc_u32 s75, s75, 0
  global_load_dwordx4 v[152:155], v8, s[74:75] sc1
  s_add_u32 s74, s74, 16384
  s_addc_u32 s75, s75, 0
  global_load_dwordx4 v[156:159], v8, s[74:75] sc1
  s_add_u32 s74, s74, 16384
  s_addc_u32 s75, s75, 0
  global_load_dwordx4 v[160:163], v8, s[74:75] sc1
  s_add_u32 s74, s74, 16384
  s_addc_u32 s75, s75, 0
  global_load_dwordx4 v[164:167], v8, s[74:75] sc1
  s_add_u32 s74, s74, 16384
  s_addc_u32 s75, s75, 0
  global_load_dwordx4 v[168:171], v8, s[74:75] sc1
  s_add_u32 s74, s74, 16384
  s_addc_u32 s75, s75, 0
  global_load_dwordx4 v[172:175], v8, s[74:75] sc1
  s_add_u32 s74, s74, 16384
  s_addc_u32 s75, s75, 0
  s_lshl_b32 s54, s55, 10
  s_add_u32 s76, s4, s54
  s_addc_u32 s77, s5, 0
  global_load_dwordx2 v[10:11], v9, s[76:77]
  s_and_b32 s56, s56, 0xffff0000
  v_mov_b32 v12, s56
  v_ashrrev_i32 v13, 31, v12
  v_not_b32 v13, v13
  v_or_b32 v13, 0x80000000, v13
  v_xor_b32 v12, v12, v13
  v_and_b32 v12, 0xffff0000, v12
  v_mul_f32 v13, 0xbfb8aa3b, v12
  v_exp_f32 v13, v13
  s_nop 0
  v_add_f32 v13, 1.0, v13
  v_rcp_f32 v13, v13
  s_nop 0
  v_cvt_pk_bf16_f32 v13, v13, v13
  v_and_b32 v13, 0xffff0000, v13
  s_waitcnt vmcnt(0)
  v_add_f32 v64, v64, v68
  v_add_f32 v65, v65, v69
  v_add_f32 v66, v66, v70
  v_add_f32 v67, v67, v71
  v_add_f32 v64, v64, v72
  v_add_f32 v65, v65, v73
  v_add_f32 v66, v66, v74
  v_add_f32 v67, v67, v75
  v_add_f32 v64, v64, v76
  v_add_f32 v65, v65, v77
  v_add_f32 v66, v66, v78
  v_add_f32 v67, v67, v79
  v_add_f32 v64, v64, v80
  v_add_f32 v65, v65, v81
  v_add_f32 v66, v66, v82
  v_add_f32 v67, v67, v83
  v_add_f32 v64, v64, v84
  v_add_f32 v65, v65, v85
  v_add_f32 v66, v66, v86
  v_add_f32 v67, v67, v87
  v_add_f32 v64, v64, v88
  v_add_f32 v65, v65, v89
  v_add_f32 v66, v66, v90
  v_add_f32 v67, v67, v91
  v_add_f32 v64, v64, v92
  v_add_f32 v65, v65, v93
  v_add_f32 v66, v66, v94
  v_add_f32 v67, v67, v95
  v_add_f32 v64, v64, v96
  v_add_f32 v65, v65, v97
  v_add_f32 v66, v66, v98
  v_add_f32 v67, v67, v99
  v_add_f32 v64, v64, v100
  v_add_f32 v65, v65, v101
  v_add_f32 v66, v66, v102
  v_add_f32 v67, v67, v103
  v_add_f32 v64, v64, v104
  v_add_f32 v65, v65, v105
  v_add_f32 v66, v66, v106
  v_add_f32 v67, v67, v107
  v_add_f32 v64, v64, v108
  v_add_f32 v65, v65, v109
  v_add_f32 v66, v66, v110
  v_add_f32 v67, v67, v111
  v_add_f32 v64, v64, v112
  v_add_f32 v65, v65, v113
  v_add_f32 v66, v66, v114
  v_add_f32 v67, v67, v115
  v_add_f32 v64, v64, v116
  v_add_f32 v65, v65, v117
  v_add_f32 v66, v66, v118
  v_add_f32 v67, v67, v119
  v_add_f32 v64, v64, v120
  v_add_f32 v65, v65, v121
  v_add_f32 v66, v66, v122
  v_add_f32 v67, v67, v123
  v_add_f32 v64, v64, v124
  v_add_f32 v65, v65, v125
  v_add_f32 v66, v66, v126
  v_add_f32 v67, v67, v127
  v_add_f32 v64, v64, v128
  v_add_f32 v65, v65, v129
  v_add_f32 v66, v66, v130
  v_add_f32 v67, v67, v131
  v_add_f32 v64, v64, v132
  v_add_f32 v65, v65, v133
  v_add_f32 v66, v66, v134
  v_add_f32 v67, v67, v135
  v_add_f32 v64, v64, v136
  v_add_f32 v65, v65, v137
  v_add_f32 v66, v66, v138
  v_add_f32 v67, v67, v139
  v_add_f32 v64, v64, v140
  v_add_f32 v65, v65, v141
  v_add_f32 v66, v66, v142
  v_add_f32 v67, v67, v143
  v_add_f32 v64, v64, v144
  v_add_f32 v65, v65, v145
  v_add_f32 v66, v66, v146
  v_add_f32 v67, v67, v147
  v_add_f32 v64, v64, v148
  v_add_f32 v65, v65, v149
  v_add_f32 v66, v66, v150
  v_add_f32 v67, v67, v151
  v_add_f32 v64, v64, v152
  v_add_f32 v65, v65, v153
  v_add_f32 v66, v66, v154
  v_add_f32 v67, v67, v155
  v_add_f32 v64, v64, v156
  v_add_f32 v65, v65, v157
  v_add_f32 v66, v66, v158
  v_add_f32 v67, v67, v159
  v_add_f32 v64, v64, v160
  v_add_f32 v65, v65, v161
  v_add_f32 v66, v66, v162
  v_add_f32 v67, v67, v163
  v_add_f32 v64, v64, v164
  v_add_f32 v65, v65, v165
  v_add_f32 v66, v66, v166
  v_add_f32 v67, v67, v167
  v_add_f32 v64, v64, v168
  v_add_f32 v65, v65, v169
  v_add_f32 v66, v66, v170
  v_add_f32 v67, v67, v171
  v_add_f32 v64, v64, v172
  v_add_f32 v65, v65, v173
  v_add_f32 v66, v66, v174
  v_add_f32 v67, v67, v175
  v_lshlrev_b32 v14, 16, v10
  v_and_b32 v15, 0xffff0000, v10
  v_lshlrev_b32 v16, 16, v11
  v_and_b32 v17, 0xffff0000, v11
  v_cvt_pk_bf16_f32 v64, v64, v64
  v_and_b32 v64, 0xffff0000, v64
  v_mul_f32 v64, v64, v13
  v_cvt_pk_bf16_f32 v64, v64, v64
  v_and_b32 v64, 0xffff0000, v64
  v_add_f32 v64, v64, v14
  v_cvt_pk_bf16_f32 v65, v65, v65
  v_and_b32 v65, 0xffff0000, v65
  v_mul_f32 v65, v65, v13
  v_cvt_pk_bf16_f32 v65, v65, v65
  v_and_b32 v65, 0xffff0000, v65
  v_add_f32 v65, v65, v15
  v_cvt_pk_bf16_f32 v66, v66, v66
  v_and_b32 v66, 0xffff0000, v66
  v_mul_f32 v66, v66, v13
  v_cvt_pk_bf16_f32 v66, v66, v66
  v_and_b32 v66, 0xffff0000, v66
  v_add_f32 v66, v66, v16
  v_cvt_pk_bf16_f32 v67, v67, v67
  v_and_b32 v67, 0xffff0000, v67
  v_mul_f32 v67, v67, v13
  v_cvt_pk_bf16_f32 v67, v67, v67
  v_and_b32 v67, 0xffff0000, v67
  v_add_f32 v67, v67, v17
  v_cvt_pk_bf16_f32 v10, v64, v65
  v_cvt_pk_bf16_f32 v11, v66, v67
  s_lshl_b32 s54, s57, 10
  s_add_u32 s54, s54, 79717376
  s_add_u32 s74, s16, s54
  s_addc_u32 s75, s17, 0
  global_store_dwordx2 v9, v[10:11], s[74:75] sc1
  s_lshl_b32 s54, s57, 7
  s_add_u32 s54, s54, 79716352
  v_mov_b32 v12, s54
  v_mov_b32 v13, s55
  global_store_dword v12, v13, s[16:17] sc1
  s_sub_u32 s55, s25, 28
  s_lshl_b32 s55, s55, 7
  s_add_u32 s55, s55, 78786560
  s_waitcnt vmcnt(0)
  s_barrier
  s_cmp_eq_u32 s21, 0
  s_cbranch_scc0 Lsf_27
  v_mov_b32 v58, s55
  v_mov_b32 v59, 1
  global_store_dword v58, v59, s[16:17] sc1
Lsf_27:
L_p2_main:
  v_lshlrev_b32 v16, 4, v0
  s_barrier
  s_add_u32 s64, s62, 24576
  s_addc_u32 s65, s63, 0
  global_load_dwordx4 v[4:7], v16, s[64:65]
  s_add_u32 s64, s62, 28672
  s_addc_u32 s65, s63, 0
  global_load_dwordx4 v[8:11], v16, s[64:65]
  s_add_u32 s64, s62, 32768
  s_addc_u32 s65, s63, 0
  global_load_dwordx4 v[12:15], v16, s[64:65]
  s_lshl_b32 s20, s23, 2
  s_add_u32 s20, s20, s21
  s_lshl_b32 s54, s20, 17
  s_lshl_b32 s55, s24, 8
  s_add_u32 s54, s54, s55
  s_add_u32 s74, s14, s54
  s_addc_u32 s75, s15, 0
  s_lshl_b32 s56, s21, 15
  s_waitcnt vmcnt(0)
  s_add_u32 m0, s56, 0
  s_nop 0
  global_load_lds_dwordx4 v4, s[74:75]
  s_add_u32 s74, s74, 4096
  s_addc_u32 s75, s75, 0
  s_add_u32 m0, s56, 1024
  s_nop 0
  global_load_lds_dwordx4 v4, s[74:75]
  s_add_u32 s74, s74, 4096
  s_addc_u32 s75, s75, 0
  s_add_u32 m0, s56, 2048
  s_nop 0
  global_load_lds_dwordx4 v4, s[74:75]
  s_add_u32 s74, s74, 4096
  s_addc_u32 s75, s75, 0
  s_add_u32 m0, s56, 3072
  s_nop 0
  global_load_lds_dwordx4 v4, s[74:75]
  s_add_u32 s74, s74, 4096
  s_addc_u32 s75, s75, 0
  s_add_u32 m0, s56, 4096
  s_nop 0
  global_load_lds_dwordx4 v4, s[74:75]
  s_add_u32 s74, s74, 4096
  s_addc_u32 s75, s75, 0
  s_add_u32 m0, s56, 5120
  s_nop 0
  global_load_lds_dwordx4 v4, s[74:75]
  s_add_u32 s74, s74, 4096
  s_addc_u32 s75, s75, 0
  s_add_u32 m0, s56, 6144
  s_nop 0
  global_load_lds_dwordx4 v4, s[74:75]
  s_add_u32 s74, s74, 4096
  s_addc_u32 s75, s75, 0
  s_add_u32 m0, s56, 7168
  s_nop 0
  global_load_lds_dwordx4 v4, s[74:75]
  s_add_u32 s74, s74, 4096
  s_addc_u32 s75, s75, 0
  s_add_u32 m0, s56, 8192
  s_nop 0
  global_load_lds_dwordx4 v4, s[74:75]
  s_add_u32 s74, s74, 4096
  s_addc_u32 s75, s75, 0
  s_add_u32 m0, s56, 9216
  s_nop 0
  global_load_lds_dwordx4 v4, s[74:75]
  s_add_u32 s74, s74, 4096
  s_addc_u32 s75, s75, 0
  s_add_u32 m0, s56, 10240
  s_nop 0
  global_load_lds_dwordx4 v4, s[74:75]
  s_add_u32 s74, s74, 4096
  s_addc_u32 s75, s75, 0
  s_add_u32 m0, s56, 11264
  s_nop 0
  global_load_lds_dwordx4 v4, s[74:75]
  s_add_u32 s74, s74, 4096
  s_addc_u32 s75, s75, 0
  s_add_u32 m0, s56, 12288
  s_nop 0
  global_load_lds_dwordx4 v4, s[74:75]
  s_add_u32 s74, s74, 4096
  s_addc_u32 s75, s75, 0
  s_add_u32 m0, s56, 13312
  s_nop 0
  global_load_lds_dwordx4 v4, s[74:75]
  s_add_u32 s74, s74, 4096
  s_addc_u32 s75, s75, 0
  s_add_u32 m0, s56, 14336
  s_nop 0
  global_load_lds_dwordx4 v4, s[74:75]
  s_add_u32 s74, s74, 4096
  s_addc_u32 s75, s75, 0
  s_add_u32 m0, s56, 15360
  s_nop 0
  global_load_lds_dwordx4 v4, s[74:75]
  s_add_u32 s74, s74, 4096
  s_addc_u32 s75, s75, 0
  s_add_u32 m0, s56, 16384
  s_nop 0
  global_load_lds_dwordx4 v4, s[74:75]
  s_add_u32 s74, s74, 4096
  s_addc_u32 s75, s75, 0
  s_add_u32 m0, s56, 17408
  s_nop 0
  global_load_lds_dwordx4 v4, s[74:75]
  s_add_u32 s74, s74, 4096
  s_addc_u32 s75, s75, 0
  s_add_u32 m0, s56, 18432
  s_nop 0
  global_load_lds_dwordx4 v4, s[74:75]
  s_add_u32 s74, s74, 4096
  s_addc_u32 s75, s75, 0
  s_add_u32 m0, s56, 19456
  s_nop 0
  global_load_lds_dwordx4 v4, s[74:75]
  s_add_u32 s74, s74, 4096
  s_addc_u32 s75, s75, 0
  s_add_u32 m0, s56, 20480
  s_nop 0
  global_load_lds_dwordx4 v4, s[74:75]
  s_add_u32 s74, s74, 4096
  s_addc_u32 s75, s75, 0
  s_add_u32 m0, s56, 21504
  s_nop 0
  global_load_lds_dwordx4 v4, s[74:75]
  s_add_u32 s74, s74, 4096
  s_addc_u32 s75, s75, 0
  s_add_u32 m0, s56, 22528
  s_nop 0
  global_load_lds_dwordx4 v4, s[74:75]
  s_add_u32 s74, s74, 4096
  s_addc_u32 s75, s75, 0
  s_add_u32 m0, s56, 23552
  s_nop 0
  global_load_lds_dwordx4 v4, s[74:75]
  s_add_u32 s74, s74, 4096
  s_addc_u32 s75, s75, 0
  s_add_u32 m0, s56, 24576
  s_nop 0
  global_load_lds_dwordx4 v4, s[74:75]
  s_add_u32 s74, s74, 4096
  s_addc_u32 s75, s75, 0
  s_add_u32 m0, s56, 25600
  s_nop 0
  global_load_lds_dwordx4 v4, s[74:75]
  s_add_u32 s74, s74, 4096
  s_addc_u32 s75, s75, 0
  s_add_u32 m0, s56, 26624
  s_nop 0
  global_load_lds_dwordx4 v4, s[74:75]
  s_add_u32 s74, s74, 4096
  s_addc_u32 s75, s75, 0
  s_add_u32 m0, s56, 27648
  s_nop 0
  global_load_lds_dwordx4 v4, s[74:75]
  s_add_u32 s74, s74, 4096
  s_addc_u32 s75, s75, 0
  s_add_u32 m0, s56, 28672
  s_nop 0
  global_load_lds_dwordx4 v4, s[74:75]
  s_add_u32 s74, s74, 4096
  s_addc_u32 s75, s75, 0
  s_add_u32 m0, s56, 29696
  s_nop 0
  global_load_lds_dwordx4 v4, s[74:75]
  s_add_u32 s74, s74, 4096
  s_addc_u32 s75, s75, 0
  s_add_u32 m0, s56, 30720
  s_nop 0
  global_load_lds_dwordx4 v4, s[74:75]
  s_add_u32 s74, s74, 4096
  s_addc_u32 s75, s75, 0
  s_add_u32 m0, s56, 31744
  s_nop 0
  global_load_lds_dwordx4 v4, s[74:75]
  s_add_u32 s74, s74, 4096
  s_addc_u32 s75, s75, 0
  s_waitcnt vmcnt(0)
  ds_read_b64_tr_b16 a[0:1], v8 offset:0
  ds_read_b64_tr_b16 a[2:3], v8 offset:2048
  ds_read_b64_tr_b16 a[4:5], v8 offset:4096
  ds_read_b64_tr_b16 a[6:7], v8 offset:6144
  ds_read_b64_tr_b16 a[8:9], v8 offset:8192
  ds_read_b64_tr_b16 a[10:11], v8 offset:10240
  ds_read_b64_tr_b16 a[12:13], v8 offset:12288
  ds_read_b64_tr_b16 a[14:15], v8 offset:14336
  s_waitcnt lgkmcnt(0)
  ds_read_b64_tr_b16 a[16:17], v8 offset:16384
  ds_read_b64_tr_b16 a[18:19], v8 offset:18432
  ds_read_b64_tr_b16 a[20:21], v8 offset:20480
  ds_read_b64_tr_b16 a[22:23], v8 offset:22528
  ds_read_b64_tr_b16 a[24:25], v8 offset:24576
  ds_read_b64_tr_b16 a[26:27], v8 offset:26624
  ds_read_b64_tr_b16 a[28:29], v8 offset:28672
  ds_read_b64_tr_b16 a[30:31], v8 offset:30720
  s_waitcnt lgkmcnt(0)
  ds_read_b64_tr_b16 a[32:33], v9 offset:0
  ds_read_b64_tr_b16 a[34:35], v9 offset:2048
  ds_read_b64_tr_b16 a[36:37], v9 offset:4096
  ds_read_b64_tr_b16 a[38:39], v9 offset:6144
  ds_read_b64_tr_b16 a[40:41], v9 offset:8192
  ds_read_b64_tr_b16 a[42:43], v9 offset:10240
  ds_read_b64_tr_b16 a[44:45], v9 offset:12288
  ds_read_b64_tr_b16 a[46:47], v9 offset:14336
  s_waitcnt lgkmcnt(0)
  ds_read_b64_tr_b16 a[48:49], v9 offset:16384
  ds_read_b64_tr_b16 a[50:51], v9 offset:18432
  ds_read_b64_tr_b16 a[52:53], v9 offset:20480
  ds_read_b64_tr_b16 a[54:55], v9 offset:22528
  ds_read_b64_tr_b16 a[56:57], v9 offset:24576
  ds_read_b64_tr_b16 a[58:59], v9 offset:26624
  ds_read_b64_tr_b16 a[60:61], v9 offset:28672
  ds_read_b64_tr_b16 a[62:63], v9 offset:30720
  s_waitcnt lgkmcnt(0)
  ds_read_b64_tr_b16 a[64:65], v10 offset:0
  ds_read_b64_tr_b16 a[66:67], v10 offset:2048
  ds_read_b64_tr_b16 a[68:69], v10 offset:4096
  ds_read_b64_tr_b16 a[70:71], v10 offset:6144
  ds_read_b64_tr_b16 a[72:73], v10 offset:8192
  ds_read_b64_tr_b16 a[74:75], v10 offset:10240
  ds_read_b64_tr_b16 a[76:77], v10 offset:12288
  ds_read_b64_tr_b16 a[78:79], v10 offset:14336
  s_waitcnt lgkmcnt(0)
  ds_read_b64_tr_b16 a[80:81], v10 offset:16384
  ds_read_b64_tr_b16 a[82:83], v10 offset:18432
  ds_read_b64_tr_b16 a[84:85], v10 offset:20480
  ds_read_b64_tr_b16 a[86:87], v10 offset:22528
  ds_read_b64_tr_b16 a[88:89], v10 offset:24576
  ds_read_b64_tr_b16 a[90:91], v10 offset:26624
  ds_read_b64_tr_b16 a[92:93], v10 offset:28672
  ds_read_b64_tr_b16 a[94:95], v10 offset:30720
  s_waitcnt lgkmcnt(0)
  ds_read_b64_tr_b16 a[96:97], v11 offset:0
  ds_read_b64_tr_b16 a[98:99], v11 offset:2048
  ds_read_b64_tr_b16 a[100:101], v11 offset:4096
  ds_read_b64_tr_b16 a[102:103], v11 offset:6144
  ds_read_b64_tr_b16 a[104:105], v11 offset:8192
  ds_read_b64_tr_b16 a[106:107], v11 offset:10240
  ds_read_b64_tr_b16 a[108:109], v11 offset:12288
  ds_read_b64_tr_b16 a[110:111], v11 offset:14336
  s_waitcnt lgkmcnt(0)
  ds_read_b64_tr_b16 a[112:113], v11 offset:16384
  ds_read_b64_tr_b16 a[114:115], v11 offset:18432
  ds_read_b64_tr_b16 a[116:117], v11 offset:20480
  ds_read_b64_tr_b16 a[118:119], v11 offset:22528
  ds_read_b64_tr_b16 a[120:121], v11 offset:24576
  ds_read_b64_tr_b16 a[122:123], v11 offset:26624
  ds_read_b64_tr_b16 a[124:125], v11 offset:28672
  ds_read_b64_tr_b16 a[126:127], v11 offset:30720
  s_waitcnt lgkmcnt(0)
  s_mov_b32 s27, 0
  s_branch Lwc_29
Lwc_28:
  s_sleep 8
Lwc_29:
  global_load_dword v16, v3, s[18:19] offset:68 sc1
  s_add_u32 s27, s27, 1
  s_cmp_gt_u32 s27, 0x400000
  s_cbranch_scc1 L_end
  s_waitcnt vmcnt(0)
  v_readfirstlane_b32 s54, v16
  s_nop 0
  s_cmp_ge_u32 s54, 96
  s_cbranch_scc0 Lwc_28
  v_and_b32 v16, 3, v1
  s_lshl_b32 s54, s20, 2
  v_add_u32 v16, s54, v16
  v_lshlrev_b32 v16, 7, v16
  v_add_u32 v16, 78790720, v16
  s_mov_b32 s27, 0
  s_branch Lwf_31
Lwf_30:
  s_sleep 8
Lwf_31:
  global_load_dword v17, v16, s[16:17] sc1
  s_add_u32 s27, s27, 1
  s_cmp_gt_u32 s27, 0x400000
  s_cbranch_scc1 L_end
  s_waitcnt vmcnt(0)
  v_cmp_ne_u32 vcc, 1, v17
  s_cbranch_vccnz Lwf_30
  s_mov_b32 s28, s22
  s_mov_b32 s82, 0
  s_mov_b32 s29, 1
  s_mov_b32 s83, 1
  s_mov_b64 s[84:85], s[30:31]
  s_barrier
L_p2_seg:
  s_cmp_ge_u32 s21, 2
  s_cbranch_scc1 L_p2_pre_skip
  s_cmp_eq_u32 s83, 0
  s_cbranch_scc1 L_p2_nf
  v_and_b32 v16, 3, v1
  v_lshlrev_b32 v16, 7, v16
  v_add_u32 v16, 78786560, v16
  s_mov_b32 s27, 0
  s_branch Lwf_33
Lwf_32:
  s_sleep 8
Lwf_33:
  global_load_dword v17, v16, s[16:17] sc1
  s_add_u32 s27, s27, 1
  s_cmp_gt_u32 s27, 0x400000
  s_cbranch_scc1 L_end
  s_waitcnt vmcnt(0)
  v_cmp_ne_u32 vcc, 1, v17
  s_cbranch_vccnz Lwf_32
  v_and_b32 v16, 7, v1
  v_lshlrev_b32 v16, 7, v16
  v_add_u32 v16, 79716352, v16
  global_load_dword v17, v16, s[16:17] sc1
  s_waitcnt vmcnt(0)
  v_readlane_b32 s42, v17, 0
  v_readlane_b32 s43, v17, 1
  v_readlane_b32 s44, v17, 2
  v_readlane_b32 s45, v17, 3
  v_readlane_b32 s46, v17, 4
  v_readlane_b32 s47, v17, 5
  v_readlane_b32 s48, v17, 6
  v_readlane_b32 s49, v17, 7
L_p2_nf:
  s_lshl_b32 s54, s28, 15
  s_lshl_b32 s55, s24, 8
  s_lshl_b32 s56, s23, 5
  s_add_u32 s55, s55, s56
  s_add_u32 s54, s54, s55
  s_add_u32 s74, s4, s54
  s_addc_u32 s75, s5, 0
  s_add_u32 s84, s30, s54
  s_addc_u32 s85, s31, 0
  s_lshl_b32 s54, s28, 8
  s_add_u32 s54, s54, 79699968
  s_add_u32 s80, s16, s54
  s_addc_u32 s81, s17, 0
  global_load_dwordx2 v[26:27], v14, s[74:75]
  global_load_dwordx2 v[28:29], v15, s[80:81] sc1
  s_lshl_b32 s54, s28, 5
  v_and_b32 v16, 31, v1
  v_add_u32 v16, s54, v16
  v_and_b32 v17, 0x3ff, v14
  s_add_u32 s55, s55, 79717376
  v_add_u32 v17, s55, v17
  s_waitcnt vmcnt(0)
  v_cmp_eq_u32 vcc, s42, v16
  s_cbranch_vccz Lsel_34
  s_mov_b64 exec, vcc
  v_add_u32 v23, 0, v17
  global_load_dwordx2 v[26:27], v23, s[16:17] sc1
  s_waitcnt vmcnt(0)
  s_mov_b64 exec, -1
Lsel_34:
  v_cmp_eq_u32 vcc, s43, v16
  s_cbranch_vccz Lsel_35
  s_mov_b64 exec, vcc
  v_add_u32 v23, 1024, v17
  global_load_dwordx2 v[26:27], v23, s[16:17] sc1
  s_waitcnt vmcnt(0)
  s_mov_b64 exec, -1
Lsel_35:
  v_cmp_eq_u32 vcc, s44, v16
  s_cbranch_vccz Lsel_36
  s_mov_b64 exec, vcc
  v_add_u32 v23, 2048, v17
  global_load_dwordx2 v[26:27], v23, s[16:17] sc1
  s_waitcnt vmcnt(0)
  s_mov_b64 exec, -1
Lsel_36:
  v_cmp_eq_u32 vcc, s45, v16
  s_cbranch_vccz Lsel_37
  s_mov_b64 exec, vcc
  v_add_u32 v23, 3072, v17
  global_load_dwordx2 v[26:27], v23, s[16:17] sc1
  s_waitcnt vmcnt(0)
  s_mov_b64 exec, -1
Lsel_37:
  v_cmp_eq_u32 vcc, s46, v16
  s_cbranch_vccz Lsel_38
  s_mov_b64 exec, vcc
  v_add_u32 v23, 4096, v17
  global_load_dwordx2 v[26:27], v23, s[16:17] sc1
  s_waitcnt vmcnt(0)
  s_mov_b64 exec, -1
Lsel_38:
  v_cmp_eq_u32 vcc, s47, v16
  s_cbranch_vccz Lsel_39
  s_mov_b64 exec, vcc
  v_add_u32 v23, 5120, v17
  global_load_dwordx2 v[26:27], v23, s[16:17] sc1
  s_waitcnt vmcnt(0)
  s_mov_b64 exec, -1
Lsel_39:
  v_cmp_eq_u32 vcc, s48, v16
  s_cbranch_vccz Lsel_40
  s_mov_b64 exec, vcc
  v_add_u32 v23, 6144, v17
  global_load_dwordx2 v[26:27], v23, s[16:17] sc1
  s_waitcnt vmcnt(0)
  s_mov_b64 exec, -1
Lsel_40:
  v_cmp_eq_u32 vcc, s49, v16
  s_cbranch_vccz Lsel_41
  s_mov_b64 exec, vcc
  v_add_u32 v23, 7168, v17
  global_load_dwordx2 v[26:27], v23, s[16:17] sc1
  s_waitcnt vmcnt(0)
  s_mov_b64 exec, -1
Lsel_41:
  v_lshlrev_b32 v96, 16, v26
  v_and_b32 v97, 0xffff0000, v26
  v_lshlrev_b32 v98, 16, v27
  v_and_b32 v99, 0xffff0000, v27
  v_mul_f32 v96, v96, v29
  v_cvt_pk_bf16_f32 v96, v96, v96
  v_and_b32 v96, 0xffff0000, v96
  v_mul_f32 v97, v97, v29
  v_cvt_pk_bf16_f32 v97, v97, v97
  v_and_b32 v97, 0xffff0000, v97
  v_mul_f32 v98, v98, v29
  v_cvt_pk_bf16_f32 v98, v98, v98
  v_and_b32 v98, 0xffff0000, v98
  v_mul_f32 v99, v99, v29
  v_cvt_pk_bf16_f32 v99, v99, v99
  v_and_b32 v99, 0xffff0000, v99
  v_accvgpr_write_b32 a160, v96
  v_accvgpr_write_b32 a161, v97
  v_accvgpr_write_b32 a162, v98
  v_accvgpr_write_b32 a163, v99
  v_accvgpr_write_b32 a164, v28
L_p2_pre_skip:
  s_lshr_b32 s55, s28, 2
  s_lshl_b32 s55, s55, 5
  s_add_u32 s55, s55, s20
  s_lshl_b32 s55, s55, 7
  s_add_u32 s55, s55, 78708736
  v_mov_b32 v16, s55
  s_mov_b32 s27, 0
  s_branch Lwf_43
Lwf_42:
  s_sleep 8
Lwf_43:
  global_load_dword v17, v16, s[16:17] sc1
  s_add_u32 s27, s27, 1
  s_cmp_gt_u32 s27, 0x400000
  s_cbranch_scc1 L_end
  s_waitcnt vmcnt(0)
  v_cmp_ne_u32 vcc, 1, v17
  s_cbranch_vccnz Lwf_42
  s_lshl_b32 s57, s28, 5
  s_add_u32 s57, s57, s20
  s_lshl_b32 s54, s57, 13
  s_add_u32 s54, s54, 33558528
  s_add_u32 s74, s16, s54
  s_addc_u32 s75, s17, 0
  s_add_u32 s76, s74, 16777216
  s_addc_u32 s77, s75, 0
  s_lshl_b32 s54, s57, 7
  s_add_u32 s54, s54, 67108864
  s_add_u32 s78, s16, s54
  s_addc_u32 s79, s17, 0
  s_lshl_b32 s54, s57, 12
  s_add_u32 s54, s54, 68157440
  s_add_u32 s80, s16, s54
  s_addc_u32 s81, s17, 0
  global_load_dwordx4 v[32:35], v2, s[76:77] offset:-4096 sc1
  global_load_dwordx4 v[36:39], v2, s[76:77] offset:-3072 sc1
  global_load_dwordx4 v[40:43], v2, s[76:77] offset:-2048 sc1
  global_load_dwordx4 v[44:47], v2, s[76:77] offset:-1024 sc1
  global_load_dwordx4 v[48:51], v2, s[76:77] offset:0 sc1
  global_load_dwordx4 v[52:55], v2, s[76:77] offset:1024 sc1
  global_load_dwordx4 v[56:59], v2, s[76:77] offset:2048 sc1
  global_load_dwordx4 v[60:63], v2, s[76:77] offset:3072 sc1
  global_load_dwordx4 a[128:131], v2, s[74:75] offset:-4096 sc1
  global_load_dwordx4 a[132:135], v2, s[74:75] offset:-3072 sc1
  global_load_dwordx4 a[136:139], v2, s[74:75] offset:-2048 sc1
  global_load_dwordx4 a[140:143], v2, s[74:75] offset:-1024 sc1
  global_load_dwordx4 a[144:147], v2, s[74:75] offset:0 sc1
  global_load_dwordx4 a[148:151], v2, s[74:75] offset:1024 sc1
  global_load_dwordx4 a[152:155], v2, s[74:75] offset:2048 sc1
  global_load_dwordx4 a[156:159], v2, s[74:75] offset:3072 sc1
  global_load_dword v18, v7, s[78:79] sc1
  s_waitcnt vmcnt(9)
  v_lshlrev_b32 v128, 16, v32
  v_and_b32 v129, 0xffff0000, v32
  v_lshlrev_b32 v130, 16, v33
  v_and_b32 v131, 0xffff0000, v33
  v_lshlrev_b32 v132, 16, v34
  v_and_b32 v133, 0xffff0000, v34
  v_lshlrev_b32 v134, 16, v35
  v_and_b32 v135, 0xffff0000, v35
  v_lshlrev_b32 v136, 16, v36
  v_and_b32 v137, 0xffff0000, v36
  v_lshlrev_b32 v138, 16, v37
  v_and_b32 v139, 0xffff0000, v37
  v_lshlrev_b32 v140, 16, v38
  v_and_b32 v141, 0xffff0000, v38
  v_lshlrev_b32 v142, 16, v39
  v_and_b32 v143, 0xffff0000, v39
  v_lshlrev_b32 v144, 16, v40
  v_and_b32 v145, 0xffff0000, v40
  v_lshlrev_b32 v146, 16, v41
  v_and_b32 v147, 0xffff0000, v41
  v_lshlrev_b32 v148, 16, v42
  v_and_b32 v149, 0xffff0000, v42
  v_lshlrev_b32 v150, 16, v43
  v_and_b32 v151, 0xffff0000, v43
  v_lshlrev_b32 v152, 16, v44
  v_and_b32 v153, 0xffff0000, v44
  v_lshlrev_b32 v154, 16, v45
  v_and_b32 v155, 0xffff0000, v45
  v_lshlrev_b32 v156, 16, v46
  v_and_b32 v157, 0xffff0000, v46
  v_lshlrev_b32 v158, 16, v47
  v_and_b32 v159, 0xffff0000, v47
  v_lshlrev_b32 v160, 16, v48
  v_and_b32 v161, 0xffff0000, v48
  v_lshlrev_b32 v162, 16, v49
  v_and_b32 v163, 0xffff0000, v49
  v_lshlrev_b32 v164, 16, v50
  v_and_b32 v165, 0xffff0000, v50
  v_lshlrev_b32 v166, 16, v51
  v_and_b32 v167, 0xffff0000, v51
  v_lshlrev_b32 v168, 16, v52
  v_and_b32 v169, 0xffff0000, v52
  v_lshlrev_b32 v170, 16, v53
  v_and_b32 v171, 0xffff0000, v53
  v_lshlrev_b32 v172, 16, v54
  v_and_b32 v173, 0xffff0000, v54
  v_lshlrev_b32 v174, 16, v55
  v_and_b32 v175, 0xffff0000, v55
  v_lshlrev_b32 v176, 16, v56
  v_and_b32 v177, 0xffff0000, v56
  v_lshlrev_b32 v178, 16, v57
  v_and_b32 v179, 0xffff0000, v57
  v_lshlrev_b32 v180, 16, v58
  v_and_b32 v181, 0xffff0000, v58
  v_lshlrev_b32 v182, 16, v59
  v_and_b32 v183, 0xffff0000, v59
  v_lshlrev_b32 v184, 16, v60
  v_and_b32 v185, 0xffff0000, v60
  v_lshlrev_b32 v186, 16, v61
  v_and_b32 v187, 0xffff0000, v61
  v_lshlrev_b32 v188, 16, v62
  v_and_b32 v189, 0xffff0000, v62
  v_lshlrev_b32 v190, 16, v63
  v_and_b32 v191, 0xffff0000, v63
  s_mov_b32 s27, 0
  v_and_b32 v17, 3, v1
  v_lshlrev_b32 v17, 10, v17
  s_branch L_p2_kv3
  s_branch L_p2_kv2
L_p2_kv1:
  s_sleep 1
L_p2_kv2:
  global_load_dword v16, v17, s[80:81] sc1
  s_add_u32 s27, s27, 1
  s_cmp_gt_u32 s27, 0x400000
  s_cbranch_scc1 L_end
  s_waitcnt vmcnt(0)
  v_cmp_eq_u32 vcc, -1, v16
  s_cbranch_vccnz L_p2_kv1
L_p2_kv:
  s_sleep 4
L_p2_kv3:
  global_load_dwordx4 v[64:67], v5, s[80:81] offset:0 sc1
  global_load_dwordx4 v[68:71], v5, s[80:81] offset:512 sc1
  global_load_dwordx4 v[72:75], v5, s[80:81] offset:1024 sc1
  global_load_dwordx4 v[76:79], v5, s[80:81] offset:1536 sc1
  global_load_dwordx4 v[80:83], v5, s[80:81] offset:2048 sc1
  global_load_dwordx4 v[84:87], v5, s[80:81] offset:2560 sc1
  global_load_dwordx4 v[88:91], v5, s[80:81] offset:3072 sc1
  global_load_dwordx4 v[92:95], v5, s[80:81] offset:3584 sc1
  global_load_dwordx4 v[96:99], v6, s[80:81] offset:0 sc1
  global_load_dwordx4 v[100:103], v6, s[80:81] offset:1024 sc1
  global_load_dwordx4 v[104:107], v6, s[80:81] offset:2048 sc1
  global_load_dwordx4 v[108:111], v6, s[80:81] offset:3072 sc1
  s_add_u32 s27, s27, 1
  s_cmp_gt_u32 s27, 0x400000
  s_cbranch_scc1 L_end
  s_waitcnt vmcnt(0)
  v_max3_u32 v16, v64, v68, v72
  v_max3_u32 v16, v16, v76, v80
  v_max3_u32 v16, v16, v84, v88
  v_max3_u32 v16, v16, v92, v96
  v_max3_u32 v16, v16, v100, v104
  v_max_u32 v16, v16, v108
  v_cmp_eq_u32 vcc, -1, v16
  s_cbranch_vccnz L_p2_kv
  v_mfma_f32_32x32x16_bf16 v[112:127], v[64:67], a[128:131], 0
  v_mfma_f32_32x32x16_bf16 v[112:127], v[68:71], a[132:135], v[112:127]
  v_mfma_f32_32x32x16_bf16 v[112:127], v[72:75], a[136:139], v[112:127]
  v_mfma_f32_32x32x16_bf16 v[112:127], v[76:79], a[140:143], v[112:127]
  v_mfma_f32_32x32x16_bf16 v[112:127], v[80:83], a[144:147], v[112:127]
  v_mfma_f32_32x32x16_bf16 v[112:127], v[84:87], a[148:151], v[112:127]
  v_mfma_f32_32x32x16_bf16 v[112:127], v[88:91], a[152:155], v[112:127]
  v_mfma_f32_32x32x16_bf16 v[112:127], v[92:95], a[156:159], v[112:127]
  v_cmp_lt_u32 vcc, 31, v1
  s_nop 1
  v_cndmask_b32 v96, v96, v98, vcc
  v_cndmask_b32 v97, v97, v99, vcc
  v_cndmask_b32 v100, v100, v102, vcc
  v_cndmask_b32 v101, v101, v103, vcc
  v_cndmask_b32 v104, v104, v106, vcc
  v_cndmask_b32 v105, v105, v107, vcc
  v_cndmask_b32 v108, v108, v110, vcc
  v_cndmask_b32 v109, v109, v111, vcc
  s_nop 0
  v_mul_f32 v112, s26, v112
  v_mul_f32 v113, s26, v113
  v_mul_f32 v114, s26, v114
  v_mul_f32 v115, s26, v115
  v_max3_f32 v19, v112, v113, v114
  v_max3_f32 v19, v19, v115, v18
  v_mov_b32 v20, v19
  s_nop 1
  v_permlane32_swap_b32 v19, v20
  v_max_f32 v19, v19, v20
  v_sub_f32 v112, v112, v19
  v_sub_f32 v113, v113, v19
  v_sub_f32 v114, v114, v19
  v_sub_f32 v115, v115, v19
  v_sub_f32 v21, v18, v19
  v_exp_f32 v112, v112
  v_exp_f32 v113, v113
  v_exp_f32 v114, v114
  v_exp_f32 v115, v115
  v_exp_f32 v21, v21
  v_add_f32 v22, v112, v113
  v_add_f32 v20, v114, v115
  v_add_f32 v22, v22, v20
  v_mov_b32 v20, v22
  s_nop 1
  v_permlane32_swap_b32 v22, v20
  v_add_f32 v22, v22, v20
  v_add_f32 v22, v22, v21
  v_rcp_f32 v22, v22
  s_nop 0
  v_mul_f32 v21, v21, v22
  v_mul_f32 v112, v112, v22
  v_mul_f32 v113, v113, v22
  v_mul_f32 v114, v114, v22
  v_mul_f32 v115, v115, v22
  v_cvt_pk_bf16_f32 v24, v112, v113
  v_cvt_pk_bf16_f32 v25, v114, v115
  v_mul_f32 v128, v128, v21
  v_mul_f32 v129, v129, v21
  v_mul_f32 v130, v130, v21
  v_mul_f32 v131, v131, v21
  v_mul_f32 v132, v132, v21
  v_mul_f32 v133, v133, v21
  v_mul_f32 v134, v134, v21
  v_mul_f32 v135, v135, v21
  v_mul_f32 v136, v136, v21
  v_mul_f32 v137, v137, v21
  v_mul_f32 v138, v138, v21
  v_mul_f32 v139, v139, v21
  v_mul_f32 v140, v140, v21
  v_mul_f32 v141, v141, v21
  v_mul_f32 v142, v142, v21
  v_mul_f32 v143, v143, v21
  s_nop 1
  v_mfma_f32_32x32x8_bf16 v[128:143], v[96:97], v[24:25], v[128:143]
  v_mul_f32 v144, v144, v21
  v_mul_f32 v145, v145, v21
  v_mul_f32 v146, v146, v21
  v_mul_f32 v147, v147, v21
  v_mul_f32 v148, v148, v21
  v_mul_f32 v149, v149, v21
  v_mul_f32 v150, v150, v21
  v_mul_f32 v151, v151, v21
  v_mul_f32 v152, v152, v21
  v_mul_f32 v153, v153, v21
  v_mul_f32 v154, v154, v21
  v_mul_f32 v155, v155, v21
  v_mul_f32 v156, v156, v21
  v_mul_f32 v157, v157, v21
  v_mul_f32 v158, v158, v21
  v_mul_f32 v159, v159, v21
  s_nop 1
  v_mfma_f32_32x32x8_bf16 v[144:159], v[100:101], v[24:25], v[144:159]
  v_mul_f32 v160, v160, v21
  v_mul_f32 v161, v161, v21
  v_mul_f32 v162, v162, v21
  v_mul_f32 v163, v163, v21
  v_mul_f32 v164, v164, v21
  v_mul_f32 v165, v165, v21
  v_mul_f32 v166, v166, v21
  v_mul_f32 v167, v167, v21
  v_mul_f32 v168, v168, v21
  v_mul_f32 v169, v169, v21
  v_mul_f32 v170, v170, v21
  v_mul_f32 v171, v171, v21
  v_mul_f32 v172, v172, v21
  v_mul_f32 v173, v173, v21
  v_mul_f32 v174, v174, v21
  v_mul_f32 v175, v175, v21
  s_nop 1
  v_mfma_f32_32x32x8_bf16 v[160:175], v[104:105], v[24:25], v[160:175]
  v_mul_f32 v176, v176, v21
  v_mul_f32 v177, v177, v21
  v_mul_f32 v178, v178, v21
  v_mul_f32 v179, v179, v21
  v_mul_f32 v180, v180, v21
  v_mul_f32 v181, v181, v21
  v_mul_f32 v182, v182, v21
  v_mul_f32 v183, v183, v21
  v_mul_f32 v184, v184, v21
  v_mul_f32 v185, v185, v21
  v_mul_f32 v186, v186, v21
  v_mul_f32 v187, v187, v21
  v_mul_f32 v188, v188, v21
  v_mul_f32 v189, v189, v21
  v_mul_f32 v190, v190, v21
  v_mul_f32 v191, v191, v21
  s_nop 1
  v_mfma_f32_32x32x8_bf16 v[176:191], v[108:109], v[24:25], v[176:191]
  v_cvt_pk_bf16_f32 v32, v128, v129
  v_cvt_pk_bf16_f32 v33, v130, v131
  v_cvt_pk_bf16_f32 v34, v132, v133
  v_cvt_pk_bf16_f32 v35, v134, v135
  v_cvt_pk_bf16_f32 v36, v136, v137
  v_cvt_pk_bf16_f32 v37, v138, v139
  v_cvt_pk_bf16_f32 v38, v140, v141
  v_cvt_pk_bf16_f32 v39, v142, v143
  v_mfma_f32_32x32x16_bf16 v[192:207], a[0:3], v[32:35], 0
  v_mfma_f32_32x32x16_bf16 v[208:223], a[32:35], v[32:35], 0
  v_mfma_f32_32x32x16_bf16 v[224:239], a[64:67], v[32:35], 0
  v_mfma_f32_32x32x16_bf16 v[240:255], a[96:99], v[32:35], 0
  v_mfma_f32_32x32x16_bf16 v[192:207], a[4:7], v[36:39], v[192:207]
  v_mfma_f32_32x32x16_bf16 v[208:223], a[36:39], v[36:39], v[208:223]
  v_mfma_f32_32x32x16_bf16 v[224:239], a[68:71], v[36:39], v[224:239]
  v_mfma_f32_32x32x16_bf16 v[240:255], a[100:103], v[36:39], v[240:255]
  v_cvt_pk_bf16_f32 v40, v144, v145
  v_cvt_pk_bf16_f32 v41, v146, v147
  v_cvt_pk_bf16_f32 v42, v148, v149
  v_cvt_pk_bf16_f32 v43, v150, v151
  v_cvt_pk_bf16_f32 v44, v152, v153
  v_cvt_pk_bf16_f32 v45, v154, v155
  v_cvt_pk_bf16_f32 v46, v156, v157
  v_cvt_pk_bf16_f32 v47, v158, v159
  v_mfma_f32_32x32x16_bf16 v[192:207], a[8:11], v[40:43], v[192:207]
  v_mfma_f32_32x32x16_bf16 v[208:223], a[40:43], v[40:43], v[208:223]
  v_mfma_f32_32x32x16_bf16 v[224:239], a[72:75], v[40:43], v[224:239]
  v_mfma_f32_32x32x16_bf16 v[240:255], a[104:107], v[40:43], v[240:255]
  v_mfma_f32_32x32x16_bf16 v[192:207], a[12:15], v[44:47], v[192:207]
  v_mfma_f32_32x32x16_bf16 v[208:223], a[44:47], v[44:47], v[208:223]
  v_mfma_f32_32x32x16_bf16 v[224:239], a[76:79], v[44:47], v[224:239]
  v_mfma_f32_32x32x16_bf16 v[240:255], a[108:111], v[44:47], v[240:255]
  v_cvt_pk_bf16_f32 v48, v160, v161
  v_cvt_pk_bf16_f32 v49, v162, v163
  v_cvt_pk_bf16_f32 v50, v164, v165
  v_cvt_pk_bf16_f32 v51, v166, v167
  v_cvt_pk_bf16_f32 v52, v168, v169
  v_cvt_pk_bf16_f32 v53, v170, v171
  v_cvt_pk_bf16_f32 v54, v172, v173
  v_cvt_pk_bf16_f32 v55, v174, v175
  v_mfma_f32_32x32x16_bf16 v[192:207], a[16:19], v[48:51], v[192:207]
  v_mfma_f32_32x32x16_bf16 v[208:223], a[48:51], v[48:51], v[208:223]
  v_mfma_f32_32x32x16_bf16 v[224:239], a[80:83], v[48:51], v[224:239]
  v_mfma_f32_32x32x16_bf16 v[240:255], a[112:115], v[48:51], v[240:255]
  v_mfma_f32_32x32x16_bf16 v[192:207], a[20:23], v[52:55], v[192:207]
  v_mfma_f32_32x32x16_bf16 v[208:223], a[52:55], v[52:55], v[208:223]
  v_mfma_f32_32x32x16_bf16 v[224:239], a[84:87], v[52:55], v[224:239]
  v_mfma_f32_32x32x16_bf16 v[240:255], a[116:119], v[52:55], v[240:255]
  v_cvt_pk_bf16_f32 v56, v176, v177
  v_cvt_pk_bf16_f32 v57, v178, v179
  v_cvt_pk_bf16_f32 v58, v180, v181
  v_cvt_pk_bf16_f32 v59, v182, v183
  v_cvt_pk_bf16_f32 v60, v184, v185
  v_cvt_pk_bf16_f32 v61, v186, v187
  v_cvt_pk_bf16_f32 v62, v188, v189
  v_cvt_pk_bf16_f32 v63, v190, v191
  v_mfma_f32_32x32x16_bf16 v[192:207], a[24:27], v[56:59], v[192:207]
  v_mfma_f32_32x32x16_bf16 v[208:223], a[56:59], v[56:59], v[208:223]
  v_mfma_f32_32x32x16_bf16 v[224:239], a[88:91], v[56:59], v[224:239]
  v_mfma_f32_32x32x16_bf16 v[240:255], a[120:123], v[56:59], v[240:255]
  v_mfma_f32_32x32x16_bf16 v[192:207], a[28:31], v[60:63], v[192:207]
  v_mfma_f32_32x32x16_bf16 v[208:223], a[60:63], v[60:63], v[208:223]
  v_mfma_f32_32x32x16_bf16 v[224:239], a[92:95], v[60:63], v[224:239]
  v_mfma_f32_32x32x16_bf16 v[240:255], a[124:127], v[60:63], v[240:255]
  s_nop 8
  ds_write_b128 v12, v[192:195] offset:0
  ds_write_b128 v12, v[196:199] offset:1024
  ds_write_b128 v12, v[200:203] offset:2048
  ds_write_b128 v12, v[204:207] offset:3072
  ds_write_b128 v12, v[208:211] offset:4096
  ds_write_b128 v12, v[212:215] offset:5120
  ds_write_b128 v12, v[216:219] offset:6144
  ds_write_b128 v12, v[220:223] offset:7168
  ds_write_b128 v12, v[224:227] offset:8192
  ds_write_b128 v12, v[228:231] offset:9216
  ds_write_b128 v12, v[232:235] offset:10240
  ds_write_b128 v12, v[236:239] offset:11264
  ds_write_b128 v12, v[240:243] offset:12288
  ds_write_b128 v12, v[244:247] offset:13312
  ds_write_b128 v12, v[248:251] offset:14336
  ds_write_b128 v12, v[252:255] offset:15360
  s_lshl_b32 s54, s22, 1
  s_add_u32 s54, s54, s82
  s_lshl_b32 s54, s54, 2
  s_add_u32 s54, s54, s24
  s_lshl_b32 s54, s54, 17
  s_add_u32 s54, s54, 80740352
  s_lshl_b32 s55, s21, 15
  s_lshl_b32 s56, s23, 11
  s_add_u32 s55, s55, s56
  s_add_u32 s55, s55, s54
  s_add_u32 s74, s16, s55
  s_addc_u32 s75, s17, 0
  s_add_u32 s76, s74, 16384
  s_addc_u32 s77, s75, 0
  s_lshl_b32 s55, s23, 14
  s_lshl_b32 s56, s21, 10
  s_add_u32 s55, s55, s56
  s_add_u32 s55, s55, s54
  s_add_u32 s78, s16, s55
  s_addc_u32 s79, s17, 0
  s_waitcnt lgkmcnt(0)
  s_barrier
  ds_read_b128 v[64:67], v13 offset:0
  ds_read_b128 v[68:71], v13 offset:1024
  ds_read_b128 v[72:75], v13 offset:2048
  ds_read_b128 v[76:79], v13 offset:3072
  ds_read_b128 v[80:83], v13 offset:16384
  ds_read_b128 v[84:87], v13 offset:17408
  ds_read_b128 v[88:91], v13 offset:18432
  ds_read_b128 v[92:95], v13 offset:19456
  ds_read_b128 v[96:99], v13 offset:32768
  ds_read_b128 v[100:103], v13 offset:33792
  ds_read_b128 v[104:107], v13 offset:34816
  ds_read_b128 v[108:111], v13 offset:35840
  ds_read_b128 v[112:115], v13 offset:49152
  ds_read_b128 v[116:119], v13 offset:50176
  ds_read_b128 v[120:123], v13 offset:51200
  ds_read_b128 v[124:127], v13 offset:52224
  s_waitcnt lgkmcnt(8)
  v_add_f32 v64, v64, v80
  v_add_f32 v65, v65, v81
  v_add_f32 v66, v66, v82
  v_add_f32 v67, v67, v83
  v_add_f32 v68, v68, v84
  v_add_f32 v69, v69, v85
  v_add_f32 v70, v70, v86
  v_add_f32 v71, v71, v87
  v_add_f32 v72, v72, v88
  v_add_f32 v73, v73, v89
  v_add_f32 v74, v74, v90
  v_add_f32 v75, v75, v91
  v_add_f32 v76, v76, v92
  v_add_f32 v77, v77, v93
  v_add_f32 v78, v78, v94
  v_add_f32 v79, v79, v95
  s_waitcnt lgkmcnt(0)
  v_add_f32 v96, v96, v112
  v_add_f32 v97, v97, v113
  v_add_f32 v98, v98, v114
  v_add_f32 v99, v99, v115
  v_add_f32 v100, v100, v116
  v_add_f32 v101, v101, v117
  v_add_f32 v102, v102, v118
  v_add_f32 v103, v103, v119
  v_add_f32 v104, v104, v120
  v_add_f32 v105, v105, v121
  v_add_f32 v106, v106, v122
  v_add_f32 v107, v107, v123
  v_add_f32 v108, v108, v124
  v_add_f32 v109, v109, v125
  v_add_f32 v110, v110, v126
  v_add_f32 v111, v111, v127
  s_barrier
  v_add_f32 v64, v64, v96
  v_add_f32 v65, v65, v97
  v_add_f32 v66, v66, v98
  v_add_f32 v67, v67, v99
  v_and_or_b32 v64, v64, -2, s29
  global_store_dwordx4 v2, v[64:67], s[74:75] offset:0 sc1
  v_add_f32 v68, v68, v100
  v_add_f32 v69, v69, v101
  v_add_f32 v70, v70, v102
  v_add_f32 v71, v71, v103
  v_and_or_b32 v68, v68, -2, s29
  global_store_dwordx4 v2, v[68:71], s[74:75] offset:1024 sc1
  v_add_f32 v72, v72, v104
  v_add_f32 v73, v73, v105
  v_add_f32 v74, v74, v106
  v_add_f32 v75, v75, v107
  v_and_or_b32 v72, v72, -2, s29
  global_store_dwordx4 v2, v[72:75], s[76:77] offset:0 sc1
  v_add_f32 v76, v76, v108
  v_add_f32 v77, v77, v109
  v_add_f32 v78, v78, v110
  v_add_f32 v79, v79, v111
  v_and_or_b32 v76, v76, -2, s29
  global_store_dwordx4 v2, v[76:79], s[76:77] offset:1024 sc1
  s_cmp_ge_u32 s21, 2
  s_cbranch_scc1 L_p2_next
  s_add_u32 s80, s78, 8192
  s_addc_u32 s81, s79, 0
  v_accvgpr_read_b32 v96, a160
  v_accvgpr_read_b32 v97, a161
  v_accvgpr_read_b32 v98, a162
  v_accvgpr_read_b32 v99, a163
  v_accvgpr_read_b32 v28, a164
  s_waitcnt vmcnt(0)
  s_mov_b32 s27, 0
L_p2_fp:
  global_load_dwordx4 v[64:67], v2, s[78:79] offset:0 sc1
  v_add_u32 v30, 4096, v2
  global_load_dwordx4 v[68:71], v2, s[78:79] offset:2048 sc1
  global_load_dwordx4 v[72:75], v2, s[80:81] offset:-4096 sc1
  global_load_dwordx4 v[76:79], v2, s[80:81] offset:-2048 sc1
  global_load_dwordx4 v[80:83], v2, s[80:81] offset:0 sc1
  global_load_dwordx4 v[84:87], v2, s[80:81] offset:2048 sc1
  global_load_dwordx4 v[88:91], v30, s[80:81] offset:0 sc1
  global_load_dwordx4 v[92:95], v30, s[80:81] offset:2048 sc1
  s_add_u32 s27, s27, 1
  s_cmp_gt_u32 s27, 0x400000
  s_cbranch_scc1 L_end
  s_waitcnt vmcnt(0)
  v_xor_b32 v16, s29, v64
  v_xor_b32 v17, s29, v68
  v_or_b32 v16, v16, v17
  v_xor_b32 v17, s29, v72
  v_or_b32 v16, v16, v17
  v_xor_b32 v17, s29, v76
  v_or_b32 v16, v16, v17
  v_xor_b32 v17, s29, v80
  v_or_b32 v16, v16, v17
  v_xor_b32 v17, s29, v84
  v_or_b32 v16, v16, v17
  v_xor_b32 v17, s29, v88
  v_or_b32 v16, v16, v17
  v_xor_b32 v17, s29, v92
  v_or_b32 v16, v16, v17
  v_and_b32 v16, 1, v16
  v_cmp_ne_u32 vcc, 0, v16
  s_cbranch_vccnz L_p2_fp
  v_add_f32 v64, v64, v68
  v_add_f32 v65, v65, v69
  v_add_f32 v66, v66, v70
  v_add_f32 v67, v67, v71
  v_add_f32 v64, v64, v72
  v_add_f32 v65, v65, v73
  v_add_f32 v66, v66, v74
  v_add_f32 v67, v67, v75
  v_add_f32 v64, v64, v76
  v_add_f32 v65, v65, v77
  v_add_f32 v66, v66, v78
  v_add_f32 v67, v67, v79
  v_add_f32 v64, v64, v80
  v_add_f32 v65, v65, v81
  v_add_f32 v66, v66, v82
  v_add_f32 v67, v67, v83
  v_add_f32 v64, v64, v84
  v_add_f32 v65, v65, v85
  v_add_f32 v66, v66, v86
  v_add_f32 v67, v67, v87
  v_add_f32 v64, v64, v88
  v_add_f32 v65, v65, v89
  v_add_f32 v66, v66, v90
  v_add_f32 v67, v67, v91
  v_add_f32 v64, v64, v92
  v_add_f32 v65, v65, v93
  v_add_f32 v66, v66, v94
  v_add_f32 v67, v67, v95
  v_cvt_pk_bf16_f32 v64, v64, v64
  v_and_b32 v64, 0xffff0000, v64
  v_mul_f32 v64, v64, v28
  v_cvt_pk_bf16_f32 v64, v64, v64
  v_and_b32 v64, 0xffff0000, v64
  v_add_f32 v64, v64, v96
  v_cvt_pk_bf16_f32 v65, v65, v65
  v_and_b32 v65, 0xffff0000, v65
  v_mul_f32 v65, v65, v28
  v_cvt_pk_bf16_f32 v65, v65, v65
  v_and_b32 v65, 0xffff0000, v65
  v_add_f32 v65, v65, v97
  v_cvt_pk_bf16_f32 v66, v66, v66
  v_and_b32 v66, 0xffff0000, v66
  v_mul_f32 v66, v66, v28
  v_cvt_pk_bf16_f32 v66, v66, v66
  v_and_b32 v66, 0xffff0000, v66
  v_add_f32 v66, v66, v98
  v_cvt_pk_bf16_f32 v67, v67, v67
  v_and_b32 v67, 0xffff0000, v67
  v_mul_f32 v67, v67, v28
  v_cvt_pk_bf16_f32 v67, v67, v67
  v_and_b32 v67, 0xffff0000, v67
  v_add_f32 v67, v67, v99
  v_cvt_pk_bf16_f32 v26, v64, v65
  v_cvt_pk_bf16_f32 v27, v66, v67
  global_store_dwordx2 v14, v[26:27], s[84:85]
L_p2_next:
  s_mov_b32 s83, 0
  s_xor_b32 s82, s82, 1
  s_xor_b32 s54, s82, 1
  s_xor_b32 s29, s29, s54
  s_add_u32 s28, s28, 3
  s_cmp_lt_u32 s28, 64
  s_cbranch_scc1 L_p2_seg
  s_branch L_end
L_role_rec:
  s_mov_b32 s20, s55
  s_mov_b32 s23, 0
  v_lshrrev_b32 v1, 6, v0
  v_lshlrev_b32 v76, 4, v0
  s_nop 0
  v_readfirstlane_b32 s21, v1
  s_getpc_b64 s[64:65]
Lpc_44:
  s_add_u32 s64, s64, L_rec_step_f0-Lpc_44
  s_addc_u32 s65, s65, 0
  v_lshlrev_b32 v77, 6, v0
  global_load_dword v78, v77, s[64:65]
  s_getpc_b64 s[64:65]
Lpc_45:
  s_add_u32 s64, s64, L_rec_last-Lpc_45
  s_addc_u32 s65, s65, 0
  v_lshlrev_b32 v77, 1, v0
  v_and_b32 v77, -4, v77
  global_load_dword v79, v77, s[64:65]
  s_getpc_b64 s[62:63]
  s_add_u32 s62, s62, L_tables@rel32@lo+4
  s_addc_u32 s63, s63, L_tables@rel32@hi+12
  s_add_u32 s64, s62, 36864
  s_addc_u32 s65, s63, 0
  global_load_dwordx4 v[0:3], v76, s[64:65]
  s_add_u32 s64, s62, 40960
  s_addc_u32 s65, s63, 0
  global_load_dwordx4 v[4:7], v76, s[64:65]
  s_add_u32 s64, s62, 45056
  s_addc_u32 s65, s63, 0
  global_load_dwordx4 v[8:11], v76, s[64:65]
  s_add_u32 s64, s62, 49152
  s_addc_u32 s65, s63, 0
  global_load_dwordx4 v[12:15], v76, s[64:65]
  s_add_u32 s64, s62, 53248
  s_addc_u32 s65, s63, 0
  global_load_dwordx4 v[44:47], v76, s[64:65]
  s_add_u32 s64, s62, 57344
  s_addc_u32 s65, s63, 0
  global_load_dwordx4 v[48:51], v76, s[64:65]
  s_add_u32 s64, s62, 61440
  s_addc_u32 s65, s63, 0
  global_load_dwordx4 v[52:55], v76, s[64:65]
  v_bfe_u32 v82, v76, 8, 2
  v_bfe_u32 v83, v76, 4, 4
  v_and_b32 v84, 1, v82
  s_and_b32 s54, s21, 1
  s_lshl_b32 s54, s54, 2
  v_or_b32 v84, s54, v84
  v_lshlrev_b32 v84, 1, v84
  v_xor_b32 v83, v83, v84
  v_lshlrev_b32 v83, 4, v83
  v_lshl_add_u32 v80, v82, 13, v83
  v_xor_b32 v81, 64, v80
  s_lshl_b32 s54, s21, 18
  s_lshl_b32 s55, s20, 8
  s_add_u32 s54, s54, s55
  s_add_u32 s54, s54, 0
  s_add_u32 s64, s10, s54
  s_addc_u32 s65, s11, 0
  s_lshl_b32 s56, s21, 13
  s_add_u32 s56, s56, 32768
  s_mov_b32 m0, s56
  s_add_u32 s56, s56, 1024
  global_load_lds_dwordx4 v80, s[64:65]
  s_add_u32 s64, s64, 32768
  s_addc_u32 s65, s65, 0
  s_mov_b32 m0, s56
  s_add_u32 s56, s56, 1024
  global_load_lds_dwordx4 v80, s[64:65]
  s_add_u32 s64, s64, 32768
  s_addc_u32 s65, s65, 0
  s_mov_b32 m0, s56
  s_add_u32 s56, s56, 1024
  global_load_lds_dwordx4 v80, s[64:65]
  s_add_u32 s64, s64, 32768
  s_addc_u32 s65, s65, 0
  s_mov_b32 m0, s56
  s_add_u32 s56, s56, 1024
  global_load_lds_dwordx4 v80, s[64:65]
  s_add_u32 s64, s64, 32768
  s_addc_u32 s65, s65, 0
  s_mov_b32 m0, s56
  s_add_u32 s56, s56, 1024
  global_load_lds_dwordx4 v81, s[64:65]
  s_add_u32 s64, s64, 32768
  s_addc_u32 s65, s65, 0
  s_mov_b32 m0, s56
  s_add_u32 s56, s56, 1024
  global_load_lds_dwordx4 v81, s[64:65]
  s_add_u32 s64, s64, 32768
  s_addc_u32 s65, s65, 0
  s_mov_b32 m0, s56
  s_add_u32 s56, s56, 1024
  global_load_lds_dwordx4 v81, s[64:65]
  s_add_u32 s64, s64, 32768
  s_addc_u32 s65, s65, 0
  s_mov_b32 m0, s56
  s_add_u32 s56, s56, 1024
  global_load_lds_dwordx4 v81, s[64:65]
  s_lshl_b32 s54, s21, 18
  s_lshl_b32 s55, s20, 8
  s_add_u32 s54, s54, s55
  s_add_u32 s54, s54, 1048576
  s_add_u32 s64, s10, s54
  s_addc_u32 s65, s11, 0
  s_lshl_b32 s56, s21, 13
  s_add_u32 s56, s56, 65536
  s_mov_b32 m0, s56
  s_add_u32 s56, s56, 1024
  global_load_lds_dwordx4 v80, s[64:65]
  s_add_u32 s64, s64, 32768
  s_addc_u32 s65, s65, 0
  s_mov_b32 m0, s56
  s_add_u32 s56, s56, 1024
  global_load_lds_dwordx4 v80, s[64:65]
  s_add_u32 s64, s64, 32768
  s_addc_u32 s65, s65, 0
  s_mov_b32 m0, s56
  s_add_u32 s56, s56, 1024
  global_load_lds_dwordx4 v80, s[64:65]
  s_add_u32 s64, s64, 32768
  s_addc_u32 s65, s65, 0
  s_mov_b32 m0, s56
  s_add_u32 s56, s56, 1024
  global_load_lds_dwordx4 v80, s[64:65]
  s_add_u32 s64, s64, 32768
  s_addc_u32 s65, s65, 0
  s_mov_b32 m0, s56
  s_add_u32 s56, s56, 1024
  global_load_lds_dwordx4 v81, s[64:65]
  s_add_u32 s64, s64, 32768
  s_addc_u32 s65, s65, 0
  s_mov_b32 m0, s56
  s_add_u32 s56, s56, 1024
  global_load_lds_dwordx4 v81, s[64:65]
  s_add_u32 s64, s64, 32768
  s_addc_u32 s65, s65, 0
  s_mov_b32 m0, s56
  s_add_u32 s56, s56, 1024
  global_load_lds_dwordx4 v81, s[64:65]
  s_add_u32 s64, s64, 32768
  s_addc_u32 s65, s65, 0
  s_mov_b32 m0, s56
  s_add_u32 s56, s56, 1024
  global_load_lds_dwordx4 v81, s[64:65]
  s_lshl_b32 s54, s21, 18
  s_lshl_b32 s55, s20, 8
  s_add_u32 s54, s54, s55
  s_add_u32 s54, s54, 2097152
  s_add_u32 s64, s10, s54
  s_addc_u32 s65, s11, 0
  s_lshl_b32 s56, s21, 13
  s_add_u32 s56, s56, 98304
  s_mov_b32 m0, s56
  s_add_u32 s56, s56, 1024
  global_load_lds_dwordx4 v80, s[64:65]
  s_add_u32 s64, s64, 32768
  s_addc_u32 s65, s65, 0
  s_mov_b32 m0, s56
  s_add_u32 s56, s56, 1024
  global_load_lds_dwordx4 v80, s[64:65]
  s_add_u32 s64, s64, 32768
  s_addc_u32 s65, s65, 0
  s_mov_b32 m0, s56
  s_add_u32 s56, s56, 1024
  global_load_lds_dwordx4 v80, s[64:65]
  s_add_u32 s64, s64, 32768
  s_addc_u32 s65, s65, 0
  s_mov_b32 m0, s56
  s_add_u32 s56, s56, 1024
  global_load_lds_dwordx4 v80, s[64:65]
  s_add_u32 s64, s64, 32768
  s_addc_u32 s65, s65, 0
  s_mov_b32 m0, s56
  s_add_u32 s56, s56, 1024
  global_load_lds_dwordx4 v81, s[64:65]
  s_add_u32 s64, s64, 32768
  s_addc_u32 s65, s65, 0
  s_mov_b32 m0, s56
  s_add_u32 s56, s56, 1024
  global_load_lds_dwordx4 v81, s[64:65]
  s_add_u32 s64, s64, 32768
  s_addc_u32 s65, s65, 0
  s_mov_b32 m0, s56
  s_add_u32 s56, s56, 1024
  global_load_lds_dwordx4 v81, s[64:65]
  s_add_u32 s64, s64, 32768
  s_addc_u32 s65, s65, 0
  s_mov_b32 m0, s56
  s_add_u32 s56, s56, 1024
  global_load_lds_dwordx4 v81, s[64:65]
  s_lshl_b32 s54, s21, 18
  s_lshl_b32 s55, s20, 8
  s_add_u32 s54, s54, s55
  s_add_u32 s54, s54, 3145728
  s_add_u32 s64, s10, s54
  s_addc_u32 s65, s11, 0
  s_lshl_b32 s56, s21, 13
  s_add_u32 s56, s56, 131072
  s_mov_b32 m0, s56
  s_add_u32 s56, s56, 1024
  global_load_lds_dwordx4 v80, s[64:65]
  s_add_u32 s64, s64, 32768
  s_addc_u32 s65, s65, 0
  s_mov_b32 m0, s56
  s_add_u32 s56, s56, 1024
  global_load_lds_dwordx4 v80, s[64:65]
  s_add_u32 s64, s64, 32768
  s_addc_u32 s65, s65, 0
  s_mov_b32 m0, s56
  s_add_u32 s56, s56, 1024
  global_load_lds_dwordx4 v80, s[64:65]
  s_add_u32 s64, s64, 32768
  s_addc_u32 s65, s65, 0
  s_mov_b32 m0, s56
  s_add_u32 s56, s56, 1024
  global_load_lds_dwordx4 v80, s[64:65]
  s_add_u32 s64, s64, 32768
  s_addc_u32 s65, s65, 0
  s_mov_b32 m0, s56
  s_add_u32 s56, s56, 1024
  global_load_lds_dwordx4 v81, s[64:65]
  s_add_u32 s64, s64, 32768
  s_addc_u32 s65, s65, 0
  s_mov_b32 m0, s56
  s_add_u32 s56, s56, 1024
  global_load_lds_dwordx4 v81, s[64:65]
  s_add_u32 s64, s64, 32768
  s_addc_u32 s65, s65, 0
  s_mov_b32 m0, s56
  s_add_u32 s56, s56, 1024
  global_load_lds_dwordx4 v81, s[64:65]
  s_add_u32 s64, s64, 32768
  s_addc_u32 s65, s65, 0
  s_mov_b32 m0, s56
  s_add_u32 s56, s56, 1024
  global_load_lds_dwordx4 v81, s[64:65]
  s_mov_b32 s24, 0x3e0293ee
  s_mov_b32 s25, 0x00003f80
  s_mov_b32 s26, 0x3f800000
  s_mov_b32 s60, 0x33333333
  s_mov_b32 s61, 0x33333333
  v_mov_b32 v36, 0
  v_mov_b32 v37, 0
  v_mov_b32 v38, 0
  v_mov_b32 v39, 0
  v_mov_b32 v40, 0
  v_mov_b32 v41, 0
  v_mov_b32 v42, 0
  v_mov_b32 v43, 0
  s_add_u32 s28, s16, 76546048
  s_addc_u32 s29, s17, 0
  s_add_u32 s30, s16, 76677120
  s_addc_u32 s31, s17, 0
  s_add_u32 s32, s16, 76808192
  s_addc_u32 s33, s17, 0
  s_add_u32 s34, s16, 76939264
  s_addc_u32 s35, s17, 0
  s_add_u32 s40, s16, 77594624
  s_addc_u32 s41, s17, 0
  s_add_u32 s42, s16, 77602816
  s_addc_u32 s43, s17, 0
  s_add_u32 s44, s16, 77611008
  s_addc_u32 s45, s17, 0
  s_add_u32 s46, s16, 77619200
  s_addc_u32 s47, s17, 0
  s_mov_b32 s48, 0xff
  s_mov_b32 s49, 0xff
  s_add_u32 s50, s16, 68026368
  s_addc_u32 s51, s17, 0
  s_add_u32 s52, s16, 78643200
  s_addc_u32 s53, s17, 0
  s_and_b32 s54, s21, 1
  s_lshr_b32 s55, s21, 1
  s_mul_i32 s55, s55, 16384
  s_lshl_b32 s56, s54, 12
  s_add_u32 s55, s55, s56
  s_add_u32 s58, s55, 8192
  s_add_u32 s59, s55, 16384
  s_lshl_b32 s57, s20, 12
  s_waitcnt vmcnt(32)
  v_lshrrev_b32 v56, 12, v6
  v_add_u32 v56, s20, v56
  v_and_b32 v56, 31, v56
  v_lshl_add_u32 v6, v56, 6, v6
  s_lshr_b32 s54, s20, 3
  s_lshl_b32 s54, s54, 11
  s_bfe_u32 s55, s20, 0x10002
  s_lshl_b32 s55, s55, 9
  s_add_u32 s54, s54, s55
  s_and_b32 s55, s20, 3
  s_lshl_b32 s55, s55, 6
  s_add_u32 s54, s54, s55
  v_add_u32 v7, s54, v7
  s_lshl_b32 s54, s20, 12
  v_add_u32 v9, s54, v9
  s_lshl_b32 s54, s20, 13
  v_add_u32 v15, s54, v15
  v_mov_b32 v56, 0
  v_mov_b32 v57, 0
  v_mov_b32 v58, 0
  v_mov_b32 v59, 0
  v_mov_b32 v60, -1
  v_add_u32 v61, s57, v76
  s_waitcnt vmcnt(24)
  s_barrier
  s_cmp_eq_u32 s21, 0
  s_cbranch_scc0 Lwv_47
  ds_read_b64_tr_b16 a[128:129], v48 offset:0
  ds_read_b64_tr_b16 a[130:131], v48 offset:512
  ds_read_b64_tr_b16 a[132:133], v48 offset:2048
  ds_read_b64_tr_b16 a[134:135], v48 offset:2560
  ds_read_b64_tr_b16 a[192:193], v49 offset:0
  ds_read_b64_tr_b16 a[194:195], v49 offset:512
  ds_read_b64_tr_b16 a[196:197], v49 offset:2048
  ds_read_b64_tr_b16 a[198:199], v49 offset:2560
  ds_read_b64_tr_b16 a[136:137], v48 offset:16384
  ds_read_b64_tr_b16 a[138:139], v48 offset:16896
  ds_read_b64_tr_b16 a[140:141], v48 offset:18432
  ds_read_b64_tr_b16 a[142:143], v48 offset:18944
  ds_read_b64_tr_b16 a[200:201], v49 offset:16384
  ds_read_b64_tr_b16 a[202:203], v49 offset:16896
  ds_read_b64_tr_b16 a[204:205], v49 offset:18432
  ds_read_b64_tr_b16 a[206:207], v49 offset:18944
  s_branch Lwv_46
Lwv_47:
  s_cmp_eq_u32 s21, 1
  s_cbranch_scc0 Lwv_48
  ds_read_b64_tr_b16 a[144:145], v48 offset:0
  ds_read_b64_tr_b16 a[146:147], v48 offset:512
  ds_read_b64_tr_b16 a[148:149], v48 offset:2048
  ds_read_b64_tr_b16 a[150:151], v48 offset:2560
  ds_read_b64_tr_b16 a[208:209], v49 offset:0
  ds_read_b64_tr_b16 a[210:211], v49 offset:512
  ds_read_b64_tr_b16 a[212:213], v49 offset:2048
  ds_read_b64_tr_b16 a[214:215], v49 offset:2560
  ds_read_b64_tr_b16 a[152:153], v48 offset:16384
  ds_read_b64_tr_b16 a[154:155], v48 offset:16896
  ds_read_b64_tr_b16 a[156:157], v48 offset:18432
  ds_read_b64_tr_b16 a[158:159], v48 offset:18944
  ds_read_b64_tr_b16 a[216:217], v49 offset:16384
  ds_read_b64_tr_b16 a[218:219], v49 offset:16896
  ds_read_b64_tr_b16 a[220:221], v49 offset:18432
  ds_read_b64_tr_b16 a[222:223], v49 offset:18944
  s_branch Lwv_46
Lwv_48:
  s_cmp_eq_u32 s21, 2
  s_cbranch_scc0 Lwv_49
  ds_read_b64_tr_b16 a[160:161], v48 offset:0
  ds_read_b64_tr_b16 a[162:163], v48 offset:512
  ds_read_b64_tr_b16 a[164:165], v48 offset:2048
  ds_read_b64_tr_b16 a[166:167], v48 offset:2560
  ds_read_b64_tr_b16 a[224:225], v49 offset:0
  ds_read_b64_tr_b16 a[226:227], v49 offset:512
  ds_read_b64_tr_b16 a[228:229], v49 offset:2048
  ds_read_b64_tr_b16 a[230:231], v49 offset:2560
  ds_read_b64_tr_b16 a[168:169], v48 offset:16384
  ds_read_b64_tr_b16 a[170:171], v48 offset:16896
  ds_read_b64_tr_b16 a[172:173], v48 offset:18432
  ds_read_b64_tr_b16 a[174:175], v48 offset:18944
  ds_read_b64_tr_b16 a[232:233], v49 offset:16384
  ds_read_b64_tr_b16 a[234:235], v49 offset:16896
  ds_read_b64_tr_b16 a[236:237], v49 offset:18432
  ds_read_b64_tr_b16 a[238:239], v49 offset:18944
  s_branch Lwv_46
Lwv_49:
  ds_read_b64_tr_b16 a[176:177], v48 offset:0
  ds_read_b64_tr_b16 a[178:179], v48 offset:512
  ds_read_b64_tr_b16 a[180:181], v48 offset:2048
  ds_read_b64_tr_b16 a[182:183], v48 offset:2560
  ds_read_b64_tr_b16 a[240:241], v49 offset:0
  ds_read_b64_tr_b16 a[242:243], v49 offset:512
  ds_read_b64_tr_b16 a[244:245], v49 offset:2048
  ds_read_b64_tr_b16 a[246:247], v49 offset:2560
  ds_read_b64_tr_b16 a[184:185], v48 offset:16384
  ds_read_b64_tr_b16 a[186:187], v48 offset:16896
  ds_read_b64_tr_b16 a[188:189], v48 offset:18432
  ds_read_b64_tr_b16 a[190:191], v48 offset:18944
  ds_read_b64_tr_b16 a[248:249], v49 offset:16384
  ds_read_b64_tr_b16 a[250:251], v49 offset:16896
  ds_read_b64_tr_b16 a[252:253], v49 offset:18432
  ds_read_b64_tr_b16 a[254:255], v49 offset:18944
Lwv_46:
  s_waitcnt lgkmcnt(0)
  s_barrier
  s_lshl_b32 s54, s21, 18
  s_lshl_b32 s55, s20, 8
  s_add_u32 s54, s54, s55
  s_add_u32 s54, s54, 0
  s_add_u32 s64, s8, s54
  s_addc_u32 s65, s9, 0
  s_lshl_b32 s56, s21, 13
  s_add_u32 s56, s56, 32768
  s_mov_b32 m0, s56
  s_add_u32 s56, s56, 1024
  global_load_lds_dwordx4 v80, s[64:65]
  s_add_u32 s64, s64, 32768
  s_addc_u32 s65, s65, 0
  s_mov_b32 m0, s56
  s_add_u32 s56, s56, 1024
  global_load_lds_dwordx4 v80, s[64:65]
  s_add_u32 s64, s64, 32768
  s_addc_u32 s65, s65, 0
  s_mov_b32 m0, s56
  s_add_u32 s56, s56, 1024
  global_load_lds_dwordx4 v80, s[64:65]
  s_add_u32 s64, s64, 32768
  s_addc_u32 s65, s65, 0
  s_mov_b32 m0, s56
  s_add_u32 s56, s56, 1024
  global_load_lds_dwordx4 v80, s[64:65]
  s_add_u32 s64, s64, 32768
  s_addc_u32 s65, s65, 0
  s_mov_b32 m0, s56
  s_add_u32 s56, s56, 1024
  global_load_lds_dwordx4 v81, s[64:65]
  s_add_u32 s64, s64, 32768
  s_addc_u32 s65, s65, 0
  s_mov_b32 m0, s56
  s_add_u32 s56, s56, 1024
  global_load_lds_dwordx4 v81, s[64:65]
  s_add_u32 s64, s64, 32768
  s_addc_u32 s65, s65, 0
  s_mov_b32 m0, s56
  s_add_u32 s56, s56, 1024
  global_load_lds_dwordx4 v81, s[64:65]
  s_add_u32 s64, s64, 32768
  s_addc_u32 s65, s65, 0
  s_mov_b32 m0, s56
  s_add_u32 s56, s56, 1024
  global_load_lds_dwordx4 v81, s[64:65]
  s_waitcnt vmcnt(24)
  s_barrier
  s_cmp_eq_u32 s21, 0
  s_cbranch_scc0 Lwv_52
  ds_read_b64_tr_b16 a[144:145], v48 offset:32768
  ds_read_b64_tr_b16 a[146:147], v48 offset:33280
  ds_read_b64_tr_b16 a[148:149], v48 offset:34816
  ds_read_b64_tr_b16 a[150:151], v48 offset:35328
  ds_read_b64_tr_b16 a[208:209], v49 offset:32768
  ds_read_b64_tr_b16 a[210:211], v49 offset:33280
  ds_read_b64_tr_b16 a[212:213], v49 offset:34816
  ds_read_b64_tr_b16 a[214:215], v49 offset:35328
  ds_read_b64_tr_b16 a[152:153], v48 offset:49152
  ds_read_b64_tr_b16 a[154:155], v48 offset:49664
  ds_read_b64_tr_b16 a[156:157], v48 offset:51200
  ds_read_b64_tr_b16 a[158:159], v48 offset:51712
  ds_read_b64_tr_b16 a[216:217], v49 offset:49152
  ds_read_b64_tr_b16 a[218:219], v49 offset:49664
  ds_read_b64_tr_b16 a[220:221], v49 offset:51200
  ds_read_b64_tr_b16 a[222:223], v49 offset:51712
  s_branch Lwv_51
Lwv_52:
  s_cmp_eq_u32 s21, 1
  s_cbranch_scc0 Lwv_53
  ds_read_b64_tr_b16 a[128:129], v48 offset:32768
  ds_read_b64_tr_b16 a[130:131], v48 offset:33280
  ds_read_b64_tr_b16 a[132:133], v48 offset:34816
  ds_read_b64_tr_b16 a[134:135], v48 offset:35328
  ds_read_b64_tr_b16 a[192:193], v49 offset:32768
  ds_read_b64_tr_b16 a[194:195], v49 offset:33280
  ds_read_b64_tr_b16 a[196:197], v49 offset:34816
  ds_read_b64_tr_b16 a[198:199], v49 offset:35328
  ds_read_b64_tr_b16 a[136:137], v48 offset:49152
  ds_read_b64_tr_b16 a[138:139], v48 offset:49664
  ds_read_b64_tr_b16 a[140:141], v48 offset:51200
  ds_read_b64_tr_b16 a[142:143], v48 offset:51712
  ds_read_b64_tr_b16 a[200:201], v49 offset:49152
  ds_read_b64_tr_b16 a[202:203], v49 offset:49664
  ds_read_b64_tr_b16 a[204:205], v49 offset:51200
  ds_read_b64_tr_b16 a[206:207], v49 offset:51712
  s_branch Lwv_51
Lwv_53:
  s_cmp_eq_u32 s21, 2
  s_cbranch_scc0 Lwv_54
  ds_read_b64_tr_b16 a[176:177], v48 offset:32768
  ds_read_b64_tr_b16 a[178:179], v48 offset:33280
  ds_read_b64_tr_b16 a[180:181], v48 offset:34816
  ds_read_b64_tr_b16 a[182:183], v48 offset:35328
  ds_read_b64_tr_b16 a[240:241], v49 offset:32768
  ds_read_b64_tr_b16 a[242:243], v49 offset:33280
  ds_read_b64_tr_b16 a[244:245], v49 offset:34816
  ds_read_b64_tr_b16 a[246:247], v49 offset:35328
  ds_read_b64_tr_b16 a[184:185], v48 offset:49152
  ds_read_b64_tr_b16 a[186:187], v48 offset:49664
  ds_read_b64_tr_b16 a[188:189], v48 offset:51200
  ds_read_b64_tr_b16 a[190:191], v48 offset:51712
  ds_read_b64_tr_b16 a[248:249], v49 offset:49152
  ds_read_b64_tr_b16 a[250:251], v49 offset:49664
  ds_read_b64_tr_b16 a[252:253], v49 offset:51200
  ds_read_b64_tr_b16 a[254:255], v49 offset:51712
  s_branch Lwv_51
Lwv_54:
  ds_read_b64_tr_b16 a[160:161], v48 offset:32768
  ds_read_b64_tr_b16 a[162:163], v48 offset:33280
  ds_read_b64_tr_b16 a[164:165], v48 offset:34816
  ds_read_b64_tr_b16 a[166:167], v48 offset:35328
  ds_read_b64_tr_b16 a[224:225], v49 offset:32768
  ds_read_b64_tr_b16 a[226:227], v49 offset:33280
  ds_read_b64_tr_b16 a[228:229], v49 offset:34816
  ds_read_b64_tr_b16 a[230:231], v49 offset:35328
  ds_read_b64_tr_b16 a[168:169], v48 offset:49152
  ds_read_b64_tr_b16 a[170:171], v48 offset:49664
  ds_read_b64_tr_b16 a[172:173], v48 offset:51200
  ds_read_b64_tr_b16 a[174:175], v48 offset:51712
  ds_read_b64_tr_b16 a[232:233], v49 offset:49152
  ds_read_b64_tr_b16 a[234:235], v49 offset:49664
  ds_read_b64_tr_b16 a[236:237], v49 offset:51200
  ds_read_b64_tr_b16 a[238:239], v49 offset:51712
Lwv_51:
  s_waitcnt lgkmcnt(0)
  s_barrier
  s_lshl_b32 s54, s21, 18
  s_lshl_b32 s55, s20, 8
  s_add_u32 s54, s54, s55
  s_add_u32 s54, s54, 1048576
  s_add_u32 s64, s8, s54
  s_addc_u32 s65, s9, 0
  s_lshl_b32 s56, s21, 13
  s_add_u32 s56, s56, 65536
  s_mov_b32 m0, s56
  s_add_u32 s56, s56, 1024
  global_load_lds_dwordx4 v80, s[64:65]
  s_add_u32 s64, s64, 32768
  s_addc_u32 s65, s65, 0
  s_mov_b32 m0, s56
  s_add_u32 s56, s56, 1024
  global_load_lds_dwordx4 v80, s[64:65]
  s_add_u32 s64, s64, 32768
  s_addc_u32 s65, s65, 0
  s_mov_b32 m0, s56
  s_add_u32 s56, s56, 1024
  global_load_lds_dwordx4 v80, s[64:65]
  s_add_u32 s64, s64, 32768
  s_addc_u32 s65, s65, 0
  s_mov_b32 m0, s56
  s_add_u32 s56, s56, 1024
  global_load_lds_dwordx4 v80, s[64:65]
  s_add_u32 s64, s64, 32768
  s_addc_u32 s65, s65, 0
  s_mov_b32 m0, s56
  s_add_u32 s56, s56, 1024
  global_load_lds_dwordx4 v81, s[64:65]
  s_add_u32 s64, s64, 32768
  s_addc_u32 s65, s65, 0
  s_mov_b32 m0, s56
  s_add_u32 s56, s56, 1024
  global_load_lds_dwordx4 v81, s[64:65]
  s_add_u32 s64, s64, 32768
  s_addc_u32 s65, s65, 0
  s_mov_b32 m0, s56
  s_add_u32 s56, s56, 1024
  global_load_lds_dwordx4 v81, s[64:65]
  s_add_u32 s64, s64, 32768
  s_addc_u32 s65, s65, 0
  s_mov_b32 m0, s56
  s_add_u32 s56, s56, 1024
  global_load_lds_dwordx4 v81, s[64:65]
  global_store_dwordx4 v61, v[56:59], s[28:29] sc1
  global_store_dwordx4 v61, v[56:59], s[30:31] sc1
  global_store_dwordx4 v61, v[56:59], s[32:33] sc1
  global_store_dwordx4 v61, v[56:59], s[34:35] sc1
  global_store_dword v7, v60, s[40:41] sc1
  global_store_dword v7, v60, s[42:43] sc1
  global_store_dword v7, v60, s[44:45] sc1
  global_store_dword v7, v60, s[46:47] sc1
  s_waitcnt vmcnt(32)
  s_barrier
  s_cmp_eq_u32 s21, 0
  s_cbranch_scc0 Lwv_57
  ds_read_b64_tr_b16 a[160:161], v50 offset:0
  ds_read_b64_tr_b16 a[162:163], v50 offset:512
  ds_read_b64_tr_b16 a[164:165], v50 offset:2048
  ds_read_b64_tr_b16 a[166:167], v50 offset:2560
  ds_read_b64_tr_b16 a[224:225], v51 offset:0
  ds_read_b64_tr_b16 a[226:227], v51 offset:512
  ds_read_b64_tr_b16 a[228:229], v51 offset:2048
  ds_read_b64_tr_b16 a[230:231], v51 offset:2560
  ds_read_b64_tr_b16 a[168:169], v50 offset:16384
  ds_read_b64_tr_b16 a[170:171], v50 offset:16896
  ds_read_b64_tr_b16 a[172:173], v50 offset:18432
  ds_read_b64_tr_b16 a[174:175], v50 offset:18944
  ds_read_b64_tr_b16 a[232:233], v51 offset:16384
  ds_read_b64_tr_b16 a[234:235], v51 offset:16896
  ds_read_b64_tr_b16 a[236:237], v51 offset:18432
  ds_read_b64_tr_b16 a[238:239], v51 offset:18944
  s_branch Lwv_56
Lwv_57:
  s_cmp_eq_u32 s21, 1
  s_cbranch_scc0 Lwv_58
  ds_read_b64_tr_b16 a[176:177], v50 offset:0
  ds_read_b64_tr_b16 a[178:179], v50 offset:512
  ds_read_b64_tr_b16 a[180:181], v50 offset:2048
  ds_read_b64_tr_b16 a[182:183], v50 offset:2560
  ds_read_b64_tr_b16 a[240:241], v51 offset:0
  ds_read_b64_tr_b16 a[242:243], v51 offset:512
  ds_read_b64_tr_b16 a[244:245], v51 offset:2048
  ds_read_b64_tr_b16 a[246:247], v51 offset:2560
  ds_read_b64_tr_b16 a[184:185], v50 offset:16384
  ds_read_b64_tr_b16 a[186:187], v50 offset:16896
  ds_read_b64_tr_b16 a[188:189], v50 offset:18432
  ds_read_b64_tr_b16 a[190:191], v50 offset:18944
  ds_read_b64_tr_b16 a[248:249], v51 offset:16384
  ds_read_b64_tr_b16 a[250:251], v51 offset:16896
  ds_read_b64_tr_b16 a[252:253], v51 offset:18432
  ds_read_b64_tr_b16 a[254:255], v51 offset:18944
  s_branch Lwv_56
Lwv_58:
  s_cmp_eq_u32 s21, 2
  s_cbranch_scc0 Lwv_59
  ds_read_b64_tr_b16 a[128:129], v50 offset:0
  ds_read_b64_tr_b16 a[130:131], v50 offset:512
  ds_read_b64_tr_b16 a[132:133], v50 offset:2048
  ds_read_b64_tr_b16 a[134:135], v50 offset:2560
  ds_read_b64_tr_b16 a[192:193], v51 offset:0
  ds_read_b64_tr_b16 a[194:195], v51 offset:512
  ds_read_b64_tr_b16 a[196:197], v51 offset:2048
  ds_read_b64_tr_b16 a[198:199], v51 offset:2560
  ds_read_b64_tr_b16 a[136:137], v50 offset:16384
  ds_read_b64_tr_b16 a[138:139], v50 offset:16896
  ds_read_b64_tr_b16 a[140:141], v50 offset:18432
  ds_read_b64_tr_b16 a[142:143], v50 offset:18944
  ds_read_b64_tr_b16 a[200:201], v51 offset:16384
  ds_read_b64_tr_b16 a[202:203], v51 offset:16896
  ds_read_b64_tr_b16 a[204:205], v51 offset:18432
  ds_read_b64_tr_b16 a[206:207], v51 offset:18944
  s_branch Lwv_56
Lwv_59:
  ds_read_b64_tr_b16 a[144:145], v50 offset:0
  ds_read_b64_tr_b16 a[146:147], v50 offset:512
  ds_read_b64_tr_b16 a[148:149], v50 offset:2048
  ds_read_b64_tr_b16 a[150:151], v50 offset:2560
  ds_read_b64_tr_b16 a[208:209], v51 offset:0
  ds_read_b64_tr_b16 a[210:211], v51 offset:512
  ds_read_b64_tr_b16 a[212:213], v51 offset:2048
  ds_read_b64_tr_b16 a[214:215], v51 offset:2560
  ds_read_b64_tr_b16 a[152:153], v50 offset:16384
  ds_read_b64_tr_b16 a[154:155], v50 offset:16896
  ds_read_b64_tr_b16 a[156:157], v50 offset:18432
  ds_read_b64_tr_b16 a[158:159], v50 offset:18944
  ds_read_b64_tr_b16 a[216:217], v51 offset:16384
  ds_read_b64_tr_b16 a[218:219], v51 offset:16896
  ds_read_b64_tr_b16 a[220:221], v51 offset:18432
  ds_read_b64_tr_b16 a[222:223], v51 offset:18944
Lwv_56:
  s_waitcnt lgkmcnt(0)
  s_barrier
  s_lshl_b32 s54, s21, 18
  s_lshl_b32 s55, s20, 8
  s_add_u32 s54, s54, s55
  s_add_u32 s54, s54, 2097152
  s_add_u32 s64, s8, s54
  s_addc_u32 s65, s9, 0
  s_lshl_b32 s56, s21, 13
  s_add_u32 s56, s56, 98304
  s_mov_b32 m0, s56
  s_add_u32 s56, s56, 1024
  global_load_lds_dwordx4 v80, s[64:65]
  s_add_u32 s64, s64, 32768
  s_addc_u32 s65, s65, 0
  s_mov_b32 m0, s56
  s_add_u32 s56, s56, 1024
  global_load_lds_dwordx4 v80, s[64:65]
  s_add_u32 s64, s64, 32768
  s_addc_u32 s65, s65, 0
  s_mov_b32 m0, s56
  s_add_u32 s56, s56, 1024
  global_load_lds_dwordx4 v80, s[64:65]
  s_add_u32 s64, s64, 32768
  s_addc_u32 s65, s65, 0
  s_mov_b32 m0, s56
  s_add_u32 s56, s56, 1024
  global_load_lds_dwordx4 v80, s[64:65]
  s_add_u32 s64, s64, 32768
  s_addc_u32 s65, s65, 0
  s_mov_b32 m0, s56
  s_add_u32 s56, s56, 1024
  global_load_lds_dwordx4 v81, s[64:65]
  s_add_u32 s64, s64, 32768
  s_addc_u32 s65, s65, 0
  s_mov_b32 m0, s56
  s_add_u32 s56, s56, 1024
  global_load_lds_dwordx4 v81, s[64:65]
  s_add_u32 s64, s64, 32768
  s_addc_u32 s65, s65, 0
  s_mov_b32 m0, s56
  s_add_u32 s56, s56, 1024
  global_load_lds_dwordx4 v81, s[64:65]
  s_add_u32 s64, s64, 32768
  s_addc_u32 s65, s65, 0
  s_mov_b32 m0, s56
  s_add_u32 s56, s56, 1024
  global_load_lds_dwordx4 v81, s[64:65]
  global_load_dword v62, v53, s[6:7] offset:0
  global_load_dword v63, v53, s[6:7] offset:128
  global_load_dword v64, v53, s[6:7] offset:256
  global_load_dword v65, v53, s[6:7] offset:384
  global_load_dword v66, v53, s[6:7] offset:512
  global_load_dword v67, v53, s[6:7] offset:640
  global_load_dword v68, v53, s[6:7] offset:768
  global_load_dword v69, v53, s[6:7] offset:896
  s_waitcnt vmcnt(40)
  s_barrier
  s_cmp_eq_u32 s21, 0
  s_cbranch_scc0 Lwv_62
  ds_read_b64_tr_b16 a[176:177], v50 offset:32768
  ds_read_b64_tr_b16 a[178:179], v50 offset:33280
  ds_read_b64_tr_b16 a[180:181], v50 offset:34816
  ds_read_b64_tr_b16 a[182:183], v50 offset:35328
  ds_read_b64_tr_b16 a[240:241], v51 offset:32768
  ds_read_b64_tr_b16 a[242:243], v51 offset:33280
  ds_read_b64_tr_b16 a[244:245], v51 offset:34816
  ds_read_b64_tr_b16 a[246:247], v51 offset:35328
  ds_read_b64_tr_b16 a[184:185], v50 offset:49152
  ds_read_b64_tr_b16 a[186:187], v50 offset:49664
  ds_read_b64_tr_b16 a[188:189], v50 offset:51200
  ds_read_b64_tr_b16 a[190:191], v50 offset:51712
  ds_read_b64_tr_b16 a[248:249], v51 offset:49152
  ds_read_b64_tr_b16 a[250:251], v51 offset:49664
  ds_read_b64_tr_b16 a[252:253], v51 offset:51200
  ds_read_b64_tr_b16 a[254:255], v51 offset:51712
  s_branch Lwv_61
Lwv_62:
  s_cmp_eq_u32 s21, 1
  s_cbranch_scc0 Lwv_63
  ds_read_b64_tr_b16 a[160:161], v50 offset:32768
  ds_read_b64_tr_b16 a[162:163], v50 offset:33280
  ds_read_b64_tr_b16 a[164:165], v50 offset:34816
  ds_read_b64_tr_b16 a[166:167], v50 offset:35328
  ds_read_b64_tr_b16 a[224:225], v51 offset:32768
  ds_read_b64_tr_b16 a[226:227], v51 offset:33280
  ds_read_b64_tr_b16 a[228:229], v51 offset:34816
  ds_read_b64_tr_b16 a[230:231], v51 offset:35328
  ds_read_b64_tr_b16 a[168:169], v50 offset:49152
  ds_read_b64_tr_b16 a[170:171], v50 offset:49664
  ds_read_b64_tr_b16 a[172:173], v50 offset:51200
  ds_read_b64_tr_b16 a[174:175], v50 offset:51712
  ds_read_b64_tr_b16 a[232:233], v51 offset:49152
  ds_read_b64_tr_b16 a[234:235], v51 offset:49664
  ds_read_b64_tr_b16 a[236:237], v51 offset:51200
  ds_read_b64_tr_b16 a[238:239], v51 offset:51712
  s_branch Lwv_61
Lwv_63:
  s_cmp_eq_u32 s21, 2
  s_cbranch_scc0 Lwv_64
  ds_read_b64_tr_b16 a[144:145], v50 offset:32768
  ds_read_b64_tr_b16 a[146:147], v50 offset:33280
  ds_read_b64_tr_b16 a[148:149], v50 offset:34816
  ds_read_b64_tr_b16 a[150:151], v50 offset:35328
  ds_read_b64_tr_b16 a[208:209], v51 offset:32768
  ds_read_b64_tr_b16 a[210:211], v51 offset:33280
  ds_read_b64_tr_b16 a[212:213], v51 offset:34816
  ds_read_b64_tr_b16 a[214:215], v51 offset:35328
  ds_read_b64_tr_b16 a[152:153], v50 offset:49152
  ds_read_b64_tr_b16 a[154:155], v50 offset:49664
  ds_read_b64_tr_b16 a[156:157], v50 offset:51200
  ds_read_b64_tr_b16 a[158:159], v50 offset:51712
  ds_read_b64_tr_b16 a[216:217], v51 offset:49152
  ds_read_b64_tr_b16 a[218:219], v51 offset:49664
  ds_read_b64_tr_b16 a[220:221], v51 offset:51200
  ds_read_b64_tr_b16 a[222:223], v51 offset:51712
  s_branch Lwv_61
Lwv_64:
  ds_read_b64_tr_b16 a[128:129], v50 offset:32768
  ds_read_b64_tr_b16 a[130:131], v50 offset:33280
  ds_read_b64_tr_b16 a[132:133], v50 offset:34816
  ds_read_b64_tr_b16 a[134:135], v50 offset:35328
  ds_read_b64_tr_b16 a[192:193], v51 offset:32768
  ds_read_b64_tr_b16 a[194:195], v51 offset:33280
  ds_read_b64_tr_b16 a[196:197], v51 offset:34816
  ds_read_b64_tr_b16 a[198:199], v51 offset:35328
  ds_read_b64_tr_b16 a[136:137], v50 offset:49152
  ds_read_b64_tr_b16 a[138:139], v50 offset:49664
  ds_read_b64_tr_b16 a[140:141], v50 offset:51200
  ds_read_b64_tr_b16 a[142:143], v50 offset:51712
  ds_read_b64_tr_b16 a[200:201], v51 offset:49152
  ds_read_b64_tr_b16 a[202:203], v51 offset:49664
  ds_read_b64_tr_b16 a[204:205], v51 offset:51200
  ds_read_b64_tr_b16 a[206:207], v51 offset:51712
Lwv_61:
  s_waitcnt lgkmcnt(0)
  s_barrier
  s_lshl_b32 s54, s21, 18
  s_lshl_b32 s55, s20, 8
  s_add_u32 s54, s54, s55
  s_add_u32 s54, s54, 3145728
  s_add_u32 s64, s8, s54
  s_addc_u32 s65, s9, 0
  s_lshl_b32 s56, s21, 13
  s_add_u32 s56, s56, 131072
  s_mov_b32 m0, s56
  s_add_u32 s56, s56, 1024
  global_load_lds_dwordx4 v80, s[64:65]
  s_add_u32 s64, s64, 32768
  s_addc_u32 s65, s65, 0
  s_mov_b32 m0, s56
  s_add_u32 s56, s56, 1024
  global_load_lds_dwordx4 v80, s[64:65]
  s_add_u32 s64, s64, 32768
  s_addc_u32 s65, s65, 0
  s_mov_b32 m0, s56
  s_add_u32 s56, s56, 1024
  global_load_lds_dwordx4 v80, s[64:65]
  s_add_u32 s64, s64, 32768
  s_addc_u32 s65, s65, 0
  s_mov_b32 m0, s56
  s_add_u32 s56, s56, 1024
  global_load_lds_dwordx4 v80, s[64:65]
  s_add_u32 s64, s64, 32768
  s_addc_u32 s65, s65, 0
  s_mov_b32 m0, s56
  s_add_u32 s56, s56, 1024
  global_load_lds_dwordx4 v81, s[64:65]
  s_add_u32 s64, s64, 32768
  s_addc_u32 s65, s65, 0
  s_mov_b32 m0, s56
  s_add_u32 s56, s56, 1024
  global_load_lds_dwordx4 v81, s[64:65]
  s_add_u32 s64, s64, 32768
  s_addc_u32 s65, s65, 0
  s_mov_b32 m0, s56
  s_add_u32 s56, s56, 1024
  global_load_lds_dwordx4 v81, s[64:65]
  s_add_u32 s64, s64, 32768
  s_addc_u32 s65, s65, 0
  s_mov_b32 m0, s56
  s_add_u32 s56, s56, 1024
  global_load_lds_dwordx4 v81, s[64:65]
  s_waitcnt vmcnt(40)
  s_barrier
  s_cmp_eq_u32 s21, 0
  s_cbranch_scc0 Lwv_67
  ds_read_b64_tr_b16 a[0:1], v48 offset:0
  ds_read_b64_tr_b16 a[2:3], v48 offset:512
  ds_read_b64_tr_b16 a[4:5], v48 offset:2048
  ds_read_b64_tr_b16 a[6:7], v48 offset:2560
  ds_read_b64_tr_b16 a[64:65], v49 offset:0
  ds_read_b64_tr_b16 a[66:67], v49 offset:512
  ds_read_b64_tr_b16 a[68:69], v49 offset:2048
  ds_read_b64_tr_b16 a[70:71], v49 offset:2560
  ds_read_b64_tr_b16 a[8:9], v48 offset:16384
  ds_read_b64_tr_b16 a[10:11], v48 offset:16896
  ds_read_b64_tr_b16 a[12:13], v48 offset:18432
  ds_read_b64_tr_b16 a[14:15], v48 offset:18944
  ds_read_b64_tr_b16 a[72:73], v49 offset:16384
  ds_read_b64_tr_b16 a[74:75], v49 offset:16896
  ds_read_b64_tr_b16 a[76:77], v49 offset:18432
  ds_read_b64_tr_b16 a[78:79], v49 offset:18944
  s_branch Lwv_66
Lwv_67:
  s_cmp_eq_u32 s21, 1
  s_cbranch_scc0 Lwv_68
  ds_read_b64_tr_b16 a[16:17], v48 offset:0
  ds_read_b64_tr_b16 a[18:19], v48 offset:512
  ds_read_b64_tr_b16 a[20:21], v48 offset:2048
  ds_read_b64_tr_b16 a[22:23], v48 offset:2560
  ds_read_b64_tr_b16 a[80:81], v49 offset:0
  ds_read_b64_tr_b16 a[82:83], v49 offset:512
  ds_read_b64_tr_b16 a[84:85], v49 offset:2048
  ds_read_b64_tr_b16 a[86:87], v49 offset:2560
  ds_read_b64_tr_b16 a[24:25], v48 offset:16384
  ds_read_b64_tr_b16 a[26:27], v48 offset:16896
  ds_read_b64_tr_b16 a[28:29], v48 offset:18432
  ds_read_b64_tr_b16 a[30:31], v48 offset:18944
  ds_read_b64_tr_b16 a[88:89], v49 offset:16384
  ds_read_b64_tr_b16 a[90:91], v49 offset:16896
  ds_read_b64_tr_b16 a[92:93], v49 offset:18432
  ds_read_b64_tr_b16 a[94:95], v49 offset:18944
  s_branch Lwv_66
Lwv_68:
  s_cmp_eq_u32 s21, 2
  s_cbranch_scc0 Lwv_69
  ds_read_b64_tr_b16 a[32:33], v48 offset:0
  ds_read_b64_tr_b16 a[34:35], v48 offset:512
  ds_read_b64_tr_b16 a[36:37], v48 offset:2048
  ds_read_b64_tr_b16 a[38:39], v48 offset:2560
  ds_read_b64_tr_b16 a[96:97], v49 offset:0
  ds_read_b64_tr_b16 a[98:99], v49 offset:512
  ds_read_b64_tr_b16 a[100:101], v49 offset:2048
  ds_read_b64_tr_b16 a[102:103], v49 offset:2560
  ds_read_b64_tr_b16 a[40:41], v48 offset:16384
  ds_read_b64_tr_b16 a[42:43], v48 offset:16896
  ds_read_b64_tr_b16 a[44:45], v48 offset:18432
  ds_read_b64_tr_b16 a[46:47], v48 offset:18944
  ds_read_b64_tr_b16 a[104:105], v49 offset:16384
  ds_read_b64_tr_b16 a[106:107], v49 offset:16896
  ds_read_b64_tr_b16 a[108:109], v49 offset:18432
  ds_read_b64_tr_b16 a[110:111], v49 offset:18944
  s_branch Lwv_66
Lwv_69:
  ds_read_b64_tr_b16 a[48:49], v48 offset:0
  ds_read_b64_tr_b16 a[50:51], v48 offset:512
  ds_read_b64_tr_b16 a[52:53], v48 offset:2048
  ds_read_b64_tr_b16 a[54:55], v48 offset:2560
  ds_read_b64_tr_b16 a[112:113], v49 offset:0
  ds_read_b64_tr_b16 a[114:115], v49 offset:512
  ds_read_b64_tr_b16 a[116:117], v49 offset:2048
  ds_read_b64_tr_b16 a[118:119], v49 offset:2560
  ds_read_b64_tr_b16 a[56:57], v48 offset:16384
  ds_read_b64_tr_b16 a[58:59], v48 offset:16896
  ds_read_b64_tr_b16 a[60:61], v48 offset:18432
  ds_read_b64_tr_b16 a[62:63], v48 offset:18944
  ds_read_b64_tr_b16 a[120:121], v49 offset:16384
  ds_read_b64_tr_b16 a[122:123], v49 offset:16896
  ds_read_b64_tr_b16 a[124:125], v49 offset:18432
  ds_read_b64_tr_b16 a[126:127], v49 offset:18944
Lwv_66:
  s_waitcnt lgkmcnt(0)
  s_barrier
  s_lshl_b32 s54, s21, 18
  s_lshl_b32 s55, s20, 8
  s_add_u32 s54, s54, s55
  s_add_u32 s54, s54, 0
  s_add_u32 s64, s12, s54
  s_addc_u32 s65, s13, 0
  s_lshl_b32 s56, s21, 13
  s_add_u32 s56, s56, 32768
  s_mov_b32 m0, s56
  s_add_u32 s56, s56, 1024
  global_load_lds_dwordx4 v80, s[64:65]
  s_add_u32 s64, s64, 32768
  s_addc_u32 s65, s65, 0
  s_mov_b32 m0, s56
  s_add_u32 s56, s56, 1024
  global_load_lds_dwordx4 v80, s[64:65]
  s_add_u32 s64, s64, 32768
  s_addc_u32 s65, s65, 0
  s_mov_b32 m0, s56
  s_add_u32 s56, s56, 1024
  global_load_lds_dwordx4 v80, s[64:65]
  s_add_u32 s64, s64, 32768
  s_addc_u32 s65, s65, 0
  s_mov_b32 m0, s56
  s_add_u32 s56, s56, 1024
  global_load_lds_dwordx4 v80, s[64:65]
  s_add_u32 s64, s64, 32768
  s_addc_u32 s65, s65, 0
  s_mov_b32 m0, s56
  s_add_u32 s56, s56, 1024
  global_load_lds_dwordx4 v81, s[64:65]
  s_add_u32 s64, s64, 32768
  s_addc_u32 s65, s65, 0
  s_mov_b32 m0, s56
  s_add_u32 s56, s56, 1024
  global_load_lds_dwordx4 v81, s[64:65]
  s_add_u32 s64, s64, 32768
  s_addc_u32 s65, s65, 0
  s_mov_b32 m0, s56
  s_add_u32 s56, s56, 1024
  global_load_lds_dwordx4 v81, s[64:65]
  s_add_u32 s64, s64, 32768
  s_addc_u32 s65, s65, 0
  s_mov_b32 m0, s56
  s_add_u32 s56, s56, 1024
  global_load_lds_dwordx4 v81, s[64:65]
  s_waitcnt vmcnt(40)
  s_barrier
  s_cmp_eq_u32 s21, 0
  s_cbranch_scc0 Lwv_72
  ds_read_b64_tr_b16 a[16:17], v48 offset:32768
  ds_read_b64_tr_b16 a[18:19], v48 offset:33280
  ds_read_b64_tr_b16 a[20:21], v48 offset:34816
  ds_read_b64_tr_b16 a[22:23], v48 offset:35328
  ds_read_b64_tr_b16 a[80:81], v49 offset:32768
  ds_read_b64_tr_b16 a[82:83], v49 offset:33280
  ds_read_b64_tr_b16 a[84:85], v49 offset:34816
  ds_read_b64_tr_b16 a[86:87], v49 offset:35328
  ds_read_b64_tr_b16 a[24:25], v48 offset:49152
  ds_read_b64_tr_b16 a[26:27], v48 offset:49664
  ds_read_b64_tr_b16 a[28:29], v48 offset:51200
  ds_read_b64_tr_b16 a[30:31], v48 offset:51712
  ds_read_b64_tr_b16 a[88:89], v49 offset:49152
  ds_read_b64_tr_b16 a[90:91], v49 offset:49664
  ds_read_b64_tr_b16 a[92:93], v49 offset:51200
  ds_read_b64_tr_b16 a[94:95], v49 offset:51712
  s_branch Lwv_71
Lwv_72:
  s_cmp_eq_u32 s21, 1
  s_cbranch_scc0 Lwv_73
  ds_read_b64_tr_b16 a[0:1], v48 offset:32768
  ds_read_b64_tr_b16 a[2:3], v48 offset:33280
  ds_read_b64_tr_b16 a[4:5], v48 offset:34816
  ds_read_b64_tr_b16 a[6:7], v48 offset:35328
  ds_read_b64_tr_b16 a[64:65], v49 offset:32768
  ds_read_b64_tr_b16 a[66:67], v49 offset:33280
  ds_read_b64_tr_b16 a[68:69], v49 offset:34816
  ds_read_b64_tr_b16 a[70:71], v49 offset:35328
  ds_read_b64_tr_b16 a[8:9], v48 offset:49152
  ds_read_b64_tr_b16 a[10:11], v48 offset:49664
  ds_read_b64_tr_b16 a[12:13], v48 offset:51200
  ds_read_b64_tr_b16 a[14:15], v48 offset:51712
  ds_read_b64_tr_b16 a[72:73], v49 offset:49152
  ds_read_b64_tr_b16 a[74:75], v49 offset:49664
  ds_read_b64_tr_b16 a[76:77], v49 offset:51200
  ds_read_b64_tr_b16 a[78:79], v49 offset:51712
  s_branch Lwv_71
Lwv_73:
  s_cmp_eq_u32 s21, 2
  s_cbranch_scc0 Lwv_74
  ds_read_b64_tr_b16 a[48:49], v48 offset:32768
  ds_read_b64_tr_b16 a[50:51], v48 offset:33280
  ds_read_b64_tr_b16 a[52:53], v48 offset:34816
  ds_read_b64_tr_b16 a[54:55], v48 offset:35328
  ds_read_b64_tr_b16 a[112:113], v49 offset:32768
  ds_read_b64_tr_b16 a[114:115], v49 offset:33280
  ds_read_b64_tr_b16 a[116:117], v49 offset:34816
  ds_read_b64_tr_b16 a[118:119], v49 offset:35328
  ds_read_b64_tr_b16 a[56:57], v48 offset:49152
  ds_read_b64_tr_b16 a[58:59], v48 offset:49664
  ds_read_b64_tr_b16 a[60:61], v48 offset:51200
  ds_read_b64_tr_b16 a[62:63], v48 offset:51712
  ds_read_b64_tr_b16 a[120:121], v49 offset:49152
  ds_read_b64_tr_b16 a[122:123], v49 offset:49664
  ds_read_b64_tr_b16 a[124:125], v49 offset:51200
  ds_read_b64_tr_b16 a[126:127], v49 offset:51712
  s_branch Lwv_71
Lwv_74:
  ds_read_b64_tr_b16 a[32:33], v48 offset:32768
  ds_read_b64_tr_b16 a[34:35], v48 offset:33280
  ds_read_b64_tr_b16 a[36:37], v48 offset:34816
  ds_read_b64_tr_b16 a[38:39], v48 offset:35328
  ds_read_b64_tr_b16 a[96:97], v49 offset:32768
  ds_read_b64_tr_b16 a[98:99], v49 offset:33280
  ds_read_b64_tr_b16 a[100:101], v49 offset:34816
  ds_read_b64_tr_b16 a[102:103], v49 offset:35328
  ds_read_b64_tr_b16 a[40:41], v48 offset:49152
  ds_read_b64_tr_b16 a[42:43], v48 offset:49664
  ds_read_b64_tr_b16 a[44:45], v48 offset:51200
  ds_read_b64_tr_b16 a[46:47], v48 offset:51712
  ds_read_b64_tr_b16 a[104:105], v49 offset:49152
  ds_read_b64_tr_b16 a[106:107], v49 offset:49664
  ds_read_b64_tr_b16 a[108:109], v49 offset:51200
  ds_read_b64_tr_b16 a[110:111], v49 offset:51712
Lwv_71:
  s_waitcnt lgkmcnt(0)
  s_barrier
  s_lshl_b32 s54, s21, 18
  s_lshl_b32 s55, s20, 8
  s_add_u32 s54, s54, s55
  s_add_u32 s54, s54, 1048576
  s_add_u32 s64, s12, s54
  s_addc_u32 s65, s13, 0
  s_lshl_b32 s56, s21, 13
  s_add_u32 s56, s56, 65536
  s_mov_b32 m0, s56
  s_add_u32 s56, s56, 1024
  global_load_lds_dwordx4 v80, s[64:65]
  s_add_u32 s64, s64, 32768
  s_addc_u32 s65, s65, 0
  s_mov_b32 m0, s56
  s_add_u32 s56, s56, 1024
  global_load_lds_dwordx4 v80, s[64:65]
  s_add_u32 s64, s64, 32768
  s_addc_u32 s65, s65, 0
  s_mov_b32 m0, s56
  s_add_u32 s56, s56, 1024
  global_load_lds_dwordx4 v80, s[64:65]
  s_add_u32 s64, s64, 32768
  s_addc_u32 s65, s65, 0
  s_mov_b32 m0, s56
  s_add_u32 s56, s56, 1024
  global_load_lds_dwordx4 v80, s[64:65]
  s_add_u32 s64, s64, 32768
  s_addc_u32 s65, s65, 0
  s_mov_b32 m0, s56
  s_add_u32 s56, s56, 1024
  global_load_lds_dwordx4 v81, s[64:65]
  s_add_u32 s64, s64, 32768
  s_addc_u32 s65, s65, 0
  s_mov_b32 m0, s56
  s_add_u32 s56, s56, 1024
  global_load_lds_dwordx4 v81, s[64:65]
  s_add_u32 s64, s64, 32768
  s_addc_u32 s65, s65, 0
  s_mov_b32 m0, s56
  s_add_u32 s56, s56, 1024
  global_load_lds_dwordx4 v81, s[64:65]
  s_add_u32 s64, s64, 32768
  s_addc_u32 s65, s65, 0
  s_mov_b32 m0, s56
  s_add_u32 s56, s56, 1024
  global_load_lds_dwordx4 v81, s[64:65]
  s_waitcnt vmcnt(32)
  s_barrier
  s_cmp_eq_u32 s21, 0
  s_cbranch_scc0 Lwv_77
  ds_read_b64_tr_b16 a[32:33], v50 offset:0
  ds_read_b64_tr_b16 a[34:35], v50 offset:512
  ds_read_b64_tr_b16 a[36:37], v50 offset:2048
  ds_read_b64_tr_b16 a[38:39], v50 offset:2560
  ds_read_b64_tr_b16 a[96:97], v51 offset:0
  ds_read_b64_tr_b16 a[98:99], v51 offset:512
  ds_read_b64_tr_b16 a[100:101], v51 offset:2048
  ds_read_b64_tr_b16 a[102:103], v51 offset:2560
  ds_read_b64_tr_b16 a[40:41], v50 offset:16384
  ds_read_b64_tr_b16 a[42:43], v50 offset:16896
  ds_read_b64_tr_b16 a[44:45], v50 offset:18432
  ds_read_b64_tr_b16 a[46:47], v50 offset:18944
  ds_read_b64_tr_b16 a[104:105], v51 offset:16384
  ds_read_b64_tr_b16 a[106:107], v51 offset:16896
  ds_read_b64_tr_b16 a[108:109], v51 offset:18432
  ds_read_b64_tr_b16 a[110:111], v51 offset:18944
  s_branch Lwv_76
Lwv_77:
  s_cmp_eq_u32 s21, 1
  s_cbranch_scc0 Lwv_78
  ds_read_b64_tr_b16 a[48:49], v50 offset:0
  ds_read_b64_tr_b16 a[50:51], v50 offset:512
  ds_read_b64_tr_b16 a[52:53], v50 offset:2048
  ds_read_b64_tr_b16 a[54:55], v50 offset:2560
  ds_read_b64_tr_b16 a[112:113], v51 offset:0
  ds_read_b64_tr_b16 a[114:115], v51 offset:512
  ds_read_b64_tr_b16 a[116:117], v51 offset:2048
  ds_read_b64_tr_b16 a[118:119], v51 offset:2560
  ds_read_b64_tr_b16 a[56:57], v50 offset:16384
  ds_read_b64_tr_b16 a[58:59], v50 offset:16896
  ds_read_b64_tr_b16 a[60:61], v50 offset:18432
  ds_read_b64_tr_b16 a[62:63], v50 offset:18944
  ds_read_b64_tr_b16 a[120:121], v51 offset:16384
  ds_read_b64_tr_b16 a[122:123], v51 offset:16896
  ds_read_b64_tr_b16 a[124:125], v51 offset:18432
  ds_read_b64_tr_b16 a[126:127], v51 offset:18944
  s_branch Lwv_76
Lwv_78:
  s_cmp_eq_u32 s21, 2
  s_cbranch_scc0 Lwv_79
  ds_read_b64_tr_b16 a[0:1], v50 offset:0
  ds_read_b64_tr_b16 a[2:3], v50 offset:512
  ds_read_b64_tr_b16 a[4:5], v50 offset:2048
  ds_read_b64_tr_b16 a[6:7], v50 offset:2560
  ds_read_b64_tr_b16 a[64:65], v51 offset:0
  ds_read_b64_tr_b16 a[66:67], v51 offset:512
  ds_read_b64_tr_b16 a[68:69], v51 offset:2048
  ds_read_b64_tr_b16 a[70:71], v51 offset:2560
  ds_read_b64_tr_b16 a[8:9], v50 offset:16384
  ds_read_b64_tr_b16 a[10:11], v50 offset:16896
  ds_read_b64_tr_b16 a[12:13], v50 offset:18432
  ds_read_b64_tr_b16 a[14:15], v50 offset:18944
  ds_read_b64_tr_b16 a[72:73], v51 offset:16384
  ds_read_b64_tr_b16 a[74:75], v51 offset:16896
  ds_read_b64_tr_b16 a[76:77], v51 offset:18432
  ds_read_b64_tr_b16 a[78:79], v51 offset:18944
  s_branch Lwv_76
Lwv_79:
  ds_read_b64_tr_b16 a[16:17], v50 offset:0
  ds_read_b64_tr_b16 a[18:19], v50 offset:512
  ds_read_b64_tr_b16 a[20:21], v50 offset:2048
  ds_read_b64_tr_b16 a[22:23], v50 offset:2560
  ds_read_b64_tr_b16 a[80:81], v51 offset:0
  ds_read_b64_tr_b16 a[82:83], v51 offset:512
  ds_read_b64_tr_b16 a[84:85], v51 offset:2048
  ds_read_b64_tr_b16 a[86:87], v51 offset:2560
  ds_read_b64_tr_b16 a[24:25], v50 offset:16384
  ds_read_b64_tr_b16 a[26:27], v50 offset:16896
  ds_read_b64_tr_b16 a[28:29], v50 offset:18432
  ds_read_b64_tr_b16 a[30:31], v50 offset:18944
  ds_read_b64_tr_b16 a[88:89], v51 offset:16384
  ds_read_b64_tr_b16 a[90:91], v51 offset:16896
  ds_read_b64_tr_b16 a[92:93], v51 offset:18432
  ds_read_b64_tr_b16 a[94:95], v51 offset:18944
Lwv_76:
  s_waitcnt lgkmcnt(0)
  s_barrier
  s_lshl_b32 s54, s21, 18
  s_lshl_b32 s55, s20, 8
  s_add_u32 s54, s54, s55
  s_add_u32 s54, s54, 2097152
  s_add_u32 s64, s12, s54
  s_addc_u32 s65, s13, 0
  s_lshl_b32 s56, s21, 13
  s_add_u32 s56, s56, 98304
  s_mov_b32 m0, s56
  s_add_u32 s56, s56, 1024
  global_load_lds_dwordx4 v80, s[64:65]
  s_add_u32 s64, s64, 32768
  s_addc_u32 s65, s65, 0
  s_mov_b32 m0, s56
  s_add_u32 s56, s56, 1024
  global_load_lds_dwordx4 v80, s[64:65]
  s_add_u32 s64, s64, 32768
  s_addc_u32 s65, s65, 0
  s_mov_b32 m0, s56
  s_add_u32 s56, s56, 1024
  global_load_lds_dwordx4 v80, s[64:65]
  s_add_u32 s64, s64, 32768
  s_addc_u32 s65, s65, 0
  s_mov_b32 m0, s56
  s_add_u32 s56, s56, 1024
  global_load_lds_dwordx4 v80, s[64:65]
  s_add_u32 s64, s64, 32768
  s_addc_u32 s65, s65, 0
  s_mov_b32 m0, s56
  s_add_u32 s56, s56, 1024
  global_load_lds_dwordx4 v81, s[64:65]
  s_add_u32 s64, s64, 32768
  s_addc_u32 s65, s65, 0
  s_mov_b32 m0, s56
  s_add_u32 s56, s56, 1024
  global_load_lds_dwordx4 v81, s[64:65]
  s_add_u32 s64, s64, 32768
  s_addc_u32 s65, s65, 0
  s_mov_b32 m0, s56
  s_add_u32 s56, s56, 1024
  global_load_lds_dwordx4 v81, s[64:65]
  s_add_u32 s64, s64, 32768
  s_addc_u32 s65, s65, 0
  s_mov_b32 m0, s56
  s_add_u32 s56, s56, 1024
  global_load_lds_dwordx4 v81, s[64:65]
  s_waitcnt vmcnt(24)
  s_barrier
  s_cmp_eq_u32 s21, 0
  s_cbranch_scc0 L_rec_noinc
  v_mov_b32 v56, 1
  s_mov_b64 exec, 1
  global_atomic_add v36, v56, s[18:19] offset:132
  s_mov_b64 exec, -1
L_rec_noinc:
  s_cmp_eq_u32 s21, 0
  s_cbranch_scc0 Lwv_82
  ds_read_b64_tr_b16 a[48:49], v50 offset:32768
  ds_read_b64_tr_b16 a[50:51], v50 offset:33280
  ds_read_b64_tr_b16 a[52:53], v50 offset:34816
  ds_read_b64_tr_b16 a[54:55], v50 offset:35328
  ds_read_b64_tr_b16 a[112:113], v51 offset:32768
  ds_read_b64_tr_b16 a[114:115], v51 offset:33280
  ds_read_b64_tr_b16 a[116:117], v51 offset:34816
  ds_read_b64_tr_b16 a[118:119], v51 offset:35328
  ds_read_b64_tr_b16 a[56:57], v50 offset:49152
  ds_read_b64_tr_b16 a[58:59], v50 offset:49664
  ds_read_b64_tr_b16 a[60:61], v50 offset:51200
  ds_read_b64_tr_b16 a[62:63], v50 offset:51712
  ds_read_b64_tr_b16 a[120:121], v51 offset:49152
  ds_read_b64_tr_b16 a[122:123], v51 offset:49664
  ds_read_b64_tr_b16 a[124:125], v51 offset:51200
  ds_read_b64_tr_b16 a[126:127], v51 offset:51712
  s_branch Lwv_81
Lwv_82:
  s_cmp_eq_u32 s21, 1
  s_cbranch_scc0 Lwv_83
  ds_read_b64_tr_b16 a[32:33], v50 offset:32768
  ds_read_b64_tr_b16 a[34:35], v50 offset:33280
  ds_read_b64_tr_b16 a[36:37], v50 offset:34816
  ds_read_b64_tr_b16 a[38:39], v50 offset:35328
  ds_read_b64_tr_b16 a[96:97], v51 offset:32768
  ds_read_b64_tr_b16 a[98:99], v51 offset:33280
  ds_read_b64_tr_b16 a[100:101], v51 offset:34816
  ds_read_b64_tr_b16 a[102:103], v51 offset:35328
  ds_read_b64_tr_b16 a[40:41], v50 offset:49152
  ds_read_b64_tr_b16 a[42:43], v50 offset:49664
  ds_read_b64_tr_b16 a[44:45], v50 offset:51200
  ds_read_b64_tr_b16 a[46:47], v50 offset:51712
  ds_read_b64_tr_b16 a[104:105], v51 offset:49152
  ds_read_b64_tr_b16 a[106:107], v51 offset:49664
  ds_read_b64_tr_b16 a[108:109], v51 offset:51200
  ds_read_b64_tr_b16 a[110:111], v51 offset:51712
  s_branch Lwv_81
Lwv_83:
  s_cmp_eq_u32 s21, 2
  s_cbranch_scc0 Lwv_84
  ds_read_b64_tr_b16 a[16:17], v50 offset:32768
  ds_read_b64_tr_b16 a[18:19], v50 offset:33280
  ds_read_b64_tr_b16 a[20:21], v50 offset:34816
  ds_read_b64_tr_b16 a[22:23], v50 offset:35328
  ds_read_b64_tr_b16 a[80:81], v51 offset:32768
  ds_read_b64_tr_b16 a[82:83], v51 offset:33280
  ds_read_b64_tr_b16 a[84:85], v51 offset:34816
  ds_read_b64_tr_b16 a[86:87], v51 offset:35328
  ds_read_b64_tr_b16 a[24:25], v50 offset:49152
  ds_read_b64_tr_b16 a[26:27], v50 offset:49664
  ds_read_b64_tr_b16 a[28:29], v50 offset:51200
  ds_read_b64_tr_b16 a[30:31], v50 offset:51712
  ds_read_b64_tr_b16 a[88:89], v51 offset:49152
  ds_read_b64_tr_b16 a[90:91], v51 offset:49664
  ds_read_b64_tr_b16 a[92:93], v51 offset:51200
  ds_read_b64_tr_b16 a[94:95], v51 offset:51712
  s_branch Lwv_81
Lwv_84:
  ds_read_b64_tr_b16 a[0:1], v50 offset:32768
  ds_read_b64_tr_b16 a[2:3], v50 offset:33280
  ds_read_b64_tr_b16 a[4:5], v50 offset:34816
  ds_read_b64_tr_b16 a[6:7], v50 offset:35328
  ds_read_b64_tr_b16 a[64:65], v51 offset:32768
  ds_read_b64_tr_b16 a[66:67], v51 offset:33280
  ds_read_b64_tr_b16 a[68:69], v51 offset:34816
  ds_read_b64_tr_b16 a[70:71], v51 offset:35328
  ds_read_b64_tr_b16 a[8:9], v50 offset:49152
  ds_read_b64_tr_b16 a[10:11], v50 offset:49664
  ds_read_b64_tr_b16 a[12:13], v50 offset:51200
  ds_read_b64_tr_b16 a[14:15], v50 offset:51712
  ds_read_b64_tr_b16 a[72:73], v51 offset:49152
  ds_read_b64_tr_b16 a[74:75], v51 offset:49664
  ds_read_b64_tr_b16 a[76:77], v51 offset:51200
  ds_read_b64_tr_b16 a[78:79], v51 offset:51712
Lwv_81:
  ds_write_b32 v54, v62 offset:0
  ds_write_b32 v54, v63 offset:1024
  ds_write_b32 v54, v64 offset:2048
  ds_write_b32 v54, v65 offset:3072
  ds_write_b32 v54, v66 offset:4096
  ds_write_b32 v54, v67 offset:5120
  ds_write_b32 v54, v68 offset:6144
  ds_write_b32 v54, v69 offset:7168
  s_waitcnt lgkmcnt(0)
  s_barrier
  s_lshl_b32 s54, s21, 18
  s_lshl_b32 s55, s20, 8
  s_add_u32 s54, s54, s55
  s_add_u32 s54, s54, 3145728
  s_add_u32 s64, s12, s54
  s_addc_u32 s65, s13, 0
  s_lshl_b32 s56, s21, 13
  s_add_u32 s56, s56, 131072
  s_mov_b32 m0, s56
  s_add_u32 s56, s56, 1024
  global_load_lds_dwordx4 v80, s[64:65]
  s_add_u32 s64, s64, 32768
  s_addc_u32 s65, s65, 0
  s_mov_b32 m0, s56
  s_add_u32 s56, s56, 1024
  global_load_lds_dwordx4 v80, s[64:65]
  s_add_u32 s64, s64, 32768
  s_addc_u32 s65, s65, 0
  s_mov_b32 m0, s56
  s_add_u32 s56, s56, 1024
  global_load_lds_dwordx4 v80, s[64:65]
  s_add_u32 s64, s64, 32768
  s_addc_u32 s65, s65, 0
  s_mov_b32 m0, s56
  s_add_u32 s56, s56, 1024
  global_load_lds_dwordx4 v80, s[64:65]
  s_add_u32 s64, s64, 32768
  s_addc_u32 s65, s65, 0
  s_mov_b32 m0, s56
  s_add_u32 s56, s56, 1024
  global_load_lds_dwordx4 v81, s[64:65]
  s_add_u32 s64, s64, 32768
  s_addc_u32 s65, s65, 0
  s_mov_b32 m0, s56
  s_add_u32 s56, s56, 1024
  global_load_lds_dwordx4 v81, s[64:65]
  s_add_u32 s64, s64, 32768
  s_addc_u32 s65, s65, 0
  s_mov_b32 m0, s56
  s_add_u32 s56, s56, 1024
  global_load_lds_dwordx4 v81, s[64:65]
  s_add_u32 s64, s64, 32768
  s_addc_u32 s65, s65, 0
  s_mov_b32 m0, s56
  s_add_u32 s56, s56, 1024
  global_load_lds_dwordx4 v81, s[64:65]
  s_waitcnt vmcnt(24)
  s_barrier
  s_cmp_eq_u32 s21, 0
  s_cbranch_scc0 Lwv_87
  ds_read_b64_tr_b16 v[128:129], v48 offset:0
  ds_read_b64_tr_b16 v[130:131], v48 offset:512
  ds_read_b64_tr_b16 v[132:133], v48 offset:2048
  ds_read_b64_tr_b16 v[134:135], v48 offset:2560
  ds_read_b64_tr_b16 v[192:193], v49 offset:0
  ds_read_b64_tr_b16 v[194:195], v49 offset:512
  ds_read_b64_tr_b16 v[196:197], v49 offset:2048
  ds_read_b64_tr_b16 v[198:199], v49 offset:2560
  ds_read_b64_tr_b16 v[136:137], v48 offset:16384
  ds_read_b64_tr_b16 v[138:139], v48 offset:16896
  ds_read_b64_tr_b16 v[140:141], v48 offset:18432
  ds_read_b64_tr_b16 v[142:143], v48 offset:18944
  ds_read_b64_tr_b16 v[200:201], v49 offset:16384
  ds_read_b64_tr_b16 v[202:203], v49 offset:16896
  ds_read_b64_tr_b16 v[204:205], v49 offset:18432
  ds_read_b64_tr_b16 v[206:207], v49 offset:18944
  s_branch Lwv_86
Lwv_87:
  s_cmp_eq_u32 s21, 1
  s_cbranch_scc0 Lwv_88
  ds_read_b64_tr_b16 v[144:145], v48 offset:0
  ds_read_b64_tr_b16 v[146:147], v48 offset:512
  ds_read_b64_tr_b16 v[148:149], v48 offset:2048
  ds_read_b64_tr_b16 v[150:151], v48 offset:2560
  ds_read_b64_tr_b16 v[208:209], v49 offset:0
  ds_read_b64_tr_b16 v[210:211], v49 offset:512
  ds_read_b64_tr_b16 v[212:213], v49 offset:2048
  ds_read_b64_tr_b16 v[214:215], v49 offset:2560
  ds_read_b64_tr_b16 v[152:153], v48 offset:16384
  ds_read_b64_tr_b16 v[154:155], v48 offset:16896
  ds_read_b64_tr_b16 v[156:157], v48 offset:18432
  ds_read_b64_tr_b16 v[158:159], v48 offset:18944
  ds_read_b64_tr_b16 v[216:217], v49 offset:16384
  ds_read_b64_tr_b16 v[218:219], v49 offset:16896
  ds_read_b64_tr_b16 v[220:221], v49 offset:18432
  ds_read_b64_tr_b16 v[222:223], v49 offset:18944
  s_branch Lwv_86
Lwv_88:
  s_cmp_eq_u32 s21, 2
  s_cbranch_scc0 Lwv_89
  ds_read_b64_tr_b16 v[160:161], v48 offset:0
  ds_read_b64_tr_b16 v[162:163], v48 offset:512
  ds_read_b64_tr_b16 v[164:165], v48 offset:2048
  ds_read_b64_tr_b16 v[166:167], v48 offset:2560
  ds_read_b64_tr_b16 v[224:225], v49 offset:0
  ds_read_b64_tr_b16 v[226:227], v49 offset:512
  ds_read_b64_tr_b16 v[228:229], v49 offset:2048
  ds_read_b64_tr_b16 v[230:231], v49 offset:2560
  ds_read_b64_tr_b16 v[168:169], v48 offset:16384
  ds_read_b64_tr_b16 v[170:171], v48 offset:16896
  ds_read_b64_tr_b16 v[172:173], v48 offset:18432
  ds_read_b64_tr_b16 v[174:175], v48 offset:18944
  ds_read_b64_tr_b16 v[232:233], v49 offset:16384
  ds_read_b64_tr_b16 v[234:235], v49 offset:16896
  ds_read_b64_tr_b16 v[236:237], v49 offset:18432
  ds_read_b64_tr_b16 v[238:239], v49 offset:18944
  s_branch Lwv_86
Lwv_89:
  ds_read_b64_tr_b16 v[176:177], v48 offset:0
  ds_read_b64_tr_b16 v[178:179], v48 offset:512
  ds_read_b64_tr_b16 v[180:181], v48 offset:2048
  ds_read_b64_tr_b16 v[182:183], v48 offset:2560
  ds_read_b64_tr_b16 v[240:241], v49 offset:0
  ds_read_b64_tr_b16 v[242:243], v49 offset:512
  ds_read_b64_tr_b16 v[244:245], v49 offset:2048
  ds_read_b64_tr_b16 v[246:247], v49 offset:2560
  ds_read_b64_tr_b16 v[184:185], v48 offset:16384
  ds_read_b64_tr_b16 v[186:187], v48 offset:16896
  ds_read_b64_tr_b16 v[188:189], v48 offset:18432
  ds_read_b64_tr_b16 v[190:191], v48 offset:18944
  ds_read_b64_tr_b16 v[248:249], v49 offset:16384
  ds_read_b64_tr_b16 v[250:251], v49 offset:16896
  ds_read_b64_tr_b16 v[252:253], v49 offset:18432
  ds_read_b64_tr_b16 v[254:255], v49 offset:18944
Lwv_86:
  s_waitcnt lgkmcnt(0)
  s_barrier
  s_lshl_b32 s54, s21, 15
  s_lshl_b32 s55, s20, 17
  s_add_u32 s54, s54, s55
  s_add_u32 s54, s54, 0
  s_add_u32 s64, s14, s54
  s_addc_u32 s65, s15, 0
  s_lshl_b32 s56, s21, 13
  s_add_u32 s56, s56, 32768
  s_mov_b32 m0, s56
  s_add_u32 s56, s56, 1024
  global_load_lds_dwordx4 v46, s[64:65]
  s_add_u32 s64, s64, 4096
  s_addc_u32 s65, s65, 0
  s_mov_b32 m0, s56
  s_add_u32 s56, s56, 1024
  global_load_lds_dwordx4 v47, s[64:65]
  s_add_u32 s64, s64, 4096
  s_addc_u32 s65, s65, 0
  s_mov_b32 m0, s56
  s_add_u32 s56, s56, 1024
  global_load_lds_dwordx4 v46, s[64:65]
  s_add_u32 s64, s64, 4096
  s_addc_u32 s65, s65, 0
  s_mov_b32 m0, s56
  s_add_u32 s56, s56, 1024
  global_load_lds_dwordx4 v47, s[64:65]
  s_add_u32 s64, s64, 4096
  s_addc_u32 s65, s65, 0
  s_mov_b32 m0, s56
  s_add_u32 s56, s56, 1024
  global_load_lds_dwordx4 v46, s[64:65]
  s_add_u32 s64, s64, 4096
  s_addc_u32 s65, s65, 0
  s_mov_b32 m0, s56
  s_add_u32 s56, s56, 1024
  global_load_lds_dwordx4 v47, s[64:65]
  s_add_u32 s64, s64, 4096
  s_addc_u32 s65, s65, 0
  s_mov_b32 m0, s56
  s_add_u32 s56, s56, 1024
  global_load_lds_dwordx4 v46, s[64:65]
  s_add_u32 s64, s64, 4096
  s_addc_u32 s65, s65, 0
  s_mov_b32 m0, s56
  s_add_u32 s56, s56, 1024
  global_load_lds_dwordx4 v47, s[64:65]
  s_waitcnt vmcnt(24)
  s_barrier
  s_cmp_eq_u32 s21, 0
  s_cbranch_scc0 Lwv_92
  ds_read_b64_tr_b16 v[144:145], v48 offset:32768
  ds_read_b64_tr_b16 v[146:147], v48 offset:33280
  ds_read_b64_tr_b16 v[148:149], v48 offset:34816
  ds_read_b64_tr_b16 v[150:151], v48 offset:35328
  ds_read_b64_tr_b16 v[208:209], v49 offset:32768
  ds_read_b64_tr_b16 v[210:211], v49 offset:33280
  ds_read_b64_tr_b16 v[212:213], v49 offset:34816
  ds_read_b64_tr_b16 v[214:215], v49 offset:35328
  ds_read_b64_tr_b16 v[152:153], v48 offset:49152
  ds_read_b64_tr_b16 v[154:155], v48 offset:49664
  ds_read_b64_tr_b16 v[156:157], v48 offset:51200
  ds_read_b64_tr_b16 v[158:159], v48 offset:51712
  ds_read_b64_tr_b16 v[216:217], v49 offset:49152
  ds_read_b64_tr_b16 v[218:219], v49 offset:49664
  ds_read_b64_tr_b16 v[220:221], v49 offset:51200
  ds_read_b64_tr_b16 v[222:223], v49 offset:51712
  s_branch Lwv_91
Lwv_92:
  s_cmp_eq_u32 s21, 1
  s_cbranch_scc0 Lwv_93
  ds_read_b64_tr_b16 v[128:129], v48 offset:32768
  ds_read_b64_tr_b16 v[130:131], v48 offset:33280
  ds_read_b64_tr_b16 v[132:133], v48 offset:34816
  ds_read_b64_tr_b16 v[134:135], v48 offset:35328
  ds_read_b64_tr_b16 v[192:193], v49 offset:32768
  ds_read_b64_tr_b16 v[194:195], v49 offset:33280
  ds_read_b64_tr_b16 v[196:197], v49 offset:34816
  ds_read_b64_tr_b16 v[198:199], v49 offset:35328
  ds_read_b64_tr_b16 v[136:137], v48 offset:49152
  ds_read_b64_tr_b16 v[138:139], v48 offset:49664
  ds_read_b64_tr_b16 v[140:141], v48 offset:51200
  ds_read_b64_tr_b16 v[142:143], v48 offset:51712
  ds_read_b64_tr_b16 v[200:201], v49 offset:49152
  ds_read_b64_tr_b16 v[202:203], v49 offset:49664
  ds_read_b64_tr_b16 v[204:205], v49 offset:51200
  ds_read_b64_tr_b16 v[206:207], v49 offset:51712
  s_branch Lwv_91
Lwv_93:
  s_cmp_eq_u32 s21, 2
  s_cbranch_scc0 Lwv_94
  ds_read_b64_tr_b16 v[176:177], v48 offset:32768
  ds_read_b64_tr_b16 v[178:179], v48 offset:33280
  ds_read_b64_tr_b16 v[180:181], v48 offset:34816
  ds_read_b64_tr_b16 v[182:183], v48 offset:35328
  ds_read_b64_tr_b16 v[240:241], v49 offset:32768
  ds_read_b64_tr_b16 v[242:243], v49 offset:33280
  ds_read_b64_tr_b16 v[244:245], v49 offset:34816
  ds_read_b64_tr_b16 v[246:247], v49 offset:35328
  ds_read_b64_tr_b16 v[184:185], v48 offset:49152
  ds_read_b64_tr_b16 v[186:187], v48 offset:49664
  ds_read_b64_tr_b16 v[188:189], v48 offset:51200
  ds_read_b64_tr_b16 v[190:191], v48 offset:51712
  ds_read_b64_tr_b16 v[248:249], v49 offset:49152
  ds_read_b64_tr_b16 v[250:251], v49 offset:49664
  ds_read_b64_tr_b16 v[252:253], v49 offset:51200
  ds_read_b64_tr_b16 v[254:255], v49 offset:51712
  s_branch Lwv_91
Lwv_94:
  ds_read_b64_tr_b16 v[160:161], v48 offset:32768
  ds_read_b64_tr_b16 v[162:163], v48 offset:33280
  ds_read_b64_tr_b16 v[164:165], v48 offset:34816
  ds_read_b64_tr_b16 v[166:167], v48 offset:35328
  ds_read_b64_tr_b16 v[224:225], v49 offset:32768
  ds_read_b64_tr_b16 v[226:227], v49 offset:33280
  ds_read_b64_tr_b16 v[228:229], v49 offset:34816
  ds_read_b64_tr_b16 v[230:231], v49 offset:35328
  ds_read_b64_tr_b16 v[168:169], v48 offset:49152
  ds_read_b64_tr_b16 v[170:171], v48 offset:49664
  ds_read_b64_tr_b16 v[172:173], v48 offset:51200
  ds_read_b64_tr_b16 v[174:175], v48 offset:51712
  ds_read_b64_tr_b16 v[232:233], v49 offset:49152
  ds_read_b64_tr_b16 v[234:235], v49 offset:49664
  ds_read_b64_tr_b16 v[236:237], v49 offset:51200
  ds_read_b64_tr_b16 v[238:239], v49 offset:51712
Lwv_91:
  s_waitcnt lgkmcnt(0)
  s_barrier
  s_lshl_b32 s54, s21, 15
  s_lshl_b32 s55, s20, 17
  s_add_u32 s54, s54, s55
  s_add_u32 s54, s54, 256
  s_add_u32 s64, s14, s54
  s_addc_u32 s65, s15, 0
  s_lshl_b32 s56, s21, 13
  s_add_u32 s56, s56, 65536
  s_mov_b32 m0, s56
  s_add_u32 s56, s56, 1024
  global_load_lds_dwordx4 v46, s[64:65]
  s_add_u32 s64, s64, 4096
  s_addc_u32 s65, s65, 0
  s_mov_b32 m0, s56
  s_add_u32 s56, s56, 1024
  global_load_lds_dwordx4 v47, s[64:65]
  s_add_u32 s64, s64, 4096
  s_addc_u32 s65, s65, 0
  s_mov_b32 m0, s56
  s_add_u32 s56, s56, 1024
  global_load_lds_dwordx4 v46, s[64:65]
  s_add_u32 s64, s64, 4096
  s_addc_u32 s65, s65, 0
  s_mov_b32 m0, s56
  s_add_u32 s56, s56, 1024
  global_load_lds_dwordx4 v47, s[64:65]
  s_add_u32 s64, s64, 4096
  s_addc_u32 s65, s65, 0
  s_mov_b32 m0, s56
  s_add_u32 s56, s56, 1024
  global_load_lds_dwordx4 v46, s[64:65]
  s_add_u32 s64, s64, 4096
  s_addc_u32 s65, s65, 0
  s_mov_b32 m0, s56
  s_add_u32 s56, s56, 1024
  global_load_lds_dwordx4 v47, s[64:65]
  s_add_u32 s64, s64, 4096
  s_addc_u32 s65, s65, 0
  s_mov_b32 m0, s56
  s_add_u32 s56, s56, 1024
  global_load_lds_dwordx4 v46, s[64:65]
  s_add_u32 s64, s64, 4096
  s_addc_u32 s65, s65, 0
  s_mov_b32 m0, s56
  s_add_u32 s56, s56, 1024
  global_load_lds_dwordx4 v47, s[64:65]
  s_waitcnt vmcnt(24)
  s_barrier
  s_cmp_eq_u32 s21, 0
  s_cbranch_scc0 Lwv_97
  ds_read_b64_tr_b16 v[160:161], v50 offset:0
  ds_read_b64_tr_b16 v[162:163], v50 offset:512
  ds_read_b64_tr_b16 v[164:165], v50 offset:2048
  ds_read_b64_tr_b16 v[166:167], v50 offset:2560
  ds_read_b64_tr_b16 v[224:225], v51 offset:0
  ds_read_b64_tr_b16 v[226:227], v51 offset:512
  ds_read_b64_tr_b16 v[228:229], v51 offset:2048
  ds_read_b64_tr_b16 v[230:231], v51 offset:2560
  ds_read_b64_tr_b16 v[168:169], v50 offset:16384
  ds_read_b64_tr_b16 v[170:171], v50 offset:16896
  ds_read_b64_tr_b16 v[172:173], v50 offset:18432
  ds_read_b64_tr_b16 v[174:175], v50 offset:18944
  ds_read_b64_tr_b16 v[232:233], v51 offset:16384
  ds_read_b64_tr_b16 v[234:235], v51 offset:16896
  ds_read_b64_tr_b16 v[236:237], v51 offset:18432
  ds_read_b64_tr_b16 v[238:239], v51 offset:18944
  s_branch Lwv_96
Lwv_97:
  s_cmp_eq_u32 s21, 1
  s_cbranch_scc0 Lwv_98
  ds_read_b64_tr_b16 v[176:177], v50 offset:0
  ds_read_b64_tr_b16 v[178:179], v50 offset:512
  ds_read_b64_tr_b16 v[180:181], v50 offset:2048
  ds_read_b64_tr_b16 v[182:183], v50 offset:2560
  ds_read_b64_tr_b16 v[240:241], v51 offset:0
  ds_read_b64_tr_b16 v[242:243], v51 offset:512
  ds_read_b64_tr_b16 v[244:245], v51 offset:2048
  ds_read_b64_tr_b16 v[246:247], v51 offset:2560
  ds_read_b64_tr_b16 v[184:185], v50 offset:16384
  ds_read_b64_tr_b16 v[186:187], v50 offset:16896
  ds_read_b64_tr_b16 v[188:189], v50 offset:18432
  ds_read_b64_tr_b16 v[190:191], v50 offset:18944
  ds_read_b64_tr_b16 v[248:249], v51 offset:16384
  ds_read_b64_tr_b16 v[250:251], v51 offset:16896
  ds_read_b64_tr_b16 v[252:253], v51 offset:18432
  ds_read_b64_tr_b16 v[254:255], v51 offset:18944
  s_branch Lwv_96
Lwv_98:
  s_cmp_eq_u32 s21, 2
  s_cbranch_scc0 Lwv_99
  ds_read_b64_tr_b16 v[128:129], v50 offset:0
  ds_read_b64_tr_b16 v[130:131], v50 offset:512
  ds_read_b64_tr_b16 v[132:133], v50 offset:2048
  ds_read_b64_tr_b16 v[134:135], v50 offset:2560
  ds_read_b64_tr_b16 v[192:193], v51 offset:0
  ds_read_b64_tr_b16 v[194:195], v51 offset:512
  ds_read_b64_tr_b16 v[196:197], v51 offset:2048
  ds_read_b64_tr_b16 v[198:199], v51 offset:2560
  ds_read_b64_tr_b16 v[136:137], v50 offset:16384
  ds_read_b64_tr_b16 v[138:139], v50 offset:16896
  ds_read_b64_tr_b16 v[140:141], v50 offset:18432
  ds_read_b64_tr_b16 v[142:143], v50 offset:18944
  ds_read_b64_tr_b16 v[200:201], v51 offset:16384
  ds_read_b64_tr_b16 v[202:203], v51 offset:16896
  ds_read_b64_tr_b16 v[204:205], v51 offset:18432
  ds_read_b64_tr_b16 v[206:207], v51 offset:18944
  s_branch Lwv_96
Lwv_99:
  ds_read_b64_tr_b16 v[144:145], v50 offset:0
  ds_read_b64_tr_b16 v[146:147], v50 offset:512
  ds_read_b64_tr_b16 v[148:149], v50 offset:2048
  ds_read_b64_tr_b16 v[150:151], v50 offset:2560
  ds_read_b64_tr_b16 v[208:209], v51 offset:0
  ds_read_b64_tr_b16 v[210:211], v51 offset:512
  ds_read_b64_tr_b16 v[212:213], v51 offset:2048
  ds_read_b64_tr_b16 v[214:215], v51 offset:2560
  ds_read_b64_tr_b16 v[152:153], v50 offset:16384
  ds_read_b64_tr_b16 v[154:155], v50 offset:16896
  ds_read_b64_tr_b16 v[156:157], v50 offset:18432
  ds_read_b64_tr_b16 v[158:159], v50 offset:18944
  ds_read_b64_tr_b16 v[216:217], v51 offset:16384
  ds_read_b64_tr_b16 v[218:219], v51 offset:16896
  ds_read_b64_tr_b16 v[220:221], v51 offset:18432
  ds_read_b64_tr_b16 v[222:223], v51 offset:18944
Lwv_96:
  s_waitcnt lgkmcnt(0)
  s_barrier
  s_lshl_b32 s54, s21, 15
  s_lshl_b32 s55, s20, 17
  s_add_u32 s54, s54, s55
  s_add_u32 s54, s54, 512
  s_add_u32 s64, s14, s54
  s_addc_u32 s65, s15, 0
  s_lshl_b32 s56, s21, 13
  s_add_u32 s56, s56, 98304
  s_mov_b32 m0, s56
  s_add_u32 s56, s56, 1024
  global_load_lds_dwordx4 v46, s[64:65]
  s_add_u32 s64, s64, 4096
  s_addc_u32 s65, s65, 0
  s_mov_b32 m0, s56
  s_add_u32 s56, s56, 1024
  global_load_lds_dwordx4 v47, s[64:65]
  s_add_u32 s64, s64, 4096
  s_addc_u32 s65, s65, 0
  s_mov_b32 m0, s56
  s_add_u32 s56, s56, 1024
  global_load_lds_dwordx4 v46, s[64:65]
  s_add_u32 s64, s64, 4096
  s_addc_u32 s65, s65, 0
  s_mov_b32 m0, s56
  s_add_u32 s56, s56, 1024
  global_load_lds_dwordx4 v47, s[64:65]
  s_add_u32 s64, s64, 4096
  s_addc_u32 s65, s65, 0
  s_mov_b32 m0, s56
  s_add_u32 s56, s56, 1024
  global_load_lds_dwordx4 v46, s[64:65]
  s_add_u32 s64, s64, 4096
  s_addc_u32 s65, s65, 0
  s_mov_b32 m0, s56
  s_add_u32 s56, s56, 1024
  global_load_lds_dwordx4 v47, s[64:65]
  s_add_u32 s64, s64, 4096
  s_addc_u32 s65, s65, 0
  s_mov_b32 m0, s56
  s_add_u32 s56, s56, 1024
  global_load_lds_dwordx4 v46, s[64:65]
  s_add_u32 s64, s64, 4096
  s_addc_u32 s65, s65, 0
  s_mov_b32 m0, s56
  s_add_u32 s56, s56, 1024
  global_load_lds_dwordx4 v47, s[64:65]
  s_waitcnt vmcnt(24)
  s_barrier
  s_cmp_eq_u32 s21, 0
  s_cbranch_scc0 Lwv_102
  ds_read_b64_tr_b16 v[176:177], v50 offset:32768
  ds_read_b64_tr_b16 v[178:179], v50 offset:33280
  ds_read_b64_tr_b16 v[180:181], v50 offset:34816
  ds_read_b64_tr_b16 v[182:183], v50 offset:35328
  ds_read_b64_tr_b16 v[240:241], v51 offset:32768
  ds_read_b64_tr_b16 v[242:243], v51 offset:33280
  ds_read_b64_tr_b16 v[244:245], v51 offset:34816
  ds_read_b64_tr_b16 v[246:247], v51 offset:35328
  ds_read_b64_tr_b16 v[184:185], v50 offset:49152
  ds_read_b64_tr_b16 v[186:187], v50 offset:49664
  ds_read_b64_tr_b16 v[188:189], v50 offset:51200
  ds_read_b64_tr_b16 v[190:191], v50 offset:51712
  ds_read_b64_tr_b16 v[248:249], v51 offset:49152
  ds_read_b64_tr_b16 v[250:251], v51 offset:49664
  ds_read_b64_tr_b16 v[252:253], v51 offset:51200
  ds_read_b64_tr_b16 v[254:255], v51 offset:51712
  s_branch Lwv_101
Lwv_102:
  s_cmp_eq_u32 s21, 1
  s_cbranch_scc0 Lwv_103
  ds_read_b64_tr_b16 v[160:161], v50 offset:32768
  ds_read_b64_tr_b16 v[162:163], v50 offset:33280
  ds_read_b64_tr_b16 v[164:165], v50 offset:34816
  ds_read_b64_tr_b16 v[166:167], v50 offset:35328
  ds_read_b64_tr_b16 v[224:225], v51 offset:32768
  ds_read_b64_tr_b16 v[226:227], v51 offset:33280
  ds_read_b64_tr_b16 v[228:229], v51 offset:34816
  ds_read_b64_tr_b16 v[230:231], v51 offset:35328
  ds_read_b64_tr_b16 v[168:169], v50 offset:49152
  ds_read_b64_tr_b16 v[170:171], v50 offset:49664
  ds_read_b64_tr_b16 v[172:173], v50 offset:51200
  ds_read_b64_tr_b16 v[174:175], v50 offset:51712
  ds_read_b64_tr_b16 v[232:233], v51 offset:49152
  ds_read_b64_tr_b16 v[234:235], v51 offset:49664
  ds_read_b64_tr_b16 v[236:237], v51 offset:51200
  ds_read_b64_tr_b16 v[238:239], v51 offset:51712
  s_branch Lwv_101
Lwv_103:
  s_cmp_eq_u32 s21, 2
  s_cbranch_scc0 Lwv_104
  ds_read_b64_tr_b16 v[144:145], v50 offset:32768
  ds_read_b64_tr_b16 v[146:147], v50 offset:33280
  ds_read_b64_tr_b16 v[148:149], v50 offset:34816
  ds_read_b64_tr_b16 v[150:151], v50 offset:35328
  ds_read_b64_tr_b16 v[208:209], v51 offset:32768
  ds_read_b64_tr_b16 v[210:211], v51 offset:33280
  ds_read_b64_tr_b16 v[212:213], v51 offset:34816
  ds_read_b64_tr_b16 v[214:215], v51 offset:35328
  ds_read_b64_tr_b16 v[152:153], v50 offset:49152
  ds_read_b64_tr_b16 v[154:155], v50 offset:49664
  ds_read_b64_tr_b16 v[156:157], v50 offset:51200
  ds_read_b64_tr_b16 v[158:159], v50 offset:51712
  ds_read_b64_tr_b16 v[216:217], v51 offset:49152
  ds_read_b64_tr_b16 v[218:219], v51 offset:49664
  ds_read_b64_tr_b16 v[220:221], v51 offset:51200
  ds_read_b64_tr_b16 v[222:223], v51 offset:51712
  s_branch Lwv_101
Lwv_104:
  ds_read_b64_tr_b16 v[128:129], v50 offset:32768
  ds_read_b64_tr_b16 v[130:131], v50 offset:33280
  ds_read_b64_tr_b16 v[132:133], v50 offset:34816
  ds_read_b64_tr_b16 v[134:135], v50 offset:35328
  ds_read_b64_tr_b16 v[192:193], v51 offset:32768
  ds_read_b64_tr_b16 v[194:195], v51 offset:33280
  ds_read_b64_tr_b16 v[196:197], v51 offset:34816
  ds_read_b64_tr_b16 v[198:199], v51 offset:35328
  ds_read_b64_tr_b16 v[136:137], v50 offset:49152
  ds_read_b64_tr_b16 v[138:139], v50 offset:49664
  ds_read_b64_tr_b16 v[140:141], v50 offset:51200
  ds_read_b64_tr_b16 v[142:143], v50 offset:51712
  ds_read_b64_tr_b16 v[200:201], v51 offset:49152
  ds_read_b64_tr_b16 v[202:203], v51 offset:49664
  ds_read_b64_tr_b16 v[204:205], v51 offset:51200
  ds_read_b64_tr_b16 v[206:207], v51 offset:51712
Lwv_101:
  s_waitcnt lgkmcnt(0)
  s_barrier
  s_lshl_b32 s54, s21, 15
  s_lshl_b32 s55, s20, 17
  s_add_u32 s54, s54, s55
  s_add_u32 s54, s54, 768
  s_add_u32 s64, s14, s54
  s_addc_u32 s65, s15, 0
  s_lshl_b32 s56, s21, 13
  s_add_u32 s56, s56, 131072
  s_mov_b32 m0, s56
  s_add_u32 s56, s56, 1024
  global_load_lds_dwordx4 v46, s[64:65]
  s_add_u32 s64, s64, 4096
  s_addc_u32 s65, s65, 0
  s_mov_b32 m0, s56
  s_add_u32 s56, s56, 1024
  global_load_lds_dwordx4 v47, s[64:65]
  s_add_u32 s64, s64, 4096
  s_addc_u32 s65, s65, 0
  s_mov_b32 m0, s56
  s_add_u32 s56, s56, 1024
  global_load_lds_dwordx4 v46, s[64:65]
  s_add_u32 s64, s64, 4096
  s_addc_u32 s65, s65, 0
  s_mov_b32 m0, s56
  s_add_u32 s56, s56, 1024
  global_load_lds_dwordx4 v47, s[64:65]
  s_add_u32 s64, s64, 4096
  s_addc_u32 s65, s65, 0
  s_mov_b32 m0, s56
  s_add_u32 s56, s56, 1024
  global_load_lds_dwordx4 v46, s[64:65]
  s_add_u32 s64, s64, 4096
  s_addc_u32 s65, s65, 0
  s_mov_b32 m0, s56
  s_add_u32 s56, s56, 1024
  global_load_lds_dwordx4 v47, s[64:65]
  s_add_u32 s64, s64, 4096
  s_addc_u32 s65, s65, 0
  s_mov_b32 m0, s56
  s_add_u32 s56, s56, 1024
  global_load_lds_dwordx4 v46, s[64:65]
  s_add_u32 s64, s64, 4096
  s_addc_u32 s65, s65, 0
  s_mov_b32 m0, s56
  s_add_u32 s56, s56, 1024
  global_load_lds_dwordx4 v47, s[64:65]
  s_add_u32 s36, s28, s57
  s_addc_u32 s37, s29, 0
  s_add_u32 s38, s32, s57
  s_addc_u32 s39, s33, 0
  s_mov_b32 s8, 0x3030303
  s_mov_b32 s9, 0x3030303
  s_mov_b32 s10, 0xc0c0c0c
  s_mov_b32 s11, 0xc0c0c0c
  s_mov_b32 s12, 0x30303030
  s_mov_b32 s13, 0x30303030
  s_mov_b32 s14, 0xc0c0c0c0
  s_mov_b32 s15, 0xc0c0c0c0
  s_lshl_b32 s4, s20, 7
  s_waitcnt vmcnt(0)
  s_barrier
  v_lshrrev_b32 v56, 4, v0
  v_and_b32 v56, 3, v56
  s_lshl_b32 s54, s20, 2
  v_add_u32 v56, s54, v56
  v_lshlrev_b32 v56, 7, v56
  v_add_u32 v56, 147456, v56
  global_load_dwordx2 v[40:41], v36, s[18:19] offset:128 sc1
  global_load_dword v42, v36, s[18:19] offset:68 sc1
  s_waitcnt vmcnt(0)
  global_load_dword v43, v56, s[52:53] sc1
  v_xor_b32 v53, 192, v52
  ds_read_b64_tr_b16 v[56:57], v53 offset:8192
  ds_read_b64_tr_b16 v[58:59], v53 offset:8704
  ds_read_b64_tr_b16 v[60:61], v53 offset:12288
  ds_read_b64_tr_b16 v[62:63], v53 offset:12800
  v_xor_b32 v53, 224, v52
  ds_read_b64_tr_b16 v[64:65], v53 offset:0
  ds_read_b64_tr_b16 v[66:67], v53 offset:512
  ds_read_b64_tr_b16 v[68:69], v53 offset:4096
  ds_read_b64_tr_b16 v[70:71], v53 offset:4608
  v_xor_b32 v53, 224, v52
  ds_read_b64_tr_b16 v[72:73], v53 offset:8192
  ds_read_b64_tr_b16 v[74:75], v53 offset:8704
  ds_read_b64_tr_b16 v[76:77], v53 offset:12288
  ds_read_b64_tr_b16 v[78:79], v53 offset:12800
  s_waitcnt lgkmcnt(0)
  ds_write_b128 v55, v[56:59] offset:0
  ds_write_b128 v55, v[60:63] offset:1024
  ds_write_b128 v55, v[64:67] offset:2048
  ds_write_b128 v55, v[68:71] offset:3072
  ds_write_b128 v55, v[72:75] offset:4096
  ds_write_b128 v55, v[76:79] offset:5120
  s_waitcnt lgkmcnt(0)
  v_xor_b32 v53, 0, v52
  ds_read_b64_tr_b16 v[32:33], v53 offset:0
  ds_read_b64_tr_b16 v[34:35], v53 offset:512
  ds_read_b64_tr_b16 v[36:37], v53 offset:4096
  ds_read_b64_tr_b16 v[38:39], v53 offset:4608
  v_xor_b32 v53, 0, v52
  ds_read_b64_tr_b16 v[44:45], v53 offset:8192
  ds_read_b64_tr_b16 v[46:47], v53 offset:8704
  ds_read_b64_tr_b16 v[48:49], v53 offset:12288
  ds_read_b64_tr_b16 v[50:51], v53 offset:12800
  v_xor_b32 v53, 32, v52
  ds_read_b64_tr_b16 v[56:57], v53 offset:0
  ds_read_b64_tr_b16 v[58:59], v53 offset:512
  ds_read_b64_tr_b16 v[60:61], v53 offset:4096
  ds_read_b64_tr_b16 v[62:63], v53 offset:4608
  s_waitcnt lgkmcnt(4)
  v_xor_b32 v53, 32, v52
  ds_read_b64_tr_b16 v[64:65], v53 offset:8192
  ds_read_b64_tr_b16 v[66:67], v53 offset:8704
  ds_read_b64_tr_b16 v[68:69], v53 offset:12288
  ds_read_b64_tr_b16 v[70:71], v53 offset:12800
  v_xor_b32 v53, 64, v52
  ds_read_b64_tr_b16 v[72:73], v53 offset:0
  ds_read_b64_tr_b16 v[74:75], v53 offset:512
  ds_read_b64_tr_b16 v[76:77], v53 offset:4096
  ds_read_b64_tr_b16 v[78:79], v53 offset:4608
  v_xor_b32 v53, 64, v52
  ds_read_b64_tr_b16 v[16:17], v53 offset:8192
  ds_read_b64_tr_b16 v[18:19], v53 offset:8704
  ds_read_b64_tr_b16 v[20:21], v53 offset:12288
  ds_read_b64_tr_b16 v[22:23], v53 offset:12800
  s_waitcnt lgkmcnt(4)
  v_xor_b32 v53, 96, v52
  ds_read_b64_tr_b16 v[24:25], v53 offset:0
  ds_read_b64_tr_b16 v[26:27], v53 offset:512
  ds_read_b64_tr_b16 v[28:29], v53 offset:4096
  ds_read_b64_tr_b16 v[30:31], v53 offset:4608
  v_xor_b32 v53, 96, v52
  ds_read_b64_tr_b16 v[80:81], v53 offset:8192
  ds_read_b64_tr_b16 v[82:83], v53 offset:8704
  ds_read_b64_tr_b16 v[84:85], v53 offset:12288
  ds_read_b64_tr_b16 v[86:87], v53 offset:12800
  v_xor_b32 v53, 128, v52
  ds_read_b64_tr_b16 v[88:89], v53 offset:0
  ds_read_b64_tr_b16 v[90:91], v53 offset:512
  ds_read_b64_tr_b16 v[92:93], v53 offset:4096
  ds_read_b64_tr_b16 v[94:95], v53 offset:4608
  s_waitcnt lgkmcnt(4)
  v_xor_b32 v53, 128, v52
  ds_read_b64_tr_b16 v[96:97], v53 offset:8192
  ds_read_b64_tr_b16 v[98:99], v53 offset:8704
  ds_read_b64_tr_b16 v[100:101], v53 offset:12288
  ds_read_b64_tr_b16 v[102:103], v53 offset:12800
  v_xor_b32 v53, 160, v52
  ds_read_b64_tr_b16 v[104:105], v53 offset:0
  ds_read_b64_tr_b16 v[106:107], v53 offset:512
  ds_read_b64_tr_b16 v[108:109], v53 offset:4096
  ds_read_b64_tr_b16 v[110:111], v53 offset:4608
  v_xor_b32 v53, 160, v52
  ds_read_b64_tr_b16 v[112:113], v53 offset:8192
  ds_read_b64_tr_b16 v[114:115], v53 offset:8704
  ds_read_b64_tr_b16 v[116:117], v53 offset:12288
  ds_read_b64_tr_b16 v[118:119], v53 offset:12800
  s_waitcnt lgkmcnt(4)
  v_xor_b32 v53, 192, v52
  ds_read_b64_tr_b16 v[120:121], v53 offset:0
  ds_read_b64_tr_b16 v[122:123], v53 offset:512
  ds_read_b64_tr_b16 v[124:125], v53 offset:4096
  ds_read_b64_tr_b16 v[126:127], v53 offset:4608
  s_waitcnt lgkmcnt(0)
  s_barrier
  ds_write_b128 v11, a[128:131] offset:14336
  ds_write_b128 v11, a[132:135] offset:15360
  ds_write_b128 v11, a[192:195] offset:16384
  ds_write_b128 v11, a[196:199] offset:17408
  ds_write_b128 v11, a[136:139] offset:18432
  ds_write_b128 v11, a[140:143] offset:19456
  ds_write_b128 v11, a[200:203] offset:20480
  ds_write_b128 v11, a[204:207] offset:21504
  ds_write_b128 v11, a[0:3] offset:22528
  ds_write_b128 v11, a[4:7] offset:23552
  s_waitcnt lgkmcnt(0)
  ds_write_b128 v11, v[32:35] offset:4096
  ds_write_b128 v11, v[36:39] offset:5120
  ds_write_b128 v11, v[44:47] offset:6144
  ds_write_b128 v11, v[48:51] offset:7168
  ds_write_b128 v11, v[56:59] offset:8192
  ds_write_b128 v11, v[60:63] offset:9216
  ds_write_b128 v11, v[64:67] offset:10240
  ds_write_b128 v11, v[68:71] offset:11264
  ds_write_b128 v11, v[72:75] offset:12288
  ds_write_b128 v11, v[76:79] offset:13312
  ds_write_b128 v11, v[120:123] offset:24576
  ds_write_b128 v11, v[124:127] offset:25600
  v_accvgpr_write_b32 a128, v80
  v_accvgpr_write_b32 a129, v81
  v_accvgpr_write_b32 a130, v82
  v_accvgpr_write_b32 a131, v83
  v_accvgpr_write_b32 a132, v84
  v_accvgpr_write_b32 a133, v85
  v_accvgpr_write_b32 a134, v86
  v_accvgpr_write_b32 a135, v87
  v_accvgpr_write_b32 a192, v88
  v_accvgpr_write_b32 a193, v89
  v_accvgpr_write_b32 a194, v90
  v_accvgpr_write_b32 a195, v91
  v_accvgpr_write_b32 a196, v92
  v_accvgpr_write_b32 a197, v93
  v_accvgpr_write_b32 a198, v94
  v_accvgpr_write_b32 a199, v95
  v_accvgpr_write_b32 a136, v96
  v_accvgpr_write_b32 a137, v97
  v_accvgpr_write_b32 a138, v98
  v_accvgpr_write_b32 a139, v99
  v_accvgpr_write_b32 a140, v100
  v_accvgpr_write_b32 a141, v101
  v_accvgpr_write_b32 a142, v102
  v_accvgpr_write_b32 a143, v103
  v_accvgpr_write_b32 a200, v104
  v_accvgpr_write_b32 a201, v105
  v_accvgpr_write_b32 a202, v106
  v_accvgpr_write_b32 a203, v107
  v_accvgpr_write_b32 a204, v108
  v_accvgpr_write_b32 a205, v109
  v_accvgpr_write_b32 a206, v110
  v_accvgpr_write_b32 a207, v111
  v_accvgpr_write_b32 a0, v112
  v_accvgpr_write_b32 a1, v113
  v_accvgpr_write_b32 a2, v114
  v_accvgpr_write_b32 a3, v115
  v_accvgpr_write_b32 a4, v116
  v_accvgpr_write_b32 a5, v117
  v_accvgpr_write_b32 a6, v118
  v_accvgpr_write_b32 a7, v119
  s_waitcnt lgkmcnt(0)
  ds_read_b128 v[56:59], v55 offset:0
  ds_read_b128 v[60:63], v55 offset:1024
  ds_read_b128 v[64:67], v55 offset:2048
  ds_read_b128 v[68:71], v55 offset:3072
  ds_read_b128 v[72:75], v55 offset:4096
  ds_read_b128 v[76:79], v55 offset:5120
  s_waitcnt lgkmcnt(0)
  ds_write_b128 v11, v[56:59] offset:26624
  ds_write_b128 v11, v[60:63] offset:27648
  ds_write_b128 v11, v[64:67] offset:28672
  ds_write_b128 v11, v[68:71] offset:29696
  ds_write_b128 v11, v[72:75] offset:30720
  ds_write_b128 v11, v[76:79] offset:31744
  s_waitcnt vmcnt(0)
  v_readfirstlane_b32 s70, v40
  v_readfirstlane_b32 s71, v41
  v_readfirstlane_b32 s72, v42
  v_cmp_ne_u32 s[74:75], 1, v43
  v_mov_b32 v32, 0x3f803f80
  v_mov_b32 v33, 0x3f803f80
  v_mov_b32 v34, 0x3f803f80
  v_mov_b32 v35, 0x3f803f80
  v_mov_b32 v36, 0
  v_mov_b32 v37, 0
  v_mov_b32 v38, 0
  v_mov_b32 v39, 0
  v_mov_b32 v40, 0
  v_mov_b32 v41, 0
  v_mov_b32 v42, 0
  v_mov_b32 v43, 0
  s_waitcnt lgkmcnt(0)
  s_barrier
  s_mov_b32 s23, 0
  s_min_u32 s70, s70, s71
  s_cmp_lt_u32 s70, 32
  s_cbranch_scc1 L_rec_slowchk
  s_cmp_lt_u32 s72, 96
  s_cbranch_scc1 L_rec_slowchk
  s_cmp_lg_u64 s[74:75], 0
  s_cbranch_scc1 L_rec_slowchk
  s_mov_b32 m0, s58
  s_nop 0
  global_load_lds_dwordx4 v15, s[16:17] offset:0 sc1
  global_load_lds_dwordx4 v15, s[16:17] offset:1024 sc1
  global_load_lds_dwordx4 v15, s[16:17] offset:2048 sc1
  global_load_lds_dwordx4 v15, s[16:17] offset:3072 sc1
  v_add_u32 v15, 0x40000, v15
  s_waitcnt vmcnt(0)
  s_branch L_rec_go
L_rec_slowchk:
  s_mov_b32 s27, 0
L_rec_md:
  s_add_u32 s27, s27, 1
  s_cmp_gt_u32 s27, 0x400000
  s_cbranch_scc1 L_end
  v_mbcnt_lo_u32_b32 v56, -1, 0
  v_mbcnt_hi_u32_b32 v56, -1, v56
  v_and_b32 v56, 7, v56
  v_lshlrev_b32 v56, 2, v56
  v_mov_b32 v57, 128
  v_cmp_eq_u32 vcc, 0, v56
  s_nop 1
  v_cndmask_b32 v56, v56, v57, vcc
  global_load_dword v57, v56, s[18:19] sc1
  s_waitcnt vmcnt(0)
  v_readlane_b32 s70, v57, 0
  v_readlane_b32 s71, v57, 1
  v_readlane_b32 s72, v57, 2
  v_readlane_b32 s73, v57, 3
  v_readlane_b32 s74, v57, 4
  v_readlane_b32 s75, v57, 5
  v_readlane_b32 s76, v57, 6
  v_readlane_b32 s77, v57, 7
  s_add_u32 s54, s70, s71
  s_add_u32 s54, s54, s72
  s_add_u32 s54, s54, s73
  s_add_u32 s54, s54, s74
  s_add_u32 s54, s54, s75
  s_add_u32 s54, s54, s76
  s_add_u32 s54, s54, s77
  s_mov_b32 s23, 0
  s_cmp_ge_u32 s70, 32
  s_cbranch_scc1 L_rec_mdok
  s_mov_b32 s23, 1
  s_cmp_ge_u32 s54, 256
  s_cbranch_scc0 L_rec_md
L_rec_mdok:
  s_mov_b32 s27, 0
L_rec_gi:
  global_load_dword v56, v36, s[18:19] offset:68 sc1
  s_add_u32 s27, s27, 1
  s_cmp_gt_u32 s27, 0x400000
  s_cbranch_scc1 L_end
  s_waitcnt vmcnt(0)
  v_readfirstlane_b32 s54, v56
  s_nop 0
  s_cmp_ge_u32 s54, 96
  s_cbranch_scc0 L_rec_gi
  v_and_b32 v56, 3, v8
  v_lshrrev_b32 v56, 4, v0
  v_and_b32 v56, 3, v56
  s_lshl_b32 s54, s20, 2
  v_add_u32 v56, s54, v56
  v_lshlrev_b32 v56, 7, v56
  v_add_u32 v56, 147456, v56
  s_mov_b32 s27, 0
L_rec_f0:
  global_load_dword v57, v56, s[52:53] sc1
  s_add_u32 s27, s27, 1
  s_cmp_gt_u32 s27, 0x400000
  s_cbranch_scc1 L_end
  s_waitcnt vmcnt(0)
  v_cmp_ne_u32 vcc, 1, v57
  s_cbranch_vccnz L_rec_f0
  s_mov_b32 m0, s58
  s_nop 0
  global_load_lds_dwordx4 v15, s[16:17] offset:0 sc1
  global_load_lds_dwordx4 v15, s[16:17] offset:1024 sc1
  global_load_lds_dwordx4 v15, s[16:17] offset:2048 sc1
  global_load_lds_dwordx4 v15, s[16:17] offset:3072 sc1
  v_add_u32 v15, 0x40000, v15
L_rec_i0:
  global_load_dword v56, v36, s[18:19] offset:132 sc1
  s_add_u32 s27, s27, 1
  s_cmp_gt_u32 s27, 0x400000
  s_cbranch_scc1 L_end
  s_waitcnt vmcnt(0)
  v_readfirstlane_b32 s54, v56
  s_nop 0
  s_cmp_ge_u32 s54, 32
  s_cbranch_scc0 L_rec_i0
L_rec_go:
  s_mov_b32 s22, 0
  s_and_b32 s54, s20, 0
  s_mul_i32 s54, s54, 32768
  s_add_u32 s76, s40, s54
  s_addc_u32 s77, s41, 0
  s_add_u32 s78, s42, s54
  s_addc_u32 s79, s43, 0
  s_add_u32 s80, s44, s54
  s_addc_u32 s81, s45, 0
  s_add_u32 s82, s46, s54
  s_addc_u32 s83, s47, 0
  v_mfma_f32_32x32x8_bf16 v[80:95], v[36:37], v[36:37], 0
  v_mfma_f32_32x32x8_bf16 v[96:111], v[36:37], v[36:37], 0
  v_mov_b32 v116, -1
  v_mov_b32 v112, 0
  v_mov_b32 v113, 0
  v_mov_b32 v114, 0
  v_mov_b32 v115, 0
  ds_read_b128 v[44:47], v12 offset:0
  ds_read_b128 v[48:51], v12 offset:1024
  v_xor_b32 v76, 2048, v12
  v_xor_b32 v77, 4096, v12
  v_xor_b32 v78, 6144, v12
  s_nop 15
  ds_read_b128 v[52:55], v11 offset:14336
  ds_read_b128 v[56:59], v11 offset:15360
  ds_read_b128 v[60:63], v11 offset:16384
  ds_read_b128 v[64:67], v11 offset:17408
  ds_read_b128 v[68:71], v11 offset:18432
  ds_read_b128 v[72:75], v11 offset:19456
  ds_read_b128 v[104:107], v11 offset:20480
  ds_read_b128 v[108:111], v11 offset:21504
  ds_read_b128 v[120:123], v11 offset:22528
  ds_read_b128 v[124:127], v11 offset:23552
  s_waitcnt lgkmcnt(0)
  s_barrier
  s_cmp_eq_u32 s23, 0
  s_cbranch_scc0 L_rec_step_s0
L_rec_step_f0:
  s_waitcnt lgkmcnt(2)
  v_smfmac_f32_16x16x64_bf16 v[88:91], v[44:47], v[52:59], v1
  v_smfmac_f32_16x16x64_bf16 v[92:95], v[44:47], v[60:67], v1
  v_smfmac_f32_16x16x64_bf16 v[88:91], v[48:51], v[68:75], v1
  s_waitcnt lgkmcnt(0)
  s_barrier
  ds_read_b128 v[52:55], v76 offset:0
  ds_read_b128 v[56:59], v76 offset:1024
  v_smfmac_f32_16x16x64_bf16 v[92:95], v[48:51], v[104:111], v1
  ds_read_b128 v[60:63], v77 offset:0
  v_smfmac_f32_16x16x64_bf16 v[80:83], v[44:47], v[120:127], v1
  ds_read_b128 v[64:67], v77 offset:1024
  v_smfmac_f32_16x16x64_bf16 v[84:87], v[44:47], a[64:71], v1
  ds_read_b128 v[68:71], v78 offset:0
  v_smfmac_f32_16x16x64_bf16 v[80:83], v[48:51], a[8:15], v1
  ds_read_b128 v[72:75], v78 offset:1024
  v_smfmac_f32_16x16x64_bf16 v[84:87], v[48:51], a[72:79], v1
  global_store_dwordx4 v9, v[112:115], s[50:51] sc1
  s_waitcnt lgkmcnt(5)
  v_smfmac_f32_16x16x64_bf16 v[88:91], v[52:55], a[144:151], v1
  s_mov_b32 m0, s59
  v_smfmac_f32_16x16x64_bf16 v[92:95], v[52:55], a[208:215], v1
  global_load_lds_dwordx4 v15, s[16:17] offset:0 sc1
  s_waitcnt lgkmcnt(4)
  v_smfmac_f32_16x16x64_bf16 v[88:91], v[56:59], a[152:159], v1
  v_smfmac_f32_16x16x64_bf16 v[92:95], v[56:59], a[216:223], v1
  global_load_lds_dwordx4 v15, s[16:17] offset:1024 sc1
  s_waitcnt lgkmcnt(3)
  v_smfmac_f32_16x16x64_bf16 v[88:91], v[60:63], a[160:167], v1
  v_smfmac_f32_16x16x64_bf16 v[92:95], v[60:63], a[224:231], v1
  global_load_lds_dwordx4 v15, s[16:17] offset:2048 sc1
  s_waitcnt lgkmcnt(2)
  v_smfmac_f32_16x16x64_bf16 v[88:91], v[64:67], a[168:175], v1
  v_smfmac_f32_16x16x64_bf16 v[92:95], v[64:67], a[232:239], v1
  global_load_lds_dwordx4 v15, s[16:17] offset:3072 sc1
  v_add_u32 v15, 0x40000, v15
  s_waitcnt lgkmcnt(1)
  v_smfmac_f32_16x16x64_bf16 v[88:91], v[68:71], a[176:183], v1
  global_store_dword v7, v116, s[42:43]
  v_add_u32 v9, 0x20000, v9
  v_smfmac_f32_16x16x64_bf16 v[92:95], v[68:71], a[240:247], v1
  s_waitcnt vmcnt(6)
  ds_read_b128 v[104:107], v0 offset:10240
  s_waitcnt lgkmcnt(1)
  v_smfmac_f32_16x16x64_bf16 v[88:91], v[72:75], a[184:191], v1
  v_smfmac_f32_16x16x64_bf16 v[92:95], v[72:75], a[248:255], v1
  ds_read_b128 v[108:111], v0 offset:11264
  v_smfmac_f32_16x16x64_bf16 v[80:83], v[52:55], a[16:23], v1
  v_smfmac_f32_16x16x64_bf16 v[84:87], v[52:55], a[80:87], v1
  v_smfmac_f32_16x16x64_bf16 v[80:83], v[56:59], a[24:31], v1
  v_smfmac_f32_16x16x64_bf16 v[84:87], v[56:59], a[88:95], v1
  v_smfmac_f32_16x16x64_bf16 v[80:83], v[60:63], a[32:39], v1
  v_smfmac_f32_16x16x64_bf16 v[84:87], v[60:63], a[96:103], v1
  v_smfmac_f32_16x16x64_bf16 v[80:83], v[64:67], a[40:47], v1
  v_smfmac_f32_16x16x64_bf16 v[84:87], v[64:67], a[104:111], v1
  v_add_f32 v88, v88, v90
  v_add_f32 v89, v89, v91
  v_smfmac_f32_16x16x64_bf16 v[80:83], v[68:71], a[48:55], v1
  v_add_f32 v92, v92, v94
  v_add_f32 v93, v93, v95
  v_smfmac_f32_16x16x64_bf16 v[84:87], v[68:71], a[112:119], v1
  v_cvt_pk_bf16_f32 v78, v88, v89
  v_cvt_pk_bf16_f32 v79, v92, v93
  v_smfmac_f32_16x16x64_bf16 v[80:83], v[72:75], a[56:63], v1
  ds_write2_b32 v2, v78, v79 offset0:1 offset1:129
  ds_read_b128 v[88:91], v0 offset:8192
  v_smfmac_f32_16x16x64_bf16 v[84:87], v[72:75], a[120:127], v1
  ds_read_b128 v[92:95], v0 offset:9216
  v_smfmac_f32_16x16x64_bf16 v[96:99], v[44:47], v[128:135], v1
  v_smfmac_f32_16x16x64_bf16 v[100:103], v[44:47], v[192:199], v1
  ds_read_b128 v[44:47], v0 offset:12288
  s_nop 4
  v_add_f32 v80, v80, v82
  v_add_f32 v81, v81, v83
  v_add_f32 v84, v84, v86
  v_add_f32 v85, v85, v87
  v_cvt_pk_bf16_f32 v76, v80, v81
  v_cvt_pk_bf16_f32 v77, v84, v85
  ds_write2_b32 v2, v76, v77 offset0:0 offset1:128
  v_smfmac_f32_16x16x64_bf16 v[96:99], v[48:51], v[136:143], v1
  v_smfmac_f32_16x16x64_bf16 v[100:103], v[48:51], v[200:207], v1
  ds_read_b128 v[48:51], v0 offset:13312
  v_smfmac_f32_16x16x64_bf16 v[96:99], v[52:55], v[144:151], v1
  v_smfmac_f32_16x16x64_bf16 v[100:103], v[52:55], v[208:215], v1
  v_smfmac_f32_16x16x64_bf16 v[96:99], v[56:59], v[152:159], v1
  s_waitcnt vmcnt(6)
  s_waitcnt lgkmcnt(1)
  s_barrier
  ds_read_b64_tr_b16 v[112:113], v3 offset:0
  ds_read_b64_tr_b16 v[114:115], v3 offset:256
  v_smfmac_f32_16x16x64_bf16 v[100:103], v[56:59], v[216:223], v1
  ds_read_b64_tr_b16 v[116:117], v3 offset:1024
  ds_read_b64_tr_b16 v[118:119], v3 offset:1280
  v_smfmac_f32_16x16x64_bf16 v[96:99], v[60:63], v[160:167], v1
  ds_read_b64_tr_b16 v[120:121], v3 offset:2048
  ds_read_b64_tr_b16 v[122:123], v3 offset:2304
  v_smfmac_f32_16x16x64_bf16 v[100:103], v[60:63], v[224:231], v1
  ds_read_b64_tr_b16 v[124:125], v3 offset:3072
  ds_read_b64_tr_b16 v[126:127], v3 offset:3328
  v_smfmac_f32_16x16x64_bf16 v[96:99], v[64:67], v[168:175], v1
  ds_read_b128 v[52:55], v0 offset:14336
  v_smfmac_f32_16x16x64_bf16 v[100:103], v[64:67], v[232:239], v1
  ds_read_b128 v[56:59], v0 offset:15360
  s_waitcnt lgkmcnt(8)
  v_mfma_f32_16x16x32_bf16 v[80:83], v[88:91], v[112:115], 0
  s_waitcnt lgkmcnt(6)
  v_mfma_f32_16x16x32_bf16 v[80:83], v[92:95], v[116:119], v[80:83]
  ds_read_b128 v[60:63], v11 offset:8192
  s_waitcnt lgkmcnt(5)
  v_mfma_f32_16x16x32_bf16 v[80:83], v[104:107], v[120:123], v[80:83]
  ds_read_b128 v[64:67], v11 offset:9216
  s_waitcnt lgkmcnt(4)
  v_mfma_f32_16x16x32_bf16 v[80:83], v[108:111], v[124:127], v[80:83]
  ds_read_b128 v[108:111], v12 offset:24576
  v_mfma_f32_16x16x32_bf16 v[88:91], v[112:115], v[112:115], 0
  ds_read_b128 v[92:95], v12 offset:25600
  v_mfma_f32_16x16x32_bf16 v[88:91], v[116:119], v[116:119], v[88:91]
  v_mfma_f32_16x16x32_bf16 v[88:91], v[120:123], v[120:123], v[88:91]
  v_mfma_f32_16x16x32_bf16 v[88:91], v[124:127], v[124:127], v[88:91]
  s_nop 1
  v_exp_f32 v78, v80
  v_mfma_f32_16x16x32_bf16 v[84:87], v[44:47], v[112:115], 0
  v_exp_f32 v79, v81
  ds_read_b128 v[44:47], v11 offset:4096
  v_mfma_f32_16x16x32_bf16 v[84:87], v[48:51], v[116:119], v[84:87]
  ds_read_b128 v[48:51], v11 offset:5120
  v_cvt_pk_bf16_f32 v104, v78, v79
  v_exp_f32 v78, v82
  s_waitcnt lgkmcnt(7)
  v_mfma_f32_16x16x32_bf16 v[84:87], v[52:55], v[120:123], v[84:87]
  ds_read_b128 v[52:55], v11 offset:6144
  v_exp_f32 v79, v83
  s_waitcnt lgkmcnt(7)
  v_mfma_f32_16x16x32_bf16 v[84:87], v[56:59], v[124:127], v[84:87]
  ds_read_b128 v[56:59], v11 offset:7168
  v_cvt_pk_bf16_f32 v105, v78, v79
  v_max3_f32 v76, |v80|, |v81|, |v82|
  v_smfmac_f32_16x16x64_bf16 v[96:99], v[68:71], v[176:183], v1
  v_mul_f32 v90, s24, v90
  v_mul_f32 v91, s24, v91
  v_smfmac_f32_16x16x64_bf16 v[100:103], v[68:71], v[240:247], v1
  v_exp_f32 v88, v90
  v_exp_f32 v89, v91
  v_max3_f32 v76, v76, |v83|, v90
  ds_read_b128 v[68:71], v11 offset:10240
  v_smfmac_f32_16x16x64_bf16 v[96:99], v[72:75], v[184:191], v1
  v_cvt_pk_bf16_f32 v38, v88, v89
  v_cvt_pk_bf16_f32 v41, v88, v89
  v_smfmac_f32_16x16x64_bf16 v[100:103], v[72:75], v[248:255], v1
  ds_read_b128 v[72:75], v11 offset:11264
  v_max3_f32 v77, |v84|, |v85|, v91
  v_max3_f32 v76, v76, |v86|, |v87|
  v_max_f32 v76, v76, v77
  v_cmp_lt_f32 vcc, 0x42700000, v76
  v_exp_f32 v78, v84
  v_exp_f32 v79, v85
  s_nop 0
  v_cvt_pk_bf16_f32 v106, v78, v79
  v_exp_f32 v78, v86
  v_exp_f32 v79, v87
  s_nop 0
  v_cvt_pk_bf16_f32 v107, v78, v79
  s_and_b64 vcc, vcc, s[60:61]
  s_cbranch_scc1 L_rec_fb_f0
L_rec_fbret_f0:
  s_waitcnt lgkmcnt(6)
  v_add_f32 v96, v96, v98
  v_add_f32 v97, v97, v99
  v_mfma_f32_16x16x32_bf16 v[112:115], v[32:35], v[104:107], 0
  v_add_f32 v100, v100, v102
  v_mfma_f32_16x16x32_bf16 v[80:83], v[108:111], v[104:107], 0
  v_add_f32 v101, v101, v103
  v_mfma_f32_16x16x32_bf16 v[84:87], v[92:95], v[104:107], 0
  v_cvt_pk_bf16_f32 v42, v96, v97
  v_cvt_pk_bf16_f32 v43, v100, v101
  v_mfma_f32_16x16x16_bf16 v[112:115], v[32:33], v[38:39], v[112:115]
  ds_write2_b32 v13, v42, v43 offset0:0 offset1:64
  v_mfma_f32_16x16x16_bf16 v[80:83], v[42:43], v[38:39], v[80:83]
  v_mfma_f32_16x16x16_bf16 v[84:87], v[42:43], v[40:41], v[84:87]
  v_mov_b64 v[96:97], 0
  v_mov_b64 v[98:99], 0
  v_mov_b64 v[100:101], 0
  v_mov_b64 v[102:103], 0
  s_nop 0
  v_rcp_f32 v77, v112
  ds_read_b128 v[112:115], v11 offset:12288
  ds_read_b128 v[116:119], v11 offset:13312
  s_mov_b64 exec, s[60:61]
  v_mul_f32 v80, v80, v77
  v_mul_f32 v81, v81, v77
  v_mul_f32 v82, v82, v77
  v_mul_f32 v83, v83, v77
  v_cvt_pk_bf16_f32 v78, v80, v81
  v_cvt_pk_bf16_f32 v79, v82, v83
  ds_write_b64 v5, v[78:79]
  v_mul_f32 v84, v84, v77
  v_mul_f32 v85, v85, v77
  v_mul_f32 v86, v86, v77
  v_mul_f32 v87, v87, v77
  v_cvt_pk_bf16_f32 v76, v84, v85
  v_cvt_pk_bf16_f32 v77, v86, v87
  ds_write_b64 v5, v[76:77] offset:512
  s_mov_b64 exec, -1
  v_mfma_f32_32x32x8_bf16 v[80:95], v[36:37], v[36:37], 0
  v_mov_b64 v[104:105], 0
  v_mov_b64 v[106:107], 0
  v_mov_b64 v[108:109], 0
  v_mov_b64 v[110:111], 0
  s_waitcnt lgkmcnt(0)
  s_barrier
  ds_read_b128 v[120:123], v0 offset:45056
  ds_read_b128 v[124:127], v0 offset:46080
  s_waitcnt lgkmcnt(1)
  s_nop 0
  v_smfmac_f32_16x16x64_bf16 v[80:83], v[120:123], v[44:51], v1
  s_waitcnt lgkmcnt(0)
  v_smfmac_f32_16x16x64_bf16 v[80:83], v[124:127], v[52:59], v1
  ds_read_b128 v[44:47], v11 offset:24576
  v_smfmac_f32_16x16x64_bf16 v[84:87], v[120:123], v[60:67], v1
  ds_read_b128 v[48:51], v11 offset:25600
  v_smfmac_f32_16x16x64_bf16 v[84:87], v[124:127], v[68:75], v1
  ds_read_b128 v[52:55], v11 offset:26624
  v_smfmac_f32_16x16x64_bf16 v[88:91], v[120:123], v[112:119], v1
  ds_read_b128 v[56:59], v11 offset:27648
  v_smfmac_f32_16x16x64_bf16 v[88:91], v[124:127], v[16:23], v1
  ds_read_b128 v[60:63], v11 offset:28672
  v_add_f32 v80, v80, v82
  v_add_f32 v81, v81, v83
  v_cvt_pk_bf16_f32 v76, v80, v81
  v_and_or_b32 v76, v76, -2, 1
  v_smfmac_f32_16x16x64_bf16 v[92:95], v[120:123], v[24:31], v1
  ds_read_b128 v[64:67], v11 offset:29696
  v_smfmac_f32_16x16x64_bf16 v[92:95], v[124:127], a[128:135], v1
  ds_read_b128 v[68:71], v11 offset:30720
  v_add_f32 v84, v84, v86
  v_add_f32 v85, v85, v87
  v_cvt_pk_bf16_f32 v77, v84, v85
  v_smfmac_f32_16x16x64_bf16 v[96:99], v[120:123], a[192:199], v1
  ds_read_b128 v[72:75], v11 offset:31744
  v_smfmac_f32_16x16x64_bf16 v[96:99], v[124:127], a[136:143], v1
  v_add_f32 v88, v88, v90
  v_add_f32 v89, v89, v91
  v_cvt_pk_bf16_f32 v78, v88, v89
  v_smfmac_f32_16x16x64_bf16 v[100:103], v[120:123], a[200:207], v1
  v_smfmac_f32_16x16x64_bf16 v[100:103], v[124:127], a[0:7], v1
  v_add_f32 v92, v92, v94
  v_add_f32 v93, v93, v95
  v_cvt_pk_bf16_f32 v79, v92, v93
  global_store_dwordx4 v6, v[76:79], s[28:29]
  s_waitcnt lgkmcnt(6)
  v_smfmac_f32_16x16x64_bf16 v[104:107], v[120:123], v[44:51], v1
  s_waitcnt lgkmcnt(4)
  v_smfmac_f32_16x16x64_bf16 v[104:107], v[124:127], v[52:59], v1
  v_add_f32 v96, v96, v98
  v_add_f32 v97, v97, v99
  v_cvt_pk_bf16_f32 v80, v96, v97
  v_and_or_b32 v80, v80, -2, 1
  s_waitcnt lgkmcnt(2)
  v_smfmac_f32_16x16x64_bf16 v[108:111], v[120:123], v[60:67], v1
  s_waitcnt lgkmcnt(0)
  v_smfmac_f32_16x16x64_bf16 v[108:111], v[124:127], v[68:75], v1
  v_add_f32 v100, v100, v102
  v_add_f32 v101, v101, v103
  v_cvt_pk_bf16_f32 v81, v100, v101
  v_add_f32 v104, v104, v106
  v_add_f32 v105, v105, v107
  v_cvt_pk_bf16_f32 v82, v104, v105
  s_nop 1
  v_add_f32 v108, v108, v110
  v_add_f32 v109, v109, v111
  v_cvt_pk_bf16_f32 v83, v108, v109
  global_store_dwordx4 v6, v[80:83], s[30:31]
  s_lshl_b32 s54, s21, 10
  v_add_u32 v116, s54, v3
  ds_read_b64_tr_b16 v[112:113], v116
  ds_read_b64_tr_b16 v[114:115], v116 offset:256
  s_mov_b64 exec, s[60:61]
  ds_read_b128 v[112:115], v10
  s_mov_b64 exec, -1
  v_cndmask_b32 v60, 0, v14, s[8:9]
  v_cndmask_b32 v61, 0, v14, s[10:11]
  v_cndmask_b32 v62, 0, v14, s[12:13]
  v_cndmask_b32 v63, 0, v14, s[14:15]
  v_mfma_f32_32x32x8_bf16 v[80:95], v[36:37], v[36:37], 0
  v_mov_b64 v[96:97], 0
  v_mov_b64 v[98:99], 0
  v_mov_b64 v[100:101], 0
  v_mov_b64 v[102:103], 0
  ds_read_b128 v[104:107], v11 offset:20480
  ds_read_b128 v[108:111], v11 offset:21504
  ds_read_b128 v[120:123], v11 offset:22528
  ds_read_b128 v[124:127], v11 offset:23552
  ds_read_b128 v[52:55], v11 offset:14336
  ds_read_b128 v[56:59], v11 offset:15360
  ds_read_b128 v[68:71], v11 offset:18432
  ds_read_b128 v[72:75], v11 offset:19456
  v_mov_b32 v116, -1
  s_waitcnt lgkmcnt(8)
  v_min_u32 v112, -2, v112
  s_cmp_lt_u32 s21, 2
  s_cbranch_scc1 Lz_106
  s_nop 3
  s_nop 3
  s_nop 3
  s_nop 3
  s_nop 3
  s_nop 3
  s_nop 3
  s_nop 3
  s_nop 3
  s_nop 3
Lz_106:
  s_nop 3
  s_nop 3
  s_nop 3
  s_mov_b32 s27, 0
L_p2_f0:
  global_load_dwordx4 v[44:47], v8, s[36:37] sc1
  global_load_dwordx4 v[48:51], v8, s[36:37] offset:1024 sc1
  s_add_u32 s27, s27, 1
  s_cmp_gt_u32 s27, 0x400000
  s_cbranch_scc1 L_end
  s_waitcnt vmcnt(1)
  v_mfma_f32_16x16x32_bf16 v[64:67], v[44:47], v[60:63], 0
  s_waitcnt vmcnt(0)
  v_mfma_f32_16x16x32_bf16 v[64:67], v[48:51], v[60:63], v[64:67]
  v_and_b32 v117, v44, v48
  v_and_b32 v117, 1, v117
  v_cmp_ne_u32 vcc, 1, v117
  s_cbranch_vccnz L_p2_f0
  s_nop 3
  v_permlane32_swap_b32 v64, v66
  v_permlane32_swap_b32 v65, v67
  v_add_f32 v64, v64, v66
  v_add_f32 v65, v65, v67
  v_mov_b32 v66, v64
  v_mov_b32 v67, v65
  s_nop 0
  v_permlane16_swap_b32 v64, v66
  v_permlane16_swap_b32 v65, v67
  v_add_f32 v64, v64, v66
  v_add_f32 v65, v65, v67
  v_cvt_pk_bf16_f32 v64, v64, v65
  v_min_u32 v64, -2, v64
  global_store_dword v7, v64, s[40:41]
  ds_read_b128 v[60:63], v11 offset:16384
  ds_read_b128 v[64:67], v11 offset:17408
  v_xor_b32 v76, 2048, v12
  v_xor_b32 v77, 4096, v12
  v_xor_b32 v78, 6144, v12
  s_cmp_ge_u32 s21, 2
  s_cbranch_scc1 Lz_107
  s_nop 3
  s_nop 3
  s_nop 3
  s_nop 3
  s_nop 3
  s_nop 3
  s_nop 3
  s_nop 3
  s_nop 3
  s_nop 3
Lz_107:
  s_nop 3
  s_nop 3
  s_nop 3
  s_nop 3
  s_nop 3
  s_mov_b32 s27, 0
L_p3_f0:
  global_load_dwordx4 v[44:47], v12, s[76:77] sc1
  global_load_dwordx4 v[48:51], v12, s[76:77] offset:1024 sc1
  s_add_u32 s27, s27, 1
  s_cmp_gt_u32 s27, 0x400000
  s_cbranch_scc1 L_end
L_p3b_f0:
  s_waitcnt vmcnt(1)
  ds_write_b128 v12, v[44:47] offset:0
  v_max3_u32 v117, v44, v45, v46
  s_waitcnt vmcnt(0)
  ds_write_b128 v12, v[48:51] offset:1024
  v_max3_u32 v118, v47, v48, v49
  v_max3_u32 v117, v117, v50, v51
  v_max_u32 v117, v117, v118
  v_cmp_eq_u32 vcc, -1, v117
  s_cbranch_vccnz L_p3_f0
L_rec_acc_f0:
L_rec_join_f0:
  s_add_u32 s22, s22, 1
L_rec_step_f1:
  s_waitcnt lgkmcnt(2)
  v_smfmac_f32_16x16x64_bf16 v[88:91], v[44:47], v[52:59], v1
  v_smfmac_f32_16x16x64_bf16 v[92:95], v[44:47], v[60:67], v1
  v_smfmac_f32_16x16x64_bf16 v[88:91], v[48:51], v[68:75], v1
  s_waitcnt lgkmcnt(0)
  s_barrier
  ds_read_b128 v[52:55], v76 offset:0
  ds_read_b128 v[56:59], v76 offset:1024
  v_smfmac_f32_16x16x64_bf16 v[92:95], v[48:51], v[104:111], v1
  ds_read_b128 v[60:63], v77 offset:0
  v_smfmac_f32_16x16x64_bf16 v[80:83], v[44:47], v[120:127], v1
  ds_read_b128 v[64:67], v77 offset:1024
  v_smfmac_f32_16x16x64_bf16 v[84:87], v[44:47], a[64:71], v1
  ds_read_b128 v[68:71], v78 offset:0
  v_smfmac_f32_16x16x64_bf16 v[80:83], v[48:51], a[8:15], v1
  ds_read_b128 v[72:75], v78 offset:1024
  v_smfmac_f32_16x16x64_bf16 v[84:87], v[48:51], a[72:79], v1
  global_store_dwordx4 v9, v[112:115], s[50:51] sc1
  s_waitcnt lgkmcnt(5)
  v_smfmac_f32_16x16x64_bf16 v[88:91], v[52:55], a[144:151], v1
  s_mov_b32 m0, s58
  v_smfmac_f32_16x16x64_bf16 v[92:95], v[52:55], a[208:215], v1
  global_load_lds_dwordx4 v15, s[16:17] offset:0 sc1
  s_waitcnt lgkmcnt(4)
  v_smfmac_f32_16x16x64_bf16 v[88:91], v[56:59], a[152:159], v1
  v_smfmac_f32_16x16x64_bf16 v[92:95], v[56:59], a[216:223], v1
  global_load_lds_dwordx4 v15, s[16:17] offset:1024 sc1
  s_waitcnt lgkmcnt(3)
  v_smfmac_f32_16x16x64_bf16 v[88:91], v[60:63], a[160:167], v1
  v_smfmac_f32_16x16x64_bf16 v[92:95], v[60:63], a[224:231], v1
  global_load_lds_dwordx4 v15, s[16:17] offset:2048 sc1
  s_waitcnt lgkmcnt(2)
  v_smfmac_f32_16x16x64_bf16 v[88:91], v[64:67], a[168:175], v1
  v_smfmac_f32_16x16x64_bf16 v[92:95], v[64:67], a[232:239], v1
  global_load_lds_dwordx4 v15, s[16:17] offset:3072 sc1
  v_add_u32 v15, 0x40000, v15
  s_waitcnt lgkmcnt(1)
  v_smfmac_f32_16x16x64_bf16 v[88:91], v[68:71], a[176:183], v1
  global_store_dword v7, v116, s[44:45]
  v_add_u32 v9, 0x20000, v9
  v_smfmac_f32_16x16x64_bf16 v[92:95], v[68:71], a[240:247], v1
  s_waitcnt vmcnt(6)
  ds_read_b128 v[104:107], v0 offset:18432
  s_waitcnt lgkmcnt(1)
  v_smfmac_f32_16x16x64_bf16 v[88:91], v[72:75], a[184:191], v1
  v_smfmac_f32_16x16x64_bf16 v[92:95], v[72:75], a[248:255], v1
  ds_read_b128 v[108:111], v0 offset:19456
  v_smfmac_f32_16x16x64_bf16 v[80:83], v[52:55], a[16:23], v1
  v_smfmac_f32_16x16x64_bf16 v[84:87], v[52:55], a[80:87], v1
  v_smfmac_f32_16x16x64_bf16 v[80:83], v[56:59], a[24:31], v1
  v_smfmac_f32_16x16x64_bf16 v[84:87], v[56:59], a[88:95], v1
  v_smfmac_f32_16x16x64_bf16 v[80:83], v[60:63], a[32:39], v1
  v_smfmac_f32_16x16x64_bf16 v[84:87], v[60:63], a[96:103], v1
  v_smfmac_f32_16x16x64_bf16 v[80:83], v[64:67], a[40:47], v1
  v_smfmac_f32_16x16x64_bf16 v[84:87], v[64:67], a[104:111], v1
  v_add_f32 v88, v88, v90
  v_add_f32 v89, v89, v91
  v_smfmac_f32_16x16x64_bf16 v[80:83], v[68:71], a[48:55], v1
  v_add_f32 v92, v92, v94
  v_add_f32 v93, v93, v95
  v_smfmac_f32_16x16x64_bf16 v[84:87], v[68:71], a[112:119], v1
  v_cvt_pk_bf16_f32 v78, v88, v89
  v_cvt_pk_bf16_f32 v79, v92, v93
  v_smfmac_f32_16x16x64_bf16 v[80:83], v[72:75], a[56:63], v1
  ds_write2_b32 v2, v78, v79 offset0:1 offset1:129
  ds_read_b128 v[88:91], v0 offset:16384
  v_smfmac_f32_16x16x64_bf16 v[84:87], v[72:75], a[120:127], v1
  ds_read_b128 v[92:95], v0 offset:17408
  v_smfmac_f32_16x16x64_bf16 v[96:99], v[44:47], v[128:135], v1
  v_smfmac_f32_16x16x64_bf16 v[100:103], v[44:47], v[192:199], v1
  ds_read_b128 v[44:47], v0 offset:20480
  s_nop 4
  v_add_f32 v80, v80, v82
  v_add_f32 v81, v81, v83
  v_add_f32 v84, v84, v86
  v_add_f32 v85, v85, v87
  v_cvt_pk_bf16_f32 v76, v80, v81
  v_cvt_pk_bf16_f32 v77, v84, v85
  ds_write2_b32 v2, v76, v77 offset0:0 offset1:128
  v_smfmac_f32_16x16x64_bf16 v[96:99], v[48:51], v[136:143], v1
  v_smfmac_f32_16x16x64_bf16 v[100:103], v[48:51], v[200:207], v1
  ds_read_b128 v[48:51], v0 offset:21504
  v_smfmac_f32_16x16x64_bf16 v[96:99], v[52:55], v[144:151], v1
  v_smfmac_f32_16x16x64_bf16 v[100:103], v[52:55], v[208:215], v1
  v_smfmac_f32_16x16x64_bf16 v[96:99], v[56:59], v[152:159], v1
  s_waitcnt vmcnt(6)
  s_waitcnt lgkmcnt(1)
  s_barrier
  ds_read_b64_tr_b16 v[112:113], v3 offset:0
  ds_read_b64_tr_b16 v[114:115], v3 offset:256
  v_smfmac_f32_16x16x64_bf16 v[100:103], v[56:59], v[216:223], v1
  ds_read_b64_tr_b16 v[116:117], v3 offset:1024
  ds_read_b64_tr_b16 v[118:119], v3 offset:1280
  v_smfmac_f32_16x16x64_bf16 v[96:99], v[60:63], v[160:167], v1
  ds_read_b64_tr_b16 v[120:121], v3 offset:2048
  ds_read_b64_tr_b16 v[122:123], v3 offset:2304
  v_smfmac_f32_16x16x64_bf16 v[100:103], v[60:63], v[224:231], v1
  ds_read_b64_tr_b16 v[124:125], v3 offset:3072
  ds_read_b64_tr_b16 v[126:127], v3 offset:3328
  v_smfmac_f32_16x16x64_bf16 v[96:99], v[64:67], v[168:175], v1
  ds_read_b128 v[52:55], v0 offset:22528
  v_smfmac_f32_16x16x64_bf16 v[100:103], v[64:67], v[232:239], v1
  ds_read_b128 v[56:59], v0 offset:23552
  s_waitcnt lgkmcnt(8)
  v_mfma_f32_16x16x32_bf16 v[80:83], v[88:91], v[112:115], 0
  s_waitcnt lgkmcnt(6)
  v_mfma_f32_16x16x32_bf16 v[80:83], v[92:95], v[116:119], v[80:83]
  ds_read_b128 v[60:63], v11 offset:8192
  s_waitcnt lgkmcnt(5)
  v_mfma_f32_16x16x32_bf16 v[80:83], v[104:107], v[120:123], v[80:83]
  ds_read_b128 v[64:67], v11 offset:9216
  s_waitcnt lgkmcnt(4)
  v_mfma_f32_16x16x32_bf16 v[80:83], v[108:111], v[124:127], v[80:83]
  ds_read_b128 v[108:111], v12 offset:32768
  v_mfma_f32_16x16x32_bf16 v[88:91], v[112:115], v[112:115], 0
  ds_read_b128 v[92:95], v12 offset:33792
  v_mfma_f32_16x16x32_bf16 v[88:91], v[116:119], v[116:119], v[88:91]
  v_mfma_f32_16x16x32_bf16 v[88:91], v[120:123], v[120:123], v[88:91]
  v_mfma_f32_16x16x32_bf16 v[88:91], v[124:127], v[124:127], v[88:91]
  s_nop 1
  v_exp_f32 v78, v80
  v_mfma_f32_16x16x32_bf16 v[84:87], v[44:47], v[112:115], 0
  v_exp_f32 v79, v81
  ds_read_b128 v[44:47], v11 offset:4096
  v_mfma_f32_16x16x32_bf16 v[84:87], v[48:51], v[116:119], v[84:87]
  ds_read_b128 v[48:51], v11 offset:5120
  v_cvt_pk_bf16_f32 v104, v78, v79
  v_exp_f32 v78, v82
  s_waitcnt lgkmcnt(7)
  v_mfma_f32_16x16x32_bf16 v[84:87], v[52:55], v[120:123], v[84:87]
  ds_read_b128 v[52:55], v11 offset:6144
  v_exp_f32 v79, v83
  s_waitcnt lgkmcnt(7)
  v_mfma_f32_16x16x32_bf16 v[84:87], v[56:59], v[124:127], v[84:87]
  ds_read_b128 v[56:59], v11 offset:7168
  v_cvt_pk_bf16_f32 v105, v78, v79
  v_max3_f32 v76, |v80|, |v81|, |v82|
  v_smfmac_f32_16x16x64_bf16 v[96:99], v[68:71], v[176:183], v1
  v_mul_f32 v90, s24, v90
  v_mul_f32 v91, s24, v91
  v_smfmac_f32_16x16x64_bf16 v[100:103], v[68:71], v[240:247], v1
  v_exp_f32 v88, v90
  v_exp_f32 v89, v91
  v_max3_f32 v76, v76, |v83|, v90
  ds_read_b128 v[68:71], v11 offset:10240
  v_smfmac_f32_16x16x64_bf16 v[96:99], v[72:75], v[184:191], v1
  v_cvt_pk_bf16_f32 v38, v88, v89
  v_cvt_pk_bf16_f32 v41, v88, v89
  v_smfmac_f32_16x16x64_bf16 v[100:103], v[72:75], v[248:255], v1
  ds_read_b128 v[72:75], v11 offset:11264
  v_max3_f32 v77, |v84|, |v85|, v91
  v_max3_f32 v76, v76, |v86|, |v87|
  v_max_f32 v76, v76, v77
  v_cmp_lt_f32 vcc, 0x42700000, v76
  v_exp_f32 v78, v84
  v_exp_f32 v79, v85
  s_nop 0
  v_cvt_pk_bf16_f32 v106, v78, v79
  v_exp_f32 v78, v86
  v_exp_f32 v79, v87
  s_nop 0
  v_cvt_pk_bf16_f32 v107, v78, v79
  s_and_b64 vcc, vcc, s[60:61]
  s_cbranch_scc1 L_rec_fb_f1
L_rec_fbret_f1:
  s_waitcnt lgkmcnt(6)
  v_add_f32 v96, v96, v98
  v_add_f32 v97, v97, v99
  v_mfma_f32_16x16x32_bf16 v[112:115], v[32:35], v[104:107], 0
  v_add_f32 v100, v100, v102
  v_mfma_f32_16x16x32_bf16 v[80:83], v[108:111], v[104:107], 0
  v_add_f32 v101, v101, v103
  v_mfma_f32_16x16x32_bf16 v[84:87], v[92:95], v[104:107], 0
  v_cvt_pk_bf16_f32 v42, v96, v97
  v_cvt_pk_bf16_f32 v43, v100, v101
  v_mfma_f32_16x16x16_bf16 v[112:115], v[32:33], v[38:39], v[112:115]
  ds_write2_b32 v13, v42, v43 offset0:0 offset1:64
  v_mfma_f32_16x16x16_bf16 v[80:83], v[42:43], v[38:39], v[80:83]
  v_mfma_f32_16x16x16_bf16 v[84:87], v[42:43], v[40:41], v[84:87]
  v_mov_b64 v[96:97], 0
  v_mov_b64 v[98:99], 0
  v_mov_b64 v[100:101], 0
  v_mov_b64 v[102:103], 0
  s_nop 0
  v_rcp_f32 v77, v112
  ds_read_b128 v[112:115], v11 offset:12288
  ds_read_b128 v[116:119], v11 offset:13312
  s_mov_b64 exec, s[60:61]
  v_mul_f32 v80, v80, v77
  v_mul_f32 v81, v81, v77
  v_mul_f32 v82, v82, v77
  v_mul_f32 v83, v83, v77
  v_cvt_pk_bf16_f32 v78, v80, v81
  v_cvt_pk_bf16_f32 v79, v82, v83
  ds_write_b64 v5, v[78:79]
  v_mul_f32 v84, v84, v77
  v_mul_f32 v85, v85, v77
  v_mul_f32 v86, v86, v77
  v_mul_f32 v87, v87, v77
  v_cvt_pk_bf16_f32 v76, v84, v85
  v_cvt_pk_bf16_f32 v77, v86, v87
  ds_write_b64 v5, v[76:77] offset:512
  s_mov_b64 exec, -1
  v_mfma_f32_32x32x8_bf16 v[80:95], v[36:37], v[36:37], 0
  v_mov_b64 v[104:105], 0
  v_mov_b64 v[106:107], 0
  v_mov_b64 v[108:109], 0
  v_mov_b64 v[110:111], 0
  s_waitcnt lgkmcnt(0)
  s_barrier
  ds_read_b128 v[120:123], v0 offset:45056
  ds_read_b128 v[124:127], v0 offset:46080
  s_waitcnt lgkmcnt(1)
  s_nop 0
  v_smfmac_f32_16x16x64_bf16 v[80:83], v[120:123], v[44:51], v1
  s_waitcnt lgkmcnt(0)
  v_smfmac_f32_16x16x64_bf16 v[80:83], v[124:127], v[52:59], v1
  ds_read_b128 v[44:47], v11 offset:24576
  v_smfmac_f32_16x16x64_bf16 v[84:87], v[120:123], v[60:67], v1
  ds_read_b128 v[48:51], v11 offset:25600
  v_smfmac_f32_16x16x64_bf16 v[84:87], v[124:127], v[68:75], v1
  ds_read_b128 v[52:55], v11 offset:26624
  v_smfmac_f32_16x16x64_bf16 v[88:91], v[120:123], v[112:119], v1
  ds_read_b128 v[56:59], v11 offset:27648
  v_smfmac_f32_16x16x64_bf16 v[88:91], v[124:127], v[16:23], v1
  ds_read_b128 v[60:63], v11 offset:28672
  v_add_f32 v80, v80, v82
  v_add_f32 v81, v81, v83
  v_cvt_pk_bf16_f32 v76, v80, v81
  v_and_or_b32 v76, v76, -2, 1
  v_smfmac_f32_16x16x64_bf16 v[92:95], v[120:123], v[24:31], v1
  ds_read_b128 v[64:67], v11 offset:29696
  v_smfmac_f32_16x16x64_bf16 v[92:95], v[124:127], a[128:135], v1
  ds_read_b128 v[68:71], v11 offset:30720
  v_add_f32 v84, v84, v86
  v_add_f32 v85, v85, v87
  v_cvt_pk_bf16_f32 v77, v84, v85
  v_smfmac_f32_16x16x64_bf16 v[96:99], v[120:123], a[192:199], v1
  ds_read_b128 v[72:75], v11 offset:31744
  v_smfmac_f32_16x16x64_bf16 v[96:99], v[124:127], a[136:143], v1
  v_add_f32 v88, v88, v90
  v_add_f32 v89, v89, v91
  v_cvt_pk_bf16_f32 v78, v88, v89
  v_smfmac_f32_16x16x64_bf16 v[100:103], v[120:123], a[200:207], v1
  v_smfmac_f32_16x16x64_bf16 v[100:103], v[124:127], a[0:7], v1
  v_add_f32 v92, v92, v94
  v_add_f32 v93, v93, v95
  v_cvt_pk_bf16_f32 v79, v92, v93
  global_store_dwordx4 v6, v[76:79], s[32:33]
  s_waitcnt lgkmcnt(6)
  v_smfmac_f32_16x16x64_bf16 v[104:107], v[120:123], v[44:51], v1
  s_waitcnt lgkmcnt(4)
  v_smfmac_f32_16x16x64_bf16 v[104:107], v[124:127], v[52:59], v1
  v_add_f32 v96, v96, v98
  v_add_f32 v97, v97, v99
  v_cvt_pk_bf16_f32 v80, v96, v97
  v_and_or_b32 v80, v80, -2, 1
  s_waitcnt lgkmcnt(2)
  v_smfmac_f32_16x16x64_bf16 v[108:111], v[120:123], v[60:67], v1
  s_waitcnt lgkmcnt(0)
  v_smfmac_f32_16x16x64_bf16 v[108:111], v[124:127], v[68:75], v1
  v_add_f32 v100, v100, v102
  v_add_f32 v101, v101, v103
  v_cvt_pk_bf16_f32 v81, v100, v101
  v_add_f32 v104, v104, v106
  v_add_f32 v105, v105, v107
  v_cvt_pk_bf16_f32 v82, v104, v105
  s_nop 1
  v_add_f32 v108, v108, v110
  v_add_f32 v109, v109, v111
  v_cvt_pk_bf16_f32 v83, v108, v109
  global_store_dwordx4 v6, v[80:83], s[34:35]
  s_lshl_b32 s54, s21, 10
  v_add_u32 v116, s54, v3
  ds_read_b64_tr_b16 v[112:113], v116
  ds_read_b64_tr_b16 v[114:115], v116 offset:256
  s_mov_b64 exec, s[60:61]
  ds_read_b128 v[112:115], v10
  s_mov_b64 exec, -1
  v_cndmask_b32 v60, 0, v14, s[8:9]
  v_cndmask_b32 v61, 0, v14, s[10:11]
  v_cndmask_b32 v62, 0, v14, s[12:13]
  v_cndmask_b32 v63, 0, v14, s[14:15]
  v_mfma_f32_32x32x8_bf16 v[80:95], v[36:37], v[36:37], 0
  v_mov_b64 v[96:97], 0
  v_mov_b64 v[98:99], 0
  v_mov_b64 v[100:101], 0
  v_mov_b64 v[102:103], 0
  ds_read_b128 v[104:107], v11 offset:20480
  ds_read_b128 v[108:111], v11 offset:21504
  ds_read_b128 v[120:123], v11 offset:22528
  ds_read_b128 v[124:127], v11 offset:23552
  ds_read_b128 v[52:55], v11 offset:14336
  ds_read_b128 v[56:59], v11 offset:15360
  ds_read_b128 v[68:71], v11 offset:18432
  ds_read_b128 v[72:75], v11 offset:19456
  v_mov_b32 v116, -1
  s_add_u32 s4, s4, 4096
  s_lshl_b32 s54, s20, 7
  s_add_u32 s54, s54, 61440
  s_min_u32 s4, s4, s54
  v_mov_b32 v119, s4
  s_waitcnt lgkmcnt(8)
  v_min_u32 v112, -2, v112
  s_cmp_lt_u32 s21, 2
  s_cbranch_scc1 Lz_108
  s_nop 3
  s_nop 3
  s_nop 3
  s_nop 3
  s_nop 3
  s_nop 3
  s_nop 3
  s_nop 3
  s_nop 3
  s_nop 3
Lz_108:
  s_nop 3
  s_nop 3
  s_nop 3
  s_mov_b32 s27, 0
L_p2_f1:
  global_load_dwordx4 v[44:47], v8, s[38:39] sc1
  global_load_dwordx4 v[48:51], v8, s[38:39] offset:1024 sc1
  s_add_u32 s27, s27, 1
  s_cmp_gt_u32 s27, 0x400000
  s_cbranch_scc1 L_end
  s_waitcnt vmcnt(1)
  v_mfma_f32_16x16x32_bf16 v[64:67], v[44:47], v[60:63], 0
  s_waitcnt vmcnt(0)
  v_mfma_f32_16x16x32_bf16 v[64:67], v[48:51], v[60:63], v[64:67]
  v_and_b32 v117, v44, v48
  v_and_b32 v117, 1, v117
  v_cmp_ne_u32 vcc, 1, v117
  s_cbranch_vccnz L_p2_f1
  s_nop 3
  v_permlane32_swap_b32 v64, v66
  v_permlane32_swap_b32 v65, v67
  v_add_f32 v64, v64, v66
  v_add_f32 v65, v65, v67
  v_mov_b32 v66, v64
  v_mov_b32 v67, v65
  s_nop 0
  v_permlane16_swap_b32 v64, v66
  v_permlane16_swap_b32 v65, v67
  v_add_f32 v64, v64, v66
  v_add_f32 v65, v65, v67
  v_cvt_pk_bf16_f32 v64, v64, v65
  v_min_u32 v64, -2, v64
  global_store_dword v7, v64, s[42:43]
  ds_read_b128 v[60:63], v11 offset:16384
  ds_read_b128 v[64:67], v11 offset:17408
  v_xor_b32 v76, 2048, v12
  v_xor_b32 v77, 4096, v12
  v_xor_b32 v78, 6144, v12
  s_cmp_ge_u32 s21, 2
  s_cbranch_scc1 Lz_109
  s_nop 3
  s_nop 3
  s_nop 3
  s_nop 3
  s_nop 3
  s_nop 3
  s_nop 3
  s_nop 3
  s_nop 3
  s_nop 3
Lz_109:
  s_nop 3
  s_nop 3
  s_nop 3
  s_nop 3
  s_nop 3
  s_mov_b32 s27, 0
L_p3_f1:
  global_load_dwordx4 v[44:47], v12, s[78:79] sc1
  global_load_dwordx4 v[48:51], v12, s[78:79] offset:1024 sc1
  s_add_u32 s27, s27, 1
  s_cmp_gt_u32 s27, 0x400000
  s_cbranch_scc1 L_end
L_p3b_f1:
  s_waitcnt vmcnt(1)
  ds_write_b128 v12, v[44:47] offset:0
  v_max3_u32 v117, v44, v45, v46
  s_waitcnt vmcnt(0)
  ds_write_b128 v12, v[48:51] offset:1024
  v_max3_u32 v118, v47, v48, v49
  v_max3_u32 v117, v117, v50, v51
  v_max_u32 v117, v117, v118
  v_cmp_eq_u32 vcc, -1, v117
  s_cbranch_vccnz L_p3_f1
L_rec_acc_f1:
L_rec_join_f1:
  s_add_u32 s22, s22, 1
L_rec_step_f2:
  s_waitcnt lgkmcnt(2)
  v_smfmac_f32_16x16x64_bf16 v[88:91], v[44:47], v[52:59], v1
  v_smfmac_f32_16x16x64_bf16 v[92:95], v[44:47], v[60:67], v1
  v_smfmac_f32_16x16x64_bf16 v[88:91], v[48:51], v[68:75], v1
  s_waitcnt lgkmcnt(0)
  s_barrier
  ds_read_b128 v[52:55], v76 offset:0
  ds_read_b128 v[56:59], v76 offset:1024
  v_smfmac_f32_16x16x64_bf16 v[92:95], v[48:51], v[104:111], v1
  ds_read_b128 v[60:63], v77 offset:0
  v_smfmac_f32_16x16x64_bf16 v[80:83], v[44:47], v[120:127], v1
  ds_read_b128 v[64:67], v77 offset:1024
  v_smfmac_f32_16x16x64_bf16 v[84:87], v[44:47], a[64:71], v1
  ds_read_b128 v[68:71], v78 offset:0
  v_smfmac_f32_16x16x64_bf16 v[80:83], v[48:51], a[8:15], v1
  ds_read_b128 v[72:75], v78 offset:1024
  v_smfmac_f32_16x16x64_bf16 v[84:87], v[48:51], a[72:79], v1
  global_store_dwordx4 v9, v[112:115], s[50:51] sc1
  s_waitcnt lgkmcnt(5)
  v_smfmac_f32_16x16x64_bf16 v[88:91], v[52:55], a[144:151], v1
  s_mov_b32 m0, s59
  v_smfmac_f32_16x16x64_bf16 v[92:95], v[52:55], a[208:215], v1
  global_load_lds_dwordx4 v15, s[16:17] offset:0 sc1
  s_waitcnt lgkmcnt(4)
  v_smfmac_f32_16x16x64_bf16 v[88:91], v[56:59], a[152:159], v1
  v_smfmac_f32_16x16x64_bf16 v[92:95], v[56:59], a[216:223], v1
  global_load_lds_dwordx4 v15, s[16:17] offset:1024 sc1
  s_waitcnt lgkmcnt(3)
  v_smfmac_f32_16x16x64_bf16 v[88:91], v[60:63], a[160:167], v1
  v_smfmac_f32_16x16x64_bf16 v[92:95], v[60:63], a[224:231], v1
  global_load_lds_dwordx4 v15, s[16:17] offset:2048 sc1
  s_waitcnt lgkmcnt(2)
  v_smfmac_f32_16x16x64_bf16 v[88:91], v[64:67], a[168:175], v1
  v_smfmac_f32_16x16x64_bf16 v[92:95], v[64:67], a[232:239], v1
  global_load_lds_dwordx4 v15, s[16:17] offset:3072 sc1
  v_add_u32 v15, 0x40000, v15
  s_waitcnt lgkmcnt(1)
  v_smfmac_f32_16x16x64_bf16 v[88:91], v[68:71], a[176:183], v1
  global_store_dword v7, v116, s[46:47]
  v_add_u32 v9, 0x20000, v9
  v_smfmac_f32_16x16x64_bf16 v[92:95], v[68:71], a[240:247], v1
  global_load_dword v4, v119, s[52:53] sc1
  s_waitcnt vmcnt(7)
  ds_read_b128 v[104:107], v0 offset:10240
  s_waitcnt lgkmcnt(1)
  v_smfmac_f32_16x16x64_bf16 v[88:91], v[72:75], a[184:191], v1
  v_smfmac_f32_16x16x64_bf16 v[92:95], v[72:75], a[248:255], v1
  ds_read_b128 v[108:111], v0 offset:11264
  v_smfmac_f32_16x16x64_bf16 v[80:83], v[52:55], a[16:23], v1
  v_smfmac_f32_16x16x64_bf16 v[84:87], v[52:55], a[80:87], v1
  v_smfmac_f32_16x16x64_bf16 v[80:83], v[56:59], a[24:31], v1
  v_smfmac_f32_16x16x64_bf16 v[84:87], v[56:59], a[88:95], v1
  v_smfmac_f32_16x16x64_bf16 v[80:83], v[60:63], a[32:39], v1
  v_smfmac_f32_16x16x64_bf16 v[84:87], v[60:63], a[96:103], v1
  v_smfmac_f32_16x16x64_bf16 v[80:83], v[64:67], a[40:47], v1
  v_smfmac_f32_16x16x64_bf16 v[84:87], v[64:67], a[104:111], v1
  v_add_f32 v88, v88, v90
  v_add_f32 v89, v89, v91
  v_smfmac_f32_16x16x64_bf16 v[80:83], v[68:71], a[48:55], v1
  v_add_f32 v92, v92, v94
  v_add_f32 v93, v93, v95
  v_smfmac_f32_16x16x64_bf16 v[84:87], v[68:71], a[112:119], v1
  v_cvt_pk_bf16_f32 v78, v88, v89
  v_cvt_pk_bf16_f32 v79, v92, v93
  v_smfmac_f32_16x16x64_bf16 v[80:83], v[72:75], a[56:63], v1
  ds_write2_b32 v2, v78, v79 offset0:1 offset1:129
  ds_read_b128 v[88:91], v0 offset:8192
  v_smfmac_f32_16x16x64_bf16 v[84:87], v[72:75], a[120:127], v1
  ds_read_b128 v[92:95], v0 offset:9216
  v_smfmac_f32_16x16x64_bf16 v[96:99], v[44:47], v[128:135], v1
  v_smfmac_f32_16x16x64_bf16 v[100:103], v[44:47], v[192:199], v1
  ds_read_b128 v[44:47], v0 offset:12288
  s_nop 4
  v_add_f32 v80, v80, v82
  v_add_f32 v81, v81, v83
  v_add_f32 v84, v84, v86
  v_add_f32 v85, v85, v87
  v_cvt_pk_bf16_f32 v76, v80, v81
  v_cvt_pk_bf16_f32 v77, v84, v85
  ds_write2_b32 v2, v76, v77 offset0:0 offset1:128
  v_smfmac_f32_16x16x64_bf16 v[96:99], v[48:51], v[136:143], v1
  v_smfmac_f32_16x16x64_bf16 v[100:103], v[48:51], v[200:207], v1
  ds_read_b128 v[48:51], v0 offset:13312
  v_smfmac_f32_16x16x64_bf16 v[96:99], v[52:55], v[144:151], v1
  v_smfmac_f32_16x16x64_bf16 v[100:103], v[52:55], v[208:215], v1
  v_smfmac_f32_16x16x64_bf16 v[96:99], v[56:59], v[152:159], v1
  s_waitcnt vmcnt(7)
  s_waitcnt lgkmcnt(1)
  s_barrier
  ds_read_b64_tr_b16 v[112:113], v3 offset:0
  ds_read_b64_tr_b16 v[114:115], v3 offset:256
  v_smfmac_f32_16x16x64_bf16 v[100:103], v[56:59], v[216:223], v1
  ds_read_b64_tr_b16 v[116:117], v3 offset:1024
  ds_read_b64_tr_b16 v[118:119], v3 offset:1280
  v_smfmac_f32_16x16x64_bf16 v[96:99], v[60:63], v[160:167], v1
  ds_read_b64_tr_b16 v[120:121], v3 offset:2048
  ds_read_b64_tr_b16 v[122:123], v3 offset:2304
  v_smfmac_f32_16x16x64_bf16 v[100:103], v[60:63], v[224:231], v1
  ds_read_b64_tr_b16 v[124:125], v3 offset:3072
  ds_read_b64_tr_b16 v[126:127], v3 offset:3328
  v_smfmac_f32_16x16x64_bf16 v[96:99], v[64:67], v[168:175], v1
  ds_read_b128 v[52:55], v0 offset:14336
  v_smfmac_f32_16x16x64_bf16 v[100:103], v[64:67], v[232:239], v1
  ds_read_b128 v[56:59], v0 offset:15360
  s_waitcnt lgkmcnt(8)
  v_mfma_f32_16x16x32_bf16 v[80:83], v[88:91], v[112:115], 0
  s_waitcnt lgkmcnt(6)
  v_mfma_f32_16x16x32_bf16 v[80:83], v[92:95], v[116:119], v[80:83]
  ds_read_b128 v[60:63], v11 offset:8192
  s_waitcnt lgkmcnt(5)
  v_mfma_f32_16x16x32_bf16 v[80:83], v[104:107], v[120:123], v[80:83]
  ds_read_b128 v[64:67], v11 offset:9216
  s_waitcnt lgkmcnt(4)
  v_mfma_f32_16x16x32_bf16 v[80:83], v[108:111], v[124:127], v[80:83]
  ds_read_b128 v[108:111], v12 offset:24576
  v_mfma_f32_16x16x32_bf16 v[88:91], v[112:115], v[112:115], 0
  ds_read_b128 v[92:95], v12 offset:25600
  v_mfma_f32_16x16x32_bf16 v[88:91], v[116:119], v[116:119], v[88:91]
  v_mfma_f32_16x16x32_bf16 v[88:91], v[120:123], v[120:123], v[88:91]
  v_mfma_f32_16x16x32_bf16 v[88:91], v[124:127], v[124:127], v[88:91]
  s_nop 1
  v_exp_f32 v78, v80
  v_mfma_f32_16x16x32_bf16 v[84:87], v[44:47], v[112:115], 0
  v_exp_f32 v79, v81
  ds_read_b128 v[44:47], v11 offset:4096
  v_mfma_f32_16x16x32_bf16 v[84:87], v[48:51], v[116:119], v[84:87]
  ds_read_b128 v[48:51], v11 offset:5120
  v_cvt_pk_bf16_f32 v104, v78, v79
  v_exp_f32 v78, v82
  s_waitcnt lgkmcnt(7)
  v_mfma_f32_16x16x32_bf16 v[84:87], v[52:55], v[120:123], v[84:87]
  ds_read_b128 v[52:55], v11 offset:6144
  v_exp_f32 v79, v83
  s_waitcnt lgkmcnt(7)
  v_mfma_f32_16x16x32_bf16 v[84:87], v[56:59], v[124:127], v[84:87]
  ds_read_b128 v[56:59], v11 offset:7168
  v_cvt_pk_bf16_f32 v105, v78, v79
  v_max3_f32 v76, |v80|, |v81|, |v82|
  v_smfmac_f32_16x16x64_bf16 v[96:99], v[68:71], v[176:183], v1
  v_mul_f32 v90, s24, v90
  v_mul_f32 v91, s24, v91
  v_smfmac_f32_16x16x64_bf16 v[100:103], v[68:71], v[240:247], v1
  v_exp_f32 v88, v90
  v_exp_f32 v89, v91
  v_max3_f32 v76, v76, |v83|, v90
  ds_read_b128 v[68:71], v11 offset:10240
  v_smfmac_f32_16x16x64_bf16 v[96:99], v[72:75], v[184:191], v1
  v_cvt_pk_bf16_f32 v38, v88, v89
  v_cvt_pk_bf16_f32 v41, v88, v89
  v_smfmac_f32_16x16x64_bf16 v[100:103], v[72:75], v[248:255], v1
  ds_read_b128 v[72:75], v11 offset:11264
  v_max3_f32 v77, |v84|, |v85|, v91
  v_max3_f32 v76, v76, |v86|, |v87|
  v_max_f32 v76, v76, v77
  v_cmp_lt_f32 vcc, 0x42700000, v76
  v_exp_f32 v78, v84
  v_exp_f32 v79, v85
  s_nop 0
  v_cvt_pk_bf16_f32 v106, v78, v79
  v_exp_f32 v78, v86
  v_exp_f32 v79, v87
  s_nop 0
  v_cvt_pk_bf16_f32 v107, v78, v79
  s_and_b64 vcc, vcc, s[60:61]
  s_cbranch_scc1 L_rec_fb_f2
L_rec_fbret_f2:
  s_waitcnt lgkmcnt(6)
  v_add_f32 v96, v96, v98
  v_add_f32 v97, v97, v99
  v_mfma_f32_16x16x32_bf16 v[112:115], v[32:35], v[104:107], 0
  v_add_f32 v100, v100, v102
  v_mfma_f32_16x16x32_bf16 v[80:83], v[108:111], v[104:107], 0
  v_add_f32 v101, v101, v103
  v_mfma_f32_16x16x32_bf16 v[84:87], v[92:95], v[104:107], 0
  v_cvt_pk_bf16_f32 v42, v96, v97
  v_cvt_pk_bf16_f32 v43, v100, v101
  v_mfma_f32_16x16x16_bf16 v[112:115], v[32:33], v[38:39], v[112:115]
  ds_write2_b32 v13, v42, v43 offset0:0 offset1:64
  v_mfma_f32_16x16x16_bf16 v[80:83], v[42:43], v[38:39], v[80:83]
  v_mfma_f32_16x16x16_bf16 v[84:87], v[42:43], v[40:41], v[84:87]
  v_mov_b64 v[96:97], 0
  v_mov_b64 v[98:99], 0
  v_mov_b64 v[100:101], 0
  v_mov_b64 v[102:103], 0
  s_nop 0
  v_rcp_f32 v77, v112
  ds_read_b128 v[112:115], v11 offset:12288
  ds_read_b128 v[116:119], v11 offset:13312
  s_mov_b64 exec, s[60:61]
  v_mul_f32 v80, v80, v77
  v_mul_f32 v81, v81, v77
  v_mul_f32 v82, v82, v77
  v_mul_f32 v83, v83, v77
  v_cvt_pk_bf16_f32 v78, v80, v81
  v_cvt_pk_bf16_f32 v79, v82, v83
  ds_write_b64 v5, v[78:79]
  v_mul_f32 v84, v84, v77
  v_mul_f32 v85, v85, v77
  v_mul_f32 v86, v86, v77
  v_mul_f32 v87, v87, v77
  v_cvt_pk_bf16_f32 v76, v84, v85
  v_cvt_pk_bf16_f32 v77, v86, v87
  ds_write_b64 v5, v[76:77] offset:512
  s_mov_b64 exec, -1
  v_mfma_f32_32x32x8_bf16 v[80:95], v[36:37], v[36:37], 0
  v_mov_b64 v[104:105], 0
  v_mov_b64 v[106:107], 0
  v_mov_b64 v[108:109], 0
  v_mov_b64 v[110:111], 0
  s_waitcnt lgkmcnt(0)
  s_barrier
  ds_read_b128 v[120:123], v0 offset:45056
  ds_read_b128 v[124:127], v0 offset:46080
  s_waitcnt lgkmcnt(1)
  s_nop 0
  v_smfmac_f32_16x16x64_bf16 v[80:83], v[120:123], v[44:51], v1
  s_waitcnt lgkmcnt(0)
  v_smfmac_f32_16x16x64_bf16 v[80:83], v[124:127], v[52:59], v1
  ds_read_b128 v[44:47], v11 offset:24576
  v_smfmac_f32_16x16x64_bf16 v[84:87], v[120:123], v[60:67], v1
  ds_read_b128 v[48:51], v11 offset:25600
  v_smfmac_f32_16x16x64_bf16 v[84:87], v[124:127], v[68:75], v1
  ds_read_b128 v[52:55], v11 offset:26624
  v_smfmac_f32_16x16x64_bf16 v[88:91], v[120:123], v[112:119], v1
  ds_read_b128 v[56:59], v11 offset:27648
  v_smfmac_f32_16x16x64_bf16 v[88:91], v[124:127], v[16:23], v1
  ds_read_b128 v[60:63], v11 offset:28672
  v_add_f32 v80, v80, v82
  v_add_f32 v81, v81, v83
  v_cvt_pk_bf16_f32 v76, v80, v81
  v_and_or_b32 v76, v76, -2, 0
  v_smfmac_f32_16x16x64_bf16 v[92:95], v[120:123], v[24:31], v1
  ds_read_b128 v[64:67], v11 offset:29696
  v_smfmac_f32_16x16x64_bf16 v[92:95], v[124:127], a[128:135], v1
  ds_read_b128 v[68:71], v11 offset:30720
  v_add_f32 v84, v84, v86
  v_add_f32 v85, v85, v87
  v_cvt_pk_bf16_f32 v77, v84, v85
  v_smfmac_f32_16x16x64_bf16 v[96:99], v[120:123], a[192:199], v1
  ds_read_b128 v[72:75], v11 offset:31744
  v_smfmac_f32_16x16x64_bf16 v[96:99], v[124:127], a[136:143], v1
  v_add_f32 v88, v88, v90
  v_add_f32 v89, v89, v91
  v_cvt_pk_bf16_f32 v78, v88, v89
  v_smfmac_f32_16x16x64_bf16 v[100:103], v[120:123], a[200:207], v1
  v_smfmac_f32_16x16x64_bf16 v[100:103], v[124:127], a[0:7], v1
  v_add_f32 v92, v92, v94
  v_add_f32 v93, v93, v95
  v_cvt_pk_bf16_f32 v79, v92, v93
  global_store_dwordx4 v6, v[76:79], s[28:29]
  s_waitcnt lgkmcnt(6)
  v_smfmac_f32_16x16x64_bf16 v[104:107], v[120:123], v[44:51], v1
  s_waitcnt lgkmcnt(4)
  v_smfmac_f32_16x16x64_bf16 v[104:107], v[124:127], v[52:59], v1
  v_add_f32 v96, v96, v98
  v_add_f32 v97, v97, v99
  v_cvt_pk_bf16_f32 v80, v96, v97
  v_and_or_b32 v80, v80, -2, 0
  s_waitcnt lgkmcnt(2)
  v_smfmac_f32_16x16x64_bf16 v[108:111], v[120:123], v[60:67], v1
  s_waitcnt lgkmcnt(0)
  v_smfmac_f32_16x16x64_bf16 v[108:111], v[124:127], v[68:75], v1
  v_add_f32 v100, v100, v102
  v_add_f32 v101, v101, v103
  v_cvt_pk_bf16_f32 v81, v100, v101
  v_add_f32 v104, v104, v106
  v_add_f32 v105, v105, v107
  v_cvt_pk_bf16_f32 v82, v104, v105
  s_nop 1
  v_add_f32 v108, v108, v110
  v_add_f32 v109, v109, v111
  v_cvt_pk_bf16_f32 v83, v108, v109
  global_store_dwordx4 v6, v[80:83], s[30:31]
  s_lshl_b32 s54, s21, 10
  v_add_u32 v116, s54, v3
  ds_read_b64_tr_b16 v[112:113], v116
  ds_read_b64_tr_b16 v[114:115], v116 offset:256
  s_mov_b64 exec, s[60:61]
  ds_read_b128 v[112:115], v10
  s_mov_b64 exec, -1
  v_cndmask_b32 v60, 0, v14, s[8:9]
  v_cndmask_b32 v61, 0, v14, s[10:11]
  v_cndmask_b32 v62, 0, v14, s[12:13]
  v_cndmask_b32 v63, 0, v14, s[14:15]
  v_mfma_f32_32x32x8_bf16 v[80:95], v[36:37], v[36:37], 0
  v_mov_b64 v[96:97], 0
  v_mov_b64 v[98:99], 0
  v_mov_b64 v[100:101], 0
  v_mov_b64 v[102:103], 0
  ds_read_b128 v[104:107], v11 offset:20480
  ds_read_b128 v[108:111], v11 offset:21504
  ds_read_b128 v[120:123], v11 offset:22528
  ds_read_b128 v[124:127], v11 offset:23552
  ds_read_b128 v[52:55], v11 offset:14336
  ds_read_b128 v[56:59], v11 offset:15360
  ds_read_b128 v[68:71], v11 offset:18432
  ds_read_b128 v[72:75], v11 offset:19456
  v_mov_b32 v116, -1
  s_waitcnt lgkmcnt(8)
  v_min_u32 v112, -2, v112
  s_cmp_lt_u32 s21, 2
  s_cbranch_scc1 Lz_110
  s_nop 3
  s_nop 3
  s_nop 3
  s_nop 3
  s_nop 3
  s_nop 3
  s_nop 3
  s_nop 3
  s_nop 3
  s_nop 3
Lz_110:
  s_nop 3
  s_nop 3
  s_nop 3
  s_mov_b32 s27, 0
L_p2_f2:
  global_load_dwordx4 v[44:47], v8, s[36:37] sc1
  global_load_dwordx4 v[48:51], v8, s[36:37] offset:1024 sc1
  s_add_u32 s27, s27, 1
  s_cmp_gt_u32 s27, 0x400000
  s_cbranch_scc1 L_end
  s_waitcnt vmcnt(1)
  v_mfma_f32_16x16x32_bf16 v[64:67], v[44:47], v[60:63], 0
  s_waitcnt vmcnt(0)
  v_mfma_f32_16x16x32_bf16 v[64:67], v[48:51], v[60:63], v[64:67]
  v_or_b32 v117, v44, v48
  v_and_b32 v117, 1, v117
  v_cmp_ne_u32 vcc, 0, v117
  s_cbranch_vccnz L_p2_f2
  s_nop 3
  v_permlane32_swap_b32 v64, v66
  v_permlane32_swap_b32 v65, v67
  v_add_f32 v64, v64, v66
  v_add_f32 v65, v65, v67
  v_mov_b32 v66, v64
  v_mov_b32 v67, v65
  s_nop 0
  v_permlane16_swap_b32 v64, v66
  v_permlane16_swap_b32 v65, v67
  v_add_f32 v64, v64, v66
  v_add_f32 v65, v65, v67
  v_cvt_pk_bf16_f32 v64, v64, v65
  v_min_u32 v64, -2, v64
  global_store_dword v7, v64, s[44:45]
  v_readfirstlane_b32 s5, v4
  ds_read_b128 v[60:63], v11 offset:16384
  ds_read_b128 v[64:67], v11 offset:17408
  v_xor_b32 v76, 2048, v12
  v_xor_b32 v77, 4096, v12
  v_xor_b32 v78, 6144, v12
  s_cmp_ge_u32 s21, 2
  s_cbranch_scc1 Lz_111
  s_nop 3
  s_nop 3
  s_nop 3
  s_nop 3
  s_nop 3
  s_nop 3
  s_nop 3
  s_nop 3
  s_nop 3
  s_nop 3
Lz_111:
  s_nop 3
  s_nop 3
  s_nop 3
  s_nop 3
  s_nop 3
  s_mov_b32 s27, 0
L_p3_f2:
  global_load_dwordx4 v[44:47], v12, s[80:81] sc1
  global_load_dwordx4 v[48:51], v12, s[80:81] offset:1024 sc1
  s_add_u32 s27, s27, 1
  s_cmp_gt_u32 s27, 0x400000
  s_cbranch_scc1 L_end
L_p3b_f2:
  s_waitcnt vmcnt(1)
  ds_write_b128 v12, v[44:47] offset:0
  v_max3_u32 v117, v44, v45, v46
  s_waitcnt vmcnt(0)
  ds_write_b128 v12, v[48:51] offset:1024
  v_max3_u32 v118, v47, v48, v49
  v_max3_u32 v117, v117, v50, v51
  v_max_u32 v117, v117, v118
  v_cmp_eq_u32 vcc, -1, v117
  s_cbranch_vccnz L_p3_f2
  s_cmp_eq_u32 s22, 2
  s_cselect_b32 s5, 0, s5
  s_cmp_eq_u32 s5, 1
  s_cbranch_scc1 L_rec_fok_f2
  s_cmp_eq_u32 s22, 2
  s_cbranch_scc0 L_rec_fwn_f2
  v_lshrrev_b32 v117, 4, v0
  v_and_b32 v117, 3, v117
  s_lshl_b32 s54, s20, 2
  v_add_u32 v117, s54, v117
  v_lshlrev_b32 v117, 7, v117
  v_add_u32 v117, 147520, v117
  s_mov_b32 s27, 0
L_rec_fm_f2:
  global_load_dword v118, v117, s[52:53] sc1
  s_add_u32 s27, s27, 1
  s_cmp_gt_u32 s27, 0x400000
  s_cbranch_scc1 L_end
  s_waitcnt vmcnt(0)
  v_cmp_ne_u32 vcc, 1, v118
  s_cbranch_vccnz L_rec_fm_f2
  s_branch L_rec_fok_f2
L_rec_fwn_f2:
  s_mov_b32 s27, 0
  v_mov_b32 v117, s4
L_rec_fw_f2:
  global_load_dword v118, v117, s[52:53] sc1
  s_add_u32 s27, s27, 1
  s_cmp_gt_u32 s27, 0x400000
  s_cbranch_scc1 L_end
  s_waitcnt vmcnt(0)
  v_readfirstlane_b32 s54, v118
  s_nop 0
  s_cmp_eq_u32 s54, 1
  s_cbranch_scc0 L_rec_fw_f2
L_rec_fok_f2:
L_rec_acc_f2:
L_rec_join_f2:
  s_add_u32 s22, s22, 1
L_rec_step_f3:
  s_cmp_eq_u32 s22, 63
  s_cbranch_scc1 L_rec_last
  s_waitcnt lgkmcnt(2)
  v_smfmac_f32_16x16x64_bf16 v[88:91], v[44:47], v[52:59], v1
  v_smfmac_f32_16x16x64_bf16 v[92:95], v[44:47], v[60:67], v1
  v_smfmac_f32_16x16x64_bf16 v[88:91], v[48:51], v[68:75], v1
  s_waitcnt lgkmcnt(0)
  s_barrier
  ds_read_b128 v[52:55], v76 offset:0
  ds_read_b128 v[56:59], v76 offset:1024
  v_smfmac_f32_16x16x64_bf16 v[92:95], v[48:51], v[104:111], v1
  ds_read_b128 v[60:63], v77 offset:0
  v_smfmac_f32_16x16x64_bf16 v[80:83], v[44:47], v[120:127], v1
  ds_read_b128 v[64:67], v77 offset:1024
  v_smfmac_f32_16x16x64_bf16 v[84:87], v[44:47], a[64:71], v1
  ds_read_b128 v[68:71], v78 offset:0
  v_smfmac_f32_16x16x64_bf16 v[80:83], v[48:51], a[8:15], v1
  ds_read_b128 v[72:75], v78 offset:1024
  v_smfmac_f32_16x16x64_bf16 v[84:87], v[48:51], a[72:79], v1
  global_store_dwordx4 v9, v[112:115], s[50:51] sc1
  s_waitcnt lgkmcnt(5)
  v_smfmac_f32_16x16x64_bf16 v[88:91], v[52:55], a[144:151], v1
  s_mov_b32 m0, s58
  v_smfmac_f32_16x16x64_bf16 v[92:95], v[52:55], a[208:215], v1
  global_load_lds_dwordx4 v15, s[16:17] offset:0 sc1
  s_waitcnt lgkmcnt(4)
  v_smfmac_f32_16x16x64_bf16 v[88:91], v[56:59], a[152:159], v1
  v_smfmac_f32_16x16x64_bf16 v[92:95], v[56:59], a[216:223], v1
  global_load_lds_dwordx4 v15, s[16:17] offset:1024 sc1
  s_waitcnt lgkmcnt(3)
  v_smfmac_f32_16x16x64_bf16 v[88:91], v[60:63], a[160:167], v1
  v_smfmac_f32_16x16x64_bf16 v[92:95], v[60:63], a[224:231], v1
  global_load_lds_dwordx4 v15, s[16:17] offset:2048 sc1
  s_waitcnt lgkmcnt(2)
  v_smfmac_f32_16x16x64_bf16 v[88:91], v[64:67], a[168:175], v1
  v_smfmac_f32_16x16x64_bf16 v[92:95], v[64:67], a[232:239], v1
  global_load_lds_dwordx4 v15, s[16:17] offset:3072 sc1
  v_add_u32 v15, 0x40000, v15
  s_waitcnt lgkmcnt(1)
  v_smfmac_f32_16x16x64_bf16 v[88:91], v[68:71], a[176:183], v1
  global_store_dword v7, v116, s[40:41]
  v_add_u32 v9, 0x20000, v9
  v_smfmac_f32_16x16x64_bf16 v[92:95], v[68:71], a[240:247], v1
  s_waitcnt vmcnt(6)
  ds_read_b128 v[104:107], v0 offset:18432
  s_waitcnt lgkmcnt(1)
  v_smfmac_f32_16x16x64_bf16 v[88:91], v[72:75], a[184:191], v1
  v_smfmac_f32_16x16x64_bf16 v[92:95], v[72:75], a[248:255], v1
  ds_read_b128 v[108:111], v0 offset:19456
  v_smfmac_f32_16x16x64_bf16 v[80:83], v[52:55], a[16:23], v1
  v_smfmac_f32_16x16x64_bf16 v[84:87], v[52:55], a[80:87], v1
  v_smfmac_f32_16x16x64_bf16 v[80:83], v[56:59], a[24:31], v1
  v_smfmac_f32_16x16x64_bf16 v[84:87], v[56:59], a[88:95], v1
  v_smfmac_f32_16x16x64_bf16 v[80:83], v[60:63], a[32:39], v1
  v_smfmac_f32_16x16x64_bf16 v[84:87], v[60:63], a[96:103], v1
  v_smfmac_f32_16x16x64_bf16 v[80:83], v[64:67], a[40:47], v1
  v_smfmac_f32_16x16x64_bf16 v[84:87], v[64:67], a[104:111], v1
  v_add_f32 v88, v88, v90
  v_add_f32 v89, v89, v91
  v_smfmac_f32_16x16x64_bf16 v[80:83], v[68:71], a[48:55], v1
  v_add_f32 v92, v92, v94
  v_add_f32 v93, v93, v95
  v_smfmac_f32_16x16x64_bf16 v[84:87], v[68:71], a[112:119], v1
  v_cvt_pk_bf16_f32 v78, v88, v89
  v_cvt_pk_bf16_f32 v79, v92, v93
  v_smfmac_f32_16x16x64_bf16 v[80:83], v[72:75], a[56:63], v1
  ds_write2_b32 v2, v78, v79 offset0:1 offset1:129
  ds_read_b128 v[88:91], v0 offset:16384
  v_smfmac_f32_16x16x64_bf16 v[84:87], v[72:75], a[120:127], v1
  ds_read_b128 v[92:95], v0 offset:17408
  v_smfmac_f32_16x16x64_bf16 v[96:99], v[44:47], v[128:135], v1
  v_smfmac_f32_16x16x64_bf16 v[100:103], v[44:47], v[192:199], v1
  ds_read_b128 v[44:47], v0 offset:20480
  s_nop 4
  v_add_f32 v80, v80, v82
  v_add_f32 v81, v81, v83
  v_add_f32 v84, v84, v86
  v_add_f32 v85, v85, v87
  v_cvt_pk_bf16_f32 v76, v80, v81
  v_cvt_pk_bf16_f32 v77, v84, v85
  ds_write2_b32 v2, v76, v77 offset0:0 offset1:128
  v_smfmac_f32_16x16x64_bf16 v[96:99], v[48:51], v[136:143], v1
  v_smfmac_f32_16x16x64_bf16 v[100:103], v[48:51], v[200:207], v1
  ds_read_b128 v[48:51], v0 offset:21504
  v_smfmac_f32_16x16x64_bf16 v[96:99], v[52:55], v[144:151], v1
  v_smfmac_f32_16x16x64_bf16 v[100:103], v[52:55], v[208:215], v1
  v_smfmac_f32_16x16x64_bf16 v[96:99], v[56:59], v[152:159], v1
  s_waitcnt vmcnt(6)
  s_waitcnt lgkmcnt(1)
  s_barrier
  ds_read_b64_tr_b16 v[112:113], v3 offset:0
  ds_read_b64_tr_b16 v[114:115], v3 offset:256
  v_smfmac_f32_16x16x64_bf16 v[100:103], v[56:59], v[216:223], v1
  ds_read_b64_tr_b16 v[116:117], v3 offset:1024
  ds_read_b64_tr_b16 v[118:119], v3 offset:1280
  v_smfmac_f32_16x16x64_bf16 v[96:99], v[60:63], v[160:167], v1
  ds_read_b64_tr_b16 v[120:121], v3 offset:2048
  ds_read_b64_tr_b16 v[122:123], v3 offset:2304
  v_smfmac_f32_16x16x64_bf16 v[100:103], v[60:63], v[224:231], v1
  ds_read_b64_tr_b16 v[124:125], v3 offset:3072
  ds_read_b64_tr_b16 v[126:127], v3 offset:3328
  v_smfmac_f32_16x16x64_bf16 v[96:99], v[64:67], v[168:175], v1
  ds_read_b128 v[52:55], v0 offset:22528
  v_smfmac_f32_16x16x64_bf16 v[100:103], v[64:67], v[232:239], v1
  ds_read_b128 v[56:59], v0 offset:23552
  s_waitcnt lgkmcnt(8)
  v_mfma_f32_16x16x32_bf16 v[80:83], v[88:91], v[112:115], 0
  s_waitcnt lgkmcnt(6)
  v_mfma_f32_16x16x32_bf16 v[80:83], v[92:95], v[116:119], v[80:83]
  ds_read_b128 v[60:63], v11 offset:8192
  s_waitcnt lgkmcnt(5)
  v_mfma_f32_16x16x32_bf16 v[80:83], v[104:107], v[120:123], v[80:83]
  ds_read_b128 v[64:67], v11 offset:9216
  s_waitcnt lgkmcnt(4)
  v_mfma_f32_16x16x32_bf16 v[80:83], v[108:111], v[124:127], v[80:83]
  ds_read_b128 v[108:111], v12 offset:32768
  v_mfma_f32_16x16x32_bf16 v[88:91], v[112:115], v[112:115], 0
  ds_read_b128 v[92:95], v12 offset:33792
  v_mfma_f32_16x16x32_bf16 v[88:91], v[116:119], v[116:119], v[88:91]
  v_mfma_f32_16x16x32_bf16 v[88:91], v[120:123], v[120:123], v[88:91]
  v_mfma_f32_16x16x32_bf16 v[88:91], v[124:127], v[124:127], v[88:91]
  s_nop 1
  v_exp_f32 v78, v80
  v_mfma_f32_16x16x32_bf16 v[84:87], v[44:47], v[112:115], 0
  v_exp_f32 v79, v81
  ds_read_b128 v[44:47], v11 offset:4096
  v_mfma_f32_16x16x32_bf16 v[84:87], v[48:51], v[116:119], v[84:87]
  ds_read_b128 v[48:51], v11 offset:5120
  v_cvt_pk_bf16_f32 v104, v78, v79
  v_exp_f32 v78, v82
  s_waitcnt lgkmcnt(7)
  v_mfma_f32_16x16x32_bf16 v[84:87], v[52:55], v[120:123], v[84:87]
  ds_read_b128 v[52:55], v11 offset:6144
  v_exp_f32 v79, v83
  s_waitcnt lgkmcnt(7)
  v_mfma_f32_16x16x32_bf16 v[84:87], v[56:59], v[124:127], v[84:87]
  ds_read_b128 v[56:59], v11 offset:7168
  v_cvt_pk_bf16_f32 v105, v78, v79
  v_max3_f32 v76, |v80|, |v81|, |v82|
  v_smfmac_f32_16x16x64_bf16 v[96:99], v[68:71], v[176:183], v1
  v_mul_f32 v90, s24, v90
  v_mul_f32 v91, s24, v91
  v_smfmac_f32_16x16x64_bf16 v[100:103], v[68:71], v[240:247], v1
  v_exp_f32 v88, v90
  v_exp_f32 v89, v91
  v_max3_f32 v76, v76, |v83|, v90
  ds_read_b128 v[68:71], v11 offset:10240
  v_smfmac_f32_16x16x64_bf16 v[96:99], v[72:75], v[184:191], v1
  v_cvt_pk_bf16_f32 v38, v88, v89
  v_cvt_pk_bf16_f32 v41, v88, v89
  v_smfmac_f32_16x16x64_bf16 v[100:103], v[72:75], v[248:255], v1
  ds_read_b128 v[72:75], v11 offset:11264
  v_max3_f32 v77, |v84|, |v85|, v91
  v_max3_f32 v76, v76, |v86|, |v87|
  v_max_f32 v76, v76, v77
  v_cmp_lt_f32 vcc, 0x42700000, v76
  v_exp_f32 v78, v84
  v_exp_f32 v79, v85
  s_nop 0
  v_cvt_pk_bf16_f32 v106, v78, v79
  v_exp_f32 v78, v86
  v_exp_f32 v79, v87
  s_nop 0
  v_cvt_pk_bf16_f32 v107, v78, v79
  s_and_b64 vcc, vcc, s[60:61]
  s_cbranch_scc1 L_rec_fb_f3
L_rec_fbret_f3:
  s_waitcnt lgkmcnt(6)
  v_add_f32 v96, v96, v98
  v_add_f32 v97, v97, v99
  v_mfma_f32_16x16x32_bf16 v[112:115], v[32:35], v[104:107], 0
  v_add_f32 v100, v100, v102
  v_mfma_f32_16x16x32_bf16 v[80:83], v[108:111], v[104:107], 0
  v_add_f32 v101, v101, v103
  v_mfma_f32_16x16x32_bf16 v[84:87], v[92:95], v[104:107], 0
  v_cvt_pk_bf16_f32 v42, v96, v97
  v_cvt_pk_bf16_f32 v43, v100, v101
  v_mfma_f32_16x16x16_bf16 v[112:115], v[32:33], v[38:39], v[112:115]
  ds_write2_b32 v13, v42, v43 offset0:0 offset1:64
  v_mfma_f32_16x16x16_bf16 v[80:83], v[42:43], v[38:39], v[80:83]
  v_mfma_f32_16x16x16_bf16 v[84:87], v[42:43], v[40:41], v[84:87]
  v_mov_b64 v[96:97], 0
  v_mov_b64 v[98:99], 0
  v_mov_b64 v[100:101], 0
  v_mov_b64 v[102:103], 0
  s_nop 0
  v_rcp_f32 v77, v112
  ds_read_b128 v[112:115], v11 offset:12288
  ds_read_b128 v[116:119], v11 offset:13312
  s_mov_b64 exec, s[60:61]
  v_mul_f32 v80, v80, v77
  v_mul_f32 v81, v81, v77
  v_mul_f32 v82, v82, v77
  v_mul_f32 v83, v83, v77
  v_cvt_pk_bf16_f32 v78, v80, v81
  v_cvt_pk_bf16_f32 v79, v82, v83
  ds_write_b64 v5, v[78:79]
  v_mul_f32 v84, v84, v77
  v_mul_f32 v85, v85, v77
  v_mul_f32 v86, v86, v77
  v_mul_f32 v87, v87, v77
  v_cvt_pk_bf16_f32 v76, v84, v85
  v_cvt_pk_bf16_f32 v77, v86, v87
  ds_write_b64 v5, v[76:77] offset:512
  s_mov_b64 exec, -1
  v_mfma_f32_32x32x8_bf16 v[80:95], v[36:37], v[36:37], 0
  v_mov_b64 v[104:105], 0
  v_mov_b64 v[106:107], 0
  v_mov_b64 v[108:109], 0
  v_mov_b64 v[110:111], 0
  s_waitcnt lgkmcnt(0)
  s_barrier
  ds_read_b128 v[120:123], v0 offset:45056
  ds_read_b128 v[124:127], v0 offset:46080
  s_waitcnt lgkmcnt(1)
  s_nop 0
  v_smfmac_f32_16x16x64_bf16 v[80:83], v[120:123], v[44:51], v1
  s_waitcnt lgkmcnt(0)
  v_smfmac_f32_16x16x64_bf16 v[80:83], v[124:127], v[52:59], v1
  ds_read_b128 v[44:47], v11 offset:24576
  v_smfmac_f32_16x16x64_bf16 v[84:87], v[120:123], v[60:67], v1
  ds_read_b128 v[48:51], v11 offset:25600
  v_smfmac_f32_16x16x64_bf16 v[84:87], v[124:127], v[68:75], v1
  ds_read_b128 v[52:55], v11 offset:26624
  v_smfmac_f32_16x16x64_bf16 v[88:91], v[120:123], v[112:119], v1
  ds_read_b128 v[56:59], v11 offset:27648
  v_smfmac_f32_16x16x64_bf16 v[88:91], v[124:127], v[16:23], v1
  ds_read_b128 v[60:63], v11 offset:28672
  v_add_f32 v80, v80, v82
  v_add_f32 v81, v81, v83
  v_cvt_pk_bf16_f32 v76, v80, v81
  v_and_or_b32 v76, v76, -2, 0
  v_smfmac_f32_16x16x64_bf16 v[92:95], v[120:123], v[24:31], v1
  ds_read_b128 v[64:67], v11 offset:29696
  v_smfmac_f32_16x16x64_bf16 v[92:95], v[124:127], a[128:135], v1
  ds_read_b128 v[68:71], v11 offset:30720
  v_add_f32 v84, v84, v86
  v_add_f32 v85, v85, v87
  v_cvt_pk_bf16_f32 v77, v84, v85
  v_smfmac_f32_16x16x64_bf16 v[96:99], v[120:123], a[192:199], v1
  ds_read_b128 v[72:75], v11 offset:31744
  v_smfmac_f32_16x16x64_bf16 v[96:99], v[124:127], a[136:143], v1
  v_add_f32 v88, v88, v90
  v_add_f32 v89, v89, v91
  v_cvt_pk_bf16_f32 v78, v88, v89
  v_smfmac_f32_16x16x64_bf16 v[100:103], v[120:123], a[200:207], v1
  v_smfmac_f32_16x16x64_bf16 v[100:103], v[124:127], a[0:7], v1
  v_add_f32 v92, v92, v94
  v_add_f32 v93, v93, v95
  v_cvt_pk_bf16_f32 v79, v92, v93
  global_store_dwordx4 v6, v[76:79], s[32:33]
  s_waitcnt lgkmcnt(6)
  v_smfmac_f32_16x16x64_bf16 v[104:107], v[120:123], v[44:51], v1
  s_waitcnt lgkmcnt(4)
  v_smfmac_f32_16x16x64_bf16 v[104:107], v[124:127], v[52:59], v1
  v_add_f32 v96, v96, v98
  v_add_f32 v97, v97, v99
  v_cvt_pk_bf16_f32 v80, v96, v97
  v_and_or_b32 v80, v80, -2, 0
  s_waitcnt lgkmcnt(2)
  v_smfmac_f32_16x16x64_bf16 v[108:111], v[120:123], v[60:67], v1
  s_waitcnt lgkmcnt(0)
  v_smfmac_f32_16x16x64_bf16 v[108:111], v[124:127], v[68:75], v1
  v_add_f32 v100, v100, v102
  v_add_f32 v101, v101, v103
  v_cvt_pk_bf16_f32 v81, v100, v101
  v_add_f32 v104, v104, v106
  v_add_f32 v105, v105, v107
  v_cvt_pk_bf16_f32 v82, v104, v105
  s_nop 1
  v_add_f32 v108, v108, v110
  v_add_f32 v109, v109, v111
  v_cvt_pk_bf16_f32 v83, v108, v109
  global_store_dwordx4 v6, v[80:83], s[34:35]
  s_lshl_b32 s54, s21, 10
  v_add_u32 v116, s54, v3
  ds_read_b64_tr_b16 v[112:113], v116
  ds_read_b64_tr_b16 v[114:115], v116 offset:256
  s_mov_b64 exec, s[60:61]
  ds_read_b128 v[112:115], v10
  s_mov_b64 exec, -1
  v_cndmask_b32 v60, 0, v14, s[8:9]
  v_cndmask_b32 v61, 0, v14, s[10:11]
  v_cndmask_b32 v62, 0, v14, s[12:13]
  v_cndmask_b32 v63, 0, v14, s[14:15]
  v_mfma_f32_32x32x8_bf16 v[80:95], v[36:37], v[36:37], 0
  v_mov_b64 v[96:97], 0
  v_mov_b64 v[98:99], 0
  v_mov_b64 v[100:101], 0
  v_mov_b64 v[102:103], 0
  ds_read_b128 v[104:107], v11 offset:20480
  ds_read_b128 v[108:111], v11 offset:21504
  ds_read_b128 v[120:123], v11 offset:22528
  ds_read_b128 v[124:127], v11 offset:23552
  ds_read_b128 v[52:55], v11 offset:14336
  ds_read_b128 v[56:59], v11 offset:15360
  ds_read_b128 v[68:71], v11 offset:18432
  ds_read_b128 v[72:75], v11 offset:19456
  v_mov_b32 v116, -1
  s_waitcnt lgkmcnt(8)
  v_min_u32 v112, -2, v112
  s_cmp_lt_u32 s21, 2
  s_cbranch_scc1 Lz_112
  s_nop 3
  s_nop 3
  s_nop 3
  s_nop 3
  s_nop 3
  s_nop 3
  s_nop 3
  s_nop 3
  s_nop 3
  s_nop 3
Lz_112:
  s_nop 3
  s_nop 3
  s_nop 3
  s_mov_b32 s27, 0
L_p2_f3:
  global_load_dwordx4 v[44:47], v8, s[38:39] sc1
  global_load_dwordx4 v[48:51], v8, s[38:39] offset:1024 sc1
  s_add_u32 s27, s27, 1
  s_cmp_gt_u32 s27, 0x400000
  s_cbranch_scc1 L_end
  s_waitcnt vmcnt(1)
  v_mfma_f32_16x16x32_bf16 v[64:67], v[44:47], v[60:63], 0
  s_waitcnt vmcnt(0)
  v_mfma_f32_16x16x32_bf16 v[64:67], v[48:51], v[60:63], v[64:67]
  v_or_b32 v117, v44, v48
  v_and_b32 v117, 1, v117
  v_cmp_ne_u32 vcc, 0, v117
  s_cbranch_vccnz L_p2_f3
  s_nop 3
  v_permlane32_swap_b32 v64, v66
  v_permlane32_swap_b32 v65, v67
  v_add_f32 v64, v64, v66
  v_add_f32 v65, v65, v67
  v_mov_b32 v66, v64
  v_mov_b32 v67, v65
  s_nop 0
  v_permlane16_swap_b32 v64, v66
  v_permlane16_swap_b32 v65, v67
  v_add_f32 v64, v64, v66
  v_add_f32 v65, v65, v67
  v_cvt_pk_bf16_f32 v64, v64, v65
  v_min_u32 v64, -2, v64
  global_store_dword v7, v64, s[46:47]
  ds_read_b128 v[60:63], v11 offset:16384
  ds_read_b128 v[64:67], v11 offset:17408
  v_xor_b32 v76, 2048, v12
  v_xor_b32 v77, 4096, v12
  v_xor_b32 v78, 6144, v12
  s_cmp_ge_u32 s21, 2
  s_cbranch_scc1 Lz_113
  s_nop 3
  s_nop 3
  s_nop 3
  s_nop 3
  s_nop 3
  s_nop 3
  s_nop 3
  s_nop 3
  s_nop 3
  s_nop 3
Lz_113:
  s_nop 3
  s_nop 3
  s_nop 3
  s_nop 3
  s_nop 3
  s_mov_b32 s27, 0
L_p3_f3:
  global_load_dwordx4 v[44:47], v12, s[82:83] sc1
  global_load_dwordx4 v[48:51], v12, s[82:83] offset:1024 sc1
  s_add_u32 s27, s27, 1
  s_cmp_gt_u32 s27, 0x400000
  s_cbranch_scc1 L_end
L_p3b_f3:
  s_waitcnt vmcnt(1)
  ds_write_b128 v12, v[44:47] offset:0
  v_max3_u32 v117, v44, v45, v46
  s_waitcnt vmcnt(0)
  ds_write_b128 v12, v[48:51] offset:1024
  v_max3_u32 v118, v47, v48, v49
  v_max3_u32 v117, v117, v50, v51
  v_max_u32 v117, v117, v118
  v_cmp_eq_u32 vcc, -1, v117
  s_cbranch_vccnz L_p3_f3
L_rec_acc_f3:
L_rec_join_f3:
  s_add_u32 s22, s22, 1
  s_branch L_rec_step_f0
L_rec_fb_f0:
  v_max3_f32 v76, v80, v81, v82
  v_max3_f32 v77, v83, v84, v85
  v_max3_f32 v76, v76, v86, v87
  v_max3_f32 v76, v76, v90, v91
  v_max_f32 v76, v76, v77
  v_mov_b32 v77, v76
  s_nop 1
  v_permlane16_swap_b32 v76, v77
  v_max_f32 v76, v76, v77
  v_mov_b32 v77, v76
  s_nop 1
  v_permlane32_swap_b32 v76, v77
  v_max_f32 v76, v76, v77
  v_sub_f32 v80, v80, v76
  v_sub_f32 v81, v81, v76
  v_sub_f32 v82, v82, v76
  v_sub_f32 v83, v83, v76
  v_sub_f32 v84, v84, v76
  v_sub_f32 v85, v85, v76
  v_sub_f32 v86, v86, v76
  v_sub_f32 v87, v87, v76
  v_sub_f32 v90, v90, v76
  v_sub_f32 v91, v91, v76
  v_exp_f32 v78, v80
  v_exp_f32 v79, v81
  s_nop 0
  v_cvt_pk_bf16_f32 v104, v78, v79
  v_exp_f32 v78, v82
  v_exp_f32 v79, v83
  s_nop 0
  v_cvt_pk_bf16_f32 v105, v78, v79
  v_exp_f32 v78, v84
  v_exp_f32 v79, v85
  s_nop 0
  v_cvt_pk_bf16_f32 v106, v78, v79
  v_exp_f32 v78, v86
  v_exp_f32 v79, v87
  s_nop 0
  v_cvt_pk_bf16_f32 v107, v78, v79
  v_exp_f32 v88, v90
  v_exp_f32 v89, v91
  s_nop 0
  v_cvt_pk_bf16_f32 v38, v88, v89
  v_cvt_pk_bf16_f32 v41, v88, v89
  s_nop 1
  s_branch L_rec_fbret_f0
L_rec_fb_f1:
  v_max3_f32 v76, v80, v81, v82
  v_max3_f32 v77, v83, v84, v85
  v_max3_f32 v76, v76, v86, v87
  v_max3_f32 v76, v76, v90, v91
  v_max_f32 v76, v76, v77
  v_mov_b32 v77, v76
  s_nop 1
  v_permlane16_swap_b32 v76, v77
  v_max_f32 v76, v76, v77
  v_mov_b32 v77, v76
  s_nop 1
  v_permlane32_swap_b32 v76, v77
  v_max_f32 v76, v76, v77
  v_sub_f32 v80, v80, v76
  v_sub_f32 v81, v81, v76
  v_sub_f32 v82, v82, v76
  v_sub_f32 v83, v83, v76
  v_sub_f32 v84, v84, v76
  v_sub_f32 v85, v85, v76
  v_sub_f32 v86, v86, v76
  v_sub_f32 v87, v87, v76
  v_sub_f32 v90, v90, v76
  v_sub_f32 v91, v91, v76
  v_exp_f32 v78, v80
  v_exp_f32 v79, v81
  s_nop 0
  v_cvt_pk_bf16_f32 v104, v78, v79
  v_exp_f32 v78, v82
  v_exp_f32 v79, v83
  s_nop 0
  v_cvt_pk_bf16_f32 v105, v78, v79
  v_exp_f32 v78, v84
  v_exp_f32 v79, v85
  s_nop 0
  v_cvt_pk_bf16_f32 v106, v78, v79
  v_exp_f32 v78, v86
  v_exp_f32 v79, v87
  s_nop 0
  v_cvt_pk_bf16_f32 v107, v78, v79
  v_exp_f32 v88, v90
  v_exp_f32 v89, v91
  s_nop 0
  v_cvt_pk_bf16_f32 v38, v88, v89
  v_cvt_pk_bf16_f32 v41, v88, v89
  s_nop 1
  s_branch L_rec_fbret_f1
L_rec_fb_f2:
  v_max3_f32 v76, v80, v81, v82
  v_max3_f32 v77, v83, v84, v85
  v_max3_f32 v76, v76, v86, v87
  v_max3_f32 v76, v76, v90, v91
  v_max_f32 v76, v76, v77
  v_mov_b32 v77, v76
  s_nop 1
  v_permlane16_swap_b32 v76, v77
  v_max_f32 v76, v76, v77
  v_mov_b32 v77, v76
  s_nop 1
  v_permlane32_swap_b32 v76, v77
  v_max_f32 v76, v76, v77
  v_sub_f32 v80, v80, v76
  v_sub_f32 v81, v81, v76
  v_sub_f32 v82, v82, v76
  v_sub_f32 v83, v83, v76
  v_sub_f32 v84, v84, v76
  v_sub_f32 v85, v85, v76
  v_sub_f32 v86, v86, v76
  v_sub_f32 v87, v87, v76
  v_sub_f32 v90, v90, v76
  v_sub_f32 v91, v91, v76
  v_exp_f32 v78, v80
  v_exp_f32 v79, v81
  s_nop 0
  v_cvt_pk_bf16_f32 v104, v78, v79
  v_exp_f32 v78, v82
  v_exp_f32 v79, v83
  s_nop 0
  v_cvt_pk_bf16_f32 v105, v78, v79
  v_exp_f32 v78, v84
  v_exp_f32 v79, v85
  s_nop 0
  v_cvt_pk_bf16_f32 v106, v78, v79
  v_exp_f32 v78, v86
  v_exp_f32 v79, v87
  s_nop 0
  v_cvt_pk_bf16_f32 v107, v78, v79
  v_exp_f32 v88, v90
  v_exp_f32 v89, v91
  s_nop 0
  v_cvt_pk_bf16_f32 v38, v88, v89
  v_cvt_pk_bf16_f32 v41, v88, v89
  s_nop 1
  s_branch L_rec_fbret_f2
L_rec_fb_f3:
  v_max3_f32 v76, v80, v81, v82
  v_max3_f32 v77, v83, v84, v85
  v_max3_f32 v76, v76, v86, v87
  v_max3_f32 v76, v76, v90, v91
  v_max_f32 v76, v76, v77
  v_mov_b32 v77, v76
  s_nop 1
  v_permlane16_swap_b32 v76, v77
  v_max_f32 v76, v76, v77
  v_mov_b32 v77, v76
  s_nop 1
  v_permlane32_swap_b32 v76, v77
  v_max_f32 v76, v76, v77
  v_sub_f32 v80, v80, v76
  v_sub_f32 v81, v81, v76
  v_sub_f32 v82, v82, v76
  v_sub_f32 v83, v83, v76
  v_sub_f32 v84, v84, v76
  v_sub_f32 v85, v85, v76
  v_sub_f32 v86, v86, v76
  v_sub_f32 v87, v87, v76
  v_sub_f32 v90, v90, v76
  v_sub_f32 v91, v91, v76
  v_exp_f32 v78, v80
  v_exp_f32 v79, v81
  s_nop 0
  v_cvt_pk_bf16_f32 v104, v78, v79
  v_exp_f32 v78, v82
  v_exp_f32 v79, v83
  s_nop 0
  v_cvt_pk_bf16_f32 v105, v78, v79
  v_exp_f32 v78, v84
  v_exp_f32 v79, v85
  s_nop 0
  v_cvt_pk_bf16_f32 v106, v78, v79
  v_exp_f32 v78, v86
  v_exp_f32 v79, v87
  s_nop 0
  v_cvt_pk_bf16_f32 v107, v78, v79
  v_exp_f32 v88, v90
  v_exp_f32 v89, v91
  s_nop 0
  v_cvt_pk_bf16_f32 v38, v88, v89
  v_cvt_pk_bf16_f32 v41, v88, v89
  s_nop 1
  s_branch L_rec_fbret_f3
L_rec_step_s0:
  s_waitcnt lgkmcnt(2)
  v_smfmac_f32_16x16x64_bf16 v[88:91], v[44:47], v[52:59], v1
  v_smfmac_f32_16x16x64_bf16 v[92:95], v[44:47], v[60:67], v1
  v_smfmac_f32_16x16x64_bf16 v[88:91], v[48:51], v[68:75], v1
  s_waitcnt lgkmcnt(0)
  s_barrier
  ds_read_b128 v[52:55], v76 offset:0
  ds_read_b128 v[56:59], v76 offset:1024
  v_smfmac_f32_16x16x64_bf16 v[92:95], v[48:51], v[104:111], v1
  ds_read_b128 v[60:63], v77 offset:0
  v_smfmac_f32_16x16x64_bf16 v[80:83], v[44:47], v[120:127], v1
  ds_read_b128 v[64:67], v77 offset:1024
  v_smfmac_f32_16x16x64_bf16 v[84:87], v[44:47], a[64:71], v1
  ds_read_b128 v[68:71], v78 offset:0
  v_smfmac_f32_16x16x64_bf16 v[80:83], v[48:51], a[8:15], v1
  ds_read_b128 v[72:75], v78 offset:1024
  v_smfmac_f32_16x16x64_bf16 v[84:87], v[48:51], a[72:79], v1
  global_store_dwordx4 v9, v[112:115], s[50:51] sc1
  s_waitcnt lgkmcnt(5)
  v_smfmac_f32_16x16x64_bf16 v[88:91], v[52:55], a[144:151], v1
  s_mov_b32 m0, s59
  v_smfmac_f32_16x16x64_bf16 v[92:95], v[52:55], a[208:215], v1
  global_load_lds_dwordx4 v15, s[16:17] offset:0 sc1
  s_waitcnt lgkmcnt(4)
  v_smfmac_f32_16x16x64_bf16 v[88:91], v[56:59], a[152:159], v1
  v_smfmac_f32_16x16x64_bf16 v[92:95], v[56:59], a[216:223], v1
  global_load_lds_dwordx4 v15, s[16:17] offset:1024 sc1
  s_waitcnt lgkmcnt(3)
  v_smfmac_f32_16x16x64_bf16 v[88:91], v[60:63], a[160:167], v1
  v_smfmac_f32_16x16x64_bf16 v[92:95], v[60:63], a[224:231], v1
  global_load_lds_dwordx4 v15, s[16:17] offset:2048 sc1
  s_waitcnt lgkmcnt(2)
  v_smfmac_f32_16x16x64_bf16 v[88:91], v[64:67], a[168:175], v1
  v_smfmac_f32_16x16x64_bf16 v[92:95], v[64:67], a[232:239], v1
  global_load_lds_dwordx4 v15, s[16:17] offset:3072 sc1
  v_add_u32 v15, 0x40000, v15
  s_waitcnt lgkmcnt(1)
  v_smfmac_f32_16x16x64_bf16 v[88:91], v[68:71], a[176:183], v1
  global_store_dword v7, v116, s[42:43] sc1
  v_add_u32 v9, 0x20000, v9
  v_smfmac_f32_16x16x64_bf16 v[92:95], v[68:71], a[240:247], v1
  s_waitcnt vmcnt(6)
  ds_read_b128 v[104:107], v0 offset:10240
  s_waitcnt lgkmcnt(1)
  v_smfmac_f32_16x16x64_bf16 v[88:91], v[72:75], a[184:191], v1
  v_smfmac_f32_16x16x64_bf16 v[92:95], v[72:75], a[248:255], v1
  ds_read_b128 v[108:111], v0 offset:11264
  v_smfmac_f32_16x16x64_bf16 v[80:83], v[52:55], a[16:23], v1
  v_smfmac_f32_16x16x64_bf16 v[84:87], v[52:55], a[80:87], v1
  v_smfmac_f32_16x16x64_bf16 v[80:83], v[56:59], a[24:31], v1
  v_smfmac_f32_16x16x64_bf16 v[84:87], v[56:59], a[88:95], v1
  v_smfmac_f32_16x16x64_bf16 v[80:83], v[60:63], a[32:39], v1
  v_smfmac_f32_16x16x64_bf16 v[84:87], v[60:63], a[96:103], v1
  v_smfmac_f32_16x16x64_bf16 v[80:83], v[64:67], a[40:47], v1
  v_smfmac_f32_16x16x64_bf16 v[84:87], v[64:67], a[104:111], v1
  v_add_f32 v88, v88, v90
  v_add_f32 v89, v89, v91
  v_smfmac_f32_16x16x64_bf16 v[80:83], v[68:71], a[48:55], v1
  v_add_f32 v92, v92, v94
  v_add_f32 v93, v93, v95
  v_smfmac_f32_16x16x64_bf16 v[84:87], v[68:71], a[112:119], v1
  v_cvt_pk_bf16_f32 v78, v88, v89
  v_cvt_pk_bf16_f32 v79, v92, v93
  v_smfmac_f32_16x16x64_bf16 v[80:83], v[72:75], a[56:63], v1
  ds_write2_b32 v2, v78, v79 offset0:1 offset1:129
  ds_read_b128 v[88:91], v0 offset:8192
  v_smfmac_f32_16x16x64_bf16 v[84:87], v[72:75], a[120:127], v1
  ds_read_b128 v[92:95], v0 offset:9216
  v_smfmac_f32_16x16x64_bf16 v[96:99], v[44:47], v[128:135], v1
  v_smfmac_f32_16x16x64_bf16 v[100:103], v[44:47], v[192:199], v1
  ds_read_b128 v[44:47], v0 offset:12288
  s_nop 4
  v_add_f32 v80, v80, v82
  v_add_f32 v81, v81, v83
  v_add_f32 v84, v84, v86
  v_add_f32 v85, v85, v87
  v_cvt_pk_bf16_f32 v76, v80, v81
  v_cvt_pk_bf16_f32 v77, v84, v85
  ds_write2_b32 v2, v76, v77 offset0:0 offset1:128
  v_smfmac_f32_16x16x64_bf16 v[96:99], v[48:51], v[136:143], v1
  v_smfmac_f32_16x16x64_bf16 v[100:103], v[48:51], v[200:207], v1
  ds_read_b128 v[48:51], v0 offset:13312
  v_smfmac_f32_16x16x64_bf16 v[96:99], v[52:55], v[144:151], v1
  v_smfmac_f32_16x16x64_bf16 v[100:103], v[52:55], v[208:215], v1
  v_smfmac_f32_16x16x64_bf16 v[96:99], v[56:59], v[152:159], v1
  s_waitcnt vmcnt(6)
  s_waitcnt lgkmcnt(1)
  s_barrier
  ds_read_b64_tr_b16 v[112:113], v3 offset:0
  ds_read_b64_tr_b16 v[114:115], v3 offset:256
  v_smfmac_f32_16x16x64_bf16 v[100:103], v[56:59], v[216:223], v1
  ds_read_b64_tr_b16 v[116:117], v3 offset:1024
  ds_read_b64_tr_b16 v[118:119], v3 offset:1280
  v_smfmac_f32_16x16x64_bf16 v[96:99], v[60:63], v[160:167], v1
  ds_read_b64_tr_b16 v[120:121], v3 offset:2048
  ds_read_b64_tr_b16 v[122:123], v3 offset:2304
  v_smfmac_f32_16x16x64_bf16 v[100:103], v[60:63], v[224:231], v1
  ds_read_b64_tr_b16 v[124:125], v3 offset:3072
  ds_read_b64_tr_b16 v[126:127], v3 offset:3328
  v_smfmac_f32_16x16x64_bf16 v[96:99], v[64:67], v[168:175], v1
  ds_read_b128 v[52:55], v0 offset:14336
  v_smfmac_f32_16x16x64_bf16 v[100:103], v[64:67], v[232:239], v1
  ds_read_b128 v[56:59], v0 offset:15360
  s_waitcnt lgkmcnt(8)
  v_mfma_f32_16x16x32_bf16 v[80:83], v[88:91], v[112:115], 0
  s_waitcnt lgkmcnt(6)
  v_mfma_f32_16x16x32_bf16 v[80:83], v[92:95], v[116:119], v[80:83]
  ds_read_b128 v[60:63], v11 offset:8192
  s_waitcnt lgkmcnt(5)
  v_mfma_f32_16x16x32_bf16 v[80:83], v[104:107], v[120:123], v[80:83]
  ds_read_b128 v[64:67], v11 offset:9216
  s_waitcnt lgkmcnt(4)
  v_mfma_f32_16x16x32_bf16 v[80:83], v[108:111], v[124:127], v[80:83]
  ds_read_b128 v[108:111], v12 offset:24576
  v_mfma_f32_16x16x32_bf16 v[88:91], v[112:115], v[112:115], 0
  ds_read_b128 v[92:95], v12 offset:25600
  v_mfma_f32_16x16x32_bf16 v[88:91], v[116:119], v[116:119], v[88:91]
  v_mfma_f32_16x16x32_bf16 v[88:91], v[120:123], v[120:123], v[88:91]
  v_mfma_f32_16x16x32_bf16 v[88:91], v[124:127], v[124:127], v[88:91]
  s_nop 1
  v_exp_f32 v78, v80
  v_mfma_f32_16x16x32_bf16 v[84:87], v[44:47], v[112:115], 0
  v_exp_f32 v79, v81
  ds_read_b128 v[44:47], v11 offset:4096
  v_mfma_f32_16x16x32_bf16 v[84:87], v[48:51], v[116:119], v[84:87]
  ds_read_b128 v[48:51], v11 offset:5120
  v_cvt_pk_bf16_f32 v104, v78, v79
  v_exp_f32 v78, v82
  s_waitcnt lgkmcnt(7)
  v_mfma_f32_16x16x32_bf16 v[84:87], v[52:55], v[120:123], v[84:87]
  ds_read_b128 v[52:55], v11 offset:6144
  v_exp_f32 v79, v83
  s_waitcnt lgkmcnt(7)
  v_mfma_f32_16x16x32_bf16 v[84:87], v[56:59], v[124:127], v[84:87]
  ds_read_b128 v[56:59], v11 offset:7168
  v_cvt_pk_bf16_f32 v105, v78, v79
  v_max3_f32 v76, |v80|, |v81|, |v82|
  v_smfmac_f32_16x16x64_bf16 v[96:99], v[68:71], v[176:183], v1
  v_mul_f32 v90, s24, v90
  v_mul_f32 v91, s24, v91
  v_smfmac_f32_16x16x64_bf16 v[100:103], v[68:71], v[240:247], v1
  v_exp_f32 v88, v90
  v_exp_f32 v89, v91
  v_max3_f32 v76, v76, |v83|, v90
  ds_read_b128 v[68:71], v11 offset:10240
  v_smfmac_f32_16x16x64_bf16 v[96:99], v[72:75], v[184:191], v1
  v_cvt_pk_bf16_f32 v38, v88, v89
  v_cvt_pk_bf16_f32 v41, v88, v89
  v_smfmac_f32_16x16x64_bf16 v[100:103], v[72:75], v[248:255], v1
  ds_read_b128 v[72:75], v11 offset:11264
  v_max3_f32 v77, |v84|, |v85|, v91
  v_max3_f32 v76, v76, |v86|, |v87|
  v_max_f32 v76, v76, v77
  v_cmp_lt_f32 vcc, 0x42700000, v76
  v_exp_f32 v78, v84
  v_exp_f32 v79, v85
  s_nop 0
  v_cvt_pk_bf16_f32 v106, v78, v79
  v_exp_f32 v78, v86
  v_exp_f32 v79, v87
  s_nop 0
  v_cvt_pk_bf16_f32 v107, v78, v79
  s_and_b64 vcc, vcc, s[60:61]
  s_cbranch_scc1 L_rec_fb_s0
L_rec_fbret_s0:
  s_waitcnt lgkmcnt(6)
  v_add_f32 v96, v96, v98
  v_add_f32 v97, v97, v99
  v_mfma_f32_16x16x32_bf16 v[112:115], v[32:35], v[104:107], 0
  v_add_f32 v100, v100, v102
  v_mfma_f32_16x16x32_bf16 v[80:83], v[108:111], v[104:107], 0
  v_add_f32 v101, v101, v103
  v_mfma_f32_16x16x32_bf16 v[84:87], v[92:95], v[104:107], 0
  v_cvt_pk_bf16_f32 v42, v96, v97
  v_cvt_pk_bf16_f32 v43, v100, v101
  v_mfma_f32_16x16x16_bf16 v[112:115], v[32:33], v[38:39], v[112:115]
  ds_write2_b32 v13, v42, v43 offset0:0 offset1:64
  v_mfma_f32_16x16x16_bf16 v[80:83], v[42:43], v[38:39], v[80:83]
  v_mfma_f32_16x16x16_bf16 v[84:87], v[42:43], v[40:41], v[84:87]
  v_mov_b64 v[96:97], 0
  v_mov_b64 v[98:99], 0
  v_mov_b64 v[100:101], 0
  v_mov_b64 v[102:103], 0
  s_nop 0
  v_rcp_f32 v77, v112
  ds_read_b128 v[112:115], v11 offset:12288
  ds_read_b128 v[116:119], v11 offset:13312
  s_mov_b64 exec, s[60:61]
  v_mul_f32 v80, v80, v77
  v_mul_f32 v81, v81, v77
  v_mul_f32 v82, v82, v77
  v_mul_f32 v83, v83, v77
  v_cvt_pk_bf16_f32 v78, v80, v81
  v_cvt_pk_bf16_f32 v79, v82, v83
  ds_write_b64 v5, v[78:79]
  v_mul_f32 v84, v84, v77
  v_mul_f32 v85, v85, v77
  v_mul_f32 v86, v86, v77
  v_mul_f32 v87, v87, v77
  v_cvt_pk_bf16_f32 v76, v84, v85
  v_cvt_pk_bf16_f32 v77, v86, v87
  ds_write_b64 v5, v[76:77] offset:512
  s_mov_b64 exec, -1
  v_mfma_f32_32x32x8_bf16 v[80:95], v[36:37], v[36:37], 0
  v_mov_b64 v[104:105], 0
  v_mov_b64 v[106:107], 0
  v_mov_b64 v[108:109], 0
  v_mov_b64 v[110:111], 0
  s_waitcnt lgkmcnt(0)
  s_barrier
  ds_read_b128 v[120:123], v0 offset:45056
  ds_read_b128 v[124:127], v0 offset:46080
  s_waitcnt lgkmcnt(1)
  s_nop 0
  v_smfmac_f32_16x16x64_bf16 v[80:83], v[120:123], v[44:51], v1
  s_waitcnt lgkmcnt(0)
  v_smfmac_f32_16x16x64_bf16 v[80:83], v[124:127], v[52:59], v1
  ds_read_b128 v[44:47], v11 offset:24576
  v_smfmac_f32_16x16x64_bf16 v[84:87], v[120:123], v[60:67], v1
  ds_read_b128 v[48:51], v11 offset:25600
  v_smfmac_f32_16x16x64_bf16 v[84:87], v[124:127], v[68:75], v1
  ds_read_b128 v[52:55], v11 offset:26624
  v_smfmac_f32_16x16x64_bf16 v[88:91], v[120:123], v[112:119], v1
  ds_read_b128 v[56:59], v11 offset:27648
  v_smfmac_f32_16x16x64_bf16 v[88:91], v[124:127], v[16:23], v1
  ds_read_b128 v[60:63], v11 offset:28672
  v_add_f32 v80, v80, v82
  v_add_f32 v81, v81, v83
  v_cvt_pk_bf16_f32 v76, v80, v81
  v_and_or_b32 v76, v76, -2, 1
  v_smfmac_f32_16x16x64_bf16 v[92:95], v[120:123], v[24:31], v1
  ds_read_b128 v[64:67], v11 offset:29696
  v_smfmac_f32_16x16x64_bf16 v[92:95], v[124:127], a[128:135], v1
  ds_read_b128 v[68:71], v11 offset:30720
  v_add_f32 v84, v84, v86
  v_add_f32 v85, v85, v87
  v_cvt_pk_bf16_f32 v77, v84, v85
  v_smfmac_f32_16x16x64_bf16 v[96:99], v[120:123], a[192:199], v1
  ds_read_b128 v[72:75], v11 offset:31744
  v_smfmac_f32_16x16x64_bf16 v[96:99], v[124:127], a[136:143], v1
  v_add_f32 v88, v88, v90
  v_add_f32 v89, v89, v91
  v_cvt_pk_bf16_f32 v78, v88, v89
  v_smfmac_f32_16x16x64_bf16 v[100:103], v[120:123], a[200:207], v1
  v_smfmac_f32_16x16x64_bf16 v[100:103], v[124:127], a[0:7], v1
  v_add_f32 v92, v92, v94
  v_add_f32 v93, v93, v95
  v_cvt_pk_bf16_f32 v79, v92, v93
  global_store_dwordx4 v6, v[76:79], s[28:29] sc1
  s_waitcnt lgkmcnt(6)
  v_smfmac_f32_16x16x64_bf16 v[104:107], v[120:123], v[44:51], v1
  s_waitcnt lgkmcnt(4)
  v_smfmac_f32_16x16x64_bf16 v[104:107], v[124:127], v[52:59], v1
  v_add_f32 v96, v96, v98
  v_add_f32 v97, v97, v99
  v_cvt_pk_bf16_f32 v80, v96, v97
  v_and_or_b32 v80, v80, -2, 1
  s_waitcnt lgkmcnt(2)
  v_smfmac_f32_16x16x64_bf16 v[108:111], v[120:123], v[60:67], v1
  s_waitcnt lgkmcnt(0)
  v_smfmac_f32_16x16x64_bf16 v[108:111], v[124:127], v[68:75], v1
  v_add_f32 v100, v100, v102
  v_add_f32 v101, v101, v103
  v_cvt_pk_bf16_f32 v81, v100, v101
  v_add_f32 v104, v104, v106
  v_add_f32 v105, v105, v107
  v_cvt_pk_bf16_f32 v82, v104, v105
  s_nop 1
  v_add_f32 v108, v108, v110
  v_add_f32 v109, v109, v111
  v_cvt_pk_bf16_f32 v83, v108, v109
  global_store_dwordx4 v6, v[80:83], s[30:31] sc1
  s_lshl_b32 s54, s21, 10
  v_add_u32 v116, s54, v3
  ds_read_b64_tr_b16 v[112:113], v116
  ds_read_b64_tr_b16 v[114:115], v116 offset:256
  s_mov_b64 exec, s[60:61]
  ds_read_b128 v[112:115], v10
  s_mov_b64 exec, -1
  v_cndmask_b32 v60, 0, v14, s[8:9]
  v_cndmask_b32 v61, 0, v14, s[10:11]
  v_cndmask_b32 v62, 0, v14, s[12:13]
  v_cndmask_b32 v63, 0, v14, s[14:15]
  v_mfma_f32_32x32x8_bf16 v[80:95], v[36:37], v[36:37], 0
  v_mov_b64 v[96:97], 0
  v_mov_b64 v[98:99], 0
  v_mov_b64 v[100:101], 0
  v_mov_b64 v[102:103], 0
  ds_read_b128 v[104:107], v11 offset:20480
  ds_read_b128 v[108:111], v11 offset:21504
  ds_read_b128 v[120:123], v11 offset:22528
  ds_read_b128 v[124:127], v11 offset:23552
  ds_read_b128 v[52:55], v11 offset:14336
  ds_read_b128 v[56:59], v11 offset:15360
  ds_read_b128 v[68:71], v11 offset:18432
  ds_read_b128 v[72:75], v11 offset:19456
  v_mov_b32 v116, -1
  s_waitcnt lgkmcnt(8)
  v_min_u32 v112, -2, v112
  s_cmp_lt_u32 s21, 2
  s_cbranch_scc1 Lz_114
  s_nop 3
  s_nop 3
  s_nop 3
  s_nop 3
  s_nop 3
  s_nop 3
  s_nop 3
  s_nop 3
  s_nop 3
  s_nop 3
Lz_114:
  s_nop 3
  s_nop 3
  s_nop 3
  s_mov_b32 s27, 0
L_p2_s0:
  global_load_dwordx4 v[44:47], v8, s[36:37] sc1
  global_load_dwordx4 v[48:51], v8, s[36:37] offset:1024 sc1
  s_add_u32 s27, s27, 1
  s_cmp_gt_u32 s27, 0x400000
  s_cbranch_scc1 L_end
  s_waitcnt vmcnt(1)
  v_mfma_f32_16x16x32_bf16 v[64:67], v[44:47], v[60:63], 0
  s_waitcnt vmcnt(0)
  v_mfma_f32_16x16x32_bf16 v[64:67], v[48:51], v[60:63], v[64:67]
  v_and_b32 v117, v44, v48
  v_and_b32 v117, 1, v117
  v_cmp_ne_u32 vcc, 1, v117
  s_cbranch_vccnz L_p2_s0
  s_nop 3
  v_permlane32_swap_b32 v64, v66
  v_permlane32_swap_b32 v65, v67
  v_add_f32 v64, v64, v66
  v_add_f32 v65, v65, v67
  v_mov_b32 v66, v64
  v_mov_b32 v67, v65
  s_nop 0
  v_permlane16_swap_b32 v64, v66
  v_permlane16_swap_b32 v65, v67
  v_add_f32 v64, v64, v66
  v_add_f32 v65, v65, v67
  v_cvt_pk_bf16_f32 v64, v64, v65
  v_min_u32 v64, -2, v64
  global_store_dword v7, v64, s[40:41] sc1
  ds_read_b128 v[60:63], v11 offset:16384
  ds_read_b128 v[64:67], v11 offset:17408
  v_xor_b32 v76, 2048, v12
  v_xor_b32 v77, 4096, v12
  v_xor_b32 v78, 6144, v12
  s_cmp_ge_u32 s21, 2
  s_cbranch_scc1 Lz_115
  s_nop 3
  s_nop 3
  s_nop 3
  s_nop 3
  s_nop 3
  s_nop 3
  s_nop 3
  s_nop 3
  s_nop 3
  s_nop 3
Lz_115:
  s_nop 3
  s_nop 3
  s_nop 3
  s_nop 3
  s_nop 3
  s_mov_b32 s27, 0
L_p3_s0:
  global_load_dwordx4 v[44:47], v12, s[76:77] sc1
  global_load_dwordx4 v[48:51], v12, s[76:77] offset:1024 sc1
  s_add_u32 s27, s27, 1
  s_cmp_gt_u32 s27, 0x400000
  s_cbranch_scc1 L_end
L_p3b_s0:
  s_waitcnt vmcnt(1)
  ds_write_b128 v12, v[44:47] offset:0
  v_max3_u32 v117, v44, v45, v46
  s_waitcnt vmcnt(0)
  ds_write_b128 v12, v[48:51] offset:1024
  v_max3_u32 v118, v47, v48, v49
  v_max3_u32 v117, v117, v50, v51
  v_max_u32 v117, v117, v118
  v_cmp_eq_u32 vcc, -1, v117
  s_cbranch_vccnz L_p3_s0
L_rec_acc_s0:
L_rec_join_s0:
  s_add_u32 s22, s22, 1
L_rec_step_s1:
  s_waitcnt lgkmcnt(2)
  v_smfmac_f32_16x16x64_bf16 v[88:91], v[44:47], v[52:59], v1
  v_smfmac_f32_16x16x64_bf16 v[92:95], v[44:47], v[60:67], v1
  v_smfmac_f32_16x16x64_bf16 v[88:91], v[48:51], v[68:75], v1
  s_waitcnt lgkmcnt(0)
  s_barrier
  ds_read_b128 v[52:55], v76 offset:0
  ds_read_b128 v[56:59], v76 offset:1024
  v_smfmac_f32_16x16x64_bf16 v[92:95], v[48:51], v[104:111], v1
  ds_read_b128 v[60:63], v77 offset:0
  v_smfmac_f32_16x16x64_bf16 v[80:83], v[44:47], v[120:127], v1
  ds_read_b128 v[64:67], v77 offset:1024
  v_smfmac_f32_16x16x64_bf16 v[84:87], v[44:47], a[64:71], v1
  ds_read_b128 v[68:71], v78 offset:0
  v_smfmac_f32_16x16x64_bf16 v[80:83], v[48:51], a[8:15], v1
  ds_read_b128 v[72:75], v78 offset:1024
  v_smfmac_f32_16x16x64_bf16 v[84:87], v[48:51], a[72:79], v1
  global_store_dwordx4 v9, v[112:115], s[50:51] sc1
  s_waitcnt lgkmcnt(5)
  v_smfmac_f32_16x16x64_bf16 v[88:91], v[52:55], a[144:151], v1
  s_mov_b32 m0, s58
  v_smfmac_f32_16x16x64_bf16 v[92:95], v[52:55], a[208:215], v1
  global_load_lds_dwordx4 v15, s[16:17] offset:0 sc1
  s_waitcnt lgkmcnt(4)
  v_smfmac_f32_16x16x64_bf16 v[88:91], v[56:59], a[152:159], v1
  v_smfmac_f32_16x16x64_bf16 v[92:95], v[56:59], a[216:223], v1
  global_load_lds_dwordx4 v15, s[16:17] offset:1024 sc1
  s_waitcnt lgkmcnt(3)
  v_smfmac_f32_16x16x64_bf16 v[88:91], v[60:63], a[160:167], v1
  v_smfmac_f32_16x16x64_bf16 v[92:95], v[60:63], a[224:231], v1
  global_load_lds_dwordx4 v15, s[16:17] offset:2048 sc1
  s_waitcnt lgkmcnt(2)
  v_smfmac_f32_16x16x64_bf16 v[88:91], v[64:67], a[168:175], v1
  v_smfmac_f32_16x16x64_bf16 v[92:95], v[64:67], a[232:239], v1
  global_load_lds_dwordx4 v15, s[16:17] offset:3072 sc1
  v_add_u32 v15, 0x40000, v15
  s_waitcnt lgkmcnt(1)
  v_smfmac_f32_16x16x64_bf16 v[88:91], v[68:71], a[176:183], v1
  global_store_dword v7, v116, s[44:45] sc1
  v_add_u32 v9, 0x20000, v9
  v_smfmac_f32_16x16x64_bf16 v[92:95], v[68:71], a[240:247], v1
  s_waitcnt vmcnt(6)
  ds_read_b128 v[104:107], v0 offset:18432
  s_waitcnt lgkmcnt(1)
  v_smfmac_f32_16x16x64_bf16 v[88:91], v[72:75], a[184:191], v1
  v_smfmac_f32_16x16x64_bf16 v[92:95], v[72:75], a[248:255], v1
  ds_read_b128 v[108:111], v0 offset:19456
  v_smfmac_f32_16x16x64_bf16 v[80:83], v[52:55], a[16:23], v1
  v_smfmac_f32_16x16x64_bf16 v[84:87], v[52:55], a[80:87], v1
  v_smfmac_f32_16x16x64_bf16 v[80:83], v[56:59], a[24:31], v1
  v_smfmac_f32_16x16x64_bf16 v[84:87], v[56:59], a[88:95], v1
  v_smfmac_f32_16x16x64_bf16 v[80:83], v[60:63], a[32:39], v1
  v_smfmac_f32_16x16x64_bf16 v[84:87], v[60:63], a[96:103], v1
  v_smfmac_f32_16x16x64_bf16 v[80:83], v[64:67], a[40:47], v1
  v_smfmac_f32_16x16x64_bf16 v[84:87], v[64:67], a[104:111], v1
  v_add_f32 v88, v88, v90
  v_add_f32 v89, v89, v91
  v_smfmac_f32_16x16x64_bf16 v[80:83], v[68:71], a[48:55], v1
  v_add_f32 v92, v92, v94
  v_add_f32 v93, v93, v95
  v_smfmac_f32_16x16x64_bf16 v[84:87], v[68:71], a[112:119], v1
  v_cvt_pk_bf16_f32 v78, v88, v89
  v_cvt_pk_bf16_f32 v79, v92, v93
  v_smfmac_f32_16x16x64_bf16 v[80:83], v[72:75], a[56:63], v1
  ds_write2_b32 v2, v78, v79 offset0:1 offset1:129
  ds_read_b128 v[88:91], v0 offset:16384
  v_smfmac_f32_16x16x64_bf16 v[84:87], v[72:75], a[120:127], v1
  ds_read_b128 v[92:95], v0 offset:17408
  v_smfmac_f32_16x16x64_bf16 v[96:99], v[44:47], v[128:135], v1
  v_smfmac_f32_16x16x64_bf16 v[100:103], v[44:47], v[192:199], v1
  ds_read_b128 v[44:47], v0 offset:20480
  s_nop 4
  v_add_f32 v80, v80, v82
  v_add_f32 v81, v81, v83
  v_add_f32 v84, v84, v86
  v_add_f32 v85, v85, v87
  v_cvt_pk_bf16_f32 v76, v80, v81
  v_cvt_pk_bf16_f32 v77, v84, v85
  ds_write2_b32 v2, v76, v77 offset0:0 offset1:128
  v_smfmac_f32_16x16x64_bf16 v[96:99], v[48:51], v[136:143], v1
  v_smfmac_f32_16x16x64_bf16 v[100:103], v[48:51], v[200:207], v1
  ds_read_b128 v[48:51], v0 offset:21504
  v_smfmac_f32_16x16x64_bf16 v[96:99], v[52:55], v[144:151], v1
  v_smfmac_f32_16x16x64_bf16 v[100:103], v[52:55], v[208:215], v1
  v_smfmac_f32_16x16x64_bf16 v[96:99], v[56:59], v[152:159], v1
  s_waitcnt vmcnt(6)
  s_waitcnt lgkmcnt(1)
  s_barrier
  ds_read_b64_tr_b16 v[112:113], v3 offset:0
  ds_read_b64_tr_b16 v[114:115], v3 offset:256
  v_smfmac_f32_16x16x64_bf16 v[100:103], v[56:59], v[216:223], v1
  ds_read_b64_tr_b16 v[116:117], v3 offset:1024
  ds_read_b64_tr_b16 v[118:119], v3 offset:1280
  v_smfmac_f32_16x16x64_bf16 v[96:99], v[60:63], v[160:167], v1
  ds_read_b64_tr_b16 v[120:121], v3 offset:2048
  ds_read_b64_tr_b16 v[122:123], v3 offset:2304
  v_smfmac_f32_16x16x64_bf16 v[100:103], v[60:63], v[224:231], v1
  ds_read_b64_tr_b16 v[124:125], v3 offset:3072
  ds_read_b64_tr_b16 v[126:127], v3 offset:3328
  v_smfmac_f32_16x16x64_bf16 v[96:99], v[64:67], v[168:175], v1
  ds_read_b128 v[52:55], v0 offset:22528
  v_smfmac_f32_16x16x64_bf16 v[100:103], v[64:67], v[232:239], v1
  ds_read_b128 v[56:59], v0 offset:23552
  s_waitcnt lgkmcnt(8)
  v_mfma_f32_16x16x32_bf16 v[80:83], v[88:91], v[112:115], 0
  s_waitcnt lgkmcnt(6)
  v_mfma_f32_16x16x32_bf16 v[80:83], v[92:95], v[116:119], v[80:83]
  ds_read_b128 v[60:63], v11 offset:8192
  s_waitcnt lgkmcnt(5)
  v_mfma_f32_16x16x32_bf16 v[80:83], v[104:107], v[120:123], v[80:83]
  ds_read_b128 v[64:67], v11 offset:9216
  s_waitcnt lgkmcnt(4)
  v_mfma_f32_16x16x32_bf16 v[80:83], v[108:111], v[124:127], v[80:83]
  ds_read_b128 v[108:111], v12 offset:32768
  v_mfma_f32_16x16x32_bf16 v[88:91], v[112:115], v[112:115], 0
  ds_read_b128 v[92:95], v12 offset:33792
  v_mfma_f32_16x16x32_bf16 v[88:91], v[116:119], v[116:119], v[88:91]
  v_mfma_f32_16x16x32_bf16 v[88:91], v[120:123], v[120:123], v[88:91]
  v_mfma_f32_16x16x32_bf16 v[88:91], v[124:127], v[124:127], v[88:91]
  s_nop 1
  v_exp_f32 v78, v80
  v_mfma_f32_16x16x32_bf16 v[84:87], v[44:47], v[112:115], 0
  v_exp_f32 v79, v81
  ds_read_b128 v[44:47], v11 offset:4096
  v_mfma_f32_16x16x32_bf16 v[84:87], v[48:51], v[116:119], v[84:87]
  ds_read_b128 v[48:51], v11 offset:5120
  v_cvt_pk_bf16_f32 v104, v78, v79
  v_exp_f32 v78, v82
  s_waitcnt lgkmcnt(7)
  v_mfma_f32_16x16x32_bf16 v[84:87], v[52:55], v[120:123], v[84:87]
  ds_read_b128 v[52:55], v11 offset:6144
  v_exp_f32 v79, v83
  s_waitcnt lgkmcnt(7)
  v_mfma_f32_16x16x32_bf16 v[84:87], v[56:59], v[124:127], v[84:87]
  ds_read_b128 v[56:59], v11 offset:7168
  v_cvt_pk_bf16_f32 v105, v78, v79
  v_max3_f32 v76, |v80|, |v81|, |v82|
  v_smfmac_f32_16x16x64_bf16 v[96:99], v[68:71], v[176:183], v1
  v_mul_f32 v90, s24, v90
  v_mul_f32 v91, s24, v91
  v_smfmac_f32_16x16x64_bf16 v[100:103], v[68:71], v[240:247], v1
  v_exp_f32 v88, v90
  v_exp_f32 v89, v91
  v_max3_f32 v76, v76, |v83|, v90
  ds_read_b128 v[68:71], v11 offset:10240
  v_smfmac_f32_16x16x64_bf16 v[96:99], v[72:75], v[184:191], v1
  v_cvt_pk_bf16_f32 v38, v88, v89
  v_cvt_pk_bf16_f32 v41, v88, v89
  v_smfmac_f32_16x16x64_bf16 v[100:103], v[72:75], v[248:255], v1
  ds_read_b128 v[72:75], v11 offset:11264
  v_max3_f32 v77, |v84|, |v85|, v91
  v_max3_f32 v76, v76, |v86|, |v87|
  v_max_f32 v76, v76, v77
  v_cmp_lt_f32 vcc, 0x42700000, v76
  v_exp_f32 v78, v84
  v_exp_f32 v79, v85
  s_nop 0
  v_cvt_pk_bf16_f32 v106, v78, v79
  v_exp_f32 v78, v86
  v_exp_f32 v79, v87
  s_nop 0
  v_cvt_pk_bf16_f32 v107, v78, v79
  s_and_b64 vcc, vcc, s[60:61]
  s_cbranch_scc1 L_rec_fb_s1
L_rec_fbret_s1:
  s_waitcnt lgkmcnt(6)
  v_add_f32 v96, v96, v98
  v_add_f32 v97, v97, v99
  v_mfma_f32_16x16x32_bf16 v[112:115], v[32:35], v[104:107], 0
  v_add_f32 v100, v100, v102
  v_mfma_f32_16x16x32_bf16 v[80:83], v[108:111], v[104:107], 0
  v_add_f32 v101, v101, v103
  v_mfma_f32_16x16x32_bf16 v[84:87], v[92:95], v[104:107], 0
  v_cvt_pk_bf16_f32 v42, v96, v97
  v_cvt_pk_bf16_f32 v43, v100, v101
  v_mfma_f32_16x16x16_bf16 v[112:115], v[32:33], v[38:39], v[112:115]
  ds_write2_b32 v13, v42, v43 offset0:0 offset1:64
  v_mfma_f32_16x16x16_bf16 v[80:83], v[42:43], v[38:39], v[80:83]
  v_mfma_f32_16x16x16_bf16 v[84:87], v[42:43], v[40:41], v[84:87]
  v_mov_b64 v[96:97], 0
  v_mov_b64 v[98:99], 0
  v_mov_b64 v[100:101], 0
  v_mov_b64 v[102:103], 0
  s_nop 0
  v_rcp_f32 v77, v112
  ds_read_b128 v[112:115], v11 offset:12288
  ds_read_b128 v[116:119], v11 offset:13312
  s_mov_b64 exec, s[60:61]
  v_mul_f32 v80, v80, v77
  v_mul_f32 v81, v81, v77
  v_mul_f32 v82, v82, v77
  v_mul_f32 v83, v83, v77
  v_cvt_pk_bf16_f32 v78, v80, v81
  v_cvt_pk_bf16_f32 v79, v82, v83
  ds_write_b64 v5, v[78:79]
  v_mul_f32 v84, v84, v77
  v_mul_f32 v85, v85, v77
  v_mul_f32 v86, v86, v77
  v_mul_f32 v87, v87, v77
  v_cvt_pk_bf16_f32 v76, v84, v85
  v_cvt_pk_bf16_f32 v77, v86, v87
  ds_write_b64 v5, v[76:77] offset:512
  s_mov_b64 exec, -1
  v_mfma_f32_32x32x8_bf16 v[80:95], v[36:37], v[36:37], 0
  v_mov_b64 v[104:105], 0
  v_mov_b64 v[106:107], 0
  v_mov_b64 v[108:109], 0
  v_mov_b64 v[110:111], 0
  s_waitcnt lgkmcnt(0)
  s_barrier
  ds_read_b128 v[120:123], v0 offset:45056
  ds_read_b128 v[124:127], v0 offset:46080
  s_waitcnt lgkmcnt(1)
  s_nop 0
  v_smfmac_f32_16x16x64_bf16 v[80:83], v[120:123], v[44:51], v1
  s_waitcnt lgkmcnt(0)
  v_smfmac_f32_16x16x64_bf16 v[80:83], v[124:127], v[52:59], v1
  ds_read_b128 v[44:47], v11 offset:24576
  v_smfmac_f32_16x16x64_bf16 v[84:87], v[120:123], v[60:67], v1
  ds_read_b128 v[48:51], v11 offset:25600
  v_smfmac_f32_16x16x64_bf16 v[84:87], v[124:127], v[68:75], v1
  ds_read_b128 v[52:55], v11 offset:26624
  v_smfmac_f32_16x16x64_bf16 v[88:91], v[120:123], v[112:119], v1
  ds_read_b128 v[56:59], v11 offset:27648
  v_smfmac_f32_16x16x64_bf16 v[88:91], v[124:127], v[16:23], v1
  ds_read_b128 v[60:63], v11 offset:28672
  v_add_f32 v80, v80, v82
  v_add_f32 v81, v81, v83
  v_cvt_pk_bf16_f32 v76, v80, v81
  v_and_or_b32 v76, v76, -2, 1
  v_smfmac_f32_16x16x64_bf16 v[92:95], v[120:123], v[24:31], v1
  ds_read_b128 v[64:67], v11 offset:29696
  v_smfmac_f32_16x16x64_bf16 v[92:95], v[124:127], a[128:135], v1
  ds_read_b128 v[68:71], v11 offset:30720
  v_add_f32 v84, v84, v86
  v_add_f32 v85, v85, v87
  v_cvt_pk_bf16_f32 v77, v84, v85
  v_smfmac_f32_16x16x64_bf16 v[96:99], v[120:123], a[192:199], v1
  ds_read_b128 v[72:75], v11 offset:31744
  v_smfmac_f32_16x16x64_bf16 v[96:99], v[124:127], a[136:143], v1
  v_add_f32 v88, v88, v90
  v_add_f32 v89, v89, v91
  v_cvt_pk_bf16_f32 v78, v88, v89
  v_smfmac_f32_16x16x64_bf16 v[100:103], v[120:123], a[200:207], v1
  v_smfmac_f32_16x16x64_bf16 v[100:103], v[124:127], a[0:7], v1
  v_add_f32 v92, v92, v94
  v_add_f32 v93, v93, v95
  v_cvt_pk_bf16_f32 v79, v92, v93
  global_store_dwordx4 v6, v[76:79], s[32:33] sc1
  s_waitcnt lgkmcnt(6)
  v_smfmac_f32_16x16x64_bf16 v[104:107], v[120:123], v[44:51], v1
  s_waitcnt lgkmcnt(4)
  v_smfmac_f32_16x16x64_bf16 v[104:107], v[124:127], v[52:59], v1
  v_add_f32 v96, v96, v98
  v_add_f32 v97, v97, v99
  v_cvt_pk_bf16_f32 v80, v96, v97
  v_and_or_b32 v80, v80, -2, 1
  s_waitcnt lgkmcnt(2)
  v_smfmac_f32_16x16x64_bf16 v[108:111], v[120:123], v[60:67], v1
  s_waitcnt lgkmcnt(0)
  v_smfmac_f32_16x16x64_bf16 v[108:111], v[124:127], v[68:75], v1
  v_add_f32 v100, v100, v102
  v_add_f32 v101, v101, v103
  v_cvt_pk_bf16_f32 v81, v100, v101
  v_add_f32 v104, v104, v106
  v_add_f32 v105, v105, v107
  v_cvt_pk_bf16_f32 v82, v104, v105
  s_nop 1
  v_add_f32 v108, v108, v110
  v_add_f32 v109, v109, v111
  v_cvt_pk_bf16_f32 v83, v108, v109
  global_store_dwordx4 v6, v[80:83], s[34:35] sc1
  s_lshl_b32 s54, s21, 10
  v_add_u32 v116, s54, v3
  ds_read_b64_tr_b16 v[112:113], v116
  ds_read_b64_tr_b16 v[114:115], v116 offset:256
  s_mov_b64 exec, s[60:61]
  ds_read_b128 v[112:115], v10
  s_mov_b64 exec, -1
  v_cndmask_b32 v60, 0, v14, s[8:9]
  v_cndmask_b32 v61, 0, v14, s[10:11]
  v_cndmask_b32 v62, 0, v14, s[12:13]
  v_cndmask_b32 v63, 0, v14, s[14:15]
  v_mfma_f32_32x32x8_bf16 v[80:95], v[36:37], v[36:37], 0
  v_mov_b64 v[96:97], 0
  v_mov_b64 v[98:99], 0
  v_mov_b64 v[100:101], 0
  v_mov_b64 v[102:103], 0
  ds_read_b128 v[104:107], v11 offset:20480
  ds_read_b128 v[108:111], v11 offset:21504
  ds_read_b128 v[120:123], v11 offset:22528
  ds_read_b128 v[124:127], v11 offset:23552
  ds_read_b128 v[52:55], v11 offset:14336
  ds_read_b128 v[56:59], v11 offset:15360
  ds_read_b128 v[68:71], v11 offset:18432
  ds_read_b128 v[72:75], v11 offset:19456
  v_mov_b32 v116, -1
  s_add_u32 s4, s4, 4096
  s_lshl_b32 s54, s20, 7
  s_add_u32 s54, s54, 61440
  s_min_u32 s4, s4, s54
  v_mov_b32 v119, s4
  s_waitcnt lgkmcnt(8)
  v_min_u32 v112, -2, v112
  s_cmp_lt_u32 s21, 2
  s_cbranch_scc1 Lz_116
  s_nop 3
  s_nop 3
  s_nop 3
  s_nop 3
  s_nop 3
  s_nop 3
  s_nop 3
  s_nop 3
  s_nop 3
  s_nop 3
Lz_116:
  s_nop 3
  s_nop 3
  s_nop 3
  s_mov_b32 s27, 0
L_p2_s1:
  global_load_dwordx4 v[44:47], v8, s[38:39] sc1
  global_load_dwordx4 v[48:51], v8, s[38:39] offset:1024 sc1
  s_add_u32 s27, s27, 1
  s_cmp_gt_u32 s27, 0x400000
  s_cbranch_scc1 L_end
  s_waitcnt vmcnt(1)
  v_mfma_f32_16x16x32_bf16 v[64:67], v[44:47], v[60:63], 0
  s_waitcnt vmcnt(0)
  v_mfma_f32_16x16x32_bf16 v[64:67], v[48:51], v[60:63], v[64:67]
  v_and_b32 v117, v44, v48
  v_and_b32 v117, 1, v117
  v_cmp_ne_u32 vcc, 1, v117
  s_cbranch_vccnz L_p2_s1
  s_nop 3
  v_permlane32_swap_b32 v64, v66
  v_permlane32_swap_b32 v65, v67
  v_add_f32 v64, v64, v66
  v_add_f32 v65, v65, v67
  v_mov_b32 v66, v64
  v_mov_b32 v67, v65
  s_nop 0
  v_permlane16_swap_b32 v64, v66
  v_permlane16_swap_b32 v65, v67
  v_add_f32 v64, v64, v66
  v_add_f32 v65, v65, v67
  v_cvt_pk_bf16_f32 v64, v64, v65
  v_min_u32 v64, -2, v64
  global_store_dword v7, v64, s[42:43] sc1
  ds_read_b128 v[60:63], v11 offset:16384
  ds_read_b128 v[64:67], v11 offset:17408
  v_xor_b32 v76, 2048, v12
  v_xor_b32 v77, 4096, v12
  v_xor_b32 v78, 6144, v12
  s_cmp_ge_u32 s21, 2
  s_cbranch_scc1 Lz_117
  s_nop 3
  s_nop 3
  s_nop 3
  s_nop 3
  s_nop 3
  s_nop 3
  s_nop 3
  s_nop 3
  s_nop 3
  s_nop 3
Lz_117:
  s_nop 3
  s_nop 3
  s_nop 3
  s_nop 3
  s_nop 3
  s_mov_b32 s27, 0
L_p3_s1:
  global_load_dwordx4 v[44:47], v12, s[78:79] sc1
  global_load_dwordx4 v[48:51], v12, s[78:79] offset:1024 sc1
  s_add_u32 s27, s27, 1
  s_cmp_gt_u32 s27, 0x400000
  s_cbranch_scc1 L_end
L_p3b_s1:
  s_waitcnt vmcnt(1)
  ds_write_b128 v12, v[44:47] offset:0
  v_max3_u32 v117, v44, v45, v46
  s_waitcnt vmcnt(0)
  ds_write_b128 v12, v[48:51] offset:1024
  v_max3_u32 v118, v47, v48, v49
  v_max3_u32 v117, v117, v50, v51
  v_max_u32 v117, v117, v118
  v_cmp_eq_u32 vcc, -1, v117
  s_cbranch_vccnz L_p3_s1
L_rec_acc_s1:
L_rec_join_s1:
  s_add_u32 s22, s22, 1
L_rec_step_s2:
  s_waitcnt lgkmcnt(2)
  v_smfmac_f32_16x16x64_bf16 v[88:91], v[44:47], v[52:59], v1
  v_smfmac_f32_16x16x64_bf16 v[92:95], v[44:47], v[60:67], v1
  v_smfmac_f32_16x16x64_bf16 v[88:91], v[48:51], v[68:75], v1
  s_waitcnt lgkmcnt(0)
  s_barrier
  ds_read_b128 v[52:55], v76 offset:0
  ds_read_b128 v[56:59], v76 offset:1024
  v_smfmac_f32_16x16x64_bf16 v[92:95], v[48:51], v[104:111], v1
  ds_read_b128 v[60:63], v77 offset:0
  v_smfmac_f32_16x16x64_bf16 v[80:83], v[44:47], v[120:127], v1
  ds_read_b128 v[64:67], v77 offset:1024
  v_smfmac_f32_16x16x64_bf16 v[84:87], v[44:47], a[64:71], v1
  ds_read_b128 v[68:71], v78 offset:0
  v_smfmac_f32_16x16x64_bf16 v[80:83], v[48:51], a[8:15], v1
  ds_read_b128 v[72:75], v78 offset:1024
  v_smfmac_f32_16x16x64_bf16 v[84:87], v[48:51], a[72:79], v1
  global_store_dwordx4 v9, v[112:115], s[50:51] sc1
  s_waitcnt lgkmcnt(5)
  v_smfmac_f32_16x16x64_bf16 v[88:91], v[52:55], a[144:151], v1
  s_mov_b32 m0, s59
  v_smfmac_f32_16x16x64_bf16 v[92:95], v[52:55], a[208:215], v1
  global_load_lds_dwordx4 v15, s[16:17] offset:0 sc1
  s_waitcnt lgkmcnt(4)
  v_smfmac_f32_16x16x64_bf16 v[88:91], v[56:59], a[152:159], v1
  v_smfmac_f32_16x16x64_bf16 v[92:95], v[56:59], a[216:223], v1
  global_load_lds_dwordx4 v15, s[16:17] offset:1024 sc1
  s_waitcnt lgkmcnt(3)
  v_smfmac_f32_16x16x64_bf16 v[88:91], v[60:63], a[160:167], v1
  v_smfmac_f32_16x16x64_bf16 v[92:95], v[60:63], a[224:231], v1
  global_load_lds_dwordx4 v15, s[16:17] offset:2048 sc1
  s_waitcnt lgkmcnt(2)
  v_smfmac_f32_16x16x64_bf16 v[88:91], v[64:67], a[168:175], v1
  v_smfmac_f32_16x16x64_bf16 v[92:95], v[64:67], a[232:239], v1
  global_load_lds_dwordx4 v15, s[16:17] offset:3072 sc1
  v_add_u32 v15, 0x40000, v15
  s_waitcnt lgkmcnt(1)
  v_smfmac_f32_16x16x64_bf16 v[88:91], v[68:71], a[176:183], v1
  global_store_dword v7, v116, s[46:47] sc1
  v_add_u32 v9, 0x20000, v9
  v_smfmac_f32_16x16x64_bf16 v[92:95], v[68:71], a[240:247], v1
  global_load_dword v4, v119, s[52:53] sc1
  s_waitcnt vmcnt(7)
  ds_read_b128 v[104:107], v0 offset:10240
  s_waitcnt lgkmcnt(1)
  v_smfmac_f32_16x16x64_bf16 v[88:91], v[72:75], a[184:191], v1
  v_smfmac_f32_16x16x64_bf16 v[92:95], v[72:75], a[248:255], v1
  ds_read_b128 v[108:111], v0 offset:11264
  v_smfmac_f32_16x16x64_bf16 v[80:83], v[52:55], a[16:23], v1
  v_smfmac_f32_16x16x64_bf16 v[84:87], v[52:55], a[80:87], v1
  v_smfmac_f32_16x16x64_bf16 v[80:83], v[56:59], a[24:31], v1
  v_smfmac_f32_16x16x64_bf16 v[84:87], v[56:59], a[88:95], v1
  v_smfmac_f32_16x16x64_bf16 v[80:83], v[60:63], a[32:39], v1
  v_smfmac_f32_16x16x64_bf16 v[84:87], v[60:63], a[96:103], v1
  v_smfmac_f32_16x16x64_bf16 v[80:83], v[64:67], a[40:47], v1
  v_smfmac_f32_16x16x64_bf16 v[84:87], v[64:67], a[104:111], v1
  v_add_f32 v88, v88, v90
  v_add_f32 v89, v89, v91
  v_smfmac_f32_16x16x64_bf16 v[80:83], v[68:71], a[48:55], v1
  v_add_f32 v92, v92, v94
  v_add_f32 v93, v93, v95
  v_smfmac_f32_16x16x64_bf16 v[84:87], v[68:71], a[112:119], v1
  v_cvt_pk_bf16_f32 v78, v88, v89
  v_cvt_pk_bf16_f32 v79, v92, v93
  v_smfmac_f32_16x16x64_bf16 v[80:83], v[72:75], a[56:63], v1
  ds_write2_b32 v2, v78, v79 offset0:1 offset1:129
  ds_read_b128 v[88:91], v0 offset:8192
  v_smfmac_f32_16x16x64_bf16 v[84:87], v[72:75], a[120:127], v1
  ds_read_b128 v[92:95], v0 offset:9216
  v_smfmac_f32_16x16x64_bf16 v[96:99], v[44:47], v[128:135], v1
  v_smfmac_f32_16x16x64_bf16 v[100:103], v[44:47], v[192:199], v1
  ds_read_b128 v[44:47], v0 offset:12288
  s_nop 4
  v_add_f32 v80, v80, v82
  v_add_f32 v81, v81, v83
  v_add_f32 v84, v84, v86
  v_add_f32 v85, v85, v87
  v_cvt_pk_bf16_f32 v76, v80, v81
  v_cvt_pk_bf16_f32 v77, v84, v85
  ds_write2_b32 v2, v76, v77 offset0:0 offset1:128
  v_smfmac_f32_16x16x64_bf16 v[96:99], v[48:51], v[136:143], v1
  v_smfmac_f32_16x16x64_bf16 v[100:103], v[48:51], v[200:207], v1
  ds_read_b128 v[48:51], v0 offset:13312
  v_smfmac_f32_16x16x64_bf16 v[96:99], v[52:55], v[144:151], v1
  v_smfmac_f32_16x16x64_bf16 v[100:103], v[52:55], v[208:215], v1
  v_smfmac_f32_16x16x64_bf16 v[96:99], v[56:59], v[152:159], v1
  s_waitcnt vmcnt(7)
  s_waitcnt lgkmcnt(1)
  s_barrier
  ds_read_b64_tr_b16 v[112:113], v3 offset:0
  ds_read_b64_tr_b16 v[114:115], v3 offset:256
  v_smfmac_f32_16x16x64_bf16 v[100:103], v[56:59], v[216:223], v1
  ds_read_b64_tr_b16 v[116:117], v3 offset:1024
  ds_read_b64_tr_b16 v[118:119], v3 offset:1280
  v_smfmac_f32_16x16x64_bf16 v[96:99], v[60:63], v[160:167], v1
  ds_read_b64_tr_b16 v[120:121], v3 offset:2048
  ds_read_b64_tr_b16 v[122:123], v3 offset:2304
  v_smfmac_f32_16x16x64_bf16 v[100:103], v[60:63], v[224:231], v1
  ds_read_b64_tr_b16 v[124:125], v3 offset:3072
  ds_read_b64_tr_b16 v[126:127], v3 offset:3328
  v_smfmac_f32_16x16x64_bf16 v[96:99], v[64:67], v[168:175], v1
  ds_read_b128 v[52:55], v0 offset:14336
  v_smfmac_f32_16x16x64_bf16 v[100:103], v[64:67], v[232:239], v1
  ds_read_b128 v[56:59], v0 offset:15360
  s_waitcnt lgkmcnt(8)
  v_mfma_f32_16x16x32_bf16 v[80:83], v[88:91], v[112:115], 0
  s_waitcnt lgkmcnt(6)
  v_mfma_f32_16x16x32_bf16 v[80:83], v[92:95], v[116:119], v[80:83]
  ds_read_b128 v[60:63], v11 offset:8192
  s_waitcnt lgkmcnt(5)
  v_mfma_f32_16x16x32_bf16 v[80:83], v[104:107], v[120:123], v[80:83]
  ds_read_b128 v[64:67], v11 offset:9216
  s_waitcnt lgkmcnt(4)
  v_mfma_f32_16x16x32_bf16 v[80:83], v[108:111], v[124:127], v[80:83]
  ds_read_b128 v[108:111], v12 offset:24576
  v_mfma_f32_16x16x32_bf16 v[88:91], v[112:115], v[112:115], 0
  ds_read_b128 v[92:95], v12 offset:25600
  v_mfma_f32_16x16x32_bf16 v[88:91], v[116:119], v[116:119], v[88:91]
  v_mfma_f32_16x16x32_bf16 v[88:91], v[120:123], v[120:123], v[88:91]
  v_mfma_f32_16x16x32_bf16 v[88:91], v[124:127], v[124:127], v[88:91]
  s_nop 1
  v_exp_f32 v78, v80
  v_mfma_f32_16x16x32_bf16 v[84:87], v[44:47], v[112:115], 0
  v_exp_f32 v79, v81
  ds_read_b128 v[44:47], v11 offset:4096
  v_mfma_f32_16x16x32_bf16 v[84:87], v[48:51], v[116:119], v[84:87]
  ds_read_b128 v[48:51], v11 offset:5120
  v_cvt_pk_bf16_f32 v104, v78, v79
  v_exp_f32 v78, v82
  s_waitcnt lgkmcnt(7)
  v_mfma_f32_16x16x32_bf16 v[84:87], v[52:55], v[120:123], v[84:87]
  ds_read_b128 v[52:55], v11 offset:6144
  v_exp_f32 v79, v83
  s_waitcnt lgkmcnt(7)
  v_mfma_f32_16x16x32_bf16 v[84:87], v[56:59], v[124:127], v[84:87]
  ds_read_b128 v[56:59], v11 offset:7168
  v_cvt_pk_bf16_f32 v105, v78, v79
  v_max3_f32 v76, |v80|, |v81|, |v82|
  v_smfmac_f32_16x16x64_bf16 v[96:99], v[68:71], v[176:183], v1
  v_mul_f32 v90, s24, v90
  v_mul_f32 v91, s24, v91
  v_smfmac_f32_16x16x64_bf16 v[100:103], v[68:71], v[240:247], v1
  v_exp_f32 v88, v90
  v_exp_f32 v89, v91
  v_max3_f32 v76, v76, |v83|, v90
  ds_read_b128 v[68:71], v11 offset:10240
  v_smfmac_f32_16x16x64_bf16 v[96:99], v[72:75], v[184:191], v1
  v_cvt_pk_bf16_f32 v38, v88, v89
  v_cvt_pk_bf16_f32 v41, v88, v89
  v_smfmac_f32_16x16x64_bf16 v[100:103], v[72:75], v[248:255], v1
  ds_read_b128 v[72:75], v11 offset:11264
  v_max3_f32 v77, |v84|, |v85|, v91
  v_max3_f32 v76, v76, |v86|, |v87|
  v_max_f32 v76, v76, v77
  v_cmp_lt_f32 vcc, 0x42700000, v76
  v_exp_f32 v78, v84
  v_exp_f32 v79, v85
  s_nop 0
  v_cvt_pk_bf16_f32 v106, v78, v79
  v_exp_f32 v78, v86
  v_exp_f32 v79, v87
  s_nop 0
  v_cvt_pk_bf16_f32 v107, v78, v79
  s_and_b64 vcc, vcc, s[60:61]
  s_cbranch_scc1 L_rec_fb_s2
L_rec_fbret_s2:
  s_waitcnt lgkmcnt(6)
  v_add_f32 v96, v96, v98
  v_add_f32 v97, v97, v99
  v_mfma_f32_16x16x32_bf16 v[112:115], v[32:35], v[104:107], 0
  v_add_f32 v100, v100, v102
  v_mfma_f32_16x16x32_bf16 v[80:83], v[108:111], v[104:107], 0
  v_add_f32 v101, v101, v103
  v_mfma_f32_16x16x32_bf16 v[84:87], v[92:95], v[104:107], 0
  v_cvt_pk_bf16_f32 v42, v96, v97
  v_cvt_pk_bf16_f32 v43, v100, v101
  v_mfma_f32_16x16x16_bf16 v[112:115], v[32:33], v[38:39], v[112:115]
  ds_write2_b32 v13, v42, v43 offset0:0 offset1:64
  v_mfma_f32_16x16x16_bf16 v[80:83], v[42:43], v[38:39], v[80:83]
  v_mfma_f32_16x16x16_bf16 v[84:87], v[42:43], v[40:41], v[84:87]
  v_mov_b64 v[96:97], 0
  v_mov_b64 v[98:99], 0
  v_mov_b64 v[100:101], 0
  v_mov_b64 v[102:103], 0
  s_nop 0
  v_rcp_f32 v77, v112
  ds_read_b128 v[112:115], v11 offset:12288
  ds_read_b128 v[116:119], v11 offset:13312
  s_mov_b64 exec, s[60:61]
  v_mul_f32 v80, v80, v77
  v_mul_f32 v81, v81, v77
  v_mul_f32 v82, v82, v77
  v_mul_f32 v83, v83, v77
  v_cvt_pk_bf16_f32 v78, v80, v81
  v_cvt_pk_bf16_f32 v79, v82, v83
  ds_write_b64 v5, v[78:79]
  v_mul_f32 v84, v84, v77
  v_mul_f32 v85, v85, v77
  v_mul_f32 v86, v86, v77
  v_mul_f32 v87, v87, v77
  v_cvt_pk_bf16_f32 v76, v84, v85
  v_cvt_pk_bf16_f32 v77, v86, v87
  ds_write_b64 v5, v[76:77] offset:512
  s_mov_b64 exec, -1
  v_mfma_f32_32x32x8_bf16 v[80:95], v[36:37], v[36:37], 0
  v_mov_b64 v[104:105], 0
  v_mov_b64 v[106:107], 0
  v_mov_b64 v[108:109], 0
  v_mov_b64 v[110:111], 0
  s_waitcnt lgkmcnt(0)
  s_barrier
  ds_read_b128 v[120:123], v0 offset:45056
  ds_read_b128 v[124:127], v0 offset:46080
  s_waitcnt lgkmcnt(1)
  s_nop 0
  v_smfmac_f32_16x16x64_bf16 v[80:83], v[120:123], v[44:51], v1
  s_waitcnt lgkmcnt(0)
  v_smfmac_f32_16x16x64_bf16 v[80:83], v[124:127], v[52:59], v1
  ds_read_b128 v[44:47], v11 offset:24576
  v_smfmac_f32_16x16x64_bf16 v[84:87], v[120:123], v[60:67], v1
  ds_read_b128 v[48:51], v11 offset:25600
  v_smfmac_f32_16x16x64_bf16 v[84:87], v[124:127], v[68:75], v1
  ds_read_b128 v[52:55], v11 offset:26624
  v_smfmac_f32_16x16x64_bf16 v[88:91], v[120:123], v[112:119], v1
  ds_read_b128 v[56:59], v11 offset:27648
  v_smfmac_f32_16x16x64_bf16 v[88:91], v[124:127], v[16:23], v1
  ds_read_b128 v[60:63], v11 offset:28672
  v_add_f32 v80, v80, v82
  v_add_f32 v81, v81, v83
  v_cvt_pk_bf16_f32 v76, v80, v81
  v_and_or_b32 v76, v76, -2, 0
  v_smfmac_f32_16x16x64_bf16 v[92:95], v[120:123], v[24:31], v1
  ds_read_b128 v[64:67], v11 offset:29696
  v_smfmac_f32_16x16x64_bf16 v[92:95], v[124:127], a[128:135], v1
  ds_read_b128 v[68:71], v11 offset:30720
  v_add_f32 v84, v84, v86
  v_add_f32 v85, v85, v87
  v_cvt_pk_bf16_f32 v77, v84, v85
  v_smfmac_f32_16x16x64_bf16 v[96:99], v[120:123], a[192:199], v1
  ds_read_b128 v[72:75], v11 offset:31744
  v_smfmac_f32_16x16x64_bf16 v[96:99], v[124:127], a[136:143], v1
  v_add_f32 v88, v88, v90
  v_add_f32 v89, v89, v91
  v_cvt_pk_bf16_f32 v78, v88, v89
  v_smfmac_f32_16x16x64_bf16 v[100:103], v[120:123], a[200:207], v1
  v_smfmac_f32_16x16x64_bf16 v[100:103], v[124:127], a[0:7], v1
  v_add_f32 v92, v92, v94
  v_add_f32 v93, v93, v95
  v_cvt_pk_bf16_f32 v79, v92, v93
  global_store_dwordx4 v6, v[76:79], s[28:29] sc1
  s_waitcnt lgkmcnt(6)
  v_smfmac_f32_16x16x64_bf16 v[104:107], v[120:123], v[44:51], v1
  s_waitcnt lgkmcnt(4)
  v_smfmac_f32_16x16x64_bf16 v[104:107], v[124:127], v[52:59], v1
  v_add_f32 v96, v96, v98
  v_add_f32 v97, v97, v99
  v_cvt_pk_bf16_f32 v80, v96, v97
  v_and_or_b32 v80, v80, -2, 0
  s_waitcnt lgkmcnt(2)
  v_smfmac_f32_16x16x64_bf16 v[108:111], v[120:123], v[60:67], v1
  s_waitcnt lgkmcnt(0)
  v_smfmac_f32_16x16x64_bf16 v[108:111], v[124:127], v[68:75], v1
  v_add_f32 v100, v100, v102
  v_add_f32 v101, v101, v103
  v_cvt_pk_bf16_f32 v81, v100, v101
  v_add_f32 v104, v104, v106
  v_add_f32 v105, v105, v107
  v_cvt_pk_bf16_f32 v82, v104, v105
  s_nop 1
  v_add_f32 v108, v108, v110
  v_add_f32 v109, v109, v111
  v_cvt_pk_bf16_f32 v83, v108, v109
  global_store_dwordx4 v6, v[80:83], s[30:31] sc1
  s_lshl_b32 s54, s21, 10
  v_add_u32 v116, s54, v3
  ds_read_b64_tr_b16 v[112:113], v116
  ds_read_b64_tr_b16 v[114:115], v116 offset:256
  s_mov_b64 exec, s[60:61]
  ds_read_b128 v[112:115], v10
  s_mov_b64 exec, -1
  v_cndmask_b32 v60, 0, v14, s[8:9]
  v_cndmask_b32 v61, 0, v14, s[10:11]
  v_cndmask_b32 v62, 0, v14, s[12:13]
  v_cndmask_b32 v63, 0, v14, s[14:15]
  v_mfma_f32_32x32x8_bf16 v[80:95], v[36:37], v[36:37], 0
  v_mov_b64 v[96:97], 0
  v_mov_b64 v[98:99], 0
  v_mov_b64 v[100:101], 0
  v_mov_b64 v[102:103], 0
  ds_read_b128 v[104:107], v11 offset:20480
  ds_read_b128 v[108:111], v11 offset:21504
  ds_read_b128 v[120:123], v11 offset:22528
  ds_read_b128 v[124:127], v11 offset:23552
  ds_read_b128 v[52:55], v11 offset:14336
  ds_read_b128 v[56:59], v11 offset:15360
  ds_read_b128 v[68:71], v11 offset:18432
  ds_read_b128 v[72:75], v11 offset:19456
  v_mov_b32 v116, -1
  s_waitcnt lgkmcnt(8)
  v_min_u32 v112, -2, v112
  s_cmp_lt_u32 s21, 2
  s_cbranch_scc1 Lz_118
  s_nop 3
  s_nop 3
  s_nop 3
  s_nop 3
  s_nop 3
  s_nop 3
  s_nop 3
  s_nop 3
  s_nop 3
  s_nop 3
Lz_118:
  s_nop 3
  s_nop 3
  s_nop 3
  s_mov_b32 s27, 0
L_p2_s2:
  global_load_dwordx4 v[44:47], v8, s[36:37] sc1
  global_load_dwordx4 v[48:51], v8, s[36:37] offset:1024 sc1
  s_add_u32 s27, s27, 1
  s_cmp_gt_u32 s27, 0x400000
  s_cbranch_scc1 L_end
  s_waitcnt vmcnt(1)
  v_mfma_f32_16x16x32_bf16 v[64:67], v[44:47], v[60:63], 0
  s_waitcnt vmcnt(0)
  v_mfma_f32_16x16x32_bf16 v[64:67], v[48:51], v[60:63], v[64:67]
  v_or_b32 v117, v44, v48
  v_and_b32 v117, 1, v117
  v_cmp_ne_u32 vcc, 0, v117
  s_cbranch_vccnz L_p2_s2
  s_nop 3
  v_permlane32_swap_b32 v64, v66
  v_permlane32_swap_b32 v65, v67
  v_add_f32 v64, v64, v66
  v_add_f32 v65, v65, v67
  v_mov_b32 v66, v64
  v_mov_b32 v67, v65
  s_nop 0
  v_permlane16_swap_b32 v64, v66
  v_permlane16_swap_b32 v65, v67
  v_add_f32 v64, v64, v66
  v_add_f32 v65, v65, v67
  v_cvt_pk_bf16_f32 v64, v64, v65
  v_min_u32 v64, -2, v64
  global_store_dword v7, v64, s[44:45] sc1
  v_readfirstlane_b32 s5, v4
  ds_read_b128 v[60:63], v11 offset:16384
  ds_read_b128 v[64:67], v11 offset:17408
  v_xor_b32 v76, 2048, v12
  v_xor_b32 v77, 4096, v12
  v_xor_b32 v78, 6144, v12
  s_cmp_ge_u32 s21, 2
  s_cbranch_scc1 Lz_119
  s_nop 3
  s_nop 3
  s_nop 3
  s_nop 3
  s_nop 3
  s_nop 3
  s_nop 3
  s_nop 3
  s_nop 3
  s_nop 3
Lz_119:
  s_nop 3
  s_nop 3
  s_nop 3
  s_nop 3
  s_nop 3
  s_mov_b32 s27, 0
L_p3_s2:
  global_load_dwordx4 v[44:47], v12, s[80:81] sc1
  global_load_dwordx4 v[48:51], v12, s[80:81] offset:1024 sc1
  s_add_u32 s27, s27, 1
  s_cmp_gt_u32 s27, 0x400000
  s_cbranch_scc1 L_end
L_p3b_s2:
  s_waitcnt vmcnt(1)
  ds_write_b128 v12, v[44:47] offset:0
  v_max3_u32 v117, v44, v45, v46
  s_waitcnt vmcnt(0)
  ds_write_b128 v12, v[48:51] offset:1024
  v_max3_u32 v118, v47, v48, v49
  v_max3_u32 v117, v117, v50, v51
  v_max_u32 v117, v117, v118
  v_cmp_eq_u32 vcc, -1, v117
  s_cbranch_vccnz L_p3_s2
  s_cmp_eq_u32 s22, 2
  s_cselect_b32 s5, 0, s5
  s_cmp_eq_u32 s5, 1
  s_cbranch_scc1 L_rec_fok_s2
  s_cmp_eq_u32 s22, 2
  s_cbranch_scc0 L_rec_fwn_s2
  v_lshrrev_b32 v117, 4, v0
  v_and_b32 v117, 3, v117
  s_lshl_b32 s54, s20, 2
  v_add_u32 v117, s54, v117
  v_lshlrev_b32 v117, 7, v117
  v_add_u32 v117, 147520, v117
  s_mov_b32 s27, 0
L_rec_fm_s2:
  global_load_dword v118, v117, s[52:53] sc1
  s_add_u32 s27, s27, 1
  s_cmp_gt_u32 s27, 0x400000
  s_cbranch_scc1 L_end
  s_waitcnt vmcnt(0)
  v_cmp_ne_u32 vcc, 1, v118
  s_cbranch_vccnz L_rec_fm_s2
  s_branch L_rec_fok_s2
L_rec_fwn_s2:
  s_mov_b32 s27, 0
  v_mov_b32 v117, s4
L_rec_fw_s2:
  global_load_dword v118, v117, s[52:53] sc1
  s_add_u32 s27, s27, 1
  s_cmp_gt_u32 s27, 0x400000
  s_cbranch_scc1 L_end
  s_waitcnt vmcnt(0)
  v_readfirstlane_b32 s54, v118
  s_nop 0
  s_cmp_eq_u32 s54, 1
  s_cbranch_scc0 L_rec_fw_s2
L_rec_fok_s2:
L_rec_acc_s2:
L_rec_join_s2:
  s_add_u32 s22, s22, 1
L_rec_step_s3:
  s_cmp_eq_u32 s22, 63
  s_cbranch_scc1 L_rec_last
  s_waitcnt lgkmcnt(2)
  v_smfmac_f32_16x16x64_bf16 v[88:91], v[44:47], v[52:59], v1
  v_smfmac_f32_16x16x64_bf16 v[92:95], v[44:47], v[60:67], v1
  v_smfmac_f32_16x16x64_bf16 v[88:91], v[48:51], v[68:75], v1
  s_waitcnt lgkmcnt(0)
  s_barrier
  ds_read_b128 v[52:55], v76 offset:0
  ds_read_b128 v[56:59], v76 offset:1024
  v_smfmac_f32_16x16x64_bf16 v[92:95], v[48:51], v[104:111], v1
  ds_read_b128 v[60:63], v77 offset:0
  v_smfmac_f32_16x16x64_bf16 v[80:83], v[44:47], v[120:127], v1
  ds_read_b128 v[64:67], v77 offset:1024
  v_smfmac_f32_16x16x64_bf16 v[84:87], v[44:47], a[64:71], v1
  ds_read_b128 v[68:71], v78 offset:0
  v_smfmac_f32_16x16x64_bf16 v[80:83], v[48:51], a[8:15], v1
  ds_read_b128 v[72:75], v78 offset:1024
  v_smfmac_f32_16x16x64_bf16 v[84:87], v[48:51], a[72:79], v1
  global_store_dwordx4 v9, v[112:115], s[50:51] sc1
  s_waitcnt lgkmcnt(5)
  v_smfmac_f32_16x16x64_bf16 v[88:91], v[52:55], a[144:151], v1
  s_mov_b32 m0, s58
  v_smfmac_f32_16x16x64_bf16 v[92:95], v[52:55], a[208:215], v1
  global_load_lds_dwordx4 v15, s[16:17] offset:0 sc1
  s_waitcnt lgkmcnt(4)
  v_smfmac_f32_16x16x64_bf16 v[88:91], v[56:59], a[152:159], v1
  v_smfmac_f32_16x16x64_bf16 v[92:95], v[56:59], a[216:223], v1
  global_load_lds_dwordx4 v15, s[16:17] offset:1024 sc1
  s_waitcnt lgkmcnt(3)
  v_smfmac_f32_16x16x64_bf16 v[88:91], v[60:63], a[160:167], v1
  v_smfmac_f32_16x16x64_bf16 v[92:95], v[60:63], a[224:231], v1
  global_load_lds_dwordx4 v15, s[16:17] offset:2048 sc1
  s_waitcnt lgkmcnt(2)
  v_smfmac_f32_16x16x64_bf16 v[88:91], v[64:67], a[168:175], v1
  v_smfmac_f32_16x16x64_bf16 v[92:95], v[64:67], a[232:239], v1
  global_load_lds_dwordx4 v15, s[16:17] offset:3072 sc1
  v_add_u32 v15, 0x40000, v15
  s_waitcnt lgkmcnt(1)
  v_smfmac_f32_16x16x64_bf16 v[88:91], v[68:71], a[176:183], v1
  global_store_dword v7, v116, s[40:41] sc1
  v_add_u32 v9, 0x20000, v9
  v_smfmac_f32_16x16x64_bf16 v[92:95], v[68:71], a[240:247], v1
  s_waitcnt vmcnt(6)
  ds_read_b128 v[104:107], v0 offset:18432
  s_waitcnt lgkmcnt(1)
  v_smfmac_f32_16x16x64_bf16 v[88:91], v[72:75], a[184:191], v1
  v_smfmac_f32_16x16x64_bf16 v[92:95], v[72:75], a[248:255], v1
  ds_read_b128 v[108:111], v0 offset:19456
  v_smfmac_f32_16x16x64_bf16 v[80:83], v[52:55], a[16:23], v1
  v_smfmac_f32_16x16x64_bf16 v[84:87], v[52:55], a[80:87], v1
  v_smfmac_f32_16x16x64_bf16 v[80:83], v[56:59], a[24:31], v1
  v_smfmac_f32_16x16x64_bf16 v[84:87], v[56:59], a[88:95], v1
  v_smfmac_f32_16x16x64_bf16 v[80:83], v[60:63], a[32:39], v1
  v_smfmac_f32_16x16x64_bf16 v[84:87], v[60:63], a[96:103], v1
  v_smfmac_f32_16x16x64_bf16 v[80:83], v[64:67], a[40:47], v1
  v_smfmac_f32_16x16x64_bf16 v[84:87], v[64:67], a[104:111], v1
  v_add_f32 v88, v88, v90
  v_add_f32 v89, v89, v91
  v_smfmac_f32_16x16x64_bf16 v[80:83], v[68:71], a[48:55], v1
  v_add_f32 v92, v92, v94
  v_add_f32 v93, v93, v95
  v_smfmac_f32_16x16x64_bf16 v[84:87], v[68:71], a[112:119], v1
  v_cvt_pk_bf16_f32 v78, v88, v89
  v_cvt_pk_bf16_f32 v79, v92, v93
  v_smfmac_f32_16x16x64_bf16 v[80:83], v[72:75], a[56:63], v1
  ds_write2_b32 v2, v78, v79 offset0:1 offset1:129
  ds_read_b128 v[88:91], v0 offset:16384
  v_smfmac_f32_16x16x64_bf16 v[84:87], v[72:75], a[120:127], v1
  ds_read_b128 v[92:95], v0 offset:17408
  v_smfmac_f32_16x16x64_bf16 v[96:99], v[44:47], v[128:135], v1
  v_smfmac_f32_16x16x64_bf16 v[100:103], v[44:47], v[192:199], v1
  ds_read_b128 v[44:47], v0 offset:20480
  s_nop 4
  v_add_f32 v80, v80, v82
  v_add_f32 v81, v81, v83
  v_add_f32 v84, v84, v86
  v_add_f32 v85, v85, v87
  v_cvt_pk_bf16_f32 v76, v80, v81
  v_cvt_pk_bf16_f32 v77, v84, v85
  ds_write2_b32 v2, v76, v77 offset0:0 offset1:128
  v_smfmac_f32_16x16x64_bf16 v[96:99], v[48:51], v[136:143], v1
  v_smfmac_f32_16x16x64_bf16 v[100:103], v[48:51], v[200:207], v1
  ds_read_b128 v[48:51], v0 offset:21504
  v_smfmac_f32_16x16x64_bf16 v[96:99], v[52:55], v[144:151], v1
  v_smfmac_f32_16x16x64_bf16 v[100:103], v[52:55], v[208:215], v1
  v_smfmac_f32_16x16x64_bf16 v[96:99], v[56:59], v[152:159], v1
  s_waitcnt vmcnt(6)
  s_waitcnt lgkmcnt(1)
  s_barrier
  ds_read_b64_tr_b16 v[112:113], v3 offset:0
  ds_read_b64_tr_b16 v[114:115], v3 offset:256
  v_smfmac_f32_16x16x64_bf16 v[100:103], v[56:59], v[216:223], v1
  ds_read_b64_tr_b16 v[116:117], v3 offset:1024
  ds_read_b64_tr_b16 v[118:119], v3 offset:1280
  v_smfmac_f32_16x16x64_bf16 v[96:99], v[60:63], v[160:167], v1
  ds_read_b64_tr_b16 v[120:121], v3 offset:2048
  ds_read_b64_tr_b16 v[122:123], v3 offset:2304
  v_smfmac_f32_16x16x64_bf16 v[100:103], v[60:63], v[224:231], v1
  ds_read_b64_tr_b16 v[124:125], v3 offset:3072
  ds_read_b64_tr_b16 v[126:127], v3 offset:3328
  v_smfmac_f32_16x16x64_bf16 v[96:99], v[64:67], v[168:175], v1
  ds_read_b128 v[52:55], v0 offset:22528
  v_smfmac_f32_16x16x64_bf16 v[100:103], v[64:67], v[232:239], v1
  ds_read_b128 v[56:59], v0 offset:23552
  s_waitcnt lgkmcnt(8)
  v_mfma_f32_16x16x32_bf16 v[80:83], v[88:91], v[112:115], 0
  s_waitcnt lgkmcnt(6)
  v_mfma_f32_16x16x32_bf16 v[80:83], v[92:95], v[116:119], v[80:83]
  ds_read_b128 v[60:63], v11 offset:8192
  s_waitcnt lgkmcnt(5)
  v_mfma_f32_16x16x32_bf16 v[80:83], v[104:107], v[120:123], v[80:83]
  ds_read_b128 v[64:67], v11 offset:9216
  s_waitcnt lgkmcnt(4)
  v_mfma_f32_16x16x32_bf16 v[80:83], v[108:111], v[124:127], v[80:83]
  ds_read_b128 v[108:111], v12 offset:32768
  v_mfma_f32_16x16x32_bf16 v[88:91], v[112:115], v[112:115], 0
  ds_read_b128 v[92:95], v12 offset:33792
  v_mfma_f32_16x16x32_bf16 v[88:91], v[116:119], v[116:119], v[88:91]
  v_mfma_f32_16x16x32_bf16 v[88:91], v[120:123], v[120:123], v[88:91]
  v_mfma_f32_16x16x32_bf16 v[88:91], v[124:127], v[124:127], v[88:91]
  s_nop 1
  v_exp_f32 v78, v80
  v_mfma_f32_16x16x32_bf16 v[84:87], v[44:47], v[112:115], 0
  v_exp_f32 v79, v81
  ds_read_b128 v[44:47], v11 offset:4096
  v_mfma_f32_16x16x32_bf16 v[84:87], v[48:51], v[116:119], v[84:87]
  ds_read_b128 v[48:51], v11 offset:5120
  v_cvt_pk_bf16_f32 v104, v78, v79
  v_exp_f32 v78, v82
  s_waitcnt lgkmcnt(7)
  v_mfma_f32_16x16x32_bf16 v[84:87], v[52:55], v[120:123], v[84:87]
  ds_read_b128 v[52:55], v11 offset:6144
  v_exp_f32 v79, v83
  s_waitcnt lgkmcnt(7)
  v_mfma_f32_16x16x32_bf16 v[84:87], v[56:59], v[124:127], v[84:87]
  ds_read_b128 v[56:59], v11 offset:7168
  v_cvt_pk_bf16_f32 v105, v78, v79
  v_max3_f32 v76, |v80|, |v81|, |v82|
  v_smfmac_f32_16x16x64_bf16 v[96:99], v[68:71], v[176:183], v1
  v_mul_f32 v90, s24, v90
  v_mul_f32 v91, s24, v91
  v_smfmac_f32_16x16x64_bf16 v[100:103], v[68:71], v[240:247], v1
  v_exp_f32 v88, v90
  v_exp_f32 v89, v91
  v_max3_f32 v76, v76, |v83|, v90
  ds_read_b128 v[68:71], v11 offset:10240
  v_smfmac_f32_16x16x64_bf16 v[96:99], v[72:75], v[184:191], v1
  v_cvt_pk_bf16_f32 v38, v88, v89
  v_cvt_pk_bf16_f32 v41, v88, v89
  v_smfmac_f32_16x16x64_bf16 v[100:103], v[72:75], v[248:255], v1
  ds_read_b128 v[72:75], v11 offset:11264
  v_max3_f32 v77, |v84|, |v85|, v91
  v_max3_f32 v76, v76, |v86|, |v87|
  v_max_f32 v76, v76, v77
  v_cmp_lt_f32 vcc, 0x42700000, v76
  v_exp_f32 v78, v84
  v_exp_f32 v79, v85
  s_nop 0
  v_cvt_pk_bf16_f32 v106, v78, v79
  v_exp_f32 v78, v86
  v_exp_f32 v79, v87
  s_nop 0
  v_cvt_pk_bf16_f32 v107, v78, v79
  s_and_b64 vcc, vcc, s[60:61]
  s_cbranch_scc1 L_rec_fb_s3
L_rec_fbret_s3:
  s_waitcnt lgkmcnt(6)
  v_add_f32 v96, v96, v98
  v_add_f32 v97, v97, v99
  v_mfma_f32_16x16x32_bf16 v[112:115], v[32:35], v[104:107], 0
  v_add_f32 v100, v100, v102
  v_mfma_f32_16x16x32_bf16 v[80:83], v[108:111], v[104:107], 0
  v_add_f32 v101, v101, v103
  v_mfma_f32_16x16x32_bf16 v[84:87], v[92:95], v[104:107], 0
  v_cvt_pk_bf16_f32 v42, v96, v97
  v_cvt_pk_bf16_f32 v43, v100, v101
  v_mfma_f32_16x16x16_bf16 v[112:115], v[32:33], v[38:39], v[112:115]
  ds_write2_b32 v13, v42, v43 offset0:0 offset1:64
  v_mfma_f32_16x16x16_bf16 v[80:83], v[42:43], v[38:39], v[80:83]
  v_mfma_f32_16x16x16_bf16 v[84:87], v[42:43], v[40:41], v[84:87]
  v_mov_b64 v[96:97], 0
  v_mov_b64 v[98:99], 0
  v_mov_b64 v[100:101], 0
  v_mov_b64 v[102:103], 0
  s_nop 0
  v_rcp_f32 v77, v112
  ds_read_b128 v[112:115], v11 offset:12288
  ds_read_b128 v[116:119], v11 offset:13312
  s_mov_b64 exec, s[60:61]
  v_mul_f32 v80, v80, v77
  v_mul_f32 v81, v81, v77
  v_mul_f32 v82, v82, v77
  v_mul_f32 v83, v83, v77
  v_cvt_pk_bf16_f32 v78, v80, v81
  v_cvt_pk_bf16_f32 v79, v82, v83
  ds_write_b64 v5, v[78:79]
  v_mul_f32 v84, v84, v77
  v_mul_f32 v85, v85, v77
  v_mul_f32 v86, v86, v77
  v_mul_f32 v87, v87, v77
  v_cvt_pk_bf16_f32 v76, v84, v85
  v_cvt_pk_bf16_f32 v77, v86, v87
  ds_write_b64 v5, v[76:77] offset:512
  s_mov_b64 exec, -1
  v_mfma_f32_32x32x8_bf16 v[80:95], v[36:37], v[36:37], 0
  v_mov_b64 v[104:105], 0
  v_mov_b64 v[106:107], 0
  v_mov_b64 v[108:109], 0
  v_mov_b64 v[110:111], 0
  s_waitcnt lgkmcnt(0)
  s_barrier
  ds_read_b128 v[120:123], v0 offset:45056
  ds_read_b128 v[124:127], v0 offset:46080
  s_waitcnt lgkmcnt(1)
  s_nop 0
  v_smfmac_f32_16x16x64_bf16 v[80:83], v[120:123], v[44:51], v1
  s_waitcnt lgkmcnt(0)
  v_smfmac_f32_16x16x64_bf16 v[80:83], v[124:127], v[52:59], v1
  ds_read_b128 v[44:47], v11 offset:24576
  v_smfmac_f32_16x16x64_bf16 v[84:87], v[120:123], v[60:67], v1
  ds_read_b128 v[48:51], v11 offset:25600
  v_smfmac_f32_16x16x64_bf16 v[84:87], v[124:127], v[68:75], v1
  ds_read_b128 v[52:55], v11 offset:26624
  v_smfmac_f32_16x16x64_bf16 v[88:91], v[120:123], v[112:119], v1
  ds_read_b128 v[56:59], v11 offset:27648
  v_smfmac_f32_16x16x64_bf16 v[88:91], v[124:127], v[16:23], v1
  ds_read_b128 v[60:63], v11 offset:28672
  v_add_f32 v80, v80, v82
  v_add_f32 v81, v81, v83
  v_cvt_pk_bf16_f32 v76, v80, v81
  v_and_or_b32 v76, v76, -2, 0
  v_smfmac_f32_16x16x64_bf16 v[92:95], v[120:123], v[24:31], v1
  ds_read_b128 v[64:67], v11 offset:29696
  v_smfmac_f32_16x16x64_bf16 v[92:95], v[124:127], a[128:135], v1
  ds_read_b128 v[68:71], v11 offset:30720
  v_add_f32 v84, v84, v86
  v_add_f32 v85, v85, v87
  v_cvt_pk_bf16_f32 v77, v84, v85
  v_smfmac_f32_16x16x64_bf16 v[96:99], v[120:123], a[192:199], v1
  ds_read_b128 v[72:75], v11 offset:31744
  v_smfmac_f32_16x16x64_bf16 v[96:99], v[124:127], a[136:143], v1
  v_add_f32 v88, v88, v90
  v_add_f32 v89, v89, v91
  v_cvt_pk_bf16_f32 v78, v88, v89
  v_smfmac_f32_16x16x64_bf16 v[100:103], v[120:123], a[200:207], v1
  v_smfmac_f32_16x16x64_bf16 v[100:103], v[124:127], a[0:7], v1
  v_add_f32 v92, v92, v94
  v_add_f32 v93, v93, v95
  v_cvt_pk_bf16_f32 v79, v92, v93
  global_store_dwordx4 v6, v[76:79], s[32:33] sc1
  s_waitcnt lgkmcnt(6)
  v_smfmac_f32_16x16x64_bf16 v[104:107], v[120:123], v[44:51], v1
  s_waitcnt lgkmcnt(4)
  v_smfmac_f32_16x16x64_bf16 v[104:107], v[124:127], v[52:59], v1
  v_add_f32 v96, v96, v98
  v_add_f32 v97, v97, v99
  v_cvt_pk_bf16_f32 v80, v96, v97
  v_and_or_b32 v80, v80, -2, 0
  s_waitcnt lgkmcnt(2)
  v_smfmac_f32_16x16x64_bf16 v[108:111], v[120:123], v[60:67], v1
  s_waitcnt lgkmcnt(0)
  v_smfmac_f32_16x16x64_bf16 v[108:111], v[124:127], v[68:75], v1
  v_add_f32 v100, v100, v102
  v_add_f32 v101, v101, v103
  v_cvt_pk_bf16_f32 v81, v100, v101
  v_add_f32 v104, v104, v106
  v_add_f32 v105, v105, v107
  v_cvt_pk_bf16_f32 v82, v104, v105
  s_nop 1
  v_add_f32 v108, v108, v110
  v_add_f32 v109, v109, v111
  v_cvt_pk_bf16_f32 v83, v108, v109
  global_store_dwordx4 v6, v[80:83], s[34:35] sc1
  s_lshl_b32 s54, s21, 10
  v_add_u32 v116, s54, v3
  ds_read_b64_tr_b16 v[112:113], v116
  ds_read_b64_tr_b16 v[114:115], v116 offset:256
  s_mov_b64 exec, s[60:61]
  ds_read_b128 v[112:115], v10
  s_mov_b64 exec, -1
  v_cndmask_b32 v60, 0, v14, s[8:9]
  v_cndmask_b32 v61, 0, v14, s[10:11]
  v_cndmask_b32 v62, 0, v14, s[12:13]
  v_cndmask_b32 v63, 0, v14, s[14:15]
  v_mfma_f32_32x32x8_bf16 v[80:95], v[36:37], v[36:37], 0
  v_mov_b64 v[96:97], 0
  v_mov_b64 v[98:99], 0
  v_mov_b64 v[100:101], 0
  v_mov_b64 v[102:103], 0
  ds_read_b128 v[104:107], v11 offset:20480
  ds_read_b128 v[108:111], v11 offset:21504
  ds_read_b128 v[120:123], v11 offset:22528
  ds_read_b128 v[124:127], v11 offset:23552
  ds_read_b128 v[52:55], v11 offset:14336
  ds_read_b128 v[56:59], v11 offset:15360
  ds_read_b128 v[68:71], v11 offset:18432
  ds_read_b128 v[72:75], v11 offset:19456
  v_mov_b32 v116, -1
  s_waitcnt lgkmcnt(8)
  v_min_u32 v112, -2, v112
  s_cmp_lt_u32 s21, 2
  s_cbranch_scc1 Lz_120
  s_nop 3
  s_nop 3
  s_nop 3
  s_nop 3
  s_nop 3
  s_nop 3
  s_nop 3
  s_nop 3
  s_nop 3
  s_nop 3
Lz_120:
  s_nop 3
  s_nop 3
  s_nop 3
  s_mov_b32 s27, 0
L_p2_s3:
  global_load_dwordx4 v[44:47], v8, s[38:39] sc1
  global_load_dwordx4 v[48:51], v8, s[38:39] offset:1024 sc1
  s_add_u32 s27, s27, 1
  s_cmp_gt_u32 s27, 0x400000
  s_cbranch_scc1 L_end
  s_waitcnt vmcnt(1)
  v_mfma_f32_16x16x32_bf16 v[64:67], v[44:47], v[60:63], 0
  s_waitcnt vmcnt(0)
  v_mfma_f32_16x16x32_bf16 v[64:67], v[48:51], v[60:63], v[64:67]
  v_or_b32 v117, v44, v48
  v_and_b32 v117, 1, v117
  v_cmp_ne_u32 vcc, 0, v117
  s_cbranch_vccnz L_p2_s3
  s_nop 3
  v_permlane32_swap_b32 v64, v66
  v_permlane32_swap_b32 v65, v67
  v_add_f32 v64, v64, v66
  v_add_f32 v65, v65, v67
  v_mov_b32 v66, v64
  v_mov_b32 v67, v65
  s_nop 0
  v_permlane16_swap_b32 v64, v66
  v_permlane16_swap_b32 v65, v67
  v_add_f32 v64, v64, v66
  v_add_f32 v65, v65, v67
  v_cvt_pk_bf16_f32 v64, v64, v65
  v_min_u32 v64, -2, v64
  global_store_dword v7, v64, s[46:47] sc1
  ds_read_b128 v[60:63], v11 offset:16384
  ds_read_b128 v[64:67], v11 offset:17408
  v_xor_b32 v76, 2048, v12
  v_xor_b32 v77, 4096, v12
  v_xor_b32 v78, 6144, v12
  s_cmp_ge_u32 s21, 2
  s_cbranch_scc1 Lz_121
  s_nop 3
  s_nop 3
  s_nop 3
  s_nop 3
  s_nop 3
  s_nop 3
  s_nop 3
  s_nop 3
  s_nop 3
  s_nop 3
Lz_121:
  s_nop 3
  s_nop 3
  s_nop 3
  s_nop 3
  s_nop 3
  s_mov_b32 s27, 0
L_p3_s3:
  global_load_dwordx4 v[44:47], v12, s[82:83] sc1
  global_load_dwordx4 v[48:51], v12, s[82:83] offset:1024 sc1
  s_add_u32 s27, s27, 1
  s_cmp_gt_u32 s27, 0x400000
  s_cbranch_scc1 L_end
L_p3b_s3:
  s_waitcnt vmcnt(1)
  ds_write_b128 v12, v[44:47] offset:0
  v_max3_u32 v117, v44, v45, v46
  s_waitcnt vmcnt(0)
  ds_write_b128 v12, v[48:51] offset:1024
  v_max3_u32 v118, v47, v48, v49
  v_max3_u32 v117, v117, v50, v51
  v_max_u32 v117, v117, v118
  v_cmp_eq_u32 vcc, -1, v117
  s_cbranch_vccnz L_p3_s3
L_rec_acc_s3:
L_rec_join_s3:
  s_add_u32 s22, s22, 1
  s_branch L_rec_step_s0
L_rec_fb_s0:
  v_max3_f32 v76, v80, v81, v82
  v_max3_f32 v77, v83, v84, v85
  v_max3_f32 v76, v76, v86, v87
  v_max3_f32 v76, v76, v90, v91
  v_max_f32 v76, v76, v77
  v_mov_b32 v77, v76
  s_nop 1
  v_permlane16_swap_b32 v76, v77
  v_max_f32 v76, v76, v77
  v_mov_b32 v77, v76
  s_nop 1
  v_permlane32_swap_b32 v76, v77
  v_max_f32 v76, v76, v77
  v_sub_f32 v80, v80, v76
  v_sub_f32 v81, v81, v76
  v_sub_f32 v82, v82, v76
  v_sub_f32 v83, v83, v76
  v_sub_f32 v84, v84, v76
  v_sub_f32 v85, v85, v76
  v_sub_f32 v86, v86, v76
  v_sub_f32 v87, v87, v76
  v_sub_f32 v90, v90, v76
  v_sub_f32 v91, v91, v76
  v_exp_f32 v78, v80
  v_exp_f32 v79, v81
  s_nop 0
  v_cvt_pk_bf16_f32 v104, v78, v79
  v_exp_f32 v78, v82
  v_exp_f32 v79, v83
  s_nop 0
  v_cvt_pk_bf16_f32 v105, v78, v79
  v_exp_f32 v78, v84
  v_exp_f32 v79, v85
  s_nop 0
  v_cvt_pk_bf16_f32 v106, v78, v79
  v_exp_f32 v78, v86
  v_exp_f32 v79, v87
  s_nop 0
  v_cvt_pk_bf16_f32 v107, v78, v79
  v_exp_f32 v88, v90
  v_exp_f32 v89, v91
  s_nop 0
  v_cvt_pk_bf16_f32 v38, v88, v89
  v_cvt_pk_bf16_f32 v41, v88, v89
  s_nop 1
  s_branch L_rec_fbret_s0
L_rec_fb_s1:
  v_max3_f32 v76, v80, v81, v82
  v_max3_f32 v77, v83, v84, v85
  v_max3_f32 v76, v76, v86, v87
  v_max3_f32 v76, v76, v90, v91
  v_max_f32 v76, v76, v77
  v_mov_b32 v77, v76
  s_nop 1
  v_permlane16_swap_b32 v76, v77
  v_max_f32 v76, v76, v77
  v_mov_b32 v77, v76
  s_nop 1
  v_permlane32_swap_b32 v76, v77
  v_max_f32 v76, v76, v77
  v_sub_f32 v80, v80, v76
  v_sub_f32 v81, v81, v76
  v_sub_f32 v82, v82, v76
  v_sub_f32 v83, v83, v76
  v_sub_f32 v84, v84, v76
  v_sub_f32 v85, v85, v76
  v_sub_f32 v86, v86, v76
  v_sub_f32 v87, v87, v76
  v_sub_f32 v90, v90, v76
  v_sub_f32 v91, v91, v76
  v_exp_f32 v78, v80
  v_exp_f32 v79, v81
  s_nop 0
  v_cvt_pk_bf16_f32 v104, v78, v79
  v_exp_f32 v78, v82
  v_exp_f32 v79, v83
  s_nop 0
  v_cvt_pk_bf16_f32 v105, v78, v79
  v_exp_f32 v78, v84
  v_exp_f32 v79, v85
  s_nop 0
  v_cvt_pk_bf16_f32 v106, v78, v79
  v_exp_f32 v78, v86
  v_exp_f32 v79, v87
  s_nop 0
  v_cvt_pk_bf16_f32 v107, v78, v79
  v_exp_f32 v88, v90
  v_exp_f32 v89, v91
  s_nop 0
  v_cvt_pk_bf16_f32 v38, v88, v89
  v_cvt_pk_bf16_f32 v41, v88, v89
  s_nop 1
  s_branch L_rec_fbret_s1
L_rec_fb_s2:
  v_max3_f32 v76, v80, v81, v82
  v_max3_f32 v77, v83, v84, v85
  v_max3_f32 v76, v76, v86, v87
  v_max3_f32 v76, v76, v90, v91
  v_max_f32 v76, v76, v77
  v_mov_b32 v77, v76
  s_nop 1
  v_permlane16_swap_b32 v76, v77
  v_max_f32 v76, v76, v77
  v_mov_b32 v77, v76
  s_nop 1
  v_permlane32_swap_b32 v76, v77
  v_max_f32 v76, v76, v77
  v_sub_f32 v80, v80, v76
  v_sub_f32 v81, v81, v76
  v_sub_f32 v82, v82, v76
  v_sub_f32 v83, v83, v76
  v_sub_f32 v84, v84, v76
  v_sub_f32 v85, v85, v76
  v_sub_f32 v86, v86, v76
  v_sub_f32 v87, v87, v76
  v_sub_f32 v90, v90, v76
  v_sub_f32 v91, v91, v76
  v_exp_f32 v78, v80
  v_exp_f32 v79, v81
  s_nop 0
  v_cvt_pk_bf16_f32 v104, v78, v79
  v_exp_f32 v78, v82
  v_exp_f32 v79, v83
  s_nop 0
  v_cvt_pk_bf16_f32 v105, v78, v79
  v_exp_f32 v78, v84
  v_exp_f32 v79, v85
  s_nop 0
  v_cvt_pk_bf16_f32 v106, v78, v79
  v_exp_f32 v78, v86
  v_exp_f32 v79, v87
  s_nop 0
  v_cvt_pk_bf16_f32 v107, v78, v79
  v_exp_f32 v88, v90
  v_exp_f32 v89, v91
  s_nop 0
  v_cvt_pk_bf16_f32 v38, v88, v89
  v_cvt_pk_bf16_f32 v41, v88, v89
  s_nop 1
  s_branch L_rec_fbret_s2
L_rec_fb_s3:
  v_max3_f32 v76, v80, v81, v82
  v_max3_f32 v77, v83, v84, v85
  v_max3_f32 v76, v76, v86, v87
  v_max3_f32 v76, v76, v90, v91
  v_max_f32 v76, v76, v77
  v_mov_b32 v77, v76
  s_nop 1
  v_permlane16_swap_b32 v76, v77
  v_max_f32 v76, v76, v77
  v_mov_b32 v77, v76
  s_nop 1
  v_permlane32_swap_b32 v76, v77
  v_max_f32 v76, v76, v77
  v_sub_f32 v80, v80, v76
  v_sub_f32 v81, v81, v76
  v_sub_f32 v82, v82, v76
  v_sub_f32 v83, v83, v76
  v_sub_f32 v84, v84, v76
  v_sub_f32 v85, v85, v76
  v_sub_f32 v86, v86, v76
  v_sub_f32 v87, v87, v76
  v_sub_f32 v90, v90, v76
  v_sub_f32 v91, v91, v76
  v_exp_f32 v78, v80
  v_exp_f32 v79, v81
  s_nop 0
  v_cvt_pk_bf16_f32 v104, v78, v79
  v_exp_f32 v78, v82
  v_exp_f32 v79, v83
  s_nop 0
  v_cvt_pk_bf16_f32 v105, v78, v79
  v_exp_f32 v78, v84
  v_exp_f32 v79, v85
  s_nop 0
  v_cvt_pk_bf16_f32 v106, v78, v79
  v_exp_f32 v78, v86
  v_exp_f32 v79, v87
  s_nop 0
  v_cvt_pk_bf16_f32 v107, v78, v79
  v_exp_f32 v88, v90
  v_exp_f32 v89, v91
  s_nop 0
  v_cvt_pk_bf16_f32 v38, v88, v89
  v_cvt_pk_bf16_f32 v41, v88, v89
  s_nop 1
  s_branch L_rec_fbret_s3
L_rec_last:
  s_waitcnt lgkmcnt(0)
  v_smfmac_f32_16x16x64_bf16 v[88:91], v[44:47], v[52:59], v1
  v_smfmac_f32_16x16x64_bf16 v[92:95], v[44:47], v[60:67], v1
  v_smfmac_f32_16x16x64_bf16 v[88:91], v[48:51], v[68:75], v1
  v_smfmac_f32_16x16x64_bf16 v[92:95], v[48:51], v[104:111], v1
  s_barrier
  ds_read_b128 v[52:55], v76 offset:0
  ds_read_b128 v[56:59], v76 offset:1024
  ds_read_b128 v[60:63], v77 offset:0
  ds_read_b128 v[64:67], v77 offset:1024
  ds_read_b128 v[68:71], v78 offset:0
  ds_read_b128 v[72:75], v78 offset:1024
  global_store_dwordx4 v9, v[112:115], s[50:51] sc1
  v_smfmac_f32_16x16x64_bf16 v[96:99], v[44:47], v[128:135], v1
  v_smfmac_f32_16x16x64_bf16 v[100:103], v[44:47], v[192:199], v1
  v_smfmac_f32_16x16x64_bf16 v[96:99], v[48:51], v[136:143], v1
  v_smfmac_f32_16x16x64_bf16 v[100:103], v[48:51], v[200:207], v1
  v_add_u32 v9, 0x20000, v9
  s_waitcnt lgkmcnt(5)
  v_smfmac_f32_16x16x64_bf16 v[88:91], v[52:55], a[144:151], v1
  v_smfmac_f32_16x16x64_bf16 v[92:95], v[52:55], a[208:215], v1
  s_waitcnt lgkmcnt(4)
  v_smfmac_f32_16x16x64_bf16 v[88:91], v[56:59], a[152:159], v1
  v_smfmac_f32_16x16x64_bf16 v[92:95], v[56:59], a[216:223], v1
  s_waitcnt lgkmcnt(3)
  v_smfmac_f32_16x16x64_bf16 v[88:91], v[60:63], a[160:167], v1
  v_smfmac_f32_16x16x64_bf16 v[92:95], v[60:63], a[224:231], v1
  s_waitcnt lgkmcnt(2)
  v_smfmac_f32_16x16x64_bf16 v[88:91], v[64:67], a[168:175], v1
  v_smfmac_f32_16x16x64_bf16 v[92:95], v[64:67], a[232:239], v1
  s_waitcnt lgkmcnt(1)
  v_smfmac_f32_16x16x64_bf16 v[88:91], v[68:71], a[176:183], v1
  v_smfmac_f32_16x16x64_bf16 v[92:95], v[68:71], a[240:247], v1
  s_waitcnt lgkmcnt(0)
  v_smfmac_f32_16x16x64_bf16 v[88:91], v[72:75], a[184:191], v1
  v_smfmac_f32_16x16x64_bf16 v[92:95], v[72:75], a[248:255], v1
  v_smfmac_f32_16x16x64_bf16 v[96:99], v[52:55], v[144:151], v1
  v_smfmac_f32_16x16x64_bf16 v[100:103], v[52:55], v[208:215], v1
  v_smfmac_f32_16x16x64_bf16 v[96:99], v[56:59], v[152:159], v1
  v_smfmac_f32_16x16x64_bf16 v[100:103], v[56:59], v[216:223], v1
  v_smfmac_f32_16x16x64_bf16 v[96:99], v[60:63], v[160:167], v1
  v_smfmac_f32_16x16x64_bf16 v[100:103], v[60:63], v[224:231], v1
  v_smfmac_f32_16x16x64_bf16 v[96:99], v[64:67], v[168:175], v1
  v_smfmac_f32_16x16x64_bf16 v[100:103], v[64:67], v[232:239], v1
  v_smfmac_f32_16x16x64_bf16 v[96:99], v[68:71], v[176:183], v1
  v_smfmac_f32_16x16x64_bf16 v[100:103], v[68:71], v[240:247], v1
  v_add_f32 v88, v88, v90
  v_add_f32 v89, v89, v91
  v_add_f32 v92, v92, v94
  v_add_f32 v93, v93, v95
  v_cvt_pk_bf16_f32 v78, v88, v89
  v_cvt_pk_bf16_f32 v79, v92, v93
  ds_write2_b32 v2, v78, v79 offset0:1 offset1:129
  v_smfmac_f32_16x16x64_bf16 v[96:99], v[72:75], v[184:191], v1
  v_smfmac_f32_16x16x64_bf16 v[100:103], v[72:75], v[248:255], v1
  s_nop 6
  v_add_f32 v96, v96, v98
  v_add_f32 v97, v97, v99
  v_add_f32 v100, v100, v102
  v_add_f32 v101, v101, v103
  v_cvt_pk_bf16_f32 v42, v96, v97
  v_cvt_pk_bf16_f32 v43, v100, v101
  ds_write2_b32 v13, v42, v43 offset0:0 offset1:64
  s_lshl_b32 s54, s21, 10
  v_add_u32 v48, s54, v3
  ds_read_b64_tr_b16 v[44:45], v48
  ds_read_b64_tr_b16 v[46:47], v48 offset:256
  s_mov_b64 exec, s[60:61]
  ds_read_b128 v[44:47], v10
  s_mov_b64 exec, -1
  s_waitcnt lgkmcnt(0)
  v_min_u32 v44, -2, v44
  global_store_dwordx4 v9, v[44:47], s[50:51] sc1
  s_branch L_end
L_end:
  s_waitcnt vmcnt(0)
  s_endpgm
.section .rodata,"a"
.p2align 8
L_tables:
  .long 0x0, 0x0, 0x0, 0x0
  .long 0x400, 0x10, 0x10, 0x10
  .long 0x800, 0x20, 0x20, 0x20
  .long 0xc00, 0x30, 0x30, 0x30
  .long 0x1000, 0x40, 0x40, 0x40
  .long 0x1400, 0x50, 0x50, 0x50
  .long 0x1800, 0x60, 0x60, 0x60
  .long 0x1c00, 0x70, 0x70, 0x70
  .long 0x2000, 0x80, 0x80, 0x80
  .long 0x2400, 0x90, 0x90, 0x90
  .long 0x2800, 0xa0, 0xa0, 0xa0
  .long 0x2c00, 0xb0, 0xb0, 0xb0
  .long 0x3000, 0xc0, 0xc0, 0xc0
  .long 0x3400, 0xd0, 0xd0, 0xd0
  .long 0x3800, 0xe0, 0xe0, 0xe0
  .long 0x3c00, 0xf0, 0xf0, 0xf0
  .long 0x4000, 0x2040, 0x1000, 0x400
  .long 0x4400, 0x2050, 0x1010, 0x410
  .long 0x4800, 0x2060, 0x1020, 0x420
  .long 0x4c00, 0x2070, 0x1030, 0x430
  .long 0x5000, 0x2000, 0x1040, 0x440
  .long 0x5400, 0x2010, 0x1050, 0x450
  .long 0x5800, 0x2020, 0x1060, 0x460
  .long 0x5c00, 0x2030, 0x1070, 0x470
  .long 0x6000, 0x20c0, 0x1080, 0x480
  .long 0x6400, 0x20d0, 0x1090, 0x490
  .long 0x6800, 0x20e0, 0x10a0, 0x4a0
  .long 0x6c00, 0x20f0, 0x10b0, 0x4b0
  .long 0x7000, 0x2080, 0x10c0, 0x4c0
  .long 0x7400, 0x2090, 0x10d0, 0x4d0
  .long 0x7800, 0x20a0, 0x10e0, 0x4e0
  .long 0x7c00, 0x20b0, 0x10f0, 0x4f0
  .long 0x10, 0x4080, 0x100, 0x100
  .long 0x410, 0x4090, 0x110, 0x110
  .long 0x810, 0x40a0, 0x120, 0x120
  .long 0xc10, 0x40b0, 0x130, 0x130
  .long 0x1010, 0x40c0, 0x140, 0x140
  .long 0x1410, 0x40d0, 0x150, 0x150
  .long 0x1810, 0x40e0, 0x160, 0x160
  .long 0x1c10, 0x40f0, 0x170, 0x170
  .long 0x2010, 0x4000, 0x180, 0x180
  .long 0x2410, 0x4010, 0x190, 0x190
  .long 0x2810, 0x4020, 0x1a0, 0x1a0
  .long 0x2c10, 0x4030, 0x1b0, 0x1b0
  .long 0x3010, 0x4040, 0x1c0, 0x1c0
  .long 0x3410, 0x4050, 0x1d0, 0x1d0
  .long 0x3810, 0x4060, 0x1e0, 0x1e0
  .long 0x3c10, 0x4070, 0x1f0, 0x1f0
  .long 0x4010, 0x60c0, 0x1100, 0x500
  .long 0x4410, 0x60d0, 0x1110, 0x510
  .long 0x4810, 0x60e0, 0x1120, 0x520
  .long 0x4c10, 0x60f0, 0x1130, 0x530
  .long 0x5010, 0x6080, 0x1140, 0x540
  .long 0x5410, 0x6090, 0x1150, 0x550
  .long 0x5810, 0x60a0, 0x1160, 0x560
  .long 0x5c10, 0x60b0, 0x1170, 0x570
  .long 0x6010, 0x6040, 0x1180, 0x580
  .long 0x6410, 0x6050, 0x1190, 0x590
  .long 0x6810, 0x6060, 0x11a0, 0x5a0
  .long 0x6c10, 0x6070, 0x11b0, 0x5b0
  .long 0x7010, 0x6000, 0x11c0, 0x5c0
  .long 0x7410, 0x6010, 0x11d0, 0x5d0
  .long 0x7810, 0x6020, 0x11e0, 0x5e0
  .long 0x7c10, 0x6030, 0x11f0, 0x5f0
  .long 0x8000, 0x20000, 0x40000, 0x40000
  .long 0x8400, 0x20010, 0x40010, 0x40010
  .long 0x8800, 0x20020, 0x40020, 0x40020
  .long 0x8c00, 0x20030, 0x40030, 0x40030
  .long 0x9000, 0x20040, 0x40040, 0x40040
  .long 0x9400, 0x20050, 0x40050, 0x40050
  .long 0x9800, 0x20060, 0x40060, 0x40060
  .long 0x9c00, 0x20070, 0x40070, 0x40070
  .long 0xa000, 0x20080, 0x40080, 0x40080
  .long 0xa400, 0x20090, 0x40090, 0x40090
  .long 0xa800, 0x200a0, 0x400a0, 0x400a0
  .long 0xac00, 0x200b0, 0x400b0, 0x400b0
  .long 0xb000, 0x200c0, 0x400c0, 0x400c0
  .long 0xb400, 0x200d0, 0x400d0, 0x400d0
  .long 0xb800, 0x200e0, 0x400e0, 0x400e0
  .long 0xbc00, 0x200f0, 0x400f0, 0x400f0
  .long 0xc000, 0x22040, 0x41000, 0x40400
  .long 0xc400, 0x22050, 0x41010, 0x40410
  .long 0xc800, 0x22060, 0x41020, 0x40420
  .long 0xcc00, 0x22070, 0x41030, 0x40430
  .long 0xd000, 0x22000, 0x41040, 0x40440
  .long 0xd400, 0x22010, 0x41050, 0x40450
  .long 0xd800, 0x22020, 0x41060, 0x40460
  .long 0xdc00, 0x22030, 0x41070, 0x40470
  .long 0xe000, 0x220c0, 0x41080, 0x40480
  .long 0xe400, 0x220d0, 0x41090, 0x40490
  .long 0xe800, 0x220e0, 0x410a0, 0x404a0
  .long 0xec00, 0x220f0, 0x410b0, 0x404b0
  .long 0xf000, 0x22080, 0x410c0, 0x404c0
  .long 0xf400, 0x22090, 0x410d0, 0x404d0
  .long 0xf800, 0x220a0, 0x410e0, 0x404e0
  .long 0xfc00, 0x220b0, 0x410f0, 0x404f0
  .long 0x8010, 0x24080, 0x40100, 0x40100
  .long 0x8410, 0x24090, 0x40110, 0x40110
  .long 0x8810, 0x240a0, 0x40120, 0x40120
  .long 0x8c10, 0x240b0, 0x40130, 0x40130
  .long 0x9010, 0x240c0, 0x40140, 0x40140
  .long 0x9410, 0x240d0, 0x40150, 0x40150
  .long 0x9810, 0x240e0, 0x40160, 0x40160
  .long 0x9c10, 0x240f0, 0x40170, 0x40170
  .long 0xa010, 0x24000, 0x40180, 0x40180
  .long 0xa410, 0x24010, 0x40190, 0x40190
  .long 0xa810, 0x24020, 0x401a0, 0x401a0
  .long 0xac10, 0x24030, 0x401b0, 0x401b0
  .long 0xb010, 0x24040, 0x401c0, 0x401c0
  .long 0xb410, 0x24050, 0x401d0, 0x401d0
  .long 0xb810, 0x24060, 0x401e0, 0x401e0
  .long 0xbc10, 0x24070, 0x401f0, 0x401f0
  .long 0xc010, 0x260c0, 0x41100, 0x40500
  .long 0xc410, 0x260d0, 0x41110, 0x40510
  .long 0xc810, 0x260e0, 0x41120, 0x40520
  .long 0xcc10, 0x260f0, 0x41130, 0x40530
  .long 0xd010, 0x26080, 0x41140, 0x40540
  .long 0xd410, 0x26090, 0x41150, 0x40550
  .long 0xd810, 0x260a0, 0x41160, 0x40560
  .long 0xdc10, 0x260b0, 0x41170, 0x40570
  .long 0xe010, 0x26040, 0x41180, 0x40580
  .long 0xe410, 0x26050, 0x41190, 0x40590
  .long 0xe810, 0x26060, 0x411a0, 0x405a0
  .long 0xec10, 0x26070, 0x411b0, 0x405b0
  .long 0xf010, 0x26000, 0x411c0, 0x405c0
  .long 0xf410, 0x26010, 0x411d0, 0x405d0
  .long 0xf810, 0x26020, 0x411e0, 0x405e0
  .long 0xfc10, 0x26030, 0x411f0, 0x405f0
  .long 0x10000, 0x40000, 0x80000, 0x80000
  .long 0x10400, 0x40010, 0x80010, 0x80010
  .long 0x10800, 0x40020, 0x80020, 0x80020
  .long 0x10c00, 0x40030, 0x80030, 0x80030
  .long 0x11000, 0x40040, 0x80040, 0x80040
  .long 0x11400, 0x40050, 0x80050, 0x80050
  .long 0x11800, 0x40060, 0x80060, 0x80060
  .long 0x11c00, 0x40070, 0x80070, 0x80070
  .long 0x12000, 0x40080, 0x80080, 0x80080
  .long 0x12400, 0x40090, 0x80090, 0x80090
  .long 0x12800, 0x400a0, 0x800a0, 0x800a0
  .long 0x12c00, 0x400b0, 0x800b0, 0x800b0
  .long 0x13000, 0x400c0, 0x800c0, 0x800c0
  .long 0x13400, 0x400d0, 0x800d0, 0x800d0
  .long 0x13800, 0x400e0, 0x800e0, 0x800e0
  .long 0x13c00, 0x400f0, 0x800f0, 0x800f0
  .long 0x14000, 0x42040, 0x81000, 0x80400
  .long 0x14400, 0x42050, 0x81010, 0x80410
  .long 0x14800, 0x42060, 0x81020, 0x80420
  .long 0x14c00, 0x42070, 0x81030, 0x80430
  .long 0x15000, 0x42000, 0x81040, 0x80440
  .long 0x15400, 0x42010, 0x81050, 0x80450
  .long 0x15800, 0x42020, 0x81060, 0x80460
  .long 0x15c00, 0x42030, 0x81070, 0x80470
  .long 0x16000, 0x420c0, 0x81080, 0x80480
  .long 0x16400, 0x420d0, 0x81090, 0x80490
  .long 0x16800, 0x420e0, 0x810a0, 0x804a0
  .long 0x16c00, 0x420f0, 0x810b0, 0x804b0
  .long 0x17000, 0x42080, 0x810c0, 0x804c0
  .long 0x17400, 0x42090, 0x810d0, 0x804d0
  .long 0x17800, 0x420a0, 0x810e0, 0x804e0
  .long 0x17c00, 0x420b0, 0x810f0, 0x804f0
  .long 0x10010, 0x44080, 0x80100, 0x80100
  .long 0x10410, 0x44090, 0x80110, 0x80110
  .long 0x10810, 0x440a0, 0x80120, 0x80120
  .long 0x10c10, 0x440b0, 0x80130, 0x80130
  .long 0x11010, 0x440c0, 0x80140, 0x80140
  .long 0x11410, 0x440d0, 0x80150, 0x80150
  .long 0x11810, 0x440e0, 0x80160, 0x80160
  .long 0x11c10, 0x440f0, 0x80170, 0x80170
  .long 0x12010, 0x44000, 0x80180, 0x80180
  .long 0x12410, 0x44010, 0x80190, 0x80190
  .long 0x12810, 0x44020, 0x801a0, 0x801a0
  .long 0x12c10, 0x44030, 0x801b0, 0x801b0
  .long 0x13010, 0x44040, 0x801c0, 0x801c0
  .long 0x13410, 0x44050, 0x801d0, 0x801d0
  .long 0x13810, 0x44060, 0x801e0, 0x801e0
  .long 0x13c10, 0x44070, 0x801f0, 0x801f0
  .long 0x14010, 0x460c0, 0x81100, 0x80500
  .long 0x14410, 0x460d0, 0x81110, 0x80510
  .long 0x14810, 0x460e0, 0x81120, 0x80520
  .long 0x14c10, 0x460f0, 0x81130, 0x80530
  .long 0x15010, 0x46080, 0x81140, 0x80540
  .long 0x15410, 0x46090, 0x81150, 0x80550
  .long 0x15810, 0x460a0, 0x81160, 0x80560
  .long 0x15c10, 0x460b0, 0x81170, 0x80570
  .long 0x16010, 0x46040, 0x81180, 0x80580
  .long 0x16410, 0x46050, 0x81190, 0x80590
  .long 0x16810, 0x46060, 0x811a0, 0x805a0
  .long 0x16c10, 0x46070, 0x811b0, 0x805b0
  .long 0x17010, 0x46000, 0x811c0, 0x805c0
  .long 0x17410, 0x46010, 0x811d0, 0x805d0
  .long 0x17810, 0x46020, 0x811e0, 0x805e0
  .long 0x17c10, 0x46030, 0x811f0, 0x805f0
  .long 0x18000, 0x60000, 0xc0000, 0xc0000
  .long 0x18400, 0x60010, 0xc0010, 0xc0010
  .long 0x18800, 0x60020, 0xc0020, 0xc0020
  .long 0x18c00, 0x60030, 0xc0030, 0xc0030
  .long 0x19000, 0x60040, 0xc0040, 0xc0040
  .long 0x19400, 0x60050, 0xc0050, 0xc0050
  .long 0x19800, 0x60060, 0xc0060, 0xc0060
  .long 0x19c00, 0x60070, 0xc0070, 0xc0070
  .long 0x1a000, 0x60080, 0xc0080, 0xc0080
  .long 0x1a400, 0x60090, 0xc0090, 0xc0090
  .long 0x1a800, 0x600a0, 0xc00a0, 0xc00a0
  .long 0x1ac00, 0x600b0, 0xc00b0, 0xc00b0
  .long 0x1b000, 0x600c0, 0xc00c0, 0xc00c0
  .long 0x1b400, 0x600d0, 0xc00d0, 0xc00d0
  .long 0x1b800, 0x600e0, 0xc00e0, 0xc00e0
  .long 0x1bc00, 0x600f0, 0xc00f0, 0xc00f0
  .long 0x1c000, 0x62040, 0xc1000, 0xc0400
  .long 0x1c400, 0x62050, 0xc1010, 0xc0410
  .long 0x1c800, 0x62060, 0xc1020, 0xc0420
  .long 0x1cc00, 0x62070, 0xc1030, 0xc0430
  .long 0x1d000, 0x62000, 0xc1040, 0xc0440
  .long 0x1d400, 0x62010, 0xc1050, 0xc0450
  .long 0x1d800, 0x62020, 0xc1060, 0xc0460
  .long 0x1dc00, 0x62030, 0xc1070, 0xc0470
  .long 0x1e000, 0x620c0, 0xc1080, 0xc0480
  .long 0x1e400, 0x620d0, 0xc1090, 0xc0490
  .long 0x1e800, 0x620e0, 0xc10a0, 0xc04a0
  .long 0x1ec00, 0x620f0, 0xc10b0, 0xc04b0
  .long 0x1f000, 0x62080, 0xc10c0, 0xc04c0
  .long 0x1f400, 0x62090, 0xc10d0, 0xc04d0
  .long 0x1f800, 0x620a0, 0xc10e0, 0xc04e0
  .long 0x1fc00, 0x620b0, 0xc10f0, 0xc04f0
  .long 0x18010, 0x64080, 0xc0100, 0xc0100
  .long 0x18410, 0x64090, 0xc0110, 0xc0110
  .long 0x18810, 0x640a0, 0xc0120, 0xc0120
  .long 0x18c10, 0x640b0, 0xc0130, 0xc0130
  .long 0x19010, 0x640c0, 0xc0140, 0xc0140
  .long 0x19410, 0x640d0, 0xc0150, 0xc0150
  .long 0x19810, 0x640e0, 0xc0160, 0xc0160
  .long 0x19c10, 0x640f0, 0xc0170, 0xc0170
  .long 0x1a010, 0x64000, 0xc0180, 0xc0180
  .long 0x1a410, 0x64010, 0xc0190, 0xc0190
  .long 0x1a810, 0x64020, 0xc01a0, 0xc01a0
  .long 0x1ac10, 0x64030, 0xc01b0, 0xc01b0
  .long 0x1b010, 0x64040, 0xc01c0, 0xc01c0
  .long 0x1b410, 0x64050, 0xc01d0, 0xc01d0
  .long 0x1b810, 0x64060, 0xc01e0, 0xc01e0
  .long 0x1bc10, 0x64070, 0xc01f0, 0xc01f0
  .long 0x1c010, 0x660c0, 0xc1100, 0xc0500
  .long 0x1c410, 0x660d0, 0xc1110, 0xc0510
  .long 0x1c810, 0x660e0, 0xc1120, 0xc0520
  .long 0x1cc10, 0x660f0, 0xc1130, 0xc0530
  .long 0x1d010, 0x66080, 0xc1140, 0xc0540
  .long 0x1d410, 0x66090, 0xc1150, 0xc0550
  .long 0x1d810, 0x660a0, 0xc1160, 0xc0560
  .long 0x1dc10, 0x660b0, 0xc1170, 0xc0570
  .long 0x1e010, 0x66040, 0xc1180, 0xc0580
  .long 0x1e410, 0x66050, 0xc1190, 0xc0590
  .long 0x1e810, 0x66060, 0xc11a0, 0xc05a0
  .long 0x1ec10, 0x66070, 0xc11b0, 0xc05b0
  .long 0x1f010, 0x66000, 0xc11c0, 0xc05c0
  .long 0x1f410, 0x66010, 0xc11d0, 0xc05d0
  .long 0x1f810, 0x66020, 0xc11e0, 0xc05e0
  .long 0x1fc10, 0x66030, 0xc11f0, 0xc05f0
  .long 0x0, 0x40, 0x80, 0xc0
  .long 0x8, 0x48, 0x88, 0xc8
  .long 0x10, 0x50, 0x90, 0xd0
  .long 0x18, 0x58, 0x98, 0xd8
  .long 0x140, 0x100, 0x1c0, 0x180
  .long 0x148, 0x108, 0x1c8, 0x188
  .long 0x150, 0x110, 0x1d0, 0x190
  .long 0x158, 0x118, 0x1d8, 0x198
  .long 0x280, 0x2c0, 0x200, 0x240
  .long 0x288, 0x2c8, 0x208, 0x248
  .long 0x290, 0x2d0, 0x210, 0x250
  .long 0x298, 0x2d8, 0x218, 0x258
  .long 0x3c0, 0x380, 0x340, 0x300
  .long 0x3c8, 0x388, 0x348, 0x308
  .long 0x3d0, 0x390, 0x350, 0x310
  .long 0x3d8, 0x398, 0x358, 0x318
  .long 0x20, 0x60, 0xa0, 0xe0
  .long 0x28, 0x68, 0xa8, 0xe8
  .long 0x30, 0x70, 0xb0, 0xf0
  .long 0x38, 0x78, 0xb8, 0xf8
  .long 0x160, 0x120, 0x1e0, 0x1a0
  .long 0x168, 0x128, 0x1e8, 0x1a8
  .long 0x170, 0x130, 0x1f0, 0x1b0
  .long 0x178, 0x138, 0x1f8, 0x1b8
  .long 0x2a0, 0x2e0, 0x220, 0x260
  .long 0x2a8, 0x2e8, 0x228, 0x268
  .long 0x2b0, 0x2f0, 0x230, 0x270
  .long 0x2b8, 0x2f8, 0x238, 0x278
  .long 0x3e0, 0x3a0, 0x360, 0x320
  .long 0x3e8, 0x3a8, 0x368, 0x328
  .long 0x3f0, 0x3b0, 0x370, 0x330
  .long 0x3f8, 0x3b8, 0x378, 0x338
  .long 0x800, 0x840, 0x880, 0x8c0
  .long 0x808, 0x848, 0x888, 0x8c8
  .long 0x810, 0x850, 0x890, 0x8d0
  .long 0x818, 0x858, 0x898, 0x8d8
  .long 0x940, 0x900, 0x9c0, 0x980
  .long 0x948, 0x908, 0x9c8, 0x988
  .long 0x950, 0x910, 0x9d0, 0x990
  .long 0x958, 0x918, 0x9d8, 0x998
  .long 0xa80, 0xac0, 0xa00, 0xa40
  .long 0xa88, 0xac8, 0xa08, 0xa48
  .long 0xa90, 0xad0, 0xa10, 0xa50
  .long 0xa98, 0xad8, 0xa18, 0xa58
  .long 0xbc0, 0xb80, 0xb40, 0xb00
  .long 0xbc8, 0xb88, 0xb48, 0xb08
  .long 0xbd0, 0xb90, 0xb50, 0xb10
  .long 0xbd8, 0xb98, 0xb58, 0xb18
  .long 0x820, 0x860, 0x8a0, 0x8e0
  .long 0x828, 0x868, 0x8a8, 0x8e8
  .long 0x830, 0x870, 0x8b0, 0x8f0
  .long 0x838, 0x878, 0x8b8, 0x8f8
  .long 0x960, 0x920, 0x9e0, 0x9a0
  .long 0x968, 0x928, 0x9e8, 0x9a8
  .long 0x970, 0x930, 0x9f0, 0x9b0
  .long 0x978, 0x938, 0x9f8, 0x9b8
  .long 0xaa0, 0xae0, 0xa20, 0xa60
  .long 0xaa8, 0xae8, 0xa28, 0xa68
  .long 0xab0, 0xaf0, 0xa30, 0xa70
  .long 0xab8, 0xaf8, 0xa38, 0xa78
  .long 0xbe0, 0xba0, 0xb60, 0xb20
  .long 0xbe8, 0xba8, 0xb68, 0xb28
  .long 0xbf0, 0xbb0, 0xb70, 0xb30
  .long 0xbf8, 0xbb8, 0xb78, 0xb38
  .long 0x0, 0x40, 0x80, 0xc0
  .long 0x8, 0x48, 0x88, 0xc8
  .long 0x10, 0x50, 0x90, 0xd0
  .long 0x18, 0x58, 0x98, 0xd8
  .long 0x140, 0x100, 0x1c0, 0x180
  .long 0x148, 0x108, 0x1c8, 0x188
  .long 0x150, 0x110, 0x1d0, 0x190
  .long 0x158, 0x118, 0x1d8, 0x198
  .long 0x280, 0x2c0, 0x200, 0x240
  .long 0x288, 0x2c8, 0x208, 0x248
  .long 0x290, 0x2d0, 0x210, 0x250
  .long 0x298, 0x2d8, 0x218, 0x258
  .long 0x3c0, 0x380, 0x340, 0x300
  .long 0x3c8, 0x388, 0x348, 0x308
  .long 0x3d0, 0x390, 0x350, 0x310
  .long 0x3d8, 0x398, 0x358, 0x318
  .long 0x20, 0x60, 0xa0, 0xe0
  .long 0x28, 0x68, 0xa8, 0xe8
  .long 0x30, 0x70, 0xb0, 0xf0
  .long 0x38, 0x78, 0xb8, 0xf8
  .long 0x160, 0x120, 0x1e0, 0x1a0
  .long 0x168, 0x128, 0x1e8, 0x1a8
  .long 0x170, 0x130, 0x1f0, 0x1b0
  .long 0x178, 0x138, 0x1f8, 0x1b8
  .long 0x2a0, 0x2e0, 0x220, 0x260
  .long 0x2a8, 0x2e8, 0x228, 0x268
  .long 0x2b0, 0x2f0, 0x230, 0x270
  .long 0x2b8, 0x2f8, 0x238, 0x278
  .long 0x3e0, 0x3a0, 0x360, 0x320
  .long 0x3e8, 0x3a8, 0x368, 0x328
  .long 0x3f0, 0x3b0, 0x370, 0x330
  .long 0x3f8, 0x3b8, 0x378, 0x338
  .long 0x800, 0x840, 0x880, 0x8c0
  .long 0x808, 0x848, 0x888, 0x8c8
  .long 0x810, 0x850, 0x890, 0x8d0
  .long 0x818, 0x858, 0x898, 0x8d8
  .long 0x940, 0x900, 0x9c0, 0x980
  .long 0x948, 0x908, 0x9c8, 0x988
  .long 0x950, 0x910, 0x9d0, 0x990
  .long 0x958, 0x918, 0x9d8, 0x998
  .long 0xa80, 0xac0, 0xa00, 0xa40
  .long 0xa88, 0xac8, 0xa08, 0xa48
  .long 0xa90, 0xad0, 0xa10, 0xa50
  .long 0xa98, 0xad8, 0xa18, 0xa58
  .long 0xbc0, 0xb80, 0xb40, 0xb00
  .long 0xbc8, 0xb88, 0xb48, 0xb08
  .long 0xbd0, 0xb90, 0xb50, 0xb10
  .long 0xbd8, 0xb98, 0xb58, 0xb18
  .long 0x820, 0x860, 0x8a0, 0x8e0
  .long 0x828, 0x868, 0x8a8, 0x8e8
  .long 0x830, 0x870, 0x8b0, 0x8f0
  .long 0x838, 0x878, 0x8b8, 0x8f8
  .long 0x960, 0x920, 0x9e0, 0x9a0
  .long 0x968, 0x928, 0x9e8, 0x9a8
  .long 0x970, 0x930, 0x9f0, 0x9b0
  .long 0x978, 0x938, 0x9f8, 0x9b8
  .long 0xaa0, 0xae0, 0xa20, 0xa60
  .long 0xaa8, 0xae8, 0xa28, 0xa68
  .long 0xab0, 0xaf0, 0xa30, 0xa70
  .long 0xab8, 0xaf8, 0xa38, 0xa78
  .long 0xbe0, 0xba0, 0xb60, 0xb20
  .long 0xbe8, 0xba8, 0xb68, 0xb28
  .long 0xbf0, 0xbb0, 0xb70, 0xb30
  .long 0xbf8, 0xbb8, 0xb78, 0xb38
  .long 0x0, 0x40, 0x80, 0xc0
  .long 0x8, 0x48, 0x88, 0xc8
  .long 0x10, 0x50, 0x90, 0xd0
  .long 0x18, 0x58, 0x98, 0xd8
  .long 0x140, 0x100, 0x1c0, 0x180
  .long 0x148, 0x108, 0x1c8, 0x188
  .long 0x150, 0x110, 0x1d0, 0x190
  .long 0x158, 0x118, 0x1d8, 0x198
  .long 0x280, 0x2c0, 0x200, 0x240
  .long 0x288, 0x2c8, 0x208, 0x248
  .long 0x290, 0x2d0, 0x210, 0x250
  .long 0x298, 0x2d8, 0x218, 0x258
  .long 0x3c0, 0x380, 0x340, 0x300
  .long 0x3c8, 0x388, 0x348, 0x308
  .long 0x3d0, 0x390, 0x350, 0x310
  .long 0x3d8, 0x398, 0x358, 0x318
  .long 0x20, 0x60, 0xa0, 0xe0
  .long 0x28, 0x68, 0xa8, 0xe8
  .long 0x30, 0x70, 0xb0, 0xf0
  .long 0x38, 0x78, 0xb8, 0xf8
  .long 0x160, 0x120, 0x1e0, 0x1a0
  .long 0x168, 0x128, 0x1e8, 0x1a8
  .long 0x170, 0x130, 0x1f0, 0x1b0
  .long 0x178, 0x138, 0x1f8, 0x1b8
  .long 0x2a0, 0x2e0, 0x220, 0x260
  .long 0x2a8, 0x2e8, 0x228, 0x268
  .long 0x2b0, 0x2f0, 0x230, 0x270
  .long 0x2b8, 0x2f8, 0x238, 0x278
  .long 0x3e0, 0x3a0, 0x360, 0x320
  .long 0x3e8, 0x3a8, 0x368, 0x328
  .long 0x3f0, 0x3b0, 0x370, 0x330
  .long 0x3f8, 0x3b8, 0x378, 0x338
  .long 0x800, 0x840, 0x880, 0x8c0
  .long 0x808, 0x848, 0x888, 0x8c8
  .long 0x810, 0x850, 0x890, 0x8d0
  .long 0x818, 0x858, 0x898, 0x8d8
  .long 0x940, 0x900, 0x9c0, 0x980
  .long 0x948, 0x908, 0x9c8, 0x988
  .long 0x950, 0x910, 0x9d0, 0x990
  .long 0x958, 0x918, 0x9d8, 0x998
  .long 0xa80, 0xac0, 0xa00, 0xa40
  .long 0xa88, 0xac8, 0xa08, 0xa48
  .long 0xa90, 0xad0, 0xa10, 0xa50
  .long 0xa98, 0xad8, 0xa18, 0xa58
  .long 0xbc0, 0xb80, 0xb40, 0xb00
  .long 0xbc8, 0xb88, 0xb48, 0xb08
  .long 0xbd0, 0xb90, 0xb50, 0xb10
  .long 0xbd8, 0xb98, 0xb58, 0xb18
  .long 0x820, 0x860, 0x8a0, 0x8e0
  .long 0x828, 0x868, 0x8a8, 0x8e8
  .long 0x830, 0x870, 0x8b0, 0x8f0
  .long 0x838, 0x878, 0x8b8, 0x8f8
  .long 0x960, 0x920, 0x9e0, 0x9a0
  .long 0x968, 0x928, 0x9e8, 0x9a8
  .long 0x970, 0x930, 0x9f0, 0x9b0
  .long 0x978, 0x938, 0x9f8, 0x9b8
  .long 0xaa0, 0xae0, 0xa20, 0xa60
  .long 0xaa8, 0xae8, 0xa28, 0xa68
  .long 0xab0, 0xaf0, 0xa30, 0xa70
  .long 0xab8, 0xaf8, 0xa38, 0xa78
  .long 0xbe0, 0xba0, 0xb60, 0xb20
  .long 0xbe8, 0xba8, 0xb68, 0xb28
  .long 0xbf0, 0xbb0, 0xb70, 0xb30
  .long 0xbf8, 0xbb8, 0xb78, 0xb38
  .long 0x0, 0x40, 0x80, 0xc0
  .long 0x8, 0x48, 0x88, 0xc8
  .long 0x10, 0x50, 0x90, 0xd0
  .long 0x18, 0x58, 0x98, 0xd8
  .long 0x140, 0x100, 0x1c0, 0x180
  .long 0x148, 0x108, 0x1c8, 0x188
  .long 0x150, 0x110, 0x1d0, 0x190
  .long 0x158, 0x118, 0x1d8, 0x198
  .long 0x280, 0x2c0, 0x200, 0x240
  .long 0x288, 0x2c8, 0x208, 0x248
  .long 0x290, 0x2d0, 0x210, 0x250
  .long 0x298, 0x2d8, 0x218, 0x258
  .long 0x3c0, 0x380, 0x340, 0x300
  .long 0x3c8, 0x388, 0x348, 0x308
  .long 0x3d0, 0x390, 0x350, 0x310
  .long 0x3d8, 0x398, 0x358, 0x318
  .long 0x20, 0x60, 0xa0, 0xe0
  .long 0x28, 0x68, 0xa8, 0xe8
  .long 0x30, 0x70, 0xb0, 0xf0
  .long 0x38, 0x78, 0xb8, 0xf8
  .long 0x160, 0x120, 0x1e0, 0x1a0
  .long 0x168, 0x128, 0x1e8, 0x1a8
  .long 0x170, 0x130, 0x1f0, 0x1b0
  .long 0x178, 0x138, 0x1f8, 0x1b8
  .long 0x2a0, 0x2e0, 0x220, 0x260
  .long 0x2a8, 0x2e8, 0x228, 0x268
  .long 0x2b0, 0x2f0, 0x230, 0x270
  .long 0x2b8, 0x2f8, 0x238, 0x278
  .long 0x3e0, 0x3a0, 0x360, 0x320
  .long 0x3e8, 0x3a8, 0x368, 0x328
  .long 0x3f0, 0x3b0, 0x370, 0x330
  .long 0x3f8, 0x3b8, 0x378, 0x338
  .long 0x800, 0x840, 0x880, 0x8c0
  .long 0x808, 0x848, 0x888, 0x8c8
  .long 0x810, 0x850, 0x890, 0x8d0
  .long 0x818, 0x858, 0x898, 0x8d8
  .long 0x940, 0x900, 0x9c0, 0x980
  .long 0x948, 0x908, 0x9c8, 0x988
  .long 0x950, 0x910, 0x9d0, 0x990
  .long 0x958, 0x918, 0x9d8, 0x998
  .long 0xa80, 0xac0, 0xa00, 0xa40
  .long 0xa88, 0xac8, 0xa08, 0xa48
  .long 0xa90, 0xad0, 0xa10, 0xa50
  .long 0xa98, 0xad8, 0xa18, 0xa58
  .long 0xbc0, 0xb80, 0xb40, 0xb00
  .long 0xbc8, 0xb88, 0xb48, 0xb08
  .long 0xbd0, 0xb90, 0xb50, 0xb10
  .long 0xbd8, 0xb98, 0xb58, 0xb18
  .long 0x820, 0x860, 0x8a0, 0x8e0
  .long 0x828, 0x868, 0x8a8, 0x8e8
  .long 0x830, 0x870, 0x8b0, 0x8f0
  .long 0x838, 0x878, 0x8b8, 0x8f8
  .long 0x960, 0x920, 0x9e0, 0x9a0
  .long 0x968, 0x928, 0x9e8, 0x9a8
  .long 0x970, 0x930, 0x9f0, 0x9b0
  .long 0x978, 0x938, 0x9f8, 0x9b8
  .long 0xaa0, 0xae0, 0xa20, 0xa60
  .long 0xaa8, 0xae8, 0xa28, 0xa68
  .long 0xab0, 0xaf0, 0xa30, 0xa70
  .long 0xab8, 0xaf8, 0xa38, 0xa78
  .long 0xbe0, 0xba0, 0xb60, 0xb20
  .long 0xbe8, 0xba8, 0xb68, 0xb28
  .long 0xbf0, 0xbb0, 0xb70, 0xb30
  .long 0xbf8, 0xbb8, 0xb78, 0xb38
  .long 0x0, 0x0, 0x0, 0x0
  .long 0x10, 0x1, 0x4, 0x0
  .long 0x20, 0x2, 0x8, 0x0
  .long 0x30, 0x3, 0xc, 0x0
  .long 0x40, 0x4, 0x10, 0x0
  .long 0x50, 0x5, 0x14, 0x0
  .long 0x60, 0x6, 0x18, 0x0
  .long 0x70, 0x7, 0x1c, 0x0
  .long 0x80, 0x8, 0x20, 0x0
  .long 0x90, 0x9, 0x24, 0x0
  .long 0xa0, 0xa, 0x28, 0x0
  .long 0xb0, 0xb, 0x2c, 0x0
  .long 0xc0, 0xc, 0x30, 0x0
  .long 0xd0, 0xd, 0x34, 0x0
  .long 0xe0, 0xe, 0x38, 0x0
  .long 0xf0, 0xf, 0x3c, 0x0
  .long 0x100, 0x10, 0x40, 0x0
  .long 0x110, 0x11, 0x44, 0x0
  .long 0x120, 0x12, 0x48, 0x0
  .long 0x130, 0x13, 0x4c, 0x0
  .long 0x140, 0x14, 0x50, 0x0
  .long 0x150, 0x15, 0x54, 0x0
  .long 0x160, 0x16, 0x58, 0x0
  .long 0x170, 0x17, 0x5c, 0x0
  .long 0x180, 0x18, 0x60, 0x0
  .long 0x190, 0x19, 0x64, 0x0
  .long 0x1a0, 0x1a, 0x68, 0x0
  .long 0x1b0, 0x1b, 0x6c, 0x0
  .long 0x1c0, 0x1c, 0x70, 0x0
  .long 0x1d0, 0x1d, 0x74, 0x0
  .long 0x1e0, 0x1e, 0x78, 0x0
  .long 0x1f0, 0x1f, 0x7c, 0x0
  .long 0x200, 0xfffffffc, 0x0, 0x0
  .long 0x210, 0xfffffffd, 0x4, 0x0
  .long 0x220, 0xfffffffe, 0x8, 0x0
  .long 0x230, 0xffffffff, 0xc, 0x0
  .long 0x240, 0x0, 0x10, 0x0
  .long 0x250, 0x1, 0x14, 0x0
  .long 0x260, 0x2, 0x18, 0x0
  .long 0x270, 0x3, 0x1c, 0x0
  .long 0x280, 0x4, 0x20, 0x0
  .long 0x290, 0x5, 0x24, 0x0
  .long 0x2a0, 0x6, 0x28, 0x0
  .long 0x2b0, 0x7, 0x2c, 0x0
  .long 0x2c0, 0x8, 0x30, 0x0
  .long 0x2d0, 0x9, 0x34, 0x0
  .long 0x2e0, 0xa, 0x38, 0x0
  .long 0x2f0, 0xb, 0x3c, 0x0
  .long 0x300, 0xc, 0x40, 0x0
  .long 0x310, 0xd, 0x44, 0x0
  .long 0x320, 0xe, 0x48, 0x0
  .long 0x330, 0xf, 0x4c, 0x0
  .long 0x340, 0x10, 0x50, 0x0
  .long 0x350, 0x11, 0x54, 0x0
  .long 0x360, 0x12, 0x58, 0x0
  .long 0x370, 0x13, 0x5c, 0x0
  .long 0x380, 0x14, 0x60, 0x0
  .long 0x390, 0x15, 0x64, 0x0
  .long 0x3a0, 0x16, 0x68, 0x0
  .long 0x3b0, 0x17, 0x6c, 0x0
  .long 0x3c0, 0x18, 0x70, 0x0
  .long 0x3d0, 0x19, 0x74, 0x0
  .long 0x3e0, 0x1a, 0x78, 0x0
  .long 0x3f0, 0x1b, 0x7c, 0x0
  .long 0x40000, 0x0, 0x1000, 0x0
  .long 0x40010, 0x1, 0x1004, 0x0
  .long 0x40020, 0x2, 0x1008, 0x0
  .long 0x40030, 0x3, 0x100c, 0x0
  .long 0x40040, 0x4, 0x1010, 0x0
  .long 0x40050, 0x5, 0x1014, 0x0
  .long 0x40060, 0x6, 0x1018, 0x0
  .long 0x40070, 0x7, 0x101c, 0x0
  .long 0x40080, 0x8, 0x1020, 0x0
  .long 0x40090, 0x9, 0x1024, 0x0
  .long 0x400a0, 0xa, 0x1028, 0x0
  .long 0x400b0, 0xb, 0x102c, 0x0
  .long 0x400c0, 0xc, 0x1030, 0x0
  .long 0x400d0, 0xd, 0x1034, 0x0
  .long 0x400e0, 0xe, 0x1038, 0x0
  .long 0x400f0, 0xf, 0x103c, 0x0
  .long 0x40100, 0x10, 0x1040, 0x0
  .long 0x40110, 0x11, 0x1044, 0x0
  .long 0x40120, 0x12, 0x1048, 0x0
  .long 0x40130, 0x13, 0x104c, 0x0
  .long 0x40140, 0x14, 0x1050, 0x0
  .long 0x40150, 0x15, 0x1054, 0x0
  .long 0x40160, 0x16, 0x1058, 0x0
  .long 0x40170, 0x17, 0x105c, 0x0
  .long 0x40180, 0x18, 0x1060, 0x0
  .long 0x40190, 0x19, 0x1064, 0x0
  .long 0x401a0, 0x1a, 0x1068, 0x0
  .long 0x401b0, 0x1b, 0x106c, 0x0
  .long 0x401c0, 0x1c, 0x1070, 0x0
  .long 0x401d0, 0x1d, 0x1074, 0x0
  .long 0x401e0, 0x1e, 0x1078, 0x0
  .long 0x401f0, 0x1f, 0x107c, 0x0
  .long 0x40200, 0xfffffffc, 0x1000, 0x0
  .long 0x40210, 0xfffffffd, 0x1004, 0x0
  .long 0x40220, 0xfffffffe, 0x1008, 0x0
  .long 0x40230, 0xffffffff, 0x100c, 0x0
  .long 0x40240, 0x0, 0x1010, 0x0
  .long 0x40250, 0x1, 0x1014, 0x0
  .long 0x40260, 0x2, 0x1018, 0x0
  .long 0x40270, 0x3, 0x101c, 0x0
  .long 0x40280, 0x4, 0x1020, 0x0
  .long 0x40290, 0x5, 0x1024, 0x0
  .long 0x402a0, 0x6, 0x1028, 0x0
  .long 0x402b0, 0x7, 0x102c, 0x0
  .long 0x402c0, 0x8, 0x1030, 0x0
  .long 0x402d0, 0x9, 0x1034, 0x0
  .long 0x402e0, 0xa, 0x1038, 0x0
  .long 0x402f0, 0xb, 0x103c, 0x0
  .long 0x40300, 0xc, 0x1040, 0x0
  .long 0x40310, 0xd, 0x1044, 0x0
  .long 0x40320, 0xe, 0x1048, 0x0
  .long 0x40330, 0xf, 0x104c, 0x0
  .long 0x40340, 0x10, 0x1050, 0x0
  .long 0x40350, 0x11, 0x1054, 0x0
  .long 0x40360, 0x12, 0x1058, 0x0
  .long 0x40370, 0x13, 0x105c, 0x0
  .long 0x40380, 0x14, 0x1060, 0x0
  .long 0x40390, 0x15, 0x1064, 0x0
  .long 0x403a0, 0x16, 0x1068, 0x0
  .long 0x403b0, 0x17, 0x106c, 0x0
  .long 0x403c0, 0x18, 0x1070, 0x0
  .long 0x403d0, 0x19, 0x1074, 0x0
  .long 0x403e0, 0x1a, 0x1078, 0x0
  .long 0x403f0, 0x1b, 0x107c, 0x0
  .long 0x80000, 0x0, 0x2000, 0x0
  .long 0x80010, 0x1, 0x2004, 0x0
  .long 0x80020, 0x2, 0x2008, 0x0
  .long 0x80030, 0x3, 0x200c, 0x0
  .long 0x80040, 0x4, 0x2010, 0x0
  .long 0x80050, 0x5, 0x2014, 0x0
  .long 0x80060, 0x6, 0x2018, 0x0
  .long 0x80070, 0x7, 0x201c, 0x0
  .long 0x80080, 0x8, 0x2020, 0x0
  .long 0x80090, 0x9, 0x2024, 0x0
  .long 0x800a0, 0xa, 0x2028, 0x0
  .long 0x800b0, 0xb, 0x202c, 0x0
  .long 0x800c0, 0xc, 0x2030, 0x0
  .long 0x800d0, 0xd, 0x2034, 0x0
  .long 0x800e0, 0xe, 0x2038, 0x0
  .long 0x800f0, 0xf, 0x203c, 0x0
  .long 0x80100, 0x10, 0x2040, 0x0
  .long 0x80110, 0x11, 0x2044, 0x0
  .long 0x80120, 0x12, 0x2048, 0x0
  .long 0x80130, 0x13, 0x204c, 0x0
  .long 0x80140, 0x14, 0x2050, 0x0
  .long 0x80150, 0x15, 0x2054, 0x0
  .long 0x80160, 0x16, 0x2058, 0x0
  .long 0x80170, 0x17, 0x205c, 0x0
  .long 0x80180, 0x18, 0x2060, 0x0
  .long 0x80190, 0x19, 0x2064, 0x0
  .long 0x801a0, 0x1a, 0x2068, 0x0
  .long 0x801b0, 0x1b, 0x206c, 0x0
  .long 0x801c0, 0x1c, 0x2070, 0x0
  .long 0x801d0, 0x1d, 0x2074, 0x0
  .long 0x801e0, 0x1e, 0x2078, 0x0
  .long 0x801f0, 0x1f, 0x207c, 0x0
  .long 0x80200, 0xfffffffc, 0x2000, 0x0
  .long 0x80210, 0xfffffffd, 0x2004, 0x0
  .long 0x80220, 0xfffffffe, 0x2008, 0x0
  .long 0x80230, 0xffffffff, 0x200c, 0x0
  .long 0x80240, 0x0, 0x2010, 0x0
  .long 0x80250, 0x1, 0x2014, 0x0
  .long 0x80260, 0x2, 0x2018, 0x0
  .long 0x80270, 0x3, 0x201c, 0x0
  .long 0x80280, 0x4, 0x2020, 0x0
  .long 0x80290, 0x5, 0x2024, 0x0
  .long 0x802a0, 0x6, 0x2028, 0x0
  .long 0x802b0, 0x7, 0x202c, 0x0
  .long 0x802c0, 0x8, 0x2030, 0x0
  .long 0x802d0, 0x9, 0x2034, 0x0
  .long 0x802e0, 0xa, 0x2038, 0x0
  .long 0x802f0, 0xb, 0x203c, 0x0
  .long 0x80300, 0xc, 0x2040, 0x0
  .long 0x80310, 0xd, 0x2044, 0x0
  .long 0x80320, 0xe, 0x2048, 0x0
  .long 0x80330, 0xf, 0x204c, 0x0
  .long 0x80340, 0x10, 0x2050, 0x0
  .long 0x80350, 0x11, 0x2054, 0x0
  .long 0x80360, 0x12, 0x2058, 0x0
  .long 0x80370, 0x13, 0x205c, 0x0
  .long 0x80380, 0x14, 0x2060, 0x0
  .long 0x80390, 0x15, 0x2064, 0x0
  .long 0x803a0, 0x16, 0x2068, 0x0
  .long 0x803b0, 0x17, 0x206c, 0x0
  .long 0x803c0, 0x18, 0x2070, 0x0
  .long 0x803d0, 0x19, 0x2074, 0x0
  .long 0x803e0, 0x1a, 0x2078, 0x0
  .long 0x803f0, 0x1b, 0x207c, 0x0
  .long 0xc0000, 0x0, 0x3000, 0x0
  .long 0xc0010, 0x1, 0x3004, 0x0
  .long 0xc0020, 0x2, 0x3008, 0x0
  .long 0xc0030, 0x3, 0x300c, 0x0
  .long 0xc0040, 0x4, 0x3010, 0x0
  .long 0xc0050, 0x5, 0x3014, 0x0
  .long 0xc0060, 0x6, 0x3018, 0x0
  .long 0xc0070, 0x7, 0x301c, 0x0
  .long 0xc0080, 0x8, 0x3020, 0x0
  .long 0xc0090, 0x9, 0x3024, 0x0
  .long 0xc00a0, 0xa, 0x3028, 0x0
  .long 0xc00b0, 0xb, 0x302c, 0x0
  .long 0xc00c0, 0xc, 0x3030, 0x0
  .long 0xc00d0, 0xd, 0x3034, 0x0
  .long 0xc00e0, 0xe, 0x3038, 0x0
  .long 0xc00f0, 0xf, 0x303c, 0x0
  .long 0xc0100, 0x10, 0x3040, 0x0
  .long 0xc0110, 0x11, 0x3044, 0x0
  .long 0xc0120, 0x12, 0x3048, 0x0
  .long 0xc0130, 0x13, 0x304c, 0x0
  .long 0xc0140, 0x14, 0x3050, 0x0
  .long 0xc0150, 0x15, 0x3054, 0x0
  .long 0xc0160, 0x16, 0x3058, 0x0
  .long 0xc0170, 0x17, 0x305c, 0x0
  .long 0xc0180, 0x18, 0x3060, 0x0
  .long 0xc0190, 0x19, 0x3064, 0x0
  .long 0xc01a0, 0x1a, 0x3068, 0x0
  .long 0xc01b0, 0x1b, 0x306c, 0x0
  .long 0xc01c0, 0x1c, 0x3070, 0x0
  .long 0xc01d0, 0x1d, 0x3074, 0x0
  .long 0xc01e0, 0x1e, 0x3078, 0x0
  .long 0xc01f0, 0x1f, 0x307c, 0x0
  .long 0xc0200, 0xfffffffc, 0x3000, 0x0
  .long 0xc0210, 0xfffffffd, 0x3004, 0x0
  .long 0xc0220, 0xfffffffe, 0x3008, 0x0
  .long 0xc0230, 0xffffffff, 0x300c, 0x0
  .long 0xc0240, 0x0, 0x3010, 0x0
  .long 0xc0250, 0x1, 0x3014, 0x0
  .long 0xc0260, 0x2, 0x3018, 0x0
  .long 0xc0270, 0x3, 0x301c, 0x0
  .long 0xc0280, 0x4, 0x3020, 0x0
  .long 0xc0290, 0x5, 0x3024, 0x0
  .long 0xc02a0, 0x6, 0x3028, 0x0
  .long 0xc02b0, 0x7, 0x302c, 0x0
  .long 0xc02c0, 0x8, 0x3030, 0x0
  .long 0xc02d0, 0x9, 0x3034, 0x0
  .long 0xc02e0, 0xa, 0x3038, 0x0
  .long 0xc02f0, 0xb, 0x303c, 0x0
  .long 0xc0300, 0xc, 0x3040, 0x0
  .long 0xc0310, 0xd, 0x3044, 0x0
  .long 0xc0320, 0xe, 0x3048, 0x0
  .long 0xc0330, 0xf, 0x304c, 0x0
  .long 0xc0340, 0x10, 0x3050, 0x0
  .long 0xc0350, 0x11, 0x3054, 0x0
  .long 0xc0360, 0x12, 0x3058, 0x0
  .long 0xc0370, 0x13, 0x305c, 0x0
  .long 0xc0380, 0x14, 0x3060, 0x0
  .long 0xc0390, 0x15, 0x3064, 0x0
  .long 0xc03a0, 0x16, 0x3068, 0x0
  .long 0xc03b0, 0x17, 0x306c, 0x0
  .long 0xc03c0, 0x18, 0x3070, 0x0
  .long 0xc03d0, 0x19, 0x3074, 0x0
  .long 0xc03e0, 0x1a, 0x3078, 0x0
  .long 0xc03f0, 0x1b, 0x307c, 0x0
  .long 0x0, 0x0, 0x0, 0x0
  .long 0x10, 0x8, 0x0, 0x0
  .long 0x20, 0x10, 0x0, 0x0
  .long 0x30, 0x18, 0x0, 0x0
  .long 0x40, 0x80, 0x0, 0x0
  .long 0x50, 0x88, 0x0, 0x0
  .long 0x60, 0x90, 0x0, 0x0
  .long 0x70, 0x98, 0x0, 0x0
  .long 0x2000, 0x100, 0x0, 0x0
  .long 0x2010, 0x108, 0x0, 0x0
  .long 0x2020, 0x110, 0x0, 0x0
  .long 0x2030, 0x118, 0x0, 0x0
  .long 0x2040, 0x180, 0x0, 0x0
  .long 0x2050, 0x188, 0x0, 0x0
  .long 0x2060, 0x190, 0x0, 0x0
  .long 0x2070, 0x198, 0x0, 0x0
  .long 0x4000, 0x20, 0x0, 0x0
  .long 0x4010, 0x28, 0x0, 0x0
  .long 0x4020, 0x30, 0x0, 0x0
  .long 0x4030, 0x38, 0x0, 0x0
  .long 0x4040, 0xa0, 0x0, 0x0
  .long 0x4050, 0xa8, 0x0, 0x0
  .long 0x4060, 0xb0, 0x0, 0x0
  .long 0x4070, 0xb8, 0x0, 0x0
  .long 0x6000, 0x120, 0x0, 0x0
  .long 0x6010, 0x128, 0x0, 0x0
  .long 0x6020, 0x130, 0x0, 0x0
  .long 0x6030, 0x138, 0x0, 0x0
  .long 0x6040, 0x1a0, 0x0, 0x0
  .long 0x6050, 0x1a8, 0x0, 0x0
  .long 0x6060, 0x1b0, 0x0, 0x0
  .long 0x6070, 0x1b8, 0x0, 0x0
  .long 0x8000, 0x400, 0x0, 0x0
  .long 0x8010, 0x408, 0x0, 0x0
  .long 0x8020, 0x410, 0x0, 0x0
  .long 0x8030, 0x418, 0x0, 0x0
  .long 0x8040, 0x480, 0x0, 0x0
  .long 0x8050, 0x488, 0x0, 0x0
  .long 0x8060, 0x490, 0x0, 0x0
  .long 0x8070, 0x498, 0x0, 0x0
  .long 0xa000, 0x500, 0x0, 0x0
  .long 0xa010, 0x508, 0x0, 0x0
  .long 0xa020, 0x510, 0x0, 0x0
  .long 0xa030, 0x518, 0x0, 0x0
  .long 0xa040, 0x580, 0x0, 0x0
  .long 0xa050, 0x588, 0x0, 0x0
  .long 0xa060, 0x590, 0x0, 0x0
  .long 0xa070, 0x598, 0x0, 0x0
  .long 0xc000, 0x420, 0x0, 0x0
  .long 0xc010, 0x428, 0x0, 0x0
  .long 0xc020, 0x430, 0x0, 0x0
  .long 0xc030, 0x438, 0x0, 0x0
  .long 0xc040, 0x4a0, 0x0, 0x0
  .long 0xc050, 0x4a8, 0x0, 0x0
  .long 0xc060, 0x4b0, 0x0, 0x0
  .long 0xc070, 0x4b8, 0x0, 0x0
  .long 0xe000, 0x520, 0x0, 0x0
  .long 0xe010, 0x528, 0x0, 0x0
  .long 0xe020, 0x530, 0x0, 0x0
  .long 0xe030, 0x538, 0x0, 0x0
  .long 0xe040, 0x5a0, 0x0, 0x0
  .long 0xe050, 0x5a8, 0x0, 0x0
  .long 0xe060, 0x5b0, 0x0, 0x0
  .long 0xe070, 0x5b8, 0x0, 0x0
  .long 0x100000, 0x0, 0x0, 0x0
  .long 0x100010, 0x8, 0x0, 0x0
  .long 0x100020, 0x10, 0x0, 0x0
  .long 0x100030, 0x18, 0x0, 0x0
  .long 0x100040, 0x80, 0x0, 0x0
  .long 0x100050, 0x88, 0x0, 0x0
  .long 0x100060, 0x90, 0x0, 0x0
  .long 0x100070, 0x98, 0x0, 0x0
  .long 0x102000, 0x100, 0x0, 0x0
  .long 0x102010, 0x108, 0x0, 0x0
  .long 0x102020, 0x110, 0x0, 0x0
  .long 0x102030, 0x118, 0x0, 0x0
  .long 0x102040, 0x180, 0x0, 0x0
  .long 0x102050, 0x188, 0x0, 0x0
  .long 0x102060, 0x190, 0x0, 0x0
  .long 0x102070, 0x198, 0x0, 0x0
  .long 0x104000, 0x20, 0x0, 0x0
  .long 0x104010, 0x28, 0x0, 0x0
  .long 0x104020, 0x30, 0x0, 0x0
  .long 0x104030, 0x38, 0x0, 0x0
  .long 0x104040, 0xa0, 0x0, 0x0
  .long 0x104050, 0xa8, 0x0, 0x0
  .long 0x104060, 0xb0, 0x0, 0x0
  .long 0x104070, 0xb8, 0x0, 0x0
  .long 0x106000, 0x120, 0x0, 0x0
  .long 0x106010, 0x128, 0x0, 0x0
  .long 0x106020, 0x130, 0x0, 0x0
  .long 0x106030, 0x138, 0x0, 0x0
  .long 0x106040, 0x1a0, 0x0, 0x0
  .long 0x106050, 0x1a8, 0x0, 0x0
  .long 0x106060, 0x1b0, 0x0, 0x0
  .long 0x106070, 0x1b8, 0x0, 0x0
  .long 0x108000, 0x400, 0x0, 0x0
  .long 0x108010, 0x408, 0x0, 0x0
  .long 0x108020, 0x410, 0x0, 0x0
  .long 0x108030, 0x418, 0x0, 0x0
  .long 0x108040, 0x480, 0x0, 0x0
  .long 0x108050, 0x488, 0x0, 0x0
  .long 0x108060, 0x490, 0x0, 0x0
  .long 0x108070, 0x498, 0x0, 0x0
  .long 0x10a000, 0x500, 0x0, 0x0
  .long 0x10a010, 0x508, 0x0, 0x0
  .long 0x10a020, 0x510, 0x0, 0x0
  .long 0x10a030, 0x518, 0x0, 0x0
  .long 0x10a040, 0x580, 0x0, 0x0
  .long 0x10a050, 0x588, 0x0, 0x0
  .long 0x10a060, 0x590, 0x0, 0x0
  .long 0x10a070, 0x598, 0x0, 0x0
  .long 0x10c000, 0x420, 0x0, 0x0
  .long 0x10c010, 0x428, 0x0, 0x0
  .long 0x10c020, 0x430, 0x0, 0x0
  .long 0x10c030, 0x438, 0x0, 0x0
  .long 0x10c040, 0x4a0, 0x0, 0x0
  .long 0x10c050, 0x4a8, 0x0, 0x0
  .long 0x10c060, 0x4b0, 0x0, 0x0
  .long 0x10c070, 0x4b8, 0x0, 0x0
  .long 0x10e000, 0x520, 0x0, 0x0
  .long 0x10e010, 0x528, 0x0, 0x0
  .long 0x10e020, 0x530, 0x0, 0x0
  .long 0x10e030, 0x538, 0x0, 0x0
  .long 0x10e040, 0x5a0, 0x0, 0x0
  .long 0x10e050, 0x5a8, 0x0, 0x0
  .long 0x10e060, 0x5b0, 0x0, 0x0
  .long 0x10e070, 0x5b8, 0x0, 0x0
  .long 0x200000, 0x0, 0x0, 0x0
  .long 0x200010, 0x8, 0x0, 0x0
  .long 0x200020, 0x10, 0x0, 0x0
  .long 0x200030, 0x18, 0x0, 0x0
  .long 0x200040, 0x80, 0x0, 0x0
  .long 0x200050, 0x88, 0x0, 0x0
  .long 0x200060, 0x90, 0x0, 0x0
  .long 0x200070, 0x98, 0x0, 0x0
  .long 0x202000, 0x100, 0x0, 0x0
  .long 0x202010, 0x108, 0x0, 0x0
  .long 0x202020, 0x110, 0x0, 0x0
  .long 0x202030, 0x118, 0x0, 0x0
  .long 0x202040, 0x180, 0x0, 0x0
  .long 0x202050, 0x188, 0x0, 0x0
  .long 0x202060, 0x190, 0x0, 0x0
  .long 0x202070, 0x198, 0x0, 0x0
  .long 0x204000, 0x20, 0x0, 0x0
  .long 0x204010, 0x28, 0x0, 0x0
  .long 0x204020, 0x30, 0x0, 0x0
  .long 0x204030, 0x38, 0x0, 0x0
  .long 0x204040, 0xa0, 0x0, 0x0
  .long 0x204050, 0xa8, 0x0, 0x0
  .long 0x204060, 0xb0, 0x0, 0x0
  .long 0x204070, 0xb8, 0x0, 0x0
  .long 0x206000, 0x120, 0x0, 0x0
  .long 0x206010, 0x128, 0x0, 0x0
  .long 0x206020, 0x130, 0x0, 0x0
  .long 0x206030, 0x138, 0x0, 0x0
  .long 0x206040, 0x1a0, 0x0, 0x0
  .long 0x206050, 0x1a8, 0x0, 0x0
  .long 0x206060, 0x1b0, 0x0, 0x0
  .long 0x206070, 0x1b8, 0x0, 0x0
  .long 0x208000, 0x400, 0x0, 0x0
  .long 0x208010, 0x408, 0x0, 0x0
  .long 0x208020, 0x410, 0x0, 0x0
  .long 0x208030, 0x418, 0x0, 0x0
  .long 0x208040, 0x480, 0x0, 0x0
  .long 0x208050, 0x488, 0x0, 0x0
  .long 0x208060, 0x490, 0x0, 0x0
  .long 0x208070, 0x498, 0x0, 0x0
  .long 0x20a000, 0x500, 0x0, 0x0
  .long 0x20a010, 0x508, 0x0, 0x0
  .long 0x20a020, 0x510, 0x0, 0x0
  .long 0x20a030, 0x518, 0x0, 0x0
  .long 0x20a040, 0x580, 0x0, 0x0
  .long 0x20a050, 0x588, 0x0, 0x0
  .long 0x20a060, 0x590, 0x0, 0x0
  .long 0x20a070, 0x598, 0x0, 0x0
  .long 0x20c000, 0x420, 0x0, 0x0
  .long 0x20c010, 0x428, 0x0, 0x0
  .long 0x20c020, 0x430, 0x0, 0x0
  .long 0x20c030, 0x438, 0x0, 0x0
  .long 0x20c040, 0x4a0, 0x0, 0x0
  .long 0x20c050, 0x4a8, 0x0, 0x0
  .long 0x20c060, 0x4b0, 0x0, 0x0
  .long 0x20c070, 0x4b8, 0x0, 0x0
  .long 0x20e000, 0x520, 0x0, 0x0
  .long 0x20e010, 0x528, 0x0, 0x0
  .long 0x20e020, 0x530, 0x0, 0x0
  .long 0x20e030, 0x538, 0x0, 0x0
  .long 0x20e040, 0x5a0, 0x0, 0x0
  .long 0x20e050, 0x5a8, 0x0, 0x0
  .long 0x20e060, 0x5b0, 0x0, 0x0
  .long 0x20e070, 0x5b8, 0x0, 0x0
  .long 0x300000, 0x0, 0x0, 0x0
  .long 0x300010, 0x8, 0x0, 0x0
  .long 0x300020, 0x10, 0x0, 0x0
  .long 0x300030, 0x18, 0x0, 0x0
  .long 0x300040, 0x80, 0x0, 0x0
  .long 0x300050, 0x88, 0x0, 0x0
  .long 0x300060, 0x90, 0x0, 0x0
  .long 0x300070, 0x98, 0x0, 0x0
  .long 0x302000, 0x100, 0x0, 0x0
  .long 0x302010, 0x108, 0x0, 0x0
  .long 0x302020, 0x110, 0x0, 0x0
  .long 0x302030, 0x118, 0x0, 0x0
  .long 0x302040, 0x180, 0x0, 0x0
  .long 0x302050, 0x188, 0x0, 0x0
  .long 0x302060, 0x190, 0x0, 0x0
  .long 0x302070, 0x198, 0x0, 0x0
  .long 0x304000, 0x20, 0x0, 0x0
  .long 0x304010, 0x28, 0x0, 0x0
  .long 0x304020, 0x30, 0x0, 0x0
  .long 0x304030, 0x38, 0x0, 0x0
  .long 0x304040, 0xa0, 0x0, 0x0
  .long 0x304050, 0xa8, 0x0, 0x0
  .long 0x304060, 0xb0, 0x0, 0x0
  .long 0x304070, 0xb8, 0x0, 0x0
  .long 0x306000, 0x120, 0x0, 0x0
  .long 0x306010, 0x128, 0x0, 0x0
  .long 0x306020, 0x130, 0x0, 0x0
  .long 0x306030, 0x138, 0x0, 0x0
  .long 0x306040, 0x1a0, 0x0, 0x0
  .long 0x306050, 0x1a8, 0x0, 0x0
  .long 0x306060, 0x1b0, 0x0, 0x0
  .long 0x306070, 0x1b8, 0x0, 0x0
  .long 0x308000, 0x400, 0x0, 0x0
  .long 0x308010, 0x408, 0x0, 0x0
  .long 0x308020, 0x410, 0x0, 0x0
  .long 0x308030, 0x418, 0x0, 0x0
  .long 0x308040, 0x480, 0x0, 0x0
  .long 0x308050, 0x488, 0x0, 0x0
  .long 0x308060, 0x490, 0x0, 0x0
  .long 0x308070, 0x498, 0x0, 0x0
  .long 0x30a000, 0x500, 0x0, 0x0
  .long 0x30a010, 0x508, 0x0, 0x0
  .long 0x30a020, 0x510, 0x0, 0x0
  .long 0x30a030, 0x518, 0x0, 0x0
  .long 0x30a040, 0x580, 0x0, 0x0
  .long 0x30a050, 0x588, 0x0, 0x0
  .long 0x30a060, 0x590, 0x0, 0x0
  .long 0x30a070, 0x598, 0x0, 0x0
  .long 0x30c000, 0x420, 0x0, 0x0
  .long 0x30c010, 0x428, 0x0, 0x0
  .long 0x30c020, 0x430, 0x0, 0x0
  .long 0x30c030, 0x438, 0x0, 0x0
  .long 0x30c040, 0x4a0, 0x0, 0x0
  .long 0x30c050, 0x4a8, 0x0, 0x0
  .long 0x30c060, 0x4b0, 0x0, 0x0
  .long 0x30c070, 0x4b8, 0x0, 0x0
  .long 0x30e000, 0x520, 0x0, 0x0
  .long 0x30e010, 0x528, 0x0, 0x0
  .long 0x30e020, 0x530, 0x0, 0x0
  .long 0x30e030, 0x538, 0x0, 0x0
  .long 0x30e040, 0x5a0, 0x0, 0x0
  .long 0x30e050, 0x5a8, 0x0, 0x0
  .long 0x30e060, 0x5b0, 0x0, 0x0
  .long 0x30e070, 0x5b8, 0x0, 0x0
  .long 0x0, 0x0, 0x0, 0x20000
  .long 0x10, 0x8, 0x8, 0x20080
  .long 0x20, 0x10, 0x10, 0x20100
  .long 0x30, 0x18, 0x18, 0x20180
  .long 0x40, 0x80, 0x400, 0x20200
  .long 0x50, 0x88, 0x408, 0x20280
  .long 0x60, 0x90, 0x410, 0x20300
  .long 0x70, 0x98, 0x418, 0x20380
  .long 0xe00, 0x100, 0x800, 0x20400
  .long 0xe10, 0x108, 0x808, 0x20480
  .long 0xe20, 0x110, 0x810, 0x20500
  .long 0xe30, 0x118, 0x818, 0x20580
  .long 0xe40, 0x180, 0xc00, 0x20600
  .long 0xe50, 0x188, 0xc08, 0x20680
  .long 0xe60, 0x190, 0xc10, 0x20700
  .long 0xe70, 0x198, 0xc18, 0x20780
  .long 0x1c00, 0x400, 0x2000, 0x20008
  .long 0x1c10, 0x408, 0x2008, 0x20088
  .long 0x1c20, 0x410, 0x2010, 0x20108
  .long 0x1c30, 0x418, 0x2018, 0x20188
  .long 0x1c40, 0x480, 0x2400, 0x20208
  .long 0x1c50, 0x488, 0x2408, 0x20288
  .long 0x1c60, 0x490, 0x2410, 0x20308
  .long 0x1c70, 0x498, 0x2418, 0x20388
  .long 0x2a00, 0x500, 0x2800, 0x20408
  .long 0x2a10, 0x508, 0x2808, 0x20488
  .long 0x2a20, 0x510, 0x2810, 0x20508
  .long 0x2a30, 0x518, 0x2818, 0x20588
  .long 0x2a40, 0x580, 0x2c00, 0x20608
  .long 0x2a50, 0x588, 0x2c08, 0x20688
  .long 0x2a60, 0x590, 0x2c10, 0x20708
  .long 0x2a70, 0x598, 0x2c18, 0x20788
  .long 0x3800, 0x800, 0x4000, 0x20010
  .long 0x3810, 0x808, 0x4008, 0x20090
  .long 0x3820, 0x810, 0x4010, 0x20110
  .long 0x3830, 0x818, 0x4018, 0x20190
  .long 0x3840, 0x880, 0x4400, 0x20210
  .long 0x3850, 0x888, 0x4408, 0x20290
  .long 0x3860, 0x890, 0x4410, 0x20310
  .long 0x3870, 0x898, 0x4418, 0x20390
  .long 0x4600, 0x900, 0x4800, 0x20410
  .long 0x4610, 0x908, 0x4808, 0x20490
  .long 0x4620, 0x910, 0x4810, 0x20510
  .long 0x4630, 0x918, 0x4818, 0x20590
  .long 0x4640, 0x980, 0x4c00, 0x20610
  .long 0x4650, 0x988, 0x4c08, 0x20690
  .long 0x4660, 0x990, 0x4c10, 0x20710
  .long 0x4670, 0x998, 0x4c18, 0x20790
  .long 0x5400, 0xc00, 0x6000, 0x20018
  .long 0x5410, 0xc08, 0x6008, 0x20098
  .long 0x5420, 0xc10, 0x6010, 0x20118
  .long 0x5430, 0xc18, 0x6018, 0x20198
  .long 0x5440, 0xc80, 0x6400, 0x20218
  .long 0x5450, 0xc88, 0x6408, 0x20298
  .long 0x5460, 0xc90, 0x6410, 0x20318
  .long 0x5470, 0xc98, 0x6418, 0x20398
  .long 0x6200, 0xd00, 0x6800, 0x20418
  .long 0x6210, 0xd08, 0x6808, 0x20498
  .long 0x6220, 0xd10, 0x6810, 0x20518
  .long 0x6230, 0xd18, 0x6818, 0x20598
  .long 0x6240, 0xd80, 0x6c00, 0x20618
  .long 0x6250, 0xd88, 0x6c08, 0x20698
  .long 0x6260, 0xd90, 0x6c10, 0x20718
  .long 0x6270, 0xd98, 0x6c18, 0x20798
  .long 0x70000, 0x20, 0x100, 0x20020
  .long 0x70010, 0x28, 0x108, 0x200a0
  .long 0x70020, 0x30, 0x110, 0x20120
  .long 0x70030, 0x38, 0x118, 0x201a0
  .long 0x70040, 0xa0, 0x500, 0x20220
  .long 0x70050, 0xa8, 0x508, 0x202a0
  .long 0x70060, 0xb0, 0x510, 0x20320
  .long 0x70070, 0xb8, 0x518, 0x203a0
  .long 0x70e00, 0x120, 0x900, 0x20420
  .long 0x70e10, 0x128, 0x908, 0x204a0
  .long 0x70e20, 0x130, 0x910, 0x20520
  .long 0x70e30, 0x138, 0x918, 0x205a0
  .long 0x70e40, 0x1a0, 0xd00, 0x20620
  .long 0x70e50, 0x1a8, 0xd08, 0x206a0
  .long 0x70e60, 0x1b0, 0xd10, 0x20720
  .long 0x70e70, 0x1b8, 0xd18, 0x207a0
  .long 0x71c00, 0x420, 0x2100, 0x20028
  .long 0x71c10, 0x428, 0x2108, 0x200a8
  .long 0x71c20, 0x430, 0x2110, 0x20128
  .long 0x71c30, 0x438, 0x2118, 0x201a8
  .long 0x71c40, 0x4a0, 0x2500, 0x20228
  .long 0x71c50, 0x4a8, 0x2508, 0x202a8
  .long 0x71c60, 0x4b0, 0x2510, 0x20328
  .long 0x71c70, 0x4b8, 0x2518, 0x203a8
  .long 0x72a00, 0x520, 0x2900, 0x20428
  .long 0x72a10, 0x528, 0x2908, 0x204a8
  .long 0x72a20, 0x530, 0x2910, 0x20528
  .long 0x72a30, 0x538, 0x2918, 0x205a8
  .long 0x72a40, 0x5a0, 0x2d00, 0x20628
  .long 0x72a50, 0x5a8, 0x2d08, 0x206a8
  .long 0x72a60, 0x5b0, 0x2d10, 0x20728
  .long 0x72a70, 0x5b8, 0x2d18, 0x207a8
  .long 0x73800, 0x820, 0x4100, 0x20030
  .long 0x73810, 0x828, 0x4108, 0x200b0
  .long 0x73820, 0x830, 0x4110, 0x20130
  .long 0x73830, 0x838, 0x4118, 0x201b0
  .long 0x73840, 0x8a0, 0x4500, 0x20230
  .long 0x73850, 0x8a8, 0x4508, 0x202b0
  .long 0x73860, 0x8b0, 0x4510, 0x20330
  .long 0x73870, 0x8b8, 0x4518, 0x203b0
  .long 0x74600, 0x920, 0x4900, 0x20430
  .long 0x74610, 0x928, 0x4908, 0x204b0
  .long 0x74620, 0x930, 0x4910, 0x20530
  .long 0x74630, 0x938, 0x4918, 0x205b0
  .long 0x74640, 0x9a0, 0x4d00, 0x20630
  .long 0x74650, 0x9a8, 0x4d08, 0x206b0
  .long 0x74660, 0x9b0, 0x4d10, 0x20730
  .long 0x74670, 0x9b8, 0x4d18, 0x207b0
  .long 0x75400, 0xc20, 0x6100, 0x20038
  .long 0x75410, 0xc28, 0x6108, 0x200b8
  .long 0x75420, 0xc30, 0x6110, 0x20138
  .long 0x75430, 0xc38, 0x6118, 0x201b8
  .long 0x75440, 0xca0, 0x6500, 0x20238
  .long 0x75450, 0xca8, 0x6508, 0x202b8
  .long 0x75460, 0xcb0, 0x6510, 0x20338
  .long 0x75470, 0xcb8, 0x6518, 0x203b8
  .long 0x76200, 0xd20, 0x6900, 0x20438
  .long 0x76210, 0xd28, 0x6908, 0x204b8
  .long 0x76220, 0xd30, 0x6910, 0x20538
  .long 0x76230, 0xd38, 0x6918, 0x205b8
  .long 0x76240, 0xda0, 0x6d00, 0x20638
  .long 0x76250, 0xda8, 0x6d08, 0x206b8
  .long 0x76260, 0xdb0, 0x6d10, 0x20738
  .long 0x76270, 0xdb8, 0x6d18, 0x207b8
  .long 0xe0000, 0x40, 0x200, 0x20040
  .long 0xe0010, 0x48, 0x208, 0x200c0
  .long 0xe0020, 0x50, 0x210, 0x20140
  .long 0xe0030, 0x58, 0x218, 0x201c0
  .long 0xe0040, 0xc0, 0x600, 0x20240
  .long 0xe0050, 0xc8, 0x608, 0x202c0
  .long 0xe0060, 0xd0, 0x610, 0x20340
  .long 0xe0070, 0xd8, 0x618, 0x203c0
  .long 0xe0e00, 0x140, 0xa00, 0x20440
  .long 0xe0e10, 0x148, 0xa08, 0x204c0
  .long 0xe0e20, 0x150, 0xa10, 0x20540
  .long 0xe0e30, 0x158, 0xa18, 0x205c0
  .long 0xe0e40, 0x1c0, 0xe00, 0x20640
  .long 0xe0e50, 0x1c8, 0xe08, 0x206c0
  .long 0xe0e60, 0x1d0, 0xe10, 0x20740
  .long 0xe0e70, 0x1d8, 0xe18, 0x207c0
  .long 0xe1c00, 0x440, 0x2200, 0x20048
  .long 0xe1c10, 0x448, 0x2208, 0x200c8
  .long 0xe1c20, 0x450, 0x2210, 0x20148
  .long 0xe1c30, 0x458, 0x2218, 0x201c8
  .long 0xe1c40, 0x4c0, 0x2600, 0x20248
  .long 0xe1c50, 0x4c8, 0x2608, 0x202c8
  .long 0xe1c60, 0x4d0, 0x2610, 0x20348
  .long 0xe1c70, 0x4d8, 0x2618, 0x203c8
  .long 0xe2a00, 0x540, 0x2a00, 0x20448
  .long 0xe2a10, 0x548, 0x2a08, 0x204c8
  .long 0xe2a20, 0x550, 0x2a10, 0x20548
  .long 0xe2a30, 0x558, 0x2a18, 0x205c8
  .long 0xe2a40, 0x5c0, 0x2e00, 0x20648
  .long 0xe2a50, 0x5c8, 0x2e08, 0x206c8
  .long 0xe2a60, 0x5d0, 0x2e10, 0x20748
  .long 0xe2a70, 0x5d8, 0x2e18, 0x207c8
  .long 0xe3800, 0x840, 0x4200, 0x20050
  .long 0xe3810, 0x848, 0x4208, 0x200d0
  .long 0xe3820, 0x850, 0x4210, 0x20150
  .long 0xe3830, 0x858, 0x4218, 0x201d0
  .long 0xe3840, 0x8c0, 0x4600, 0x20250
  .long 0xe3850, 0x8c8, 0x4608, 0x202d0
  .long 0xe3860, 0x8d0, 0x4610, 0x20350
  .long 0xe3870, 0x8d8, 0x4618, 0x203d0
  .long 0xe4600, 0x940, 0x4a00, 0x20450
  .long 0xe4610, 0x948, 0x4a08, 0x204d0
  .long 0xe4620, 0x950, 0x4a10, 0x20550
  .long 0xe4630, 0x958, 0x4a18, 0x205d0
  .long 0xe4640, 0x9c0, 0x4e00, 0x20650
  .long 0xe4650, 0x9c8, 0x4e08, 0x206d0
  .long 0xe4660, 0x9d0, 0x4e10, 0x20750
  .long 0xe4670, 0x9d8, 0x4e18, 0x207d0
  .long 0xe5400, 0xc40, 0x6200, 0x20058
  .long 0xe5410, 0xc48, 0x6208, 0x200d8
  .long 0xe5420, 0xc50, 0x6210, 0x20158
  .long 0xe5430, 0xc58, 0x6218, 0x201d8
  .long 0xe5440, 0xcc0, 0x6600, 0x20258
  .long 0xe5450, 0xcc8, 0x6608, 0x202d8
  .long 0xe5460, 0xcd0, 0x6610, 0x20358
  .long 0xe5470, 0xcd8, 0x6618, 0x203d8
  .long 0xe6200, 0xd40, 0x6a00, 0x20458
  .long 0xe6210, 0xd48, 0x6a08, 0x204d8
  .long 0xe6220, 0xd50, 0x6a10, 0x20558
  .long 0xe6230, 0xd58, 0x6a18, 0x205d8
  .long 0xe6240, 0xdc0, 0x6e00, 0x20658
  .long 0xe6250, 0xdc8, 0x6e08, 0x206d8
  .long 0xe6260, 0xdd0, 0x6e10, 0x20758
  .long 0xe6270, 0xdd8, 0x6e18, 0x207d8
  .long 0x150000, 0x60, 0x300, 0x20060
  .long 0x150010, 0x68, 0x308, 0x200e0
  .long 0x150020, 0x70, 0x310, 0x20160
  .long 0x150030, 0x78, 0x318, 0x201e0
  .long 0x150040, 0xe0, 0x700, 0x20260
  .long 0x150050, 0xe8, 0x708, 0x202e0
  .long 0x150060, 0xf0, 0x710, 0x20360
  .long 0x150070, 0xf8, 0x718, 0x203e0
  .long 0x150e00, 0x160, 0xb00, 0x20460
  .long 0x150e10, 0x168, 0xb08, 0x204e0
  .long 0x150e20, 0x170, 0xb10, 0x20560
  .long 0x150e30, 0x178, 0xb18, 0x205e0
  .long 0x150e40, 0x1e0, 0xf00, 0x20660
  .long 0x150e50, 0x1e8, 0xf08, 0x206e0
  .long 0x150e60, 0x1f0, 0xf10, 0x20760
  .long 0x150e70, 0x1f8, 0xf18, 0x207e0
  .long 0x151c00, 0x460, 0x2300, 0x20068
  .long 0x151c10, 0x468, 0x2308, 0x200e8
  .long 0x151c20, 0x470, 0x2310, 0x20168
  .long 0x151c30, 0x478, 0x2318, 0x201e8
  .long 0x151c40, 0x4e0, 0x2700, 0x20268
  .long 0x151c50, 0x4e8, 0x2708, 0x202e8
  .long 0x151c60, 0x4f0, 0x2710, 0x20368
  .long 0x151c70, 0x4f8, 0x2718, 0x203e8
  .long 0x152a00, 0x560, 0x2b00, 0x20468
  .long 0x152a10, 0x568, 0x2b08, 0x204e8
  .long 0x152a20, 0x570, 0x2b10, 0x20568
  .long 0x152a30, 0x578, 0x2b18, 0x205e8
  .long 0x152a40, 0x5e0, 0x2f00, 0x20668
  .long 0x152a50, 0x5e8, 0x2f08, 0x206e8
  .long 0x152a60, 0x5f0, 0x2f10, 0x20768
  .long 0x152a70, 0x5f8, 0x2f18, 0x207e8
  .long 0x153800, 0x860, 0x4300, 0x20070
  .long 0x153810, 0x868, 0x4308, 0x200f0
  .long 0x153820, 0x870, 0x4310, 0x20170
  .long 0x153830, 0x878, 0x4318, 0x201f0
  .long 0x153840, 0x8e0, 0x4700, 0x20270
  .long 0x153850, 0x8e8, 0x4708, 0x202f0
  .long 0x153860, 0x8f0, 0x4710, 0x20370
  .long 0x153870, 0x8f8, 0x4718, 0x203f0
  .long 0x154600, 0x960, 0x4b00, 0x20470
  .long 0x154610, 0x968, 0x4b08, 0x204f0
  .long 0x154620, 0x970, 0x4b10, 0x20570
  .long 0x154630, 0x978, 0x4b18, 0x205f0
  .long 0x154640, 0x9e0, 0x4f00, 0x20670
  .long 0x154650, 0x9e8, 0x4f08, 0x206f0
  .long 0x154660, 0x9f0, 0x4f10, 0x20770
  .long 0x154670, 0x9f8, 0x4f18, 0x207f0
  .long 0x155400, 0xc60, 0x6300, 0x20078
  .long 0x155410, 0xc68, 0x6308, 0x200f8
  .long 0x155420, 0xc70, 0x6310, 0x20178
  .long 0x155430, 0xc78, 0x6318, 0x201f8
  .long 0x155440, 0xce0, 0x6700, 0x20278
  .long 0x155450, 0xce8, 0x6708, 0x202f8
  .long 0x155460, 0xcf0, 0x6710, 0x20378
  .long 0x155470, 0xcf8, 0x6718, 0x203f8
  .long 0x156200, 0xd60, 0x6b00, 0x20478
  .long 0x156210, 0xd68, 0x6b08, 0x204f8
  .long 0x156220, 0xd70, 0x6b10, 0x20578
  .long 0x156230, 0xd78, 0x6b18, 0x205f8
  .long 0x156240, 0xde0, 0x6f00, 0x20678
  .long 0x156250, 0xde8, 0x6f08, 0x206f8
  .long 0x156260, 0xdf0, 0x6f10, 0x20778
  .long 0x156270, 0xdf8, 0x6f18, 0x207f8
  .long 0x20000, 0x0, 0x0, 0x0
  .long 0x20080, 0x800, 0x0, 0x1
  .long 0x20100, 0x1000, 0x0, 0x2
  .long 0x20180, 0x1800, 0x0, 0x3
  .long 0x20200, 0x2000, 0x0, 0x4
  .long 0x20280, 0x2800, 0x0, 0x5
  .long 0x20300, 0x3000, 0x0, 0x6
  .long 0x20380, 0x3800, 0x0, 0x7
  .long 0x20400, 0x0, 0x0, 0x0
  .long 0x20480, 0x800, 0x0, 0x1
  .long 0x20500, 0x1000, 0x0, 0x2
  .long 0x20580, 0x1800, 0x0, 0x3
  .long 0x20600, 0x2000, 0x0, 0x4
  .long 0x20680, 0x2800, 0x0, 0x5
  .long 0x20700, 0x3000, 0x0, 0x6
  .long 0x20780, 0x3800, 0x0, 0x7
  .long 0x20010, 0x10, 0x10, 0x0
  .long 0x20090, 0x810, 0x10, 0x1
  .long 0x20110, 0x1010, 0x10, 0x2
  .long 0x20190, 0x1810, 0x10, 0x3
  .long 0x20210, 0x2010, 0x10, 0x4
  .long 0x20290, 0x2810, 0x10, 0x5
  .long 0x20310, 0x3010, 0x10, 0x6
  .long 0x20390, 0x3810, 0x10, 0x7
  .long 0x20410, 0x10, 0x10, 0x0
  .long 0x20490, 0x810, 0x10, 0x1
  .long 0x20510, 0x1010, 0x10, 0x2
  .long 0x20590, 0x1810, 0x10, 0x3
  .long 0x20610, 0x2010, 0x10, 0x4
  .long 0x20690, 0x2810, 0x10, 0x5
  .long 0x20710, 0x3010, 0x10, 0x6
  .long 0x20790, 0x3810, 0x10, 0x7
  .long 0x20020, 0x20, 0x20, 0x0
  .long 0x200a0, 0x820, 0x20, 0x1
  .long 0x20120, 0x1020, 0x20, 0x2
  .long 0x201a0, 0x1820, 0x20, 0x3
  .long 0x20220, 0x2020, 0x20, 0x4
  .long 0x202a0, 0x2820, 0x20, 0x5
  .long 0x20320, 0x3020, 0x20, 0x6
  .long 0x203a0, 0x3820, 0x20, 0x7
  .long 0x20420, 0x20, 0x20, 0x0
  .long 0x204a0, 0x820, 0x20, 0x1
  .long 0x20520, 0x1020, 0x20, 0x2
  .long 0x205a0, 0x1820, 0x20, 0x3
  .long 0x20620, 0x2020, 0x20, 0x4
  .long 0x206a0, 0x2820, 0x20, 0x5
  .long 0x20720, 0x3020, 0x20, 0x6
  .long 0x207a0, 0x3820, 0x20, 0x7
  .long 0x20030, 0x30, 0x30, 0x0
  .long 0x200b0, 0x830, 0x30, 0x1
  .long 0x20130, 0x1030, 0x30, 0x2
  .long 0x201b0, 0x1830, 0x30, 0x3
  .long 0x20230, 0x2030, 0x30, 0x4
  .long 0x202b0, 0x2830, 0x30, 0x5
  .long 0x20330, 0x3030, 0x30, 0x6
  .long 0x203b0, 0x3830, 0x30, 0x7
  .long 0x20430, 0x30, 0x30, 0x0
  .long 0x204b0, 0x830, 0x30, 0x1
  .long 0x20530, 0x1030, 0x30, 0x2
  .long 0x205b0, 0x1830, 0x30, 0x3
  .long 0x20630, 0x2030, 0x30, 0x4
  .long 0x206b0, 0x2830, 0x30, 0x5
  .long 0x20730, 0x3030, 0x30, 0x6
  .long 0x207b0, 0x3830, 0x30, 0x7
  .long 0x20000, 0x200, 0x0, 0x0
  .long 0x20080, 0xa00, 0x0, 0x1
  .long 0x20100, 0x1200, 0x0, 0x2
  .long 0x20180, 0x1a00, 0x0, 0x3
  .long 0x20200, 0x2200, 0x0, 0x4
  .long 0x20280, 0x2a00, 0x0, 0x5
  .long 0x20300, 0x3200, 0x0, 0x6
  .long 0x20380, 0x3a00, 0x0, 0x7
  .long 0x20400, 0x200, 0x0, 0x0
  .long 0x20480, 0xa00, 0x0, 0x1
  .long 0x20500, 0x1200, 0x0, 0x2
  .long 0x20580, 0x1a00, 0x0, 0x3
  .long 0x20600, 0x2200, 0x0, 0x4
  .long 0x20680, 0x2a00, 0x0, 0x5
  .long 0x20700, 0x3200, 0x0, 0x6
  .long 0x20780, 0x3a00, 0x0, 0x7
  .long 0x20010, 0x210, 0x10, 0x0
  .long 0x20090, 0xa10, 0x10, 0x1
  .long 0x20110, 0x1210, 0x10, 0x2
  .long 0x20190, 0x1a10, 0x10, 0x3
  .long 0x20210, 0x2210, 0x10, 0x4
  .long 0x20290, 0x2a10, 0x10, 0x5
  .long 0x20310, 0x3210, 0x10, 0x6
  .long 0x20390, 0x3a10, 0x10, 0x7
  .long 0x20410, 0x210, 0x10, 0x0
  .long 0x20490, 0xa10, 0x10, 0x1
  .long 0x20510, 0x1210, 0x10, 0x2
  .long 0x20590, 0x1a10, 0x10, 0x3
  .long 0x20610, 0x2210, 0x10, 0x4
  .long 0x20690, 0x2a10, 0x10, 0x5
  .long 0x20710, 0x3210, 0x10, 0x6
  .long 0x20790, 0x3a10, 0x10, 0x7
  .long 0x20020, 0x220, 0x20, 0x0
  .long 0x200a0, 0xa20, 0x20, 0x1
  .long 0x20120, 0x1220, 0x20, 0x2
  .long 0x201a0, 0x1a20, 0x20, 0x3
  .long 0x20220, 0x2220, 0x20, 0x4
  .long 0x202a0, 0x2a20, 0x20, 0x5
  .long 0x20320, 0x3220, 0x20, 0x6
  .long 0x203a0, 0x3a20, 0x20, 0x7
  .long 0x20420, 0x220, 0x20, 0x0
  .long 0x204a0, 0xa20, 0x20, 0x1
  .long 0x20520, 0x1220, 0x20, 0x2
  .long 0x205a0, 0x1a20, 0x20, 0x3
  .long 0x20620, 0x2220, 0x20, 0x4
  .long 0x206a0, 0x2a20, 0x20, 0x5
  .long 0x20720, 0x3220, 0x20, 0x6
  .long 0x207a0, 0x3a20, 0x20, 0x7
  .long 0x20030, 0x230, 0x30, 0x0
  .long 0x200b0, 0xa30, 0x30, 0x1
  .long 0x20130, 0x1230, 0x30, 0x2
  .long 0x201b0, 0x1a30, 0x30, 0x3
  .long 0x20230, 0x2230, 0x30, 0x4
  .long 0x202b0, 0x2a30, 0x30, 0x5
  .long 0x20330, 0x3230, 0x30, 0x6
  .long 0x203b0, 0x3a30, 0x30, 0x7
  .long 0x20430, 0x230, 0x30, 0x0
  .long 0x204b0, 0xa30, 0x30, 0x1
  .long 0x20530, 0x1230, 0x30, 0x2
  .long 0x205b0, 0x1a30, 0x30, 0x3
  .long 0x20630, 0x2230, 0x30, 0x4
  .long 0x206b0, 0x2a30, 0x30, 0x5
  .long 0x20730, 0x3230, 0x30, 0x6
  .long 0x207b0, 0x3a30, 0x30, 0x7
  .long 0x20000, 0x400, 0x0, 0x0
  .long 0x20080, 0xc00, 0x0, 0x1
  .long 0x20100, 0x1400, 0x0, 0x2
  .long 0x20180, 0x1c00, 0x0, 0x3
  .long 0x20200, 0x2400, 0x0, 0x4
  .long 0x20280, 0x2c00, 0x0, 0x5
  .long 0x20300, 0x3400, 0x0, 0x6
  .long 0x20380, 0x3c00, 0x0, 0x7
  .long 0x20400, 0x400, 0x0, 0x0
  .long 0x20480, 0xc00, 0x0, 0x1
  .long 0x20500, 0x1400, 0x0, 0x2
  .long 0x20580, 0x1c00, 0x0, 0x3
  .long 0x20600, 0x2400, 0x0, 0x4
  .long 0x20680, 0x2c00, 0x0, 0x5
  .long 0x20700, 0x3400, 0x0, 0x6
  .long 0x20780, 0x3c00, 0x0, 0x7
  .long 0x20010, 0x410, 0x10, 0x0
  .long 0x20090, 0xc10, 0x10, 0x1
  .long 0x20110, 0x1410, 0x10, 0x2
  .long 0x20190, 0x1c10, 0x10, 0x3
  .long 0x20210, 0x2410, 0x10, 0x4
  .long 0x20290, 0x2c10, 0x10, 0x5
  .long 0x20310, 0x3410, 0x10, 0x6
  .long 0x20390, 0x3c10, 0x10, 0x7
  .long 0x20410, 0x410, 0x10, 0x0
  .long 0x20490, 0xc10, 0x10, 0x1
  .long 0x20510, 0x1410, 0x10, 0x2
  .long 0x20590, 0x1c10, 0x10, 0x3
  .long 0x20610, 0x2410, 0x10, 0x4
  .long 0x20690, 0x2c10, 0x10, 0x5
  .long 0x20710, 0x3410, 0x10, 0x6
  .long 0x20790, 0x3c10, 0x10, 0x7
  .long 0x20020, 0x420, 0x20, 0x0
  .long 0x200a0, 0xc20, 0x20, 0x1
  .long 0x20120, 0x1420, 0x20, 0x2
  .long 0x201a0, 0x1c20, 0x20, 0x3
  .long 0x20220, 0x2420, 0x20, 0x4
  .long 0x202a0, 0x2c20, 0x20, 0x5
  .long 0x20320, 0x3420, 0x20, 0x6
  .long 0x203a0, 0x3c20, 0x20, 0x7
  .long 0x20420, 0x420, 0x20, 0x0
  .long 0x204a0, 0xc20, 0x20, 0x1
  .long 0x20520, 0x1420, 0x20, 0x2
  .long 0x205a0, 0x1c20, 0x20, 0x3
  .long 0x20620, 0x2420, 0x20, 0x4
  .long 0x206a0, 0x2c20, 0x20, 0x5
  .long 0x20720, 0x3420, 0x20, 0x6
  .long 0x207a0, 0x3c20, 0x20, 0x7
  .long 0x20030, 0x430, 0x30, 0x0
  .long 0x200b0, 0xc30, 0x30, 0x1
  .long 0x20130, 0x1430, 0x30, 0x2
  .long 0x201b0, 0x1c30, 0x30, 0x3
  .long 0x20230, 0x2430, 0x30, 0x4
  .long 0x202b0, 0x2c30, 0x30, 0x5
  .long 0x20330, 0x3430, 0x30, 0x6
  .long 0x203b0, 0x3c30, 0x30, 0x7
  .long 0x20430, 0x430, 0x30, 0x0
  .long 0x204b0, 0xc30, 0x30, 0x1
  .long 0x20530, 0x1430, 0x30, 0x2
  .long 0x205b0, 0x1c30, 0x30, 0x3
  .long 0x20630, 0x2430, 0x30, 0x4
  .long 0x206b0, 0x2c30, 0x30, 0x5
  .long 0x20730, 0x3430, 0x30, 0x6
  .long 0x207b0, 0x3c30, 0x30, 0x7
  .long 0x20000, 0x600, 0x0, 0x0
  .long 0x20080, 0xe00, 0x0, 0x1
  .long 0x20100, 0x1600, 0x0, 0x2
  .long 0x20180, 0x1e00, 0x0, 0x3
  .long 0x20200, 0x2600, 0x0, 0x4
  .long 0x20280, 0x2e00, 0x0, 0x5
  .long 0x20300, 0x3600, 0x0, 0x6
  .long 0x20380, 0x3e00, 0x0, 0x7
  .long 0x20400, 0x600, 0x0, 0x0
  .long 0x20480, 0xe00, 0x0, 0x1
  .long 0x20500, 0x1600, 0x0, 0x2
  .long 0x20580, 0x1e00, 0x0, 0x3
  .long 0x20600, 0x2600, 0x0, 0x4
  .long 0x20680, 0x2e00, 0x0, 0x5
  .long 0x20700, 0x3600, 0x0, 0x6
  .long 0x20780, 0x3e00, 0x0, 0x7
  .long 0x20010, 0x610, 0x10, 0x0
  .long 0x20090, 0xe10, 0x10, 0x1
  .long 0x20110, 0x1610, 0x10, 0x2
  .long 0x20190, 0x1e10, 0x10, 0x3
  .long 0x20210, 0x2610, 0x10, 0x4
  .long 0x20290, 0x2e10, 0x10, 0x5
  .long 0x20310, 0x3610, 0x10, 0x6
  .long 0x20390, 0x3e10, 0x10, 0x7
  .long 0x20410, 0x610, 0x10, 0x0
  .long 0x20490, 0xe10, 0x10, 0x1
  .long 0x20510, 0x1610, 0x10, 0x2
  .long 0x20590, 0x1e10, 0x10, 0x3
  .long 0x20610, 0x2610, 0x10, 0x4
  .long 0x20690, 0x2e10, 0x10, 0x5
  .long 0x20710, 0x3610, 0x10, 0x6
  .long 0x20790, 0x3e10, 0x10, 0x7
  .long 0x20020, 0x620, 0x20, 0x0
  .long 0x200a0, 0xe20, 0x20, 0x1
  .long 0x20120, 0x1620, 0x20, 0x2
  .long 0x201a0, 0x1e20, 0x20, 0x3
  .long 0x20220, 0x2620, 0x20, 0x4
  .long 0x202a0, 0x2e20, 0x20, 0x5
  .long 0x20320, 0x3620, 0x20, 0x6
  .long 0x203a0, 0x3e20, 0x20, 0x7
  .long 0x20420, 0x620, 0x20, 0x0
  .long 0x204a0, 0xe20, 0x20, 0x1
  .long 0x20520, 0x1620, 0x20, 0x2
  .long 0x205a0, 0x1e20, 0x20, 0x3
  .long 0x20620, 0x2620, 0x20, 0x4
  .long 0x206a0, 0x2e20, 0x20, 0x5
  .long 0x20720, 0x3620, 0x20, 0x6
  .long 0x207a0, 0x3e20, 0x20, 0x7
  .long 0x20030, 0x630, 0x30, 0x0
  .long 0x200b0, 0xe30, 0x30, 0x1
  .long 0x20130, 0x1630, 0x30, 0x2
  .long 0x201b0, 0x1e30, 0x30, 0x3
  .long 0x20230, 0x2630, 0x30, 0x4
  .long 0x202b0, 0x2e30, 0x30, 0x5
  .long 0x20330, 0x3630, 0x30, 0x6
  .long 0x203b0, 0x3e30, 0x30, 0x7
  .long 0x20430, 0x630, 0x30, 0x0
  .long 0x204b0, 0xe30, 0x30, 0x1
  .long 0x20530, 0x1630, 0x30, 0x2
  .long 0x205b0, 0x1e30, 0x30, 0x3
  .long 0x20630, 0x2630, 0x30, 0x4
  .long 0x206b0, 0x2e30, 0x30, 0x5
  .long 0x20730, 0x3630, 0x30, 0x6
  .long 0x207b0, 0x3e30, 0x30, 0x7
  .long 0x0, 0x20, 0x0, 0x0
  .long 0x10, 0x30, 0x10, 0x4
  .long 0x20, 0x60, 0x40, 0x8
  .long 0x30, 0x70, 0x50, 0xc
  .long 0x40, 0xa0, 0x80, 0x10
  .long 0x50, 0xb0, 0x90, 0x14
  .long 0x60, 0xe0, 0xc0, 0x18
  .long 0x70, 0xf0, 0xd0, 0x1c
  .long 0x80, 0x20, 0x100, 0x20
  .long 0x90, 0x30, 0x110, 0x24
  .long 0xa0, 0x60, 0x140, 0x28
  .long 0xb0, 0x70, 0x150, 0x2c
  .long 0xc0, 0xa0, 0x180, 0x30
  .long 0xd0, 0xb0, 0x190, 0x34
  .long 0xe0, 0xe0, 0x1c0, 0x38
  .long 0xf0, 0xf0, 0x1d0, 0x3c
  .long 0x440, 0x20, 0x200, 0x40
  .long 0x450, 0x30, 0x210, 0x44
  .long 0x460, 0x60, 0x240, 0x48
  .long 0x470, 0x70, 0x250, 0x4c
  .long 0x400, 0xa0, 0x280, 0x50
  .long 0x410, 0xb0, 0x290, 0x54
  .long 0x420, 0xe0, 0x2c0, 0x58
  .long 0x430, 0xf0, 0x2d0, 0x5c
  .long 0x4c0, 0x20, 0x300, 0x60
  .long 0x4d0, 0x30, 0x310, 0x64
  .long 0x4e0, 0x60, 0x340, 0x68
  .long 0x4f0, 0x70, 0x350, 0x6c
  .long 0x480, 0xa0, 0x380, 0x70
  .long 0x490, 0xb0, 0x390, 0x74
  .long 0x4a0, 0xe0, 0x3c0, 0x78
  .long 0x4b0, 0xf0, 0x3d0, 0x7c
  .long 0x880, 0x120, 0x0, 0x0
  .long 0x890, 0x130, 0x10, 0x4
  .long 0x8a0, 0x160, 0x40, 0x8
  .long 0x8b0, 0x170, 0x50, 0xc
  .long 0x8c0, 0x1a0, 0x80, 0x10
  .long 0x8d0, 0x1b0, 0x90, 0x14
  .long 0x8e0, 0x1e0, 0xc0, 0x18
  .long 0x8f0, 0x1f0, 0xd0, 0x1c
  .long 0x800, 0x120, 0x100, 0x20
  .long 0x810, 0x130, 0x110, 0x24
  .long 0x820, 0x160, 0x140, 0x28
  .long 0x830, 0x170, 0x150, 0x2c
  .long 0x840, 0x1a0, 0x180, 0x30
  .long 0x850, 0x1b0, 0x190, 0x34
  .long 0x860, 0x1e0, 0x1c0, 0x38
  .long 0x870, 0x1f0, 0x1d0, 0x3c
  .long 0xcc0, 0x120, 0x200, 0x40
  .long 0xcd0, 0x130, 0x210, 0x44
  .long 0xce0, 0x160, 0x240, 0x48
  .long 0xcf0, 0x170, 0x250, 0x4c
  .long 0xc80, 0x1a0, 0x280, 0x50
  .long 0xc90, 0x1b0, 0x290, 0x54
  .long 0xca0, 0x1e0, 0x2c0, 0x58
  .long 0xcb0, 0x1f0, 0x2d0, 0x5c
  .long 0xc40, 0x120, 0x300, 0x60
  .long 0xc50, 0x130, 0x310, 0x64
  .long 0xc60, 0x160, 0x340, 0x68
  .long 0xc70, 0x170, 0x350, 0x6c
  .long 0xc00, 0x1a0, 0x380, 0x70
  .long 0xc10, 0x1b0, 0x390, 0x74
  .long 0xc20, 0x1e0, 0x3c0, 0x78
  .long 0xc30, 0x1f0, 0x3d0, 0x7c
  .long 0x0, 0x20, 0x0, 0x0
  .long 0x10, 0x30, 0x10, 0x4
  .long 0x20, 0x60, 0x40, 0x8
  .long 0x30, 0x70, 0x50, 0xc
  .long 0x40, 0xa0, 0x80, 0x10
  .long 0x50, 0xb0, 0x90, 0x14
  .long 0x60, 0xe0, 0xc0, 0x18
  .long 0x70, 0xf0, 0xd0, 0x1c
  .long 0x80, 0x20, 0x100, 0x20
  .long 0x90, 0x30, 0x110, 0x24
  .long 0xa0, 0x60, 0x140, 0x28
  .long 0xb0, 0x70, 0x150, 0x2c
  .long 0xc0, 0xa0, 0x180, 0x30
  .long 0xd0, 0xb0, 0x190, 0x34
  .long 0xe0, 0xe0, 0x1c0, 0x38
  .long 0xf0, 0xf0, 0x1d0, 0x3c
  .long 0x440, 0x20, 0x200, 0x40
  .long 0x450, 0x30, 0x210, 0x44
  .long 0x460, 0x60, 0x240, 0x48
  .long 0x470, 0x70, 0x250, 0x4c
  .long 0x400, 0xa0, 0x280, 0x50
  .long 0x410, 0xb0, 0x290, 0x54
  .long 0x420, 0xe0, 0x2c0, 0x58
  .long 0x430, 0xf0, 0x2d0, 0x5c
  .long 0x4c0, 0x20, 0x300, 0x60
  .long 0x4d0, 0x30, 0x310, 0x64
  .long 0x4e0, 0x60, 0x340, 0x68
  .long 0x4f0, 0x70, 0x350, 0x6c
  .long 0x480, 0xa0, 0x380, 0x70
  .long 0x490, 0xb0, 0x390, 0x74
  .long 0x4a0, 0xe0, 0x3c0, 0x78
  .long 0x4b0, 0xf0, 0x3d0, 0x7c
  .long 0x880, 0x120, 0x0, 0x0
  .long 0x890, 0x130, 0x10, 0x4
  .long 0x8a0, 0x160, 0x40, 0x8
  .long 0x8b0, 0x170, 0x50, 0xc
  .long 0x8c0, 0x1a0, 0x80, 0x10
  .long 0x8d0, 0x1b0, 0x90, 0x14
  .long 0x8e0, 0x1e0, 0xc0, 0x18
  .long 0x8f0, 0x1f0, 0xd0, 0x1c
  .long 0x800, 0x120, 0x100, 0x20
  .long 0x810, 0x130, 0x110, 0x24
  .long 0x820, 0x160, 0x140, 0x28
  .long 0x830, 0x170, 0x150, 0x2c
  .long 0x840, 0x1a0, 0x180, 0x30
  .long 0x850, 0x1b0, 0x190, 0x34
  .long 0x860, 0x1e0, 0x1c0, 0x38
  .long 0x870, 0x1f0, 0x1d0, 0x3c
  .long 0xcc0, 0x120, 0x200, 0x40
  .long 0xcd0, 0x130, 0x210, 0x44
  .long 0xce0, 0x160, 0x240, 0x48
  .long 0xcf0, 0x170, 0x250, 0x4c
  .long 0xc80, 0x1a0, 0x280, 0x50
  .long 0xc90, 0x1b0, 0x290, 0x54
  .long 0xca0, 0x1e0, 0x2c0, 0x58
  .long 0xcb0, 0x1f0, 0x2d0, 0x5c
  .long 0xc40, 0x120, 0x300, 0x60
  .long 0xc50, 0x130, 0x310, 0x64
  .long 0xc60, 0x160, 0x340, 0x68
  .long 0xc70, 0x170, 0x350, 0x6c
  .long 0xc00, 0x1a0, 0x380, 0x70
  .long 0xc10, 0x1b0, 0x390, 0x74
  .long 0xc20, 0x1e0, 0x3c0, 0x78
  .long 0xc30, 0x1f0, 0x3d0, 0x7c
  .long 0x0, 0x20, 0x0, 0x0
  .long 0x10, 0x30, 0x10, 0x4
  .long 0x20, 0x60, 0x40, 0x8
  .long 0x30, 0x70, 0x50, 0xc
  .long 0x40, 0xa0, 0x80, 0x10
  .long 0x50, 0xb0, 0x90, 0x14
  .long 0x60, 0xe0, 0xc0, 0x18
  .long 0x70, 0xf0, 0xd0, 0x1c
  .long 0x80, 0x20, 0x100, 0x20
  .long 0x90, 0x30, 0x110, 0x24
  .long 0xa0, 0x60, 0x140, 0x28
  .long 0xb0, 0x70, 0x150, 0x2c
  .long 0xc0, 0xa0, 0x180, 0x30
  .long 0xd0, 0xb0, 0x190, 0x34
  .long 0xe0, 0xe0, 0x1c0, 0x38
  .long 0xf0, 0xf0, 0x1d0, 0x3c
  .long 0x440, 0x20, 0x200, 0x40
  .long 0x450, 0x30, 0x210, 0x44
  .long 0x460, 0x60, 0x240, 0x48
  .long 0x470, 0x70, 0x250, 0x4c
  .long 0x400, 0xa0, 0x280, 0x50
  .long 0x410, 0xb0, 0x290, 0x54
  .long 0x420, 0xe0, 0x2c0, 0x58
  .long 0x430, 0xf0, 0x2d0, 0x5c
  .long 0x4c0, 0x20, 0x300, 0x60
  .long 0x4d0, 0x30, 0x310, 0x64
  .long 0x4e0, 0x60, 0x340, 0x68
  .long 0x4f0, 0x70, 0x350, 0x6c
  .long 0x480, 0xa0, 0x380, 0x70
  .long 0x490, 0xb0, 0x390, 0x74
  .long 0x4a0, 0xe0, 0x3c0, 0x78
  .long 0x4b0, 0xf0, 0x3d0, 0x7c
  .long 0x880, 0x120, 0x0, 0x0
  .long 0x890, 0x130, 0x10, 0x4
  .long 0x8a0, 0x160, 0x40, 0x8
  .long 0x8b0, 0x170, 0x50, 0xc
  .long 0x8c0, 0x1a0, 0x80, 0x10
  .long 0x8d0, 0x1b0, 0x90, 0x14
  .long 0x8e0, 0x1e0, 0xc0, 0x18
  .long 0x8f0, 0x1f0, 0xd0, 0x1c
  .long 0x800, 0x120, 0x100, 0x20
  .long 0x810, 0x130, 0x110, 0x24
  .long 0x820, 0x160, 0x140, 0x28
  .long 0x830, 0x170, 0x150, 0x2c
  .long 0x840, 0x1a0, 0x180, 0x30
  .long 0x850, 0x1b0, 0x190, 0x34
  .long 0x860, 0x1e0, 0x1c0, 0x38
  .long 0x870, 0x1f0, 0x1d0, 0x3c
  .long 0xcc0, 0x120, 0x200, 0x40
  .long 0xcd0, 0x130, 0x210, 0x44
  .long 0xce0, 0x160, 0x240, 0x48
  .long 0xcf0, 0x170, 0x250, 0x4c
  .long 0xc80, 0x1a0, 0x280, 0x50
  .long 0xc90, 0x1b0, 0x290, 0x54
  .long 0xca0, 0x1e0, 0x2c0, 0x58
  .long 0xcb0, 0x1f0, 0x2d0, 0x5c
  .long 0xc40, 0x120, 0x300, 0x60
  .long 0xc50, 0x130, 0x310, 0x64
  .long 0xc60, 0x160, 0x340, 0x68
  .long 0xc70, 0x170, 0x350, 0x6c
  .long 0xc00, 0x1a0, 0x380, 0x70
  .long 0xc10, 0x1b0, 0x390, 0x74
  .long 0xc20, 0x1e0, 0x3c0, 0x78
  .long 0xc30, 0x1f0, 0x3d0, 0x7c
  .long 0x0, 0x20, 0x0, 0x0
  .long 0x10, 0x30, 0x10, 0x4
  .long 0x20, 0x60, 0x40, 0x8
  .long 0x30, 0x70, 0x50, 0xc
  .long 0x40, 0xa0, 0x80, 0x10
  .long 0x50, 0xb0, 0x90, 0x14
  .long 0x60, 0xe0, 0xc0, 0x18
  .long 0x70, 0xf0, 0xd0, 0x1c
  .long 0x80, 0x20, 0x100, 0x20
  .long 0x90, 0x30, 0x110, 0x24
  .long 0xa0, 0x60, 0x140, 0x28
  .long 0xb0, 0x70, 0x150, 0x2c
  .long 0xc0, 0xa0, 0x180, 0x30
  .long 0xd0, 0xb0, 0x190, 0x34
  .long 0xe0, 0xe0, 0x1c0, 0x38
  .long 0xf0, 0xf0, 0x1d0, 0x3c
  .long 0x440, 0x20, 0x200, 0x40
  .long 0x450, 0x30, 0x210, 0x44
  .long 0x460, 0x60, 0x240, 0x48
  .long 0x470, 0x70, 0x250, 0x4c
  .long 0x400, 0xa0, 0x280, 0x50
  .long 0x410, 0xb0, 0x290, 0x54
  .long 0x420, 0xe0, 0x2c0, 0x58
  .long 0x430, 0xf0, 0x2d0, 0x5c
  .long 0x4c0, 0x20, 0x300, 0x60
  .long 0x4d0, 0x30, 0x310, 0x64
  .long 0x4e0, 0x60, 0x340, 0x68
  .long 0x4f0, 0x70, 0x350, 0x6c
  .long 0x480, 0xa0, 0x380, 0x70
  .long 0x490, 0xb0, 0x390, 0x74
  .long 0x4a0, 0xe0, 0x3c0, 0x78
  .long 0x4b0, 0xf0, 0x3d0, 0x7c
  .long 0x880, 0x120, 0x0, 0x0
  .long 0x890, 0x130, 0x10, 0x4
  .long 0x8a0, 0x160, 0x40, 0x8
  .long 0x8b0, 0x170, 0x50, 0xc
  .long 0x8c0, 0x1a0, 0x80, 0x10
  .long 0x8d0, 0x1b0, 0x90, 0x14
  .long 0x8e0, 0x1e0, 0xc0, 0x18
  .long 0x8f0, 0x1f0, 0xd0, 0x1c
  .long 0x800, 0x120, 0x100, 0x20
  .long 0x810, 0x130, 0x110, 0x24
  .long 0x820, 0x160, 0x140, 0x28
  .long 0x830, 0x170, 0x150, 0x2c
  .long 0x840, 0x1a0, 0x180, 0x30
  .long 0x850, 0x1b0, 0x190, 0x34
  .long 0x860, 0x1e0, 0x1c0, 0x38
  .long 0x870, 0x1f0, 0x1d0, 0x3c
  .long 0xcc0, 0x120, 0x200, 0x40
  .long 0xcd0, 0x130, 0x210, 0x44
  .long 0xce0, 0x160, 0x240, 0x48
  .long 0xcf0, 0x170, 0x250, 0x4c
  .long 0xc80, 0x1a0, 0x280, 0x50
  .long 0xc90, 0x1b0, 0x290, 0x54
  .long 0xca0, 0x1e0, 0x2c0, 0x58
  .long 0xcb0, 0x1f0, 0x2d0, 0x5c
  .long 0xc40, 0x120, 0x300, 0x60
  .long 0xc50, 0x130, 0x310, 0x64
  .long 0xc60, 0x160, 0x340, 0x68
  .long 0xc70, 0x170, 0x350, 0x6c
  .long 0xc00, 0x1a0, 0x380, 0x70
  .long 0xc10, 0x1b0, 0x390, 0x74
  .long 0xc20, 0x1e0, 0x3c0, 0x78
  .long 0xc30, 0x1f0, 0x3d0, 0x7c
  .long 0x0, 0x40, 0x80, 0xc0
  .long 0x8, 0x48, 0x88, 0xc8
  .long 0x10, 0x50, 0x90, 0xd0
  .long 0x18, 0x58, 0x98, 0xd8
  .long 0x140, 0x100, 0x1c0, 0x180
  .long 0x148, 0x108, 0x1c8, 0x188
  .long 0x150, 0x110, 0x1d0, 0x190
  .long 0x158, 0x118, 0x1d8, 0x198
  .long 0x280, 0x2c0, 0x200, 0x240
  .long 0x288, 0x2c8, 0x208, 0x248
  .long 0x290, 0x2d0, 0x210, 0x250
  .long 0x298, 0x2d8, 0x218, 0x258
  .long 0x3c0, 0x380, 0x340, 0x300
  .long 0x3c8, 0x388, 0x348, 0x308
  .long 0x3d0, 0x390, 0x350, 0x310
  .long 0x3d8, 0x398, 0x358, 0x318
  .long 0x20, 0x60, 0xa0, 0xe0
  .long 0x28, 0x68, 0xa8, 0xe8
  .long 0x30, 0x70, 0xb0, 0xf0
  .long 0x38, 0x78, 0xb8, 0xf8
  .long 0x160, 0x120, 0x1e0, 0x1a0
  .long 0x168, 0x128, 0x1e8, 0x1a8
  .long 0x170, 0x130, 0x1f0, 0x1b0
  .long 0x178, 0x138, 0x1f8, 0x1b8
  .long 0x2a0, 0x2e0, 0x220, 0x260
  .long 0x2a8, 0x2e8, 0x228, 0x268
  .long 0x2b0, 0x2f0, 0x230, 0x270
  .long 0x2b8, 0x2f8, 0x238, 0x278
  .long 0x3e0, 0x3a0, 0x360, 0x320
  .long 0x3e8, 0x3a8, 0x368, 0x328
  .long 0x3f0, 0x3b0, 0x370, 0x330
  .long 0x3f8, 0x3b8, 0x378, 0x338
  .long 0x400, 0x440, 0x480, 0x4c0
  .long 0x408, 0x448, 0x488, 0x4c8
  .long 0x410, 0x450, 0x490, 0x4d0
  .long 0x418, 0x458, 0x498, 0x4d8
  .long 0x540, 0x500, 0x5c0, 0x580
  .long 0x548, 0x508, 0x5c8, 0x588
  .long 0x550, 0x510, 0x5d0, 0x590
  .long 0x558, 0x518, 0x5d8, 0x598
  .long 0x680, 0x6c0, 0x600, 0x640
  .long 0x688, 0x6c8, 0x608, 0x648
  .long 0x690, 0x6d0, 0x610, 0x650
  .long 0x698, 0x6d8, 0x618, 0x658
  .long 0x7c0, 0x780, 0x740, 0x700
  .long 0x7c8, 0x788, 0x748, 0x708
  .long 0x7d0, 0x790, 0x750, 0x710
  .long 0x7d8, 0x798, 0x758, 0x718
  .long 0x420, 0x460, 0x4a0, 0x4e0
  .long 0x428, 0x468, 0x4a8, 0x4e8
  .long 0x430, 0x470, 0x4b0, 0x4f0
  .long 0x438, 0x478, 0x4b8, 0x4f8
  .long 0x560, 0x520, 0x5e0, 0x5a0
  .long 0x568, 0x528, 0x5e8, 0x5a8
  .long 0x570, 0x530, 0x5f0, 0x5b0
  .long 0x578, 0x538, 0x5f8, 0x5b8
  .long 0x6a0, 0x6e0, 0x620, 0x660
  .long 0x6a8, 0x6e8, 0x628, 0x668
  .long 0x6b0, 0x6f0, 0x630, 0x670
  .long 0x6b8, 0x6f8, 0x638, 0x678
  .long 0x7e0, 0x7a0, 0x760, 0x720
  .long 0x7e8, 0x7a8, 0x768, 0x728
  .long 0x7f0, 0x7b0, 0x770, 0x730
  .long 0x7f8, 0x7b8, 0x778, 0x738
  .long 0x8000, 0x8040, 0x8080, 0x80c0
  .long 0x8008, 0x8048, 0x8088, 0x80c8
  .long 0x8010, 0x8050, 0x8090, 0x80d0
  .long 0x8018, 0x8058, 0x8098, 0x80d8
  .long 0x8140, 0x8100, 0x81c0, 0x8180
  .long 0x8148, 0x8108, 0x81c8, 0x8188
  .long 0x8150, 0x8110, 0x81d0, 0x8190
  .long 0x8158, 0x8118, 0x81d8, 0x8198
  .long 0x8280, 0x82c0, 0x8200, 0x8240
  .long 0x8288, 0x82c8, 0x8208, 0x8248
  .long 0x8290, 0x82d0, 0x8210, 0x8250
  .long 0x8298, 0x82d8, 0x8218, 0x8258
  .long 0x83c0, 0x8380, 0x8340, 0x8300
  .long 0x83c8, 0x8388, 0x8348, 0x8308
  .long 0x83d0, 0x8390, 0x8350, 0x8310
  .long 0x83d8, 0x8398, 0x8358, 0x8318
  .long 0x8020, 0x8060, 0x80a0, 0x80e0
  .long 0x8028, 0x8068, 0x80a8, 0x80e8
  .long 0x8030, 0x8070, 0x80b0, 0x80f0
  .long 0x8038, 0x8078, 0x80b8, 0x80f8
  .long 0x8160, 0x8120, 0x81e0, 0x81a0
  .long 0x8168, 0x8128, 0x81e8, 0x81a8
  .long 0x8170, 0x8130, 0x81f0, 0x81b0
  .long 0x8178, 0x8138, 0x81f8, 0x81b8
  .long 0x82a0, 0x82e0, 0x8220, 0x8260
  .long 0x82a8, 0x82e8, 0x8228, 0x8268
  .long 0x82b0, 0x82f0, 0x8230, 0x8270
  .long 0x82b8, 0x82f8, 0x8238, 0x8278
  .long 0x83e0, 0x83a0, 0x8360, 0x8320
  .long 0x83e8, 0x83a8, 0x8368, 0x8328
  .long 0x83f0, 0x83b0, 0x8370, 0x8330
  .long 0x83f8, 0x83b8, 0x8378, 0x8338
  .long 0x8400, 0x8440, 0x8480, 0x84c0
  .long 0x8408, 0x8448, 0x8488, 0x84c8
  .long 0x8410, 0x8450, 0x8490, 0x84d0
  .long 0x8418, 0x8458, 0x8498, 0x84d8
  .long 0x8540, 0x8500, 0x85c0, 0x8580
  .long 0x8548, 0x8508, 0x85c8, 0x8588
  .long 0x8550, 0x8510, 0x85d0, 0x8590
  .long 0x8558, 0x8518, 0x85d8, 0x8598
  .long 0x8680, 0x86c0, 0x8600, 0x8640
  .long 0x8688, 0x86c8, 0x8608, 0x8648
  .long 0x8690, 0x86d0, 0x8610, 0x8650
  .long 0x8698, 0x86d8, 0x8618, 0x8658
  .long 0x87c0, 0x8780, 0x8740, 0x8700
  .long 0x87c8, 0x8788, 0x8748, 0x8708
  .long 0x87d0, 0x8790, 0x8750, 0x8710
  .long 0x87d8, 0x8798, 0x8758, 0x8718
  .long 0x8420, 0x8460, 0x84a0, 0x84e0
  .long 0x8428, 0x8468, 0x84a8, 0x84e8
  .long 0x8430, 0x8470, 0x84b0, 0x84f0
  .long 0x8438, 0x8478, 0x84b8, 0x84f8
  .long 0x8560, 0x8520, 0x85e0, 0x85a0
  .long 0x8568, 0x8528, 0x85e8, 0x85a8
  .long 0x8570, 0x8530, 0x85f0, 0x85b0
  .long 0x8578, 0x8538, 0x85f8, 0x85b8
  .long 0x86a0, 0x86e0, 0x8620, 0x8660
  .long 0x86a8, 0x86e8, 0x8628, 0x8668
  .long 0x86b0, 0x86f0, 0x8630, 0x8670
  .long 0x86b8, 0x86f8, 0x8638, 0x8678
  .long 0x87e0, 0x87a0, 0x8760, 0x8720
  .long 0x87e8, 0x87a8, 0x8768, 0x8728
  .long 0x87f0, 0x87b0, 0x8770, 0x8730
  .long 0x87f8, 0x87b8, 0x8778, 0x8738
  .long 0x10000, 0x10040, 0x10080, 0x100c0
  .long 0x10008, 0x10048, 0x10088, 0x100c8
  .long 0x10010, 0x10050, 0x10090, 0x100d0
  .long 0x10018, 0x10058, 0x10098, 0x100d8
  .long 0x10140, 0x10100, 0x101c0, 0x10180
  .long 0x10148, 0x10108, 0x101c8, 0x10188
  .long 0x10150, 0x10110, 0x101d0, 0x10190
  .long 0x10158, 0x10118, 0x101d8, 0x10198
  .long 0x10280, 0x102c0, 0x10200, 0x10240
  .long 0x10288, 0x102c8, 0x10208, 0x10248
  .long 0x10290, 0x102d0, 0x10210, 0x10250
  .long 0x10298, 0x102d8, 0x10218, 0x10258
  .long 0x103c0, 0x10380, 0x10340, 0x10300
  .long 0x103c8, 0x10388, 0x10348, 0x10308
  .long 0x103d0, 0x10390, 0x10350, 0x10310
  .long 0x103d8, 0x10398, 0x10358, 0x10318
  .long 0x10020, 0x10060, 0x100a0, 0x100e0
  .long 0x10028, 0x10068, 0x100a8, 0x100e8
  .long 0x10030, 0x10070, 0x100b0, 0x100f0
  .long 0x10038, 0x10078, 0x100b8, 0x100f8
  .long 0x10160, 0x10120, 0x101e0, 0x101a0
  .long 0x10168, 0x10128, 0x101e8, 0x101a8
  .long 0x10170, 0x10130, 0x101f0, 0x101b0
  .long 0x10178, 0x10138, 0x101f8, 0x101b8
  .long 0x102a0, 0x102e0, 0x10220, 0x10260
  .long 0x102a8, 0x102e8, 0x10228, 0x10268
  .long 0x102b0, 0x102f0, 0x10230, 0x10270
  .long 0x102b8, 0x102f8, 0x10238, 0x10278
  .long 0x103e0, 0x103a0, 0x10360, 0x10320
  .long 0x103e8, 0x103a8, 0x10368, 0x10328
  .long 0x103f0, 0x103b0, 0x10370, 0x10330
  .long 0x103f8, 0x103b8, 0x10378, 0x10338
  .long 0x10400, 0x10440, 0x10480, 0x104c0
  .long 0x10408, 0x10448, 0x10488, 0x104c8
  .long 0x10410, 0x10450, 0x10490, 0x104d0
  .long 0x10418, 0x10458, 0x10498, 0x104d8
  .long 0x10540, 0x10500, 0x105c0, 0x10580
  .long 0x10548, 0x10508, 0x105c8, 0x10588
  .long 0x10550, 0x10510, 0x105d0, 0x10590
  .long 0x10558, 0x10518, 0x105d8, 0x10598
  .long 0x10680, 0x106c0, 0x10600, 0x10640
  .long 0x10688, 0x106c8, 0x10608, 0x10648
  .long 0x10690, 0x106d0, 0x10610, 0x10650
  .long 0x10698, 0x106d8, 0x10618, 0x10658
  .long 0x107c0, 0x10780, 0x10740, 0x10700
  .long 0x107c8, 0x10788, 0x10748, 0x10708
  .long 0x107d0, 0x10790, 0x10750, 0x10710
  .long 0x107d8, 0x10798, 0x10758, 0x10718
  .long 0x10420, 0x10460, 0x104a0, 0x104e0
  .long 0x10428, 0x10468, 0x104a8, 0x104e8
  .long 0x10430, 0x10470, 0x104b0, 0x104f0
  .long 0x10438, 0x10478, 0x104b8, 0x104f8
  .long 0x10560, 0x10520, 0x105e0, 0x105a0
  .long 0x10568, 0x10528, 0x105e8, 0x105a8
  .long 0x10570, 0x10530, 0x105f0, 0x105b0
  .long 0x10578, 0x10538, 0x105f8, 0x105b8
  .long 0x106a0, 0x106e0, 0x10620, 0x10660
  .long 0x106a8, 0x106e8, 0x10628, 0x10668
  .long 0x106b0, 0x106f0, 0x10630, 0x10670
  .long 0x106b8, 0x106f8, 0x10638, 0x10678
  .long 0x107e0, 0x107a0, 0x10760, 0x10720
  .long 0x107e8, 0x107a8, 0x10768, 0x10728
  .long 0x107f0, 0x107b0, 0x10770, 0x10730
  .long 0x107f8, 0x107b8, 0x10778, 0x10738
  .long 0x18000, 0x18040, 0x18080, 0x180c0
  .long 0x18008, 0x18048, 0x18088, 0x180c8
  .long 0x18010, 0x18050, 0x18090, 0x180d0
  .long 0x18018, 0x18058, 0x18098, 0x180d8
  .long 0x18140, 0x18100, 0x181c0, 0x18180
  .long 0x18148, 0x18108, 0x181c8, 0x18188
  .long 0x18150, 0x18110, 0x181d0, 0x18190
  .long 0x18158, 0x18118, 0x181d8, 0x18198
  .long 0x18280, 0x182c0, 0x18200, 0x18240
  .long 0x18288, 0x182c8, 0x18208, 0x18248
  .long 0x18290, 0x182d0, 0x18210, 0x18250
  .long 0x18298, 0x182d8, 0x18218, 0x18258
  .long 0x183c0, 0x18380, 0x18340, 0x18300
  .long 0x183c8, 0x18388, 0x18348, 0x18308
  .long 0x183d0, 0x18390, 0x18350, 0x18310
  .long 0x183d8, 0x18398, 0x18358, 0x18318
  .long 0x18020, 0x18060, 0x180a0, 0x180e0
  .long 0x18028, 0x18068, 0x180a8, 0x180e8
  .long 0x18030, 0x18070, 0x180b0, 0x180f0
  .long 0x18038, 0x18078, 0x180b8, 0x180f8
  .long 0x18160, 0x18120, 0x181e0, 0x181a0
  .long 0x18168, 0x18128, 0x181e8, 0x181a8
  .long 0x18170, 0x18130, 0x181f0, 0x181b0
  .long 0x18178, 0x18138, 0x181f8, 0x181b8
  .long 0x182a0, 0x182e0, 0x18220, 0x18260
  .long 0x182a8, 0x182e8, 0x18228, 0x18268
  .long 0x182b0, 0x182f0, 0x18230, 0x18270
  .long 0x182b8, 0x182f8, 0x18238, 0x18278
  .long 0x183e0, 0x183a0, 0x18360, 0x18320
  .long 0x183e8, 0x183a8, 0x18368, 0x18328
  .long 0x183f0, 0x183b0, 0x18370, 0x18330
  .long 0x183f8, 0x183b8, 0x18378, 0x18338
  .long 0x18400, 0x18440, 0x18480, 0x184c0
  .long 0x18408, 0x18448, 0x18488, 0x184c8
  .long 0x18410, 0x18450, 0x18490, 0x184d0
  .long 0x18418, 0x18458, 0x18498, 0x184d8
  .long 0x18540, 0x18500, 0x185c0, 0x18580
  .long 0x18548, 0x18508, 0x185c8, 0x18588
  .long 0x18550, 0x18510, 0x185d0, 0x18590
  .long 0x18558, 0x18518, 0x185d8, 0x18598
  .long 0x18680, 0x186c0, 0x18600, 0x18640
  .long 0x18688, 0x186c8, 0x18608, 0x18648
  .long 0x18690, 0x186d0, 0x18610, 0x18650
  .long 0x18698, 0x186d8, 0x18618, 0x18658
  .long 0x187c0, 0x18780, 0x18740, 0x18700
  .long 0x187c8, 0x18788, 0x18748, 0x18708
  .long 0x187d0, 0x18790, 0x18750, 0x18710
  .long 0x187d8, 0x18798, 0x18758, 0x18718
  .long 0x18420, 0x18460, 0x184a0, 0x184e0
  .long 0x18428, 0x18468, 0x184a8, 0x184e8
  .long 0x18430, 0x18470, 0x184b0, 0x184f0
  .long 0x18438, 0x18478, 0x184b8, 0x184f8
  .long 0x18560, 0x18520, 0x185e0, 0x185a0
  .long 0x18568, 0x18528, 0x185e8, 0x185a8
  .long 0x18570, 0x18530, 0x185f0, 0x185b0
  .long 0x18578, 0x18538, 0x185f8, 0x185b8
  .long 0x186a0, 0x186e0, 0x18620, 0x18660
  .long 0x186a8, 0x186e8, 0x18628, 0x18668
  .long 0x186b0, 0x186f0, 0x18630, 0x18670
  .long 0x186b8, 0x186f8, 0x18638, 0x18678
  .long 0x187e0, 0x187a0, 0x18760, 0x18720
  .long 0x187e8, 0x187a8, 0x18768, 0x18728
  .long 0x187f0, 0x187b0, 0x18770, 0x18730
  .long 0x187f8, 0x187b8, 0x18778, 0x18738
  .long 0x0, 0x0, 0x0, 0x0
  .long 0x10, 0x10, 0x400, 0x8
  .long 0x20, 0x20, 0x800, 0x10
  .long 0x30, 0x30, 0xc00, 0x18
  .long 0x40, 0x40, 0x1000, 0x20
  .long 0x50, 0x50, 0x1400, 0x28
  .long 0x60, 0x60, 0x1800, 0x30
  .long 0x70, 0x70, 0x1c00, 0x38
  .long 0x80, 0x80, 0x2000, 0x40
  .long 0x90, 0x90, 0x2400, 0x48
  .long 0xa0, 0xa0, 0x2800, 0x50
  .long 0xb0, 0xb0, 0x2c00, 0x58
  .long 0xc0, 0xc0, 0x3000, 0x60
  .long 0xd0, 0xd0, 0x3400, 0x68
  .long 0xe0, 0xe0, 0x3800, 0x70
  .long 0xf0, 0xf0, 0x3c00, 0x78
  .long 0x100, 0x100, 0x4000, 0x80
  .long 0x110, 0x110, 0x4400, 0x88
  .long 0x120, 0x120, 0x4800, 0x90
  .long 0x130, 0x130, 0x4c00, 0x98
  .long 0x140, 0x140, 0x5000, 0xa0
  .long 0x150, 0x150, 0x5400, 0xa8
  .long 0x160, 0x160, 0x5800, 0xb0
  .long 0x170, 0x170, 0x5c00, 0xb8
  .long 0x180, 0x180, 0x6000, 0xc0
  .long 0x190, 0x190, 0x6400, 0xc8
  .long 0x1a0, 0x1a0, 0x6800, 0xd0
  .long 0x1b0, 0x1b0, 0x6c00, 0xd8
  .long 0x1c0, 0x1c0, 0x7000, 0xe0
  .long 0x1d0, 0x1d0, 0x7400, 0xe8
  .long 0x1e0, 0x1e0, 0x7800, 0xf0
  .long 0x1f0, 0x1f0, 0x7c00, 0xf8
  .long 0x200, 0x200, 0x8, 0x0
  .long 0x210, 0x210, 0x408, 0x8
  .long 0x220, 0x220, 0x808, 0x10
  .long 0x230, 0x230, 0xc08, 0x18
  .long 0x240, 0x240, 0x1008, 0x20
  .long 0x250, 0x250, 0x1408, 0x28
  .long 0x260, 0x260, 0x1808, 0x30
  .long 0x270, 0x270, 0x1c08, 0x38
  .long 0x280, 0x280, 0x2008, 0x40
  .long 0x290, 0x290, 0x2408, 0x48
  .long 0x2a0, 0x2a0, 0x2808, 0x50
  .long 0x2b0, 0x2b0, 0x2c08, 0x58
  .long 0x2c0, 0x2c0, 0x3008, 0x60
  .long 0x2d0, 0x2d0, 0x3408, 0x68
  .long 0x2e0, 0x2e0, 0x3808, 0x70
  .long 0x2f0, 0x2f0, 0x3c08, 0x78
  .long 0x300, 0x300, 0x4008, 0x80
  .long 0x310, 0x310, 0x4408, 0x88
  .long 0x320, 0x320, 0x4808, 0x90
  .long 0x330, 0x330, 0x4c08, 0x98
  .long 0x340, 0x340, 0x5008, 0xa0
  .long 0x350, 0x350, 0x5408, 0xa8
  .long 0x360, 0x360, 0x5808, 0xb0
  .long 0x370, 0x370, 0x5c08, 0xb8
  .long 0x380, 0x380, 0x6008, 0xc0
  .long 0x390, 0x390, 0x6408, 0xc8
  .long 0x3a0, 0x3a0, 0x6808, 0xd0
  .long 0x3b0, 0x3b0, 0x6c08, 0xd8
  .long 0x3c0, 0x3c0, 0x7008, 0xe0
  .long 0x3d0, 0x3d0, 0x7408, 0xe8
  .long 0x3e0, 0x3e0, 0x7808, 0xf0
  .long 0x3f0, 0x3f0, 0x7c08, 0xf8
  .long 0x4000, 0x1000, 0x10, 0x0
  .long 0x4010, 0x1010, 0x410, 0x8
  .long 0x4020, 0x1020, 0x810, 0x10
  .long 0x4030, 0x1030, 0xc10, 0x18
  .long 0x4040, 0x1040, 0x1010, 0x20
  .long 0x4050, 0x1050, 0x1410, 0x28
  .long 0x4060, 0x1060, 0x1810, 0x30
  .long 0x4070, 0x1070, 0x1c10, 0x38
  .long 0x4080, 0x1080, 0x2010, 0x40
  .long 0x4090, 0x1090, 0x2410, 0x48
  .long 0x40a0, 0x10a0, 0x2810, 0x50
  .long 0x40b0, 0x10b0, 0x2c10, 0x58
  .long 0x40c0, 0x10c0, 0x3010, 0x60
  .long 0x40d0, 0x10d0, 0x3410, 0x68
  .long 0x40e0, 0x10e0, 0x3810, 0x70
  .long 0x40f0, 0x10f0, 0x3c10, 0x78
  .long 0x4100, 0x1100, 0x4010, 0x80
  .long 0x4110, 0x1110, 0x4410, 0x88
  .long 0x4120, 0x1120, 0x4810, 0x90
  .long 0x4130, 0x1130, 0x4c10, 0x98
  .long 0x4140, 0x1140, 0x5010, 0xa0
  .long 0x4150, 0x1150, 0x5410, 0xa8
  .long 0x4160, 0x1160, 0x5810, 0xb0
  .long 0x4170, 0x1170, 0x5c10, 0xb8
  .long 0x4180, 0x1180, 0x6010, 0xc0
  .long 0x4190, 0x1190, 0x6410, 0xc8
  .long 0x41a0, 0x11a0, 0x6810, 0xd0
  .long 0x41b0, 0x11b0, 0x6c10, 0xd8
  .long 0x41c0, 0x11c0, 0x7010, 0xe0
  .long 0x41d0, 0x11d0, 0x7410, 0xe8
  .long 0x41e0, 0x11e0, 0x7810, 0xf0
  .long 0x41f0, 0x11f0, 0x7c10, 0xf8
  .long 0x4200, 0x1200, 0x18, 0x0
  .long 0x4210, 0x1210, 0x418, 0x8
  .long 0x4220, 0x1220, 0x818, 0x10
  .long 0x4230, 0x1230, 0xc18, 0x18
  .long 0x4240, 0x1240, 0x1018, 0x20
  .long 0x4250, 0x1250, 0x1418, 0x28
  .long 0x4260, 0x1260, 0x1818, 0x30
  .long 0x4270, 0x1270, 0x1c18, 0x38
  .long 0x4280, 0x1280, 0x2018, 0x40
  .long 0x4290, 0x1290, 0x2418, 0x48
  .long 0x42a0, 0x12a0, 0x2818, 0x50
  .long 0x42b0, 0x12b0, 0x2c18, 0x58
  .long 0x42c0, 0x12c0, 0x3018, 0x60
  .long 0x42d0, 0x12d0, 0x3418, 0x68
  .long 0x42e0, 0x12e0, 0x3818, 0x70
  .long 0x42f0, 0x12f0, 0x3c18, 0x78
  .long 0x4300, 0x1300, 0x4018, 0x80
  .long 0x4310, 0x1310, 0x4418, 0x88
  .long 0x4320, 0x1320, 0x4818, 0x90
  .long 0x4330, 0x1330, 0x4c18, 0x98
  .long 0x4340, 0x1340, 0x5018, 0xa0
  .long 0x4350, 0x1350, 0x5418, 0xa8
  .long 0x4360, 0x1360, 0x5818, 0xb0
  .long 0x4370, 0x1370, 0x5c18, 0xb8
  .long 0x4380, 0x1380, 0x6018, 0xc0
  .long 0x4390, 0x1390, 0x6418, 0xc8
  .long 0x43a0, 0x13a0, 0x6818, 0xd0
  .long 0x43b0, 0x13b0, 0x6c18, 0xd8
  .long 0x43c0, 0x13c0, 0x7018, 0xe0
  .long 0x43d0, 0x13d0, 0x7418, 0xe8
  .long 0x43e0, 0x13e0, 0x7818, 0xf0
  .long 0x43f0, 0x13f0, 0x7c18, 0xf8
  .long 0x8000, 0x2000, 0x0, 0x0
  .long 0x8010, 0x2010, 0x400, 0x8
  .long 0x8020, 0x2020, 0x800, 0x10
  .long 0x8030, 0x2030, 0xc00, 0x18
  .long 0x8040, 0x2040, 0x1000, 0x20
  .long 0x8050, 0x2050, 0x1400, 0x28
  .long 0x8060, 0x2060, 0x1800, 0x30
  .long 0x8070, 0x2070, 0x1c00, 0x38
  .long 0x8080, 0x2080, 0x2000, 0x40
  .long 0x8090, 0x2090, 0x2400, 0x48
  .long 0x80a0, 0x20a0, 0x2800, 0x50
  .long 0x80b0, 0x20b0, 0x2c00, 0x58
  .long 0x80c0, 0x20c0, 0x3000, 0x60
  .long 0x80d0, 0x20d0, 0x3400, 0x68
  .long 0x80e0, 0x20e0, 0x3800, 0x70
  .long 0x80f0, 0x20f0, 0x3c00, 0x78
  .long 0x8100, 0x2100, 0x4000, 0x80
  .long 0x8110, 0x2110, 0x4400, 0x88
  .long 0x8120, 0x2120, 0x4800, 0x90
  .long 0x8130, 0x2130, 0x4c00, 0x98
  .long 0x8140, 0x2140, 0x5000, 0xa0
  .long 0x8150, 0x2150, 0x5400, 0xa8
  .long 0x8160, 0x2160, 0x5800, 0xb0
  .long 0x8170, 0x2170, 0x5c00, 0xb8
  .long 0x8180, 0x2180, 0x6000, 0xc0
  .long 0x8190, 0x2190, 0x6400, 0xc8
  .long 0x81a0, 0x21a0, 0x6800, 0xd0
  .long 0x81b0, 0x21b0, 0x6c00, 0xd8
  .long 0x81c0, 0x21c0, 0x7000, 0xe0
  .long 0x81d0, 0x21d0, 0x7400, 0xe8
  .long 0x81e0, 0x21e0, 0x7800, 0xf0
  .long 0x81f0, 0x21f0, 0x7c00, 0xf8
  .long 0x8200, 0x2200, 0x8, 0x0
  .long 0x8210, 0x2210, 0x408, 0x8
  .long 0x8220, 0x2220, 0x808, 0x10
  .long 0x8230, 0x2230, 0xc08, 0x18
  .long 0x8240, 0x2240, 0x1008, 0x20
  .long 0x8250, 0x2250, 0x1408, 0x28
  .long 0x8260, 0x2260, 0x1808, 0x30
  .long 0x8270, 0x2270, 0x1c08, 0x38
  .long 0x8280, 0x2280, 0x2008, 0x40
  .long 0x8290, 0x2290, 0x2408, 0x48
  .long 0x82a0, 0x22a0, 0x2808, 0x50
  .long 0x82b0, 0x22b0, 0x2c08, 0x58
  .long 0x82c0, 0x22c0, 0x3008, 0x60
  .long 0x82d0, 0x22d0, 0x3408, 0x68
  .long 0x82e0, 0x22e0, 0x3808, 0x70
  .long 0x82f0, 0x22f0, 0x3c08, 0x78
  .long 0x8300, 0x2300, 0x4008, 0x80
  .long 0x8310, 0x2310, 0x4408, 0x88
  .long 0x8320, 0x2320, 0x4808, 0x90
  .long 0x8330, 0x2330, 0x4c08, 0x98
  .long 0x8340, 0x2340, 0x5008, 0xa0
  .long 0x8350, 0x2350, 0x5408, 0xa8
  .long 0x8360, 0x2360, 0x5808, 0xb0
  .long 0x8370, 0x2370, 0x5c08, 0xb8
  .long 0x8380, 0x2380, 0x6008, 0xc0
  .long 0x8390, 0x2390, 0x6408, 0xc8
  .long 0x83a0, 0x23a0, 0x6808, 0xd0
  .long 0x83b0, 0x23b0, 0x6c08, 0xd8
  .long 0x83c0, 0x23c0, 0x7008, 0xe0
  .long 0x83d0, 0x23d0, 0x7408, 0xe8
  .long 0x83e0, 0x23e0, 0x7808, 0xf0
  .long 0x83f0, 0x23f0, 0x7c08, 0xf8
  .long 0xc000, 0x3000, 0x10, 0x0
  .long 0xc010, 0x3010, 0x410, 0x8
  .long 0xc020, 0x3020, 0x810, 0x10
  .long 0xc030, 0x3030, 0xc10, 0x18
  .long 0xc040, 0x3040, 0x1010, 0x20
  .long 0xc050, 0x3050, 0x1410, 0x28
  .long 0xc060, 0x3060, 0x1810, 0x30
  .long 0xc070, 0x3070, 0x1c10, 0x38
  .long 0xc080, 0x3080, 0x2010, 0x40
  .long 0xc090, 0x3090, 0x2410, 0x48
  .long 0xc0a0, 0x30a0, 0x2810, 0x50
  .long 0xc0b0, 0x30b0, 0x2c10, 0x58
  .long 0xc0c0, 0x30c0, 0x3010, 0x60
  .long 0xc0d0, 0x30d0, 0x3410, 0x68
  .long 0xc0e0, 0x30e0, 0x3810, 0x70
  .long 0xc0f0, 0x30f0, 0x3c10, 0x78
  .long 0xc100, 0x3100, 0x4010, 0x80
  .long 0xc110, 0x3110, 0x4410, 0x88
  .long 0xc120, 0x3120, 0x4810, 0x90
  .long 0xc130, 0x3130, 0x4c10, 0x98
  .long 0xc140, 0x3140, 0x5010, 0xa0
  .long 0xc150, 0x3150, 0x5410, 0xa8
  .long 0xc160, 0x3160, 0x5810, 0xb0
  .long 0xc170, 0x3170, 0x5c10, 0xb8
  .long 0xc180, 0x3180, 0x6010, 0xc0
  .long 0xc190, 0x3190, 0x6410, 0xc8
  .long 0xc1a0, 0x31a0, 0x6810, 0xd0
  .long 0xc1b0, 0x31b0, 0x6c10, 0xd8
  .long 0xc1c0, 0x31c0, 0x7010, 0xe0
  .long 0xc1d0, 0x31d0, 0x7410, 0xe8
  .long 0xc1e0, 0x31e0, 0x7810, 0xf0
  .long 0xc1f0, 0x31f0, 0x7c10, 0xf8
  .long 0xc200, 0x3200, 0x18, 0x0
  .long 0xc210, 0x3210, 0x418, 0x8
  .long 0xc220, 0x3220, 0x818, 0x10
  .long 0xc230, 0x3230, 0xc18, 0x18
  .long 0xc240, 0x3240, 0x1018, 0x20
  .long 0xc250, 0x3250, 0x1418, 0x28
  .long 0xc260, 0x3260, 0x1818, 0x30
  .long 0xc270, 0x3270, 0x1c18, 0x38
  .long 0xc280, 0x3280, 0x2018, 0x40
  .long 0xc290, 0x3290, 0x2418, 0x48
  .long 0xc2a0, 0x32a0, 0x2818, 0x50
  .long 0xc2b0, 0x32b0, 0x2c18, 0x58
  .long 0xc2c0, 0x32c0, 0x3018, 0x60
  .long 0xc2d0, 0x32d0, 0x3418, 0x68
  .long 0xc2e0, 0x32e0, 0x3818, 0x70
  .long 0xc2f0, 0x32f0, 0x3c18, 0x78
  .long 0xc300, 0x3300, 0x4018, 0x80
  .long 0xc310, 0x3310, 0x4418, 0x88
  .long 0xc320, 0x3320, 0x4818, 0x90
  .long 0xc330, 0x3330, 0x4c18, 0x98
  .long 0xc340, 0x3340, 0x5018, 0xa0
  .long 0xc350, 0x3350, 0x5418, 0xa8
  .long 0xc360, 0x3360, 0x5818, 0xb0
  .long 0xc370, 0x3370, 0x5c18, 0xb8
  .long 0xc380, 0x3380, 0x6018, 0xc0
  .long 0xc390, 0x3390, 0x6418, 0xc8
  .long 0xc3a0, 0x33a0, 0x6818, 0xd0
  .long 0xc3b0, 0x33b0, 0x6c18, 0xd8
  .long 0xc3c0, 0x33c0, 0x7018, 0xe0
  .long 0xc3d0, 0x33d0, 0x7418, 0xe8
  .long 0xc3e0, 0x33e0, 0x7818, 0xf0
  .long 0xc3f0, 0x33f0, 0x7c18, 0xf8
  .long 0x0, 0x4444, 0xa000, 0xa000
  .long 0x10, 0x4444, 0xa020, 0xa008
  .long 0x20, 0xeeee, 0xa040, 0xa010
  .long 0x30, 0xeeee, 0xa060, 0xa018
  .long 0x40, 0x4444, 0xa080, 0xa020
  .long 0x50, 0x4444, 0xa0a0, 0xa028
  .long 0x60, 0xeeee, 0xa0c0, 0xa030
  .long 0x70, 0xeeee, 0xa0e0, 0xa038
  .long 0x80, 0x4444, 0xa100, 0xa040
  .long 0x90, 0x4444, 0xa120, 0xa048
  .long 0xa0, 0xeeee, 0xa140, 0xa050
  .long 0xb0, 0xeeee, 0xa160, 0xa058
  .long 0xc0, 0x4444, 0xa180, 0xa060
  .long 0xd0, 0x4444, 0xa1a0, 0xa068
  .long 0xe0, 0xeeee, 0xa1c0, 0xa070
  .long 0xf0, 0xeeee, 0xa1e0, 0xa078
  .long 0x100, 0x4444, 0xa008, 0xa080
  .long 0x110, 0x4444, 0xa028, 0xa088
  .long 0x120, 0xeeee, 0xa048, 0xa090
  .long 0x130, 0xeeee, 0xa068, 0xa098
  .long 0x140, 0x4444, 0xa088, 0xa0a0
  .long 0x150, 0x4444, 0xa0a8, 0xa0a8
  .long 0x160, 0xeeee, 0xa0c8, 0xa0b0
  .long 0x170, 0xeeee, 0xa0e8, 0xa0b8
  .long 0x180, 0x4444, 0xa108, 0xa0c0
  .long 0x190, 0x4444, 0xa128, 0xa0c8
  .long 0x1a0, 0xeeee, 0xa148, 0xa0d0
  .long 0x1b0, 0xeeee, 0xa168, 0xa0d8
  .long 0x1c0, 0x4444, 0xa188, 0xa0e0
  .long 0x1d0, 0x4444, 0xa1a8, 0xa0e8
  .long 0x1e0, 0xeeee, 0xa1c8, 0xa0f0
  .long 0x1f0, 0xeeee, 0xa1e8, 0xa0f8
  .long 0x200, 0x4444, 0xa010, 0xa200
  .long 0x210, 0x4444, 0xa030, 0xa208
  .long 0x220, 0xeeee, 0xa050, 0xa210
  .long 0x230, 0xeeee, 0xa070, 0xa218
  .long 0x240, 0x4444, 0xa090, 0xa220
  .long 0x250, 0x4444, 0xa0b0, 0xa228
  .long 0x260, 0xeeee, 0xa0d0, 0xa230
  .long 0x270, 0xeeee, 0xa0f0, 0xa238
  .long 0x280, 0x4444, 0xa110, 0xa240
  .long 0x290, 0x4444, 0xa130, 0xa248
  .long 0x2a0, 0xeeee, 0xa150, 0xa250
  .long 0x2b0, 0xeeee, 0xa170, 0xa258
  .long 0x2c0, 0x4444, 0xa190, 0xa260
  .long 0x2d0, 0x4444, 0xa1b0, 0xa268
  .long 0x2e0, 0xeeee, 0xa1d0, 0xa270
  .long 0x2f0, 0xeeee, 0xa1f0, 0xa278
  .long 0x300, 0x4444, 0xa018, 0xa280
  .long 0x310, 0x4444, 0xa038, 0xa288
  .long 0x320, 0xeeee, 0xa058, 0xa290
  .long 0x330, 0xeeee, 0xa078, 0xa298
  .long 0x340, 0x4444, 0xa098, 0xa2a0
  .long 0x350, 0x4444, 0xa0b8, 0xa2a8
  .long 0x360, 0xeeee, 0xa0d8, 0xa2b0
  .long 0x370, 0xeeee, 0xa0f8, 0xa2b8
  .long 0x380, 0x4444, 0xa118, 0xa2c0
  .long 0x390, 0x4444, 0xa138, 0xa2c8
  .long 0x3a0, 0xeeee, 0xa158, 0xa2d0
  .long 0x3b0, 0xeeee, 0xa178, 0xa2d8
  .long 0x3c0, 0x4444, 0xa198, 0xa2e0
  .long 0x3d0, 0x4444, 0xa1b8, 0xa2e8
  .long 0x3e0, 0xeeee, 0xa1d8, 0xa2f0
  .long 0x3f0, 0xeeee, 0xa1f8, 0xa2f8
  .long 0x0, 0x4444, 0xa400, 0xa000
  .long 0x10, 0x4444, 0xa420, 0xa008
  .long 0x20, 0xeeee, 0xa440, 0xa010
  .long 0x30, 0xeeee, 0xa460, 0xa018
  .long 0x40, 0x4444, 0xa480, 0xa020
  .long 0x50, 0x4444, 0xa4a0, 0xa028
  .long 0x60, 0xeeee, 0xa4c0, 0xa030
  .long 0x70, 0xeeee, 0xa4e0, 0xa038
  .long 0x80, 0x4444, 0xa500, 0xa040
  .long 0x90, 0x4444, 0xa520, 0xa048
  .long 0xa0, 0xeeee, 0xa540, 0xa050
  .long 0xb0, 0xeeee, 0xa560, 0xa058
  .long 0xc0, 0x4444, 0xa580, 0xa060
  .long 0xd0, 0x4444, 0xa5a0, 0xa068
  .long 0xe0, 0xeeee, 0xa5c0, 0xa070
  .long 0xf0, 0xeeee, 0xa5e0, 0xa078
  .long 0x100, 0x4444, 0xa408, 0xa080
  .long 0x110, 0x4444, 0xa428, 0xa088
  .long 0x120, 0xeeee, 0xa448, 0xa090
  .long 0x130, 0xeeee, 0xa468, 0xa098
  .long 0x140, 0x4444, 0xa488, 0xa0a0
  .long 0x150, 0x4444, 0xa4a8, 0xa0a8
  .long 0x160, 0xeeee, 0xa4c8, 0xa0b0
  .long 0x170, 0xeeee, 0xa4e8, 0xa0b8
  .long 0x180, 0x4444, 0xa508, 0xa0c0
  .long 0x190, 0x4444, 0xa528, 0xa0c8
  .long 0x1a0, 0xeeee, 0xa548, 0xa0d0
  .long 0x1b0, 0xeeee, 0xa568, 0xa0d8
  .long 0x1c0, 0x4444, 0xa588, 0xa0e0
  .long 0x1d0, 0x4444, 0xa5a8, 0xa0e8
  .long 0x1e0, 0xeeee, 0xa5c8, 0xa0f0
  .long 0x1f0, 0xeeee, 0xa5e8, 0xa0f8
  .long 0x200, 0x4444, 0xa410, 0xa200
  .long 0x210, 0x4444, 0xa430, 0xa208
  .long 0x220, 0xeeee, 0xa450, 0xa210
  .long 0x230, 0xeeee, 0xa470, 0xa218
  .long 0x240, 0x4444, 0xa490, 0xa220
  .long 0x250, 0x4444, 0xa4b0, 0xa228
  .long 0x260, 0xeeee, 0xa4d0, 0xa230
  .long 0x270, 0xeeee, 0xa4f0, 0xa238
  .long 0x280, 0x4444, 0xa510, 0xa240
  .long 0x290, 0x4444, 0xa530, 0xa248
  .long 0x2a0, 0xeeee, 0xa550, 0xa250
  .long 0x2b0, 0xeeee, 0xa570, 0xa258
  .long 0x2c0, 0x4444, 0xa590, 0xa260
  .long 0x2d0, 0x4444, 0xa5b0, 0xa268
  .long 0x2e0, 0xeeee, 0xa5d0, 0xa270
  .long 0x2f0, 0xeeee, 0xa5f0, 0xa278
  .long 0x300, 0x4444, 0xa418, 0xa280
  .long 0x310, 0x4444, 0xa438, 0xa288
  .long 0x320, 0xeeee, 0xa458, 0xa290
  .long 0x330, 0xeeee, 0xa478, 0xa298
  .long 0x340, 0x4444, 0xa498, 0xa2a0
  .long 0x350, 0x4444, 0xa4b8, 0xa2a8
  .long 0x360, 0xeeee, 0xa4d8, 0xa2b0
  .long 0x370, 0xeeee, 0xa4f8, 0xa2b8
  .long 0x380, 0x4444, 0xa518, 0xa2c0
  .long 0x390, 0x4444, 0xa538, 0xa2c8
  .long 0x3a0, 0xeeee, 0xa558, 0xa2d0
  .long 0x3b0, 0xeeee, 0xa578, 0xa2d8
  .long 0x3c0, 0x4444, 0xa598, 0xa2e0
  .long 0x3d0, 0x4444, 0xa5b8, 0xa2e8
  .long 0x3e0, 0xeeee, 0xa5d8, 0xa2f0
  .long 0x3f0, 0xeeee, 0xa5f8, 0xa2f8
  .long 0x0, 0x4444, 0xa800, 0xa000
  .long 0x10, 0x4444, 0xa820, 0xa008
  .long 0x20, 0xeeee, 0xa840, 0xa010
  .long 0x30, 0xeeee, 0xa860, 0xa018
  .long 0x40, 0x4444, 0xa880, 0xa020
  .long 0x50, 0x4444, 0xa8a0, 0xa028
  .long 0x60, 0xeeee, 0xa8c0, 0xa030
  .long 0x70, 0xeeee, 0xa8e0, 0xa038
  .long 0x80, 0x4444, 0xa900, 0xa040
  .long 0x90, 0x4444, 0xa920, 0xa048
  .long 0xa0, 0xeeee, 0xa940, 0xa050
  .long 0xb0, 0xeeee, 0xa960, 0xa058
  .long 0xc0, 0x4444, 0xa980, 0xa060
  .long 0xd0, 0x4444, 0xa9a0, 0xa068
  .long 0xe0, 0xeeee, 0xa9c0, 0xa070
  .long 0xf0, 0xeeee, 0xa9e0, 0xa078
  .long 0x100, 0x4444, 0xa808, 0xa080
  .long 0x110, 0x4444, 0xa828, 0xa088
  .long 0x120, 0xeeee, 0xa848, 0xa090
  .long 0x130, 0xeeee, 0xa868, 0xa098
  .long 0x140, 0x4444, 0xa888, 0xa0a0
  .long 0x150, 0x4444, 0xa8a8, 0xa0a8
  .long 0x160, 0xeeee, 0xa8c8, 0xa0b0
  .long 0x170, 0xeeee, 0xa8e8, 0xa0b8
  .long 0x180, 0x4444, 0xa908, 0xa0c0
  .long 0x190, 0x4444, 0xa928, 0xa0c8
  .long 0x1a0, 0xeeee, 0xa948, 0xa0d0
  .long 0x1b0, 0xeeee, 0xa968, 0xa0d8
  .long 0x1c0, 0x4444, 0xa988, 0xa0e0
  .long 0x1d0, 0x4444, 0xa9a8, 0xa0e8
  .long 0x1e0, 0xeeee, 0xa9c8, 0xa0f0
  .long 0x1f0, 0xeeee, 0xa9e8, 0xa0f8
  .long 0x200, 0x4444, 0xa810, 0xa200
  .long 0x210, 0x4444, 0xa830, 0xa208
  .long 0x220, 0xeeee, 0xa850, 0xa210
  .long 0x230, 0xeeee, 0xa870, 0xa218
  .long 0x240, 0x4444, 0xa890, 0xa220
  .long 0x250, 0x4444, 0xa8b0, 0xa228
  .long 0x260, 0xeeee, 0xa8d0, 0xa230
  .long 0x270, 0xeeee, 0xa8f0, 0xa238
  .long 0x280, 0x4444, 0xa910, 0xa240
  .long 0x290, 0x4444, 0xa930, 0xa248
  .long 0x2a0, 0xeeee, 0xa950, 0xa250
  .long 0x2b0, 0xeeee, 0xa970, 0xa258
  .long 0x2c0, 0x4444, 0xa990, 0xa260
  .long 0x2d0, 0x4444, 0xa9b0, 0xa268
  .long 0x2e0, 0xeeee, 0xa9d0, 0xa270
  .long 0x2f0, 0xeeee, 0xa9f0, 0xa278
  .long 0x300, 0x4444, 0xa818, 0xa280
  .long 0x310, 0x4444, 0xa838, 0xa288
  .long 0x320, 0xeeee, 0xa858, 0xa290
  .long 0x330, 0xeeee, 0xa878, 0xa298
  .long 0x340, 0x4444, 0xa898, 0xa2a0
  .long 0x350, 0x4444, 0xa8b8, 0xa2a8
  .long 0x360, 0xeeee, 0xa8d8, 0xa2b0
  .long 0x370, 0xeeee, 0xa8f8, 0xa2b8
  .long 0x380, 0x4444, 0xa918, 0xa2c0
  .long 0x390, 0x4444, 0xa938, 0xa2c8
  .long 0x3a0, 0xeeee, 0xa958, 0xa2d0
  .long 0x3b0, 0xeeee, 0xa978, 0xa2d8
  .long 0x3c0, 0x4444, 0xa998, 0xa2e0
  .long 0x3d0, 0x4444, 0xa9b8, 0xa2e8
  .long 0x3e0, 0xeeee, 0xa9d8, 0xa2f0
  .long 0x3f0, 0xeeee, 0xa9f8, 0xa2f8
  .long 0x0, 0x4444, 0xac00, 0xa000
  .long 0x10, 0x4444, 0xac20, 0xa008
  .long 0x20, 0xeeee, 0xac40, 0xa010
  .long 0x30, 0xeeee, 0xac60, 0xa018
  .long 0x40, 0x4444, 0xac80, 0xa020
  .long 0x50, 0x4444, 0xaca0, 0xa028
  .long 0x60, 0xeeee, 0xacc0, 0xa030
  .long 0x70, 0xeeee, 0xace0, 0xa038
  .long 0x80, 0x4444, 0xad00, 0xa040
  .long 0x90, 0x4444, 0xad20, 0xa048
  .long 0xa0, 0xeeee, 0xad40, 0xa050
  .long 0xb0, 0xeeee, 0xad60, 0xa058
  .long 0xc0, 0x4444, 0xad80, 0xa060
  .long 0xd0, 0x4444, 0xada0, 0xa068
  .long 0xe0, 0xeeee, 0xadc0, 0xa070
  .long 0xf0, 0xeeee, 0xade0, 0xa078
  .long 0x100, 0x4444, 0xac08, 0xa080
  .long 0x110, 0x4444, 0xac28, 0xa088
  .long 0x120, 0xeeee, 0xac48, 0xa090
  .long 0x130, 0xeeee, 0xac68, 0xa098
  .long 0x140, 0x4444, 0xac88, 0xa0a0
  .long 0x150, 0x4444, 0xaca8, 0xa0a8
  .long 0x160, 0xeeee, 0xacc8, 0xa0b0
  .long 0x170, 0xeeee, 0xace8, 0xa0b8
  .long 0x180, 0x4444, 0xad08, 0xa0c0
  .long 0x190, 0x4444, 0xad28, 0xa0c8
  .long 0x1a0, 0xeeee, 0xad48, 0xa0d0
  .long 0x1b0, 0xeeee, 0xad68, 0xa0d8
  .long 0x1c0, 0x4444, 0xad88, 0xa0e0
  .long 0x1d0, 0x4444, 0xada8, 0xa0e8
  .long 0x1e0, 0xeeee, 0xadc8, 0xa0f0
  .long 0x1f0, 0xeeee, 0xade8, 0xa0f8
  .long 0x200, 0x4444, 0xac10, 0xa200
  .long 0x210, 0x4444, 0xac30, 0xa208
  .long 0x220, 0xeeee, 0xac50, 0xa210
  .long 0x230, 0xeeee, 0xac70, 0xa218
  .long 0x240, 0x4444, 0xac90, 0xa220
  .long 0x250, 0x4444, 0xacb0, 0xa228
  .long 0x260, 0xeeee, 0xacd0, 0xa230
  .long 0x270, 0xeeee, 0xacf0, 0xa238
  .long 0x280, 0x4444, 0xad10, 0xa240
  .long 0x290, 0x4444, 0xad30, 0xa248
  .long 0x2a0, 0xeeee, 0xad50, 0xa250
  .long 0x2b0, 0xeeee, 0xad70, 0xa258
  .long 0x2c0, 0x4444, 0xad90, 0xa260
  .long 0x2d0, 0x4444, 0xadb0, 0xa268
  .long 0x2e0, 0xeeee, 0xadd0, 0xa270
  .long 0x2f0, 0xeeee, 0xadf0, 0xa278
  .long 0x300, 0x4444, 0xac18, 0xa280
  .long 0x310, 0x4444, 0xac38, 0xa288
  .long 0x320, 0xeeee, 0xac58, 0xa290
  .long 0x330, 0xeeee, 0xac78, 0xa298
  .long 0x340, 0x4444, 0xac98, 0xa2a0
  .long 0x350, 0x4444, 0xacb8, 0xa2a8
  .long 0x360, 0xeeee, 0xacd8, 0xa2b0
  .long 0x370, 0xeeee, 0xacf8, 0xa2b8
  .long 0x380, 0x4444, 0xad18, 0xa2c0
  .long 0x390, 0x4444, 0xad38, 0xa2c8
  .long 0x3a0, 0xeeee, 0xad58, 0xa2d0
  .long 0x3b0, 0xeeee, 0xad78, 0xa2d8
  .long 0x3c0, 0x4444, 0xad98, 0xa2e0
  .long 0x3d0, 0x4444, 0xadb8, 0xa2e8
  .long 0x3e0, 0xeeee, 0xadd8, 0xa2f0
  .long 0x3f0, 0xeeee, 0xadf8, 0xa2f8
  .long 0xa000, 0xb000, 0x0, 0x0
  .long 0xa008, 0xb010, 0x10, 0x10
  .long 0xa010, 0x10, 0x20, 0x8
  .long 0xa018, 0x18, 0x30, 0x18
  .long 0xa020, 0xb040, 0x800, 0x20
  .long 0xa028, 0xb050, 0x810, 0x30
  .long 0xa030, 0x30, 0x820, 0x28
  .long 0xa038, 0x38, 0x830, 0x38
  .long 0xa040, 0xb080, 0x4000, 0x0
  .long 0xa048, 0xb090, 0x4010, 0x10
  .long 0xa050, 0x50, 0x4020, 0x8
  .long 0xa058, 0x58, 0x4030, 0x18
  .long 0xa060, 0xb0c0, 0x4800, 0x20
  .long 0xa068, 0xb0d0, 0x4810, 0x30
  .long 0xa070, 0x70, 0x4820, 0x28
  .long 0xa078, 0x78, 0x4830, 0x38
  .long 0xa080, 0xb008, 0x1000, 0x0
  .long 0xa088, 0xb018, 0x1010, 0x10
  .long 0xa090, 0x90, 0x1020, 0x8
  .long 0xa098, 0x98, 0x1030, 0x18
  .long 0xa0a0, 0xb048, 0x1800, 0x20
  .long 0xa0a8, 0xb058, 0x1810, 0x30
  .long 0xa0b0, 0xb0, 0x1820, 0x28
  .long 0xa0b8, 0xb8, 0x1830, 0x38
  .long 0xa0c0, 0xb088, 0x5000, 0x0
  .long 0xa0c8, 0xb098, 0x5010, 0x10
  .long 0xa0d0, 0xd0, 0x5020, 0x8
  .long 0xa0d8, 0xd8, 0x5030, 0x18
  .long 0xa0e0, 0xb0c8, 0x5800, 0x20
  .long 0xa0e8, 0xb0d8, 0x5810, 0x30
  .long 0xa0f0, 0xf0, 0x5820, 0x28
  .long 0xa0f8, 0xf8, 0x5830, 0x38
  .long 0xa200, 0xb100, 0x2000, 0x4
  .long 0xa208, 0xb110, 0x2010, 0x14
  .long 0xa210, 0x110, 0x2020, 0xc
  .long 0xa218, 0x118, 0x2030, 0x1c
  .long 0xa220, 0xb140, 0x2800, 0x24
  .long 0xa228, 0xb150, 0x2810, 0x34
  .long 0xa230, 0x130, 0x2820, 0x2c
  .long 0xa238, 0x138, 0x2830, 0x3c
  .long 0xa240, 0xb180, 0x6000, 0x4
  .long 0xa248, 0xb190, 0x6010, 0x14
  .long 0xa250, 0x150, 0x6020, 0xc
  .long 0xa258, 0x158, 0x6030, 0x1c
  .long 0xa260, 0xb1c0, 0x6800, 0x24
  .long 0xa268, 0xb1d0, 0x6810, 0x34
  .long 0xa270, 0x170, 0x6820, 0x2c
  .long 0xa278, 0x178, 0x6830, 0x3c
  .long 0xa280, 0xb108, 0x3000, 0x4
  .long 0xa288, 0xb118, 0x3010, 0x14
  .long 0xa290, 0x190, 0x3020, 0xc
  .long 0xa298, 0x198, 0x3030, 0x1c
  .long 0xa2a0, 0xb148, 0x3800, 0x24
  .long 0xa2a8, 0xb158, 0x3810, 0x34
  .long 0xa2b0, 0x1b0, 0x3820, 0x2c
  .long 0xa2b8, 0x1b8, 0x3830, 0x3c
  .long 0xa2c0, 0xb188, 0x7000, 0x4
  .long 0xa2c8, 0xb198, 0x7010, 0x14
  .long 0xa2d0, 0x1d0, 0x7020, 0xc
  .long 0xa2d8, 0x1d8, 0x7030, 0x1c
  .long 0xa2e0, 0xb1c8, 0x7800, 0x24
  .long 0xa2e8, 0xb1d8, 0x7810, 0x34
  .long 0xa2f0, 0x1f0, 0x7820, 0x2c
  .long 0xa2f8, 0x1f8, 0x7830, 0x3c
  .long 0xa400, 0xb400, 0x8000, 0x100
  .long 0xa408, 0xb410, 0x8010, 0x110
  .long 0xa410, 0x10, 0x8020, 0x108
  .long 0xa418, 0x18, 0x8030, 0x118
  .long 0xa420, 0xb440, 0x8800, 0x120
  .long 0xa428, 0xb450, 0x8810, 0x130
  .long 0xa430, 0x30, 0x8820, 0x128
  .long 0xa438, 0x38, 0x8830, 0x138
  .long 0xa440, 0xb480, 0xc000, 0x100
  .long 0xa448, 0xb490, 0xc010, 0x110
  .long 0xa450, 0x50, 0xc020, 0x108
  .long 0xa458, 0x58, 0xc030, 0x118
  .long 0xa460, 0xb4c0, 0xc800, 0x120
  .long 0xa468, 0xb4d0, 0xc810, 0x130
  .long 0xa470, 0x70, 0xc820, 0x128
  .long 0xa478, 0x78, 0xc830, 0x138
  .long 0xa480, 0xb408, 0x9000, 0x100
  .long 0xa488, 0xb418, 0x9010, 0x110
  .long 0xa490, 0x90, 0x9020, 0x108
  .long 0xa498, 0x98, 0x9030, 0x118
  .long 0xa4a0, 0xb448, 0x9800, 0x120
  .long 0xa4a8, 0xb458, 0x9810, 0x130
  .long 0xa4b0, 0xb0, 0x9820, 0x128
  .long 0xa4b8, 0xb8, 0x9830, 0x138
  .long 0xa4c0, 0xb488, 0xd000, 0x100
  .long 0xa4c8, 0xb498, 0xd010, 0x110
  .long 0xa4d0, 0xd0, 0xd020, 0x108
  .long 0xa4d8, 0xd8, 0xd030, 0x118
  .long 0xa4e0, 0xb4c8, 0xd800, 0x120
  .long 0xa4e8, 0xb4d8, 0xd810, 0x130
  .long 0xa4f0, 0xf0, 0xd820, 0x128
  .long 0xa4f8, 0xf8, 0xd830, 0x138
  .long 0xa600, 0xb500, 0xa000, 0x104
  .long 0xa608, 0xb510, 0xa010, 0x114
  .long 0xa610, 0x110, 0xa020, 0x10c
  .long 0xa618, 0x118, 0xa030, 0x11c
  .long 0xa620, 0xb540, 0xa800, 0x124
  .long 0xa628, 0xb550, 0xa810, 0x134
  .long 0xa630, 0x130, 0xa820, 0x12c
  .long 0xa638, 0x138, 0xa830, 0x13c
  .long 0xa640, 0xb580, 0xe000, 0x104
  .long 0xa648, 0xb590, 0xe010, 0x114
  .long 0xa650, 0x150, 0xe020, 0x10c
  .long 0xa658, 0x158, 0xe030, 0x11c
  .long 0xa660, 0xb5c0, 0xe800, 0x124
  .long 0xa668, 0xb5d0, 0xe810, 0x134
  .long 0xa670, 0x170, 0xe820, 0x12c
  .long 0xa678, 0x178, 0xe830, 0x13c
  .long 0xa680, 0xb508, 0xb000, 0x104
  .long 0xa688, 0xb518, 0xb010, 0x114
  .long 0xa690, 0x190, 0xb020, 0x10c
  .long 0xa698, 0x198, 0xb030, 0x11c
  .long 0xa6a0, 0xb548, 0xb800, 0x124
  .long 0xa6a8, 0xb558, 0xb810, 0x134
  .long 0xa6b0, 0x1b0, 0xb820, 0x12c
  .long 0xa6b8, 0x1b8, 0xb830, 0x13c
  .long 0xa6c0, 0xb588, 0xf000, 0x104
  .long 0xa6c8, 0xb598, 0xf010, 0x114
  .long 0xa6d0, 0x1d0, 0xf020, 0x10c
  .long 0xa6d8, 0x1d8, 0xf030, 0x11c
  .long 0xa6e0, 0xb5c8, 0xf800, 0x124
  .long 0xa6e8, 0xb5d8, 0xf810, 0x134
  .long 0xa6f0, 0x1f0, 0xf820, 0x12c
  .long 0xa6f8, 0x1f8, 0xf830, 0x13c
  .long 0xa800, 0xb020, 0x10000, 0x400
  .long 0xa808, 0xb030, 0x10010, 0x410
  .long 0xa810, 0x10, 0x10020, 0x408
  .long 0xa818, 0x18, 0x10030, 0x418
  .long 0xa820, 0xb060, 0x10800, 0x420
  .long 0xa828, 0xb070, 0x10810, 0x430
  .long 0xa830, 0x30, 0x10820, 0x428
  .long 0xa838, 0x38, 0x10830, 0x438
  .long 0xa840, 0xb0a0, 0x14000, 0x400
  .long 0xa848, 0xb0b0, 0x14010, 0x410
  .long 0xa850, 0x50, 0x14020, 0x408
  .long 0xa858, 0x58, 0x14030, 0x418
  .long 0xa860, 0xb0e0, 0x14800, 0x420
  .long 0xa868, 0xb0f0, 0x14810, 0x430
  .long 0xa870, 0x70, 0x14820, 0x428
  .long 0xa878, 0x78, 0x14830, 0x438
  .long 0xa880, 0xb028, 0x11000, 0x400
  .long 0xa888, 0xb038, 0x11010, 0x410
  .long 0xa890, 0x90, 0x11020, 0x408
  .long 0xa898, 0x98, 0x11030, 0x418
  .long 0xa8a0, 0xb068, 0x11800, 0x420
  .long 0xa8a8, 0xb078, 0x11810, 0x430
  .long 0xa8b0, 0xb0, 0x11820, 0x428
  .long 0xa8b8, 0xb8, 0x11830, 0x438
  .long 0xa8c0, 0xb0a8, 0x15000, 0x400
  .long 0xa8c8, 0xb0b8, 0x15010, 0x410
  .long 0xa8d0, 0xd0, 0x15020, 0x408
  .long 0xa8d8, 0xd8, 0x15030, 0x418
  .long 0xa8e0, 0xb0e8, 0x15800, 0x420
  .long 0xa8e8, 0xb0f8, 0x15810, 0x430
  .long 0xa8f0, 0xf0, 0x15820, 0x428
  .long 0xa8f8, 0xf8, 0x15830, 0x438
  .long 0xaa00, 0xb120, 0x12000, 0x404
  .long 0xaa08, 0xb130, 0x12010, 0x414
  .long 0xaa10, 0x110, 0x12020, 0x40c
  .long 0xaa18, 0x118, 0x12030, 0x41c
  .long 0xaa20, 0xb160, 0x12800, 0x424
  .long 0xaa28, 0xb170, 0x12810, 0x434
  .long 0xaa30, 0x130, 0x12820, 0x42c
  .long 0xaa38, 0x138, 0x12830, 0x43c
  .long 0xaa40, 0xb1a0, 0x16000, 0x404
  .long 0xaa48, 0xb1b0, 0x16010, 0x414
  .long 0xaa50, 0x150, 0x16020, 0x40c
  .long 0xaa58, 0x158, 0x16030, 0x41c
  .long 0xaa60, 0xb1e0, 0x16800, 0x424
  .long 0xaa68, 0xb1f0, 0x16810, 0x434
  .long 0xaa70, 0x170, 0x16820, 0x42c
  .long 0xaa78, 0x178, 0x16830, 0x43c
  .long 0xaa80, 0xb128, 0x13000, 0x404
  .long 0xaa88, 0xb138, 0x13010, 0x414
  .long 0xaa90, 0x190, 0x13020, 0x40c
  .long 0xaa98, 0x198, 0x13030, 0x41c
  .long 0xaaa0, 0xb168, 0x13800, 0x424
  .long 0xaaa8, 0xb178, 0x13810, 0x434
  .long 0xaab0, 0x1b0, 0x13820, 0x42c
  .long 0xaab8, 0x1b8, 0x13830, 0x43c
  .long 0xaac0, 0xb1a8, 0x17000, 0x404
  .long 0xaac8, 0xb1b8, 0x17010, 0x414
  .long 0xaad0, 0x1d0, 0x17020, 0x40c
  .long 0xaad8, 0x1d8, 0x17030, 0x41c
  .long 0xaae0, 0xb1e8, 0x17800, 0x424
  .long 0xaae8, 0xb1f8, 0x17810, 0x434
  .long 0xaaf0, 0x1f0, 0x17820, 0x42c
  .long 0xaaf8, 0x1f8, 0x17830, 0x43c
  .long 0xac00, 0xb420, 0x18000, 0x500
  .long 0xac08, 0xb430, 0x18010, 0x510
  .long 0xac10, 0x10, 0x18020, 0x508
  .long 0xac18, 0x18, 0x18030, 0x518
  .long 0xac20, 0xb460, 0x18800, 0x520
  .long 0xac28, 0xb470, 0x18810, 0x530
  .long 0xac30, 0x30, 0x18820, 0x528
  .long 0xac38, 0x38, 0x18830, 0x538
  .long 0xac40, 0xb4a0, 0x1c000, 0x500
  .long 0xac48, 0xb4b0, 0x1c010, 0x510
  .long 0xac50, 0x50, 0x1c020, 0x508
  .long 0xac58, 0x58, 0x1c030, 0x518
  .long 0xac60, 0xb4e0, 0x1c800, 0x520
  .long 0xac68, 0xb4f0, 0x1c810, 0x530
  .long 0xac70, 0x70, 0x1c820, 0x528
  .long 0xac78, 0x78, 0x1c830, 0x538
  .long 0xac80, 0xb428, 0x19000, 0x500
  .long 0xac88, 0xb438, 0x19010, 0x510
  .long 0xac90, 0x90, 0x19020, 0x508
  .long 0xac98, 0x98, 0x19030, 0x518
  .long 0xaca0, 0xb468, 0x19800, 0x520
  .long 0xaca8, 0xb478, 0x19810, 0x530
  .long 0xacb0, 0xb0, 0x19820, 0x528
  .long 0xacb8, 0xb8, 0x19830, 0x538
  .long 0xacc0, 0xb4a8, 0x1d000, 0x500
  .long 0xacc8, 0xb4b8, 0x1d010, 0x510
  .long 0xacd0, 0xd0, 0x1d020, 0x508
  .long 0xacd8, 0xd8, 0x1d030, 0x518
  .long 0xace0, 0xb4e8, 0x1d800, 0x520
  .long 0xace8, 0xb4f8, 0x1d810, 0x530
  .long 0xacf0, 0xf0, 0x1d820, 0x528
  .long 0xacf8, 0xf8, 0x1d830, 0x538
  .long 0xae00, 0xb520, 0x1a000, 0x504
  .long 0xae08, 0xb530, 0x1a010, 0x514
  .long 0xae10, 0x110, 0x1a020, 0x50c
  .long 0xae18, 0x118, 0x1a030, 0x51c
  .long 0xae20, 0xb560, 0x1a800, 0x524
  .long 0xae28, 0xb570, 0x1a810, 0x534
  .long 0xae30, 0x130, 0x1a820, 0x52c
  .long 0xae38, 0x138, 0x1a830, 0x53c
  .long 0xae40, 0xb5a0, 0x1e000, 0x504
  .long 0xae48, 0xb5b0, 0x1e010, 0x514
  .long 0xae50, 0x150, 0x1e020, 0x50c
  .long 0xae58, 0x158, 0x1e030, 0x51c
  .long 0xae60, 0xb5e0, 0x1e800, 0x524
  .long 0xae68, 0xb5f0, 0x1e810, 0x534
  .long 0xae70, 0x170, 0x1e820, 0x52c
  .long 0xae78, 0x178, 0x1e830, 0x53c
  .long 0xae80, 0xb528, 0x1b000, 0x504
  .long 0xae88, 0xb538, 0x1b010, 0x514
  .long 0xae90, 0x190, 0x1b020, 0x50c
  .long 0xae98, 0x198, 0x1b030, 0x51c
  .long 0xaea0, 0xb568, 0x1b800, 0x524
  .long 0xaea8, 0xb578, 0x1b810, 0x534
  .long 0xaeb0, 0x1b0, 0x1b820, 0x52c
  .long 0xaeb8, 0x1b8, 0x1b830, 0x53c
  .long 0xaec0, 0xb5a8, 0x1f000, 0x504
  .long 0xaec8, 0xb5b8, 0x1f010, 0x514
  .long 0xaed0, 0x1d0, 0x1f020, 0x50c
  .long 0xaed8, 0x1d8, 0x1f030, 0x51c
  .long 0xaee0, 0xb5e8, 0x1f800, 0x524
  .long 0xaee8, 0xb5f8, 0x1f810, 0x534
  .long 0xaef0, 0x1f0, 0x1f820, 0x52c
  .long 0xaef8, 0x1f8, 0x1f830, 0x53c
  .long 0x0, 0x0, 0xb800, 0xb000
  .long 0x10, 0x10, 0xb810, 0xb010
  .long 0x20, 0x20, 0xb800, 0xb020
  .long 0x30, 0x30, 0xb810, 0xb030
  .long 0x40, 0x40, 0xb820, 0xb040
  .long 0x50, 0x50, 0xb830, 0xb050
  .long 0x60, 0x60, 0xb820, 0xb060
  .long 0x70, 0x70, 0xb830, 0xb070
  .long 0x80, 0x80, 0xb840, 0xb080
  .long 0x90, 0x90, 0xb850, 0xb090
  .long 0xa0, 0xa0, 0xb840, 0xb0a0
  .long 0xb0, 0xb0, 0xb850, 0xb0b0
  .long 0xc0, 0xc0, 0xb860, 0xb0c0
  .long 0xd0, 0xd0, 0xb870, 0xb0d0
  .long 0xe0, 0xe0, 0xb860, 0xb0e0
  .long 0xf0, 0xf0, 0xb870, 0xb0f0
  .long 0x100, 0x100, 0xb880, 0xb100
  .long 0x110, 0x110, 0xb890, 0xb110
  .long 0x120, 0x120, 0xb880, 0xb120
  .long 0x130, 0x130, 0xb890, 0xb130
  .long 0x140, 0x140, 0xb8a0, 0xb140
  .long 0x150, 0x150, 0xb8b0, 0xb150
  .long 0x160, 0x160, 0xb8a0, 0xb160
  .long 0x170, 0x170, 0xb8b0, 0xb170
  .long 0x180, 0x180, 0xb8c0, 0xb180
  .long 0x190, 0x190, 0xb8d0, 0xb190
  .long 0x1a0, 0x1a0, 0xb8c0, 0xb1a0
  .long 0x1b0, 0x1b0, 0xb8d0, 0xb1b0
  .long 0x1c0, 0x1c0, 0xb8e0, 0xb1c0
  .long 0x1d0, 0x1d0, 0xb8f0, 0xb1d0
  .long 0x1e0, 0x1e0, 0xb8e0, 0xb1e0
  .long 0x1f0, 0x1f0, 0xb8f0, 0xb1f0
  .long 0x200, 0x200, 0xb900, 0xb200
  .long 0x210, 0x210, 0xb910, 0xb210
  .long 0x220, 0x220, 0xb900, 0xb220
  .long 0x230, 0x230, 0xb910, 0xb230
  .long 0x240, 0x240, 0xb920, 0xb240
  .long 0x250, 0x250, 0xb930, 0xb250
  .long 0x260, 0x260, 0xb920, 0xb260
  .long 0x270, 0x270, 0xb930, 0xb270
  .long 0x280, 0x280, 0xb940, 0xb280
  .long 0x290, 0x290, 0xb950, 0xb290
  .long 0x2a0, 0x2a0, 0xb940, 0xb2a0
  .long 0x2b0, 0x2b0, 0xb950, 0xb2b0
  .long 0x2c0, 0x2c0, 0xb960, 0xb2c0
  .long 0x2d0, 0x2d0, 0xb970, 0xb2d0
  .long 0x2e0, 0x2e0, 0xb960, 0xb2e0
  .long 0x2f0, 0x2f0, 0xb970, 0xb2f0
  .long 0x300, 0x300, 0xb980, 0xb300
  .long 0x310, 0x310, 0xb990, 0xb310
  .long 0x320, 0x320, 0xb980, 0xb320
  .long 0x330, 0x330, 0xb990, 0xb330
  .long 0x340, 0x340, 0xb9a0, 0xb340
  .long 0x350, 0x350, 0xb9b0, 0xb350
  .long 0x360, 0x360, 0xb9a0, 0xb360
  .long 0x370, 0x370, 0xb9b0, 0xb370
  .long 0x380, 0x380, 0xb9c0, 0xb380
  .long 0x390, 0x390, 0xb9d0, 0xb390
  .long 0x3a0, 0x3a0, 0xb9c0, 0xb3a0
  .long 0x3b0, 0x3b0, 0xb9d0, 0xb3b0
  .long 0x3c0, 0x3c0, 0xb9e0, 0xb3c0
  .long 0x3d0, 0x3d0, 0xb9f0, 0xb3d0
  .long 0x3e0, 0x3e0, 0xb9e0, 0xb3e0
  .long 0x3f0, 0x3f0, 0xb9f0, 0xb3f0
  .long 0x800, 0x400, 0xba00, 0x12000
  .long 0x810, 0x410, 0xba10, 0x12010
  .long 0x820, 0x420, 0xba00, 0x12020
  .long 0x830, 0x430, 0xba10, 0x12030
  .long 0x840, 0x440, 0xba20, 0x12040
  .long 0x850, 0x450, 0xba30, 0x12050
  .long 0x860, 0x460, 0xba20, 0x12060
  .long 0x870, 0x470, 0xba30, 0x12070
  .long 0x880, 0x480, 0xba40, 0x12080
  .long 0x890, 0x490, 0xba50, 0x12090
  .long 0x8a0, 0x4a0, 0xba40, 0x120a0
  .long 0x8b0, 0x4b0, 0xba50, 0x120b0
  .long 0x8c0, 0x4c0, 0xba60, 0x120c0
  .long 0x8d0, 0x4d0, 0xba70, 0x120d0
  .long 0x8e0, 0x4e0, 0xba60, 0x120e0
  .long 0x8f0, 0x4f0, 0xba70, 0x120f0
  .long 0x900, 0x500, 0xba80, 0x12100
  .long 0x910, 0x510, 0xba90, 0x12110
  .long 0x920, 0x520, 0xba80, 0x12120
  .long 0x930, 0x530, 0xba90, 0x12130
  .long 0x940, 0x540, 0xbaa0, 0x12140
  .long 0x950, 0x550, 0xbab0, 0x12150
  .long 0x960, 0x560, 0xbaa0, 0x12160
  .long 0x970, 0x570, 0xbab0, 0x12170
  .long 0x980, 0x580, 0xbac0, 0x12180
  .long 0x990, 0x590, 0xbad0, 0x12190
  .long 0x9a0, 0x5a0, 0xbac0, 0x121a0
  .long 0x9b0, 0x5b0, 0xbad0, 0x121b0
  .long 0x9c0, 0x5c0, 0xbae0, 0x121c0
  .long 0x9d0, 0x5d0, 0xbaf0, 0x121d0
  .long 0x9e0, 0x5e0, 0xbae0, 0x121e0
  .long 0x9f0, 0x5f0, 0xbaf0, 0x121f0
  .long 0xa00, 0x600, 0xbb00, 0x12200
  .long 0xa10, 0x610, 0xbb10, 0x12210
  .long 0xa20, 0x620, 0xbb00, 0x12220
  .long 0xa30, 0x630, 0xbb10, 0x12230
  .long 0xa40, 0x640, 0xbb20, 0x12240
  .long 0xa50, 0x650, 0xbb30, 0x12250
  .long 0xa60, 0x660, 0xbb20, 0x12260
  .long 0xa70, 0x670, 0xbb30, 0x12270
  .long 0xa80, 0x680, 0xbb40, 0x12280
  .long 0xa90, 0x690, 0xbb50, 0x12290
  .long 0xaa0, 0x6a0, 0xbb40, 0x122a0
  .long 0xab0, 0x6b0, 0xbb50, 0x122b0
  .long 0xac0, 0x6c0, 0xbb60, 0x122c0
  .long 0xad0, 0x6d0, 0xbb70, 0x122d0
  .long 0xae0, 0x6e0, 0xbb60, 0x122e0
  .long 0xaf0, 0x6f0, 0xbb70, 0x122f0
  .long 0xb00, 0x700, 0xbb80, 0x12300
  .long 0xb10, 0x710, 0xbb90, 0x12310
  .long 0xb20, 0x720, 0xbb80, 0x12320
  .long 0xb30, 0x730, 0xbb90, 0x12330
  .long 0xb40, 0x740, 0xbba0, 0x12340
  .long 0xb50, 0x750, 0xbbb0, 0x12350
  .long 0xb60, 0x760, 0xbba0, 0x12360
  .long 0xb70, 0x770, 0xbbb0, 0x12370
  .long 0xb80, 0x780, 0xbbc0, 0x12380
  .long 0xb90, 0x790, 0xbbd0, 0x12390
  .long 0xba0, 0x7a0, 0xbbc0, 0x123a0
  .long 0xbb0, 0x7b0, 0xbbd0, 0x123b0
  .long 0xbc0, 0x7c0, 0xbbe0, 0x123c0
  .long 0xbd0, 0x7d0, 0xbbf0, 0x123d0
  .long 0xbe0, 0x7e0, 0xbbe0, 0x123e0
  .long 0xbf0, 0x7f0, 0xbbf0, 0x123f0
  .long 0x20000, 0x800, 0xbc00, 0x19000
  .long 0x20010, 0x810, 0xbc10, 0x19010
  .long 0x20020, 0x820, 0xbc00, 0x19020
  .long 0x20030, 0x830, 0xbc10, 0x19030
  .long 0x20040, 0x840, 0xbc20, 0x19040
  .long 0x20050, 0x850, 0xbc30, 0x19050
  .long 0x20060, 0x860, 0xbc20, 0x19060
  .long 0x20070, 0x870, 0xbc30, 0x19070
  .long 0x20080, 0x880, 0xbc40, 0x19080
  .long 0x20090, 0x890, 0xbc50, 0x19090
  .long 0x200a0, 0x8a0, 0xbc40, 0x190a0
  .long 0x200b0, 0x8b0, 0xbc50, 0x190b0
  .long 0x200c0, 0x8c0, 0xbc60, 0x190c0
  .long 0x200d0, 0x8d0, 0xbc70, 0x190d0
  .long 0x200e0, 0x8e0, 0xbc60, 0x190e0
  .long 0x200f0, 0x8f0, 0xbc70, 0x190f0
  .long 0x20100, 0x900, 0xbc80, 0x19100
  .long 0x20110, 0x910, 0xbc90, 0x19110
  .long 0x20120, 0x920, 0xbc80, 0x19120
  .long 0x20130, 0x930, 0xbc90, 0x19130
  .long 0x20140, 0x940, 0xbca0, 0x19140
  .long 0x20150, 0x950, 0xbcb0, 0x19150
  .long 0x20160, 0x960, 0xbca0, 0x19160
  .long 0x20170, 0x970, 0xbcb0, 0x19170
  .long 0x20180, 0x980, 0xbcc0, 0x19180
  .long 0x20190, 0x990, 0xbcd0, 0x19190
  .long 0x201a0, 0x9a0, 0xbcc0, 0x191a0
  .long 0x201b0, 0x9b0, 0xbcd0, 0x191b0
  .long 0x201c0, 0x9c0, 0xbce0, 0x191c0
  .long 0x201d0, 0x9d0, 0xbcf0, 0x191d0
  .long 0x201e0, 0x9e0, 0xbce0, 0x191e0
  .long 0x201f0, 0x9f0, 0xbcf0, 0x191f0
  .long 0x20200, 0xa00, 0xbd00, 0x19200
  .long 0x20210, 0xa10, 0xbd10, 0x19210
  .long 0x20220, 0xa20, 0xbd00, 0x19220
  .long 0x20230, 0xa30, 0xbd10, 0x19230
  .long 0x20240, 0xa40, 0xbd20, 0x19240
  .long 0x20250, 0xa50, 0xbd30, 0x19250
  .long 0x20260, 0xa60, 0xbd20, 0x19260
  .long 0x20270, 0xa70, 0xbd30, 0x19270
  .long 0x20280, 0xa80, 0xbd40, 0x19280
  .long 0x20290, 0xa90, 0xbd50, 0x19290
  .long 0x202a0, 0xaa0, 0xbd40, 0x192a0
  .long 0x202b0, 0xab0, 0xbd50, 0x192b0
  .long 0x202c0, 0xac0, 0xbd60, 0x192c0
  .long 0x202d0, 0xad0, 0xbd70, 0x192d0
  .long 0x202e0, 0xae0, 0xbd60, 0x192e0
  .long 0x202f0, 0xaf0, 0xbd70, 0x192f0
  .long 0x20300, 0xb00, 0xbd80, 0x19300
  .long 0x20310, 0xb10, 0xbd90, 0x19310
  .long 0x20320, 0xb20, 0xbd80, 0x19320
  .long 0x20330, 0xb30, 0xbd90, 0x19330
  .long 0x20340, 0xb40, 0xbda0, 0x19340
  .long 0x20350, 0xb50, 0xbdb0, 0x19350
  .long 0x20360, 0xb60, 0xbda0, 0x19360
  .long 0x20370, 0xb70, 0xbdb0, 0x19370
  .long 0x20380, 0xb80, 0xbdc0, 0x19380
  .long 0x20390, 0xb90, 0xbdd0, 0x19390
  .long 0x203a0, 0xba0, 0xbdc0, 0x193a0
  .long 0x203b0, 0xbb0, 0xbdd0, 0x193b0
  .long 0x203c0, 0xbc0, 0xbde0, 0x193c0
  .long 0x203d0, 0xbd0, 0xbdf0, 0x193d0
  .long 0x203e0, 0xbe0, 0xbde0, 0x193e0
  .long 0x203f0, 0xbf0, 0xbdf0, 0x193f0
  .long 0x20800, 0xc00, 0xbe00, 0x20000
  .long 0x20810, 0xc10, 0xbe10, 0x20010
  .long 0x20820, 0xc20, 0xbe00, 0x20020
  .long 0x20830, 0xc30, 0xbe10, 0x20030
  .long 0x20840, 0xc40, 0xbe20, 0x20040
  .long 0x20850, 0xc50, 0xbe30, 0x20050
  .long 0x20860, 0xc60, 0xbe20, 0x20060
  .long 0x20870, 0xc70, 0xbe30, 0x20070
  .long 0x20880, 0xc80, 0xbe40, 0x20080
  .long 0x20890, 0xc90, 0xbe50, 0x20090
  .long 0x208a0, 0xca0, 0xbe40, 0x200a0
  .long 0x208b0, 0xcb0, 0xbe50, 0x200b0
  .long 0x208c0, 0xcc0, 0xbe60, 0x200c0
  .long 0x208d0, 0xcd0, 0xbe70, 0x200d0
  .long 0x208e0, 0xce0, 0xbe60, 0x200e0
  .long 0x208f0, 0xcf0, 0xbe70, 0x200f0
  .long 0x20900, 0xd00, 0xbe80, 0x20100
  .long 0x20910, 0xd10, 0xbe90, 0x20110
  .long 0x20920, 0xd20, 0xbe80, 0x20120
  .long 0x20930, 0xd30, 0xbe90, 0x20130
  .long 0x20940, 0xd40, 0xbea0, 0x20140
  .long 0x20950, 0xd50, 0xbeb0, 0x20150
  .long 0x20960, 0xd60, 0xbea0, 0x20160
  .long 0x20970, 0xd70, 0xbeb0, 0x20170
  .long 0x20980, 0xd80, 0xbec0, 0x20180
  .long 0x20990, 0xd90, 0xbed0, 0x20190
  .long 0x209a0, 0xda0, 0xbec0, 0x201a0
  .long 0x209b0, 0xdb0, 0xbed0, 0x201b0
  .long 0x209c0, 0xdc0, 0xbee0, 0x201c0
  .long 0x209d0, 0xdd0, 0xbef0, 0x201d0
  .long 0x209e0, 0xde0, 0xbee0, 0x201e0
  .long 0x209f0, 0xdf0, 0xbef0, 0x201f0
  .long 0x20a00, 0xe00, 0xbf00, 0x20200
  .long 0x20a10, 0xe10, 0xbf10, 0x20210
  .long 0x20a20, 0xe20, 0xbf00, 0x20220
  .long 0x20a30, 0xe30, 0xbf10, 0x20230
  .long 0x20a40, 0xe40, 0xbf20, 0x20240
  .long 0x20a50, 0xe50, 0xbf30, 0x20250
  .long 0x20a60, 0xe60, 0xbf20, 0x20260
  .long 0x20a70, 0xe70, 0xbf30, 0x20270
  .long 0x20a80, 0xe80, 0xbf40, 0x20280
  .long 0x20a90, 0xe90, 0xbf50, 0x20290
  .long 0x20aa0, 0xea0, 0xbf40, 0x202a0
  .long 0x20ab0, 0xeb0, 0xbf50, 0x202b0
  .long 0x20ac0, 0xec0, 0xbf60, 0x202c0
  .long 0x20ad0, 0xed0, 0xbf70, 0x202d0
  .long 0x20ae0, 0xee0, 0xbf60, 0x202e0
  .long 0x20af0, 0xef0, 0xbf70, 0x202f0
  .long 0x20b00, 0xf00, 0xbf80, 0x20300
  .long 0x20b10, 0xf10, 0xbf90, 0x20310
  .long 0x20b20, 0xf20, 0xbf80, 0x20320
  .long 0x20b30, 0xf30, 0xbf90, 0x20330
  .long 0x20b40, 0xf40, 0xbfa0, 0x20340
  .long 0x20b50, 0xf50, 0xbfb0, 0x20350
  .long 0x20b60, 0xf60, 0xbfa0, 0x20360
  .long 0x20b70, 0xf70, 0xbfb0, 0x20370
  .long 0x20b80, 0xf80, 0xbfc0, 0x20380
  .long 0x20b90, 0xf90, 0xbfd0, 0x20390
  .long 0x20ba0, 0xfa0, 0xbfc0, 0x203a0
  .long 0x20bb0, 0xfb0, 0xbfd0, 0x203b0
  .long 0x20bc0, 0xfc0, 0xbfe0, 0x203c0
  .long 0x20bd0, 0xfd0, 0xbff0, 0x203d0
  .long 0x20be0, 0xfe0, 0xbfe0, 0x203e0
  .long 0x20bf0, 0xff0, 0xbff0, 0x203f0
  .long 0x0, 0xb800, 0x3f80, 0x0
  .long 0x10, 0xb810, 0x3f800000, 0x10
  .long 0x20, 0xb820, 0x3f80, 0x20
  .long 0x30, 0xb830, 0x3f800000, 0x30
  .long 0x40, 0xb840, 0x3f80, 0x40
  .long 0x50, 0xb850, 0x3f800000, 0x50
  .long 0x60, 0xb860, 0x3f80, 0x60
  .long 0x70, 0xb870, 0x3f800000, 0x70
  .long 0x80, 0xb880, 0x3f80, 0x80
  .long 0x90, 0xb890, 0x3f800000, 0x90
  .long 0xa0, 0xb8a0, 0x3f80, 0xa0
  .long 0xb0, 0xb8b0, 0x3f800000, 0xb0
  .long 0xc0, 0xb8c0, 0x3f80, 0xc0
  .long 0xd0, 0xb8d0, 0x3f800000, 0xd0
  .long 0xe0, 0xb8e0, 0x3f80, 0xe0
  .long 0xf0, 0xb8f0, 0x3f800000, 0xf0
  .long 0x100, 0xb804, 0x3f80, 0x100
  .long 0x110, 0xb814, 0x3f800000, 0x110
  .long 0x120, 0xb824, 0x3f80, 0x120
  .long 0x130, 0xb834, 0x3f800000, 0x130
  .long 0x140, 0xb844, 0x3f80, 0x140
  .long 0x150, 0xb854, 0x3f800000, 0x150
  .long 0x160, 0xb864, 0x3f80, 0x160
  .long 0x170, 0xb874, 0x3f800000, 0x170
  .long 0x180, 0xb884, 0x3f80, 0x180
  .long 0x190, 0xb894, 0x3f800000, 0x190
  .long 0x1a0, 0xb8a4, 0x3f80, 0x1a0
  .long 0x1b0, 0xb8b4, 0x3f800000, 0x1b0
  .long 0x1c0, 0xb8c4, 0x3f80, 0x1c0
  .long 0x1d0, 0xb8d4, 0x3f800000, 0x1d0
  .long 0x1e0, 0xb8e4, 0x3f80, 0x1e0
  .long 0x1f0, 0xb8f4, 0x3f800000, 0x1f0
  .long 0x200, 0xb808, 0x3f80, 0x200
  .long 0x210, 0xb818, 0x3f800000, 0x210
  .long 0x220, 0xb828, 0x3f80, 0x220
  .long 0x230, 0xb838, 0x3f800000, 0x230
  .long 0x240, 0xb848, 0x3f80, 0x240
  .long 0x250, 0xb858, 0x3f800000, 0x250
  .long 0x260, 0xb868, 0x3f80, 0x260
  .long 0x270, 0xb878, 0x3f800000, 0x270
  .long 0x280, 0xb888, 0x3f80, 0x280
  .long 0x290, 0xb898, 0x3f800000, 0x290
  .long 0x2a0, 0xb8a8, 0x3f80, 0x2a0
  .long 0x2b0, 0xb8b8, 0x3f800000, 0x2b0
  .long 0x2c0, 0xb8c8, 0x3f80, 0x2c0
  .long 0x2d0, 0xb8d8, 0x3f800000, 0x2d0
  .long 0x2e0, 0xb8e8, 0x3f80, 0x2e0
  .long 0x2f0, 0xb8f8, 0x3f800000, 0x2f0
  .long 0x300, 0xb80c, 0x3f80, 0x300
  .long 0x310, 0xb81c, 0x3f800000, 0x310
  .long 0x320, 0xb82c, 0x3f80, 0x320
  .long 0x330, 0xb83c, 0x3f800000, 0x330
  .long 0x340, 0xb84c, 0x3f80, 0x340
  .long 0x350, 0xb85c, 0x3f800000, 0x350
  .long 0x360, 0xb86c, 0x3f80, 0x360
  .long 0x370, 0xb87c, 0x3f800000, 0x370
  .long 0x380, 0xb88c, 0x3f80, 0x380
  .long 0x390, 0xb89c, 0x3f800000, 0x390
  .long 0x3a0, 0xb8ac, 0x3f80, 0x3a0
  .long 0x3b0, 0xb8bc, 0x3f800000, 0x3b0
  .long 0x3c0, 0xb8cc, 0x3f80, 0x3c0
  .long 0x3d0, 0xb8dc, 0x3f800000, 0x3d0
  .long 0x3e0, 0xb8ec, 0x3f80, 0x3e0
  .long 0x3f0, 0xb8fc, 0x3f800000, 0x3f0
  .long 0x800, 0xba00, 0x3f80, 0x1000
  .long 0x810, 0xba10, 0x3f800000, 0x1010
  .long 0x820, 0xba20, 0x3f80, 0x1020
  .long 0x830, 0xba30, 0x3f800000, 0x1030
  .long 0x840, 0xba40, 0x3f80, 0x1040
  .long 0x850, 0xba50, 0x3f800000, 0x1050
  .long 0x860, 0xba60, 0x3f80, 0x1060
  .long 0x870, 0xba70, 0x3f800000, 0x1070
  .long 0x880, 0xba80, 0x3f80, 0x1080
  .long 0x890, 0xba90, 0x3f800000, 0x1090
  .long 0x8a0, 0xbaa0, 0x3f80, 0x10a0
  .long 0x8b0, 0xbab0, 0x3f800000, 0x10b0
  .long 0x8c0, 0xbac0, 0x3f80, 0x10c0
  .long 0x8d0, 0xbad0, 0x3f800000, 0x10d0
  .long 0x8e0, 0xbae0, 0x3f80, 0x10e0
  .long 0x8f0, 0xbaf0, 0x3f800000, 0x10f0
  .long 0x900, 0xba04, 0x3f80, 0x1100
  .long 0x910, 0xba14, 0x3f800000, 0x1110
  .long 0x920, 0xba24, 0x3f80, 0x1120
  .long 0x930, 0xba34, 0x3f800000, 0x1130
  .long 0x940, 0xba44, 0x3f80, 0x1140
  .long 0x950, 0xba54, 0x3f800000, 0x1150
  .long 0x960, 0xba64, 0x3f80, 0x1160
  .long 0x970, 0xba74, 0x3f800000, 0x1170
  .long 0x980, 0xba84, 0x3f80, 0x1180
  .long 0x990, 0xba94, 0x3f800000, 0x1190
  .long 0x9a0, 0xbaa4, 0x3f80, 0x11a0
  .long 0x9b0, 0xbab4, 0x3f800000, 0x11b0
  .long 0x9c0, 0xbac4, 0x3f80, 0x11c0
  .long 0x9d0, 0xbad4, 0x3f800000, 0x11d0
  .long 0x9e0, 0xbae4, 0x3f80, 0x11e0
  .long 0x9f0, 0xbaf4, 0x3f800000, 0x11f0
  .long 0xa00, 0xba08, 0x3f80, 0x1200
  .long 0xa10, 0xba18, 0x3f800000, 0x1210
  .long 0xa20, 0xba28, 0x3f80, 0x1220
  .long 0xa30, 0xba38, 0x3f800000, 0x1230
  .long 0xa40, 0xba48, 0x3f80, 0x1240
  .long 0xa50, 0xba58, 0x3f800000, 0x1250
  .long 0xa60, 0xba68, 0x3f80, 0x1260
  .long 0xa70, 0xba78, 0x3f800000, 0x1270
  .long 0xa80, 0xba88, 0x3f80, 0x1280
  .long 0xa90, 0xba98, 0x3f800000, 0x1290
  .long 0xaa0, 0xbaa8, 0x3f80, 0x12a0
  .long 0xab0, 0xbab8, 0x3f800000, 0x12b0
  .long 0xac0, 0xbac8, 0x3f80, 0x12c0
  .long 0xad0, 0xbad8, 0x3f800000, 0x12d0
  .long 0xae0, 0xbae8, 0x3f80, 0x12e0
  .long 0xaf0, 0xbaf8, 0x3f800000, 0x12f0
  .long 0xb00, 0xba0c, 0x3f80, 0x1300
  .long 0xb10, 0xba1c, 0x3f800000, 0x1310
  .long 0xb20, 0xba2c, 0x3f80, 0x1320
  .long 0xb30, 0xba3c, 0x3f800000, 0x1330
  .long 0xb40, 0xba4c, 0x3f80, 0x1340
  .long 0xb50, 0xba5c, 0x3f800000, 0x1350
  .long 0xb60, 0xba6c, 0x3f80, 0x1360
  .long 0xb70, 0xba7c, 0x3f800000, 0x1370
  .long 0xb80, 0xba8c, 0x3f80, 0x1380
  .long 0xb90, 0xba9c, 0x3f800000, 0x1390
  .long 0xba0, 0xbaac, 0x3f80, 0x13a0
  .long 0xbb0, 0xbabc, 0x3f800000, 0x13b0
  .long 0xbc0, 0xbacc, 0x3f80, 0x13c0
  .long 0xbd0, 0xbadc, 0x3f800000, 0x13d0
  .long 0xbe0, 0xbaec, 0x3f80, 0x13e0
  .long 0xbf0, 0xbafc, 0x3f800000, 0x13f0
  .long 0x1000, 0xbc00, 0x3f80, 0x1000000
  .long 0x1010, 0xbc10, 0x3f800000, 0x1000010
  .long 0x1020, 0xbc20, 0x3f80, 0x1000020
  .long 0x1030, 0xbc30, 0x3f800000, 0x1000030
  .long 0x1040, 0xbc40, 0x3f80, 0x1000040
  .long 0x1050, 0xbc50, 0x3f800000, 0x1000050
  .long 0x1060, 0xbc60, 0x3f80, 0x1000060
  .long 0x1070, 0xbc70, 0x3f800000, 0x1000070
  .long 0x1080, 0xbc80, 0x3f80, 0x1000080
  .long 0x1090, 0xbc90, 0x3f800000, 0x1000090
  .long 0x10a0, 0xbca0, 0x3f80, 0x10000a0
  .long 0x10b0, 0xbcb0, 0x3f800000, 0x10000b0
  .long 0x10c0, 0xbcc0, 0x3f80, 0x10000c0
  .long 0x10d0, 0xbcd0, 0x3f800000, 0x10000d0
  .long 0x10e0, 0xbce0, 0x3f80, 0x10000e0
  .long 0x10f0, 0xbcf0, 0x3f800000, 0x10000f0
  .long 0x1100, 0xbc04, 0x3f80, 0x1000100
  .long 0x1110, 0xbc14, 0x3f800000, 0x1000110
  .long 0x1120, 0xbc24, 0x3f80, 0x1000120
  .long 0x1130, 0xbc34, 0x3f800000, 0x1000130
  .long 0x1140, 0xbc44, 0x3f80, 0x1000140
  .long 0x1150, 0xbc54, 0x3f800000, 0x1000150
  .long 0x1160, 0xbc64, 0x3f80, 0x1000160
  .long 0x1170, 0xbc74, 0x3f800000, 0x1000170
  .long 0x1180, 0xbc84, 0x3f80, 0x1000180
  .long 0x1190, 0xbc94, 0x3f800000, 0x1000190
  .long 0x11a0, 0xbca4, 0x3f80, 0x10001a0
  .long 0x11b0, 0xbcb4, 0x3f800000, 0x10001b0
  .long 0x11c0, 0xbcc4, 0x3f80, 0x10001c0
  .long 0x11d0, 0xbcd4, 0x3f800000, 0x10001d0
  .long 0x11e0, 0xbce4, 0x3f80, 0x10001e0
  .long 0x11f0, 0xbcf4, 0x3f800000, 0x10001f0
  .long 0x1200, 0xbc08, 0x3f80, 0x1000200
  .long 0x1210, 0xbc18, 0x3f800000, 0x1000210
  .long 0x1220, 0xbc28, 0x3f80, 0x1000220
  .long 0x1230, 0xbc38, 0x3f800000, 0x1000230
  .long 0x1240, 0xbc48, 0x3f80, 0x1000240
  .long 0x1250, 0xbc58, 0x3f800000, 0x1000250
  .long 0x1260, 0xbc68, 0x3f80, 0x1000260
  .long 0x1270, 0xbc78, 0x3f800000, 0x1000270
  .long 0x1280, 0xbc88, 0x3f80, 0x1000280
  .long 0x1290, 0xbc98, 0x3f800000, 0x1000290
  .long 0x12a0, 0xbca8, 0x3f80, 0x10002a0
  .long 0x12b0, 0xbcb8, 0x3f800000, 0x10002b0
  .long 0x12c0, 0xbcc8, 0x3f80, 0x10002c0
  .long 0x12d0, 0xbcd8, 0x3f800000, 0x10002d0
  .long 0x12e0, 0xbce8, 0x3f80, 0x10002e0
  .long 0x12f0, 0xbcf8, 0x3f800000, 0x10002f0
  .long 0x1300, 0xbc0c, 0x3f80, 0x1000300
  .long 0x1310, 0xbc1c, 0x3f800000, 0x1000310
  .long 0x1320, 0xbc2c, 0x3f80, 0x1000320
  .long 0x1330, 0xbc3c, 0x3f800000, 0x1000330
  .long 0x1340, 0xbc4c, 0x3f80, 0x1000340
  .long 0x1350, 0xbc5c, 0x3f800000, 0x1000350
  .long 0x1360, 0xbc6c, 0x3f80, 0x1000360
  .long 0x1370, 0xbc7c, 0x3f800000, 0x1000370
  .long 0x1380, 0xbc8c, 0x3f80, 0x1000380
  .long 0x1390, 0xbc9c, 0x3f800000, 0x1000390
  .long 0x13a0, 0xbcac, 0x3f80, 0x10003a0
  .long 0x13b0, 0xbcbc, 0x3f800000, 0x10003b0
  .long 0x13c0, 0xbccc, 0x3f80, 0x10003c0
  .long 0x13d0, 0xbcdc, 0x3f800000, 0x10003d0
  .long 0x13e0, 0xbcec, 0x3f80, 0x10003e0
  .long 0x13f0, 0xbcfc, 0x3f800000, 0x10003f0
  .long 0x1800, 0xbe00, 0x3f80, 0x1001000
  .long 0x1810, 0xbe10, 0x3f800000, 0x1001010
  .long 0x1820, 0xbe20, 0x3f80, 0x1001020
  .long 0x1830, 0xbe30, 0x3f800000, 0x1001030
  .long 0x1840, 0xbe40, 0x3f80, 0x1001040
  .long 0x1850, 0xbe50, 0x3f800000, 0x1001050
  .long 0x1860, 0xbe60, 0x3f80, 0x1001060
  .long 0x1870, 0xbe70, 0x3f800000, 0x1001070
  .long 0x1880, 0xbe80, 0x3f80, 0x1001080
  .long 0x1890, 0xbe90, 0x3f800000, 0x1001090
  .long 0x18a0, 0xbea0, 0x3f80, 0x10010a0
  .long 0x18b0, 0xbeb0, 0x3f800000, 0x10010b0
  .long 0x18c0, 0xbec0, 0x3f80, 0x10010c0
  .long 0x18d0, 0xbed0, 0x3f800000, 0x10010d0
  .long 0x18e0, 0xbee0, 0x3f80, 0x10010e0
  .long 0x18f0, 0xbef0, 0x3f800000, 0x10010f0
  .long 0x1900, 0xbe04, 0x3f80, 0x1001100
  .long 0x1910, 0xbe14, 0x3f800000, 0x1001110
  .long 0x1920, 0xbe24, 0x3f80, 0x1001120
  .long 0x1930, 0xbe34, 0x3f800000, 0x1001130
  .long 0x1940, 0xbe44, 0x3f80, 0x1001140
  .long 0x1950, 0xbe54, 0x3f800000, 0x1001150
  .long 0x1960, 0xbe64, 0x3f80, 0x1001160
  .long 0x1970, 0xbe74, 0x3f800000, 0x1001170
  .long 0x1980, 0xbe84, 0x3f80, 0x1001180
  .long 0x1990, 0xbe94, 0x3f800000, 0x1001190
  .long 0x19a0, 0xbea4, 0x3f80, 0x10011a0
  .long 0x19b0, 0xbeb4, 0x3f800000, 0x10011b0
  .long 0x19c0, 0xbec4, 0x3f80, 0x10011c0
  .long 0x19d0, 0xbed4, 0x3f800000, 0x10011d0
  .long 0x19e0, 0xbee4, 0x3f80, 0x10011e0
  .long 0x19f0, 0xbef4, 0x3f800000, 0x10011f0
  .long 0x1a00, 0xbe08, 0x3f80, 0x1001200
  .long 0x1a10, 0xbe18, 0x3f800000, 0x1001210
  .long 0x1a20, 0xbe28, 0x3f80, 0x1001220
  .long 0x1a30, 0xbe38, 0x3f800000, 0x1001230
  .long 0x1a40, 0xbe48, 0x3f80, 0x1001240
  .long 0x1a50, 0xbe58, 0x3f800000, 0x1001250
  .long 0x1a60, 0xbe68, 0x3f80, 0x1001260
  .long 0x1a70, 0xbe78, 0x3f800000, 0x1001270
  .long 0x1a80, 0xbe88, 0x3f80, 0x1001280
  .long 0x1a90, 0xbe98, 0x3f800000, 0x1001290
  .long 0x1aa0, 0xbea8, 0x3f80, 0x10012a0
  .long 0x1ab0, 0xbeb8, 0x3f800000, 0x10012b0
  .long 0x1ac0, 0xbec8, 0x3f80, 0x10012c0
  .long 0x1ad0, 0xbed8, 0x3f800000, 0x10012d0
  .long 0x1ae0, 0xbee8, 0x3f80, 0x10012e0
  .long 0x1af0, 0xbef8, 0x3f800000, 0x10012f0
  .long 0x1b00, 0xbe0c, 0x3f80, 0x1001300
  .long 0x1b10, 0xbe1c, 0x3f800000, 0x1001310
  .long 0x1b20, 0xbe2c, 0x3f80, 0x1001320
  .long 0x1b30, 0xbe3c, 0x3f800000, 0x1001330
  .long 0x1b40, 0xbe4c, 0x3f80, 0x1001340
  .long 0x1b50, 0xbe5c, 0x3f800000, 0x1001350
  .long 0x1b60, 0xbe6c, 0x3f80, 0x1001360
  .long 0x1b70, 0xbe7c, 0x3f800000, 0x1001370
  .long 0x1b80, 0xbe8c, 0x3f80, 0x1001380
  .long 0x1b90, 0xbe9c, 0x3f800000, 0x1001390
  .long 0x1ba0, 0xbeac, 0x3f80, 0x10013a0
  .long 0x1bb0, 0xbebc, 0x3f800000, 0x10013b0
  .long 0x1bc0, 0xbecc, 0x3f80, 0x10013c0
  .long 0x1bd0, 0xbedc, 0x3f800000, 0x10013d0
  .long 0x1be0, 0xbeec, 0x3f80, 0x10013e0
  .long 0x1bf0, 0xbefc, 0x3f800000, 0x10013f0
  .long 0x0, 0x40, 0x0, 0x40
  .long 0x10, 0x50, 0x10, 0x50
  .long 0x20, 0x60, 0x20, 0x60
  .long 0x30, 0x70, 0x30, 0x70
  .long 0x40, 0x0, 0x40, 0x0
  .long 0x50, 0x10, 0x50, 0x10
  .long 0x60, 0x20, 0x60, 0x20
  .long 0x70, 0x30, 0x70, 0x30
  .long 0x80, 0xc0, 0x80, 0xc0
  .long 0x90, 0xd0, 0x90, 0xd0
  .long 0xa0, 0xe0, 0xa0, 0xe0
  .long 0xb0, 0xf0, 0xb0, 0xf0
  .long 0xc0, 0x80, 0xc0, 0x80
  .long 0xd0, 0x90, 0xd0, 0x90
  .long 0xe0, 0xa0, 0xe0, 0xa0
  .long 0xf0, 0xb0, 0xf0, 0xb0
  .long 0x2020, 0x2060, 0x420, 0x460
  .long 0x2030, 0x2070, 0x430, 0x470
  .long 0x2000, 0x2040, 0x400, 0x440
  .long 0x2010, 0x2050, 0x410, 0x450
  .long 0x2060, 0x2020, 0x460, 0x420
  .long 0x2070, 0x2030, 0x470, 0x430
  .long 0x2040, 0x2000, 0x440, 0x400
  .long 0x2050, 0x2010, 0x450, 0x410
  .long 0x20a0, 0x20e0, 0x4a0, 0x4e0
  .long 0x20b0, 0x20f0, 0x4b0, 0x4f0
  .long 0x2080, 0x20c0, 0x480, 0x4c0
  .long 0x2090, 0x20d0, 0x490, 0x4d0
  .long 0x20e0, 0x20a0, 0x4e0, 0x4a0
  .long 0x20f0, 0x20b0, 0x4f0, 0x4b0
  .long 0x20c0, 0x2080, 0x4c0, 0x480
  .long 0x20d0, 0x2090, 0x4d0, 0x490
  .long 0x4000, 0x4040, 0x800, 0x840
  .long 0x4010, 0x4050, 0x810, 0x850
  .long 0x4020, 0x4060, 0x820, 0x860
  .long 0x4030, 0x4070, 0x830, 0x870
  .long 0x4040, 0x4000, 0x840, 0x800
  .long 0x4050, 0x4010, 0x850, 0x810
  .long 0x4060, 0x4020, 0x860, 0x820
  .long 0x4070, 0x4030, 0x870, 0x830
  .long 0x4080, 0x40c0, 0x880, 0x8c0
  .long 0x4090, 0x40d0, 0x890, 0x8d0
  .long 0x40a0, 0x40e0, 0x8a0, 0x8e0
  .long 0x40b0, 0x40f0, 0x8b0, 0x8f0
  .long 0x40c0, 0x4080, 0x8c0, 0x880
  .long 0x40d0, 0x4090, 0x8d0, 0x890
  .long 0x40e0, 0x40a0, 0x8e0, 0x8a0
  .long 0x40f0, 0x40b0, 0x8f0, 0x8b0
  .long 0x6020, 0x6060, 0xc20, 0xc60
  .long 0x6030, 0x6070, 0xc30, 0xc70
  .long 0x6000, 0x6040, 0xc00, 0xc40
  .long 0x6010, 0x6050, 0xc10, 0xc50
  .long 0x6060, 0x6020, 0xc60, 0xc20
  .long 0x6070, 0x6030, 0xc70, 0xc30
  .long 0x6040, 0x6000, 0xc40, 0xc00
  .long 0x6050, 0x6010, 0xc50, 0xc10
  .long 0x60a0, 0x60e0, 0xca0, 0xce0
  .long 0x60b0, 0x60f0, 0xcb0, 0xcf0
  .long 0x6080, 0x60c0, 0xc80, 0xcc0
  .long 0x6090, 0x60d0, 0xc90, 0xcd0
  .long 0x60e0, 0x60a0, 0xce0, 0xca0
  .long 0x60f0, 0x60b0, 0xcf0, 0xcb0
  .long 0x60c0, 0x6080, 0xcc0, 0xc80
  .long 0x60d0, 0x6090, 0xcd0, 0xc90
  .long 0x80, 0xc0, 0x0, 0x40
  .long 0x90, 0xd0, 0x10, 0x50
  .long 0xa0, 0xe0, 0x20, 0x60
  .long 0xb0, 0xf0, 0x30, 0x70
  .long 0xc0, 0x80, 0x40, 0x0
  .long 0xd0, 0x90, 0x50, 0x10
  .long 0xe0, 0xa0, 0x60, 0x20
  .long 0xf0, 0xb0, 0x70, 0x30
  .long 0x0, 0x40, 0x80, 0xc0
  .long 0x10, 0x50, 0x90, 0xd0
  .long 0x20, 0x60, 0xa0, 0xe0
  .long 0x30, 0x70, 0xb0, 0xf0
  .long 0x40, 0x0, 0xc0, 0x80
  .long 0x50, 0x10, 0xd0, 0x90
  .long 0x60, 0x20, 0xe0, 0xa0
  .long 0x70, 0x30, 0xf0, 0xb0
  .long 0x20a0, 0x20e0, 0x420, 0x460
  .long 0x20b0, 0x20f0, 0x430, 0x470
  .long 0x2080, 0x20c0, 0x400, 0x440
  .long 0x2090, 0x20d0, 0x410, 0x450
  .long 0x20e0, 0x20a0, 0x460, 0x420
  .long 0x20f0, 0x20b0, 0x470, 0x430
  .long 0x20c0, 0x2080, 0x440, 0x400
  .long 0x20d0, 0x2090, 0x450, 0x410
  .long 0x2020, 0x2060, 0x4a0, 0x4e0
  .long 0x2030, 0x2070, 0x4b0, 0x4f0
  .long 0x2000, 0x2040, 0x480, 0x4c0
  .long 0x2010, 0x2050, 0x490, 0x4d0
  .long 0x2060, 0x2020, 0x4e0, 0x4a0
  .long 0x2070, 0x2030, 0x4f0, 0x4b0
  .long 0x2040, 0x2000, 0x4c0, 0x480
  .long 0x2050, 0x2010, 0x4d0, 0x490
  .long 0x4080, 0x40c0, 0x800, 0x840
  .long 0x4090, 0x40d0, 0x810, 0x850
  .long 0x40a0, 0x40e0, 0x820, 0x860
  .long 0x40b0, 0x40f0, 0x830, 0x870
  .long 0x40c0, 0x4080, 0x840, 0x800
  .long 0x40d0, 0x4090, 0x850, 0x810
  .long 0x40e0, 0x40a0, 0x860, 0x820
  .long 0x40f0, 0x40b0, 0x870, 0x830
  .long 0x4000, 0x4040, 0x880, 0x8c0
  .long 0x4010, 0x4050, 0x890, 0x8d0
  .long 0x4020, 0x4060, 0x8a0, 0x8e0
  .long 0x4030, 0x4070, 0x8b0, 0x8f0
  .long 0x4040, 0x4000, 0x8c0, 0x880
  .long 0x4050, 0x4010, 0x8d0, 0x890
  .long 0x4060, 0x4020, 0x8e0, 0x8a0
  .long 0x4070, 0x4030, 0x8f0, 0x8b0
  .long 0x60a0, 0x60e0, 0xc20, 0xc60
  .long 0x60b0, 0x60f0, 0xc30, 0xc70
  .long 0x6080, 0x60c0, 0xc00, 0xc40
  .long 0x6090, 0x60d0, 0xc10, 0xc50
  .long 0x60e0, 0x60a0, 0xc60, 0xc20
  .long 0x60f0, 0x60b0, 0xc70, 0xc30
  .long 0x60c0, 0x6080, 0xc40, 0xc00
  .long 0x60d0, 0x6090, 0xc50, 0xc10
  .long 0x6020, 0x6060, 0xca0, 0xce0
  .long 0x6030, 0x6070, 0xcb0, 0xcf0
  .long 0x6000, 0x6040, 0xc80, 0xcc0
  .long 0x6010, 0x6050, 0xc90, 0xcd0
  .long 0x6060, 0x6020, 0xce0, 0xca0
  .long 0x6070, 0x6030, 0xcf0, 0xcb0
  .long 0x6040, 0x6000, 0xcc0, 0xc80
  .long 0x6050, 0x6010, 0xcd0, 0xc90
  .long 0x0, 0x40, 0x80, 0xc0
  .long 0x10, 0x50, 0x90, 0xd0
  .long 0x20, 0x60, 0xa0, 0xe0
  .long 0x30, 0x70, 0xb0, 0xf0
  .long 0x40, 0x0, 0xc0, 0x80
  .long 0x50, 0x10, 0xd0, 0x90
  .long 0x60, 0x20, 0xe0, 0xa0
  .long 0x70, 0x30, 0xf0, 0xb0
  .long 0x80, 0xc0, 0x0, 0x40
  .long 0x90, 0xd0, 0x10, 0x50
  .long 0xa0, 0xe0, 0x20, 0x60
  .long 0xb0, 0xf0, 0x30, 0x70
  .long 0xc0, 0x80, 0x40, 0x0
  .long 0xd0, 0x90, 0x50, 0x10
  .long 0xe0, 0xa0, 0x60, 0x20
  .long 0xf0, 0xb0, 0x70, 0x30
  .long 0x2020, 0x2060, 0x4a0, 0x4e0
  .long 0x2030, 0x2070, 0x4b0, 0x4f0
  .long 0x2000, 0x2040, 0x480, 0x4c0
  .long 0x2010, 0x2050, 0x490, 0x4d0
  .long 0x2060, 0x2020, 0x4e0, 0x4a0
  .long 0x2070, 0x2030, 0x4f0, 0x4b0
  .long 0x2040, 0x2000, 0x4c0, 0x480
  .long 0x2050, 0x2010, 0x4d0, 0x490
  .long 0x20a0, 0x20e0, 0x420, 0x460
  .long 0x20b0, 0x20f0, 0x430, 0x470
  .long 0x2080, 0x20c0, 0x400, 0x440
  .long 0x2090, 0x20d0, 0x410, 0x450
  .long 0x20e0, 0x20a0, 0x460, 0x420
  .long 0x20f0, 0x20b0, 0x470, 0x430
  .long 0x20c0, 0x2080, 0x440, 0x400
  .long 0x20d0, 0x2090, 0x450, 0x410
  .long 0x4000, 0x4040, 0x880, 0x8c0
  .long 0x4010, 0x4050, 0x890, 0x8d0
  .long 0x4020, 0x4060, 0x8a0, 0x8e0
  .long 0x4030, 0x4070, 0x8b0, 0x8f0
  .long 0x4040, 0x4000, 0x8c0, 0x880
  .long 0x4050, 0x4010, 0x8d0, 0x890
  .long 0x4060, 0x4020, 0x8e0, 0x8a0
  .long 0x4070, 0x4030, 0x8f0, 0x8b0
  .long 0x4080, 0x40c0, 0x800, 0x840
  .long 0x4090, 0x40d0, 0x810, 0x850
  .long 0x40a0, 0x40e0, 0x820, 0x860
  .long 0x40b0, 0x40f0, 0x830, 0x870
  .long 0x40c0, 0x4080, 0x840, 0x800
  .long 0x40d0, 0x4090, 0x850, 0x810
  .long 0x40e0, 0x40a0, 0x860, 0x820
  .long 0x40f0, 0x40b0, 0x870, 0x830
  .long 0x6020, 0x6060, 0xca0, 0xce0
  .long 0x6030, 0x6070, 0xcb0, 0xcf0
  .long 0x6000, 0x6040, 0xc80, 0xcc0
  .long 0x6010, 0x6050, 0xc90, 0xcd0
  .long 0x6060, 0x6020, 0xce0, 0xca0
  .long 0x6070, 0x6030, 0xcf0, 0xcb0
  .long 0x6040, 0x6000, 0xcc0, 0xc80
  .long 0x6050, 0x6010, 0xcd0, 0xc90
  .long 0x60a0, 0x60e0, 0xc20, 0xc60
  .long 0x60b0, 0x60f0, 0xc30, 0xc70
  .long 0x6080, 0x60c0, 0xc00, 0xc40
  .long 0x6090, 0x60d0, 0xc10, 0xc50
  .long 0x60e0, 0x60a0, 0xc60, 0xc20
  .long 0x60f0, 0x60b0, 0xc70, 0xc30
  .long 0x60c0, 0x6080, 0xc40, 0xc00
  .long 0x60d0, 0x6090, 0xc50, 0xc10
  .long 0x80, 0xc0, 0x80, 0xc0
  .long 0x90, 0xd0, 0x90, 0xd0
  .long 0xa0, 0xe0, 0xa0, 0xe0
  .long 0xb0, 0xf0, 0xb0, 0xf0
  .long 0xc0, 0x80, 0xc0, 0x80
  .long 0xd0, 0x90, 0xd0, 0x90
  .long 0xe0, 0xa0, 0xe0, 0xa0
  .long 0xf0, 0xb0, 0xf0, 0xb0
  .long 0x0, 0x40, 0x0, 0x40
  .long 0x10, 0x50, 0x10, 0x50
  .long 0x20, 0x60, 0x20, 0x60
  .long 0x30, 0x70, 0x30, 0x70
  .long 0x40, 0x0, 0x40, 0x0
  .long 0x50, 0x10, 0x50, 0x10
  .long 0x60, 0x20, 0x60, 0x20
  .long 0x70, 0x30, 0x70, 0x30
  .long 0x20a0, 0x20e0, 0x4a0, 0x4e0
  .long 0x20b0, 0x20f0, 0x4b0, 0x4f0
  .long 0x2080, 0x20c0, 0x480, 0x4c0
  .long 0x2090, 0x20d0, 0x490, 0x4d0
  .long 0x20e0, 0x20a0, 0x4e0, 0x4a0
  .long 0x20f0, 0x20b0, 0x4f0, 0x4b0
  .long 0x20c0, 0x2080, 0x4c0, 0x480
  .long 0x20d0, 0x2090, 0x4d0, 0x490
  .long 0x2020, 0x2060, 0x420, 0x460
  .long 0x2030, 0x2070, 0x430, 0x470
  .long 0x2000, 0x2040, 0x400, 0x440
  .long 0x2010, 0x2050, 0x410, 0x450
  .long 0x2060, 0x2020, 0x460, 0x420
  .long 0x2070, 0x2030, 0x470, 0x430
  .long 0x2040, 0x2000, 0x440, 0x400
  .long 0x2050, 0x2010, 0x450, 0x410
  .long 0x4080, 0x40c0, 0x880, 0x8c0
  .long 0x4090, 0x40d0, 0x890, 0x8d0
  .long 0x40a0, 0x40e0, 0x8a0, 0x8e0
  .long 0x40b0, 0x40f0, 0x8b0, 0x8f0
  .long 0x40c0, 0x4080, 0x8c0, 0x880
  .long 0x40d0, 0x4090, 0x8d0, 0x890
  .long 0x40e0, 0x40a0, 0x8e0, 0x8a0
  .long 0x40f0, 0x40b0, 0x8f0, 0x8b0
  .long 0x4000, 0x4040, 0x800, 0x840
  .long 0x4010, 0x4050, 0x810, 0x850
  .long 0x4020, 0x4060, 0x820, 0x860
  .long 0x4030, 0x4070, 0x830, 0x870
  .long 0x4040, 0x4000, 0x840, 0x800
  .long 0x4050, 0x4010, 0x850, 0x810
  .long 0x4060, 0x4020, 0x860, 0x820
  .long 0x4070, 0x4030, 0x870, 0x830
  .long 0x60a0, 0x60e0, 0xca0, 0xce0
  .long 0x60b0, 0x60f0, 0xcb0, 0xcf0
  .long 0x6080, 0x60c0, 0xc80, 0xcc0
  .long 0x6090, 0x60d0, 0xc90, 0xcd0
  .long 0x60e0, 0x60a0, 0xce0, 0xca0
  .long 0x60f0, 0x60b0, 0xcf0, 0xcb0
  .long 0x60c0, 0x6080, 0xcc0, 0xc80
  .long 0x60d0, 0x6090, 0xcd0, 0xc90
  .long 0x6020, 0x6060, 0xc20, 0xc60
  .long 0x6030, 0x6070, 0xc30, 0xc70
  .long 0x6000, 0x6040, 0xc00, 0xc40
  .long 0x6010, 0x6050, 0xc10, 0xc50
  .long 0x6060, 0x6020, 0xc60, 0xc20
  .long 0x6070, 0x6030, 0xc70, 0xc30
  .long 0x6040, 0x6000, 0xc40, 0xc00
  .long 0x6050, 0x6010, 0xc50, 0xc10
  .long 0x8000, 0x8020, 0x18000, 0x18020
  .long 0x8008, 0x8028, 0x18008, 0x18028
  .long 0x8010, 0x8030, 0x18010, 0x18030
  .long 0x8018, 0x8038, 0x18018, 0x18038
  .long 0x8120, 0x8100, 0x18120, 0x18100
  .long 0x8128, 0x8108, 0x18128, 0x18108
  .long 0x8130, 0x8110, 0x18130, 0x18110
  .long 0x8138, 0x8118, 0x18138, 0x18118
  .long 0xa080, 0xa0a0, 0x1a080, 0x1a0a0
  .long 0xa088, 0xa0a8, 0x1a088, 0x1a0a8
  .long 0xa090, 0xa0b0, 0x1a090, 0x1a0b0
  .long 0xa098, 0xa0b8, 0x1a098, 0x1a0b8
  .long 0xa1a0, 0xa180, 0x1a1a0, 0x1a180
  .long 0xa1a8, 0xa188, 0x1a1a8, 0x1a188
  .long 0xa1b0, 0xa190, 0x1a1b0, 0x1a190
  .long 0xa1b8, 0xa198, 0x1a1b8, 0x1a198
  .long 0x9040, 0x9060, 0x19040, 0x19060
  .long 0x9048, 0x9068, 0x19048, 0x19068
  .long 0x9050, 0x9070, 0x19050, 0x19070
  .long 0x9058, 0x9078, 0x19058, 0x19078
  .long 0x9160, 0x9140, 0x19160, 0x19140
  .long 0x9168, 0x9148, 0x19168, 0x19148
  .long 0x9170, 0x9150, 0x19170, 0x19150
  .long 0x9178, 0x9158, 0x19178, 0x19158
  .long 0xb0c0, 0xb0e0, 0x1b0c0, 0x1b0e0
  .long 0xb0c8, 0xb0e8, 0x1b0c8, 0x1b0e8
  .long 0xb0d0, 0xb0f0, 0x1b0d0, 0x1b0f0
  .long 0xb0d8, 0xb0f8, 0x1b0d8, 0x1b0f8
  .long 0xb1e0, 0xb1c0, 0x1b1e0, 0x1b1c0
  .long 0xb1e8, 0xb1c8, 0x1b1e8, 0x1b1c8
  .long 0xb1f0, 0xb1d0, 0x1b1f0, 0x1b1d0
  .long 0xb1f8, 0xb1d8, 0x1b1f8, 0x1b1d8
  .long 0x8400, 0x8420, 0x18400, 0x18420
  .long 0x8408, 0x8428, 0x18408, 0x18428
  .long 0x8410, 0x8430, 0x18410, 0x18430
  .long 0x8418, 0x8438, 0x18418, 0x18438
  .long 0x8520, 0x8500, 0x18520, 0x18500
  .long 0x8528, 0x8508, 0x18528, 0x18508
  .long 0x8530, 0x8510, 0x18530, 0x18510
  .long 0x8538, 0x8518, 0x18538, 0x18518
  .long 0xa480, 0xa4a0, 0x1a480, 0x1a4a0
  .long 0xa488, 0xa4a8, 0x1a488, 0x1a4a8
  .long 0xa490, 0xa4b0, 0x1a490, 0x1a4b0
  .long 0xa498, 0xa4b8, 0x1a498, 0x1a4b8
  .long 0xa5a0, 0xa580, 0x1a5a0, 0x1a580
  .long 0xa5a8, 0xa588, 0x1a5a8, 0x1a588
  .long 0xa5b0, 0xa590, 0x1a5b0, 0x1a590
  .long 0xa5b8, 0xa598, 0x1a5b8, 0x1a598
  .long 0x9440, 0x9460, 0x19440, 0x19460
  .long 0x9448, 0x9468, 0x19448, 0x19468
  .long 0x9450, 0x9470, 0x19450, 0x19470
  .long 0x9458, 0x9478, 0x19458, 0x19478
  .long 0x9560, 0x9540, 0x19560, 0x19540
  .long 0x9568, 0x9548, 0x19568, 0x19548
  .long 0x9570, 0x9550, 0x19570, 0x19550
  .long 0x9578, 0x9558, 0x19578, 0x19558
  .long 0xb4c0, 0xb4e0, 0x1b4c0, 0x1b4e0
  .long 0xb4c8, 0xb4e8, 0x1b4c8, 0x1b4e8
  .long 0xb4d0, 0xb4f0, 0x1b4d0, 0x1b4f0
  .long 0xb4d8, 0xb4f8, 0x1b4d8, 0x1b4f8
  .long 0xb5e0, 0xb5c0, 0x1b5e0, 0x1b5c0
  .long 0xb5e8, 0xb5c8, 0x1b5e8, 0x1b5c8
  .long 0xb5f0, 0xb5d0, 0x1b5f0, 0x1b5d0
  .long 0xb5f8, 0xb5d8, 0x1b5f8, 0x1b5d8
  .long 0x8040, 0x8060, 0x18040, 0x18060
  .long 0x8048, 0x8068, 0x18048, 0x18068
  .long 0x8050, 0x8070, 0x18050, 0x18070
  .long 0x8058, 0x8078, 0x18058, 0x18078
  .long 0x8160, 0x8140, 0x18160, 0x18140
  .long 0x8168, 0x8148, 0x18168, 0x18148
  .long 0x8170, 0x8150, 0x18170, 0x18150
  .long 0x8178, 0x8158, 0x18178, 0x18158
  .long 0xa0c0, 0xa0e0, 0x1a0c0, 0x1a0e0
  .long 0xa0c8, 0xa0e8, 0x1a0c8, 0x1a0e8
  .long 0xa0d0, 0xa0f0, 0x1a0d0, 0x1a0f0
  .long 0xa0d8, 0xa0f8, 0x1a0d8, 0x1a0f8
  .long 0xa1e0, 0xa1c0, 0x1a1e0, 0x1a1c0
  .long 0xa1e8, 0xa1c8, 0x1a1e8, 0x1a1c8
  .long 0xa1f0, 0xa1d0, 0x1a1f0, 0x1a1d0
  .long 0xa1f8, 0xa1d8, 0x1a1f8, 0x1a1d8
  .long 0x9000, 0x9020, 0x19000, 0x19020
  .long 0x9008, 0x9028, 0x19008, 0x19028
  .long 0x9010, 0x9030, 0x19010, 0x19030
  .long 0x9018, 0x9038, 0x19018, 0x19038
  .long 0x9120, 0x9100, 0x19120, 0x19100
  .long 0x9128, 0x9108, 0x19128, 0x19108
  .long 0x9130, 0x9110, 0x19130, 0x19110
  .long 0x9138, 0x9118, 0x19138, 0x19118
  .long 0xb080, 0xb0a0, 0x1b080, 0x1b0a0
  .long 0xb088, 0xb0a8, 0x1b088, 0x1b0a8
  .long 0xb090, 0xb0b0, 0x1b090, 0x1b0b0
  .long 0xb098, 0xb0b8, 0x1b098, 0x1b0b8
  .long 0xb1a0, 0xb180, 0x1b1a0, 0x1b180
  .long 0xb1a8, 0xb188, 0x1b1a8, 0x1b188
  .long 0xb1b0, 0xb190, 0x1b1b0, 0x1b190
  .long 0xb1b8, 0xb198, 0x1b1b8, 0x1b198
  .long 0x8440, 0x8460, 0x18440, 0x18460
  .long 0x8448, 0x8468, 0x18448, 0x18468
  .long 0x8450, 0x8470, 0x18450, 0x18470
  .long 0x8458, 0x8478, 0x18458, 0x18478
  .long 0x8560, 0x8540, 0x18560, 0x18540
  .long 0x8568, 0x8548, 0x18568, 0x18548
  .long 0x8570, 0x8550, 0x18570, 0x18550
  .long 0x8578, 0x8558, 0x18578, 0x18558
  .long 0xa4c0, 0xa4e0, 0x1a4c0, 0x1a4e0
  .long 0xa4c8, 0xa4e8, 0x1a4c8, 0x1a4e8
  .long 0xa4d0, 0xa4f0, 0x1a4d0, 0x1a4f0
  .long 0xa4d8, 0xa4f8, 0x1a4d8, 0x1a4f8
  .long 0xa5e0, 0xa5c0, 0x1a5e0, 0x1a5c0
  .long 0xa5e8, 0xa5c8, 0x1a5e8, 0x1a5c8
  .long 0xa5f0, 0xa5d0, 0x1a5f0, 0x1a5d0
  .long 0xa5f8, 0xa5d8, 0x1a5f8, 0x1a5d8
  .long 0x9400, 0x9420, 0x19400, 0x19420
  .long 0x9408, 0x9428, 0x19408, 0x19428
  .long 0x9410, 0x9430, 0x19410, 0x19430
  .long 0x9418, 0x9438, 0x19418, 0x19438
  .long 0x9520, 0x9500, 0x19520, 0x19500
  .long 0x9528, 0x9508, 0x19528, 0x19508
  .long 0x9530, 0x9510, 0x19530, 0x19510
  .long 0x9538, 0x9518, 0x19538, 0x19518
  .long 0xb480, 0xb4a0, 0x1b480, 0x1b4a0
  .long 0xb488, 0xb4a8, 0x1b488, 0x1b4a8
  .long 0xb490, 0xb4b0, 0x1b490, 0x1b4b0
  .long 0xb498, 0xb4b8, 0x1b498, 0x1b4b8
  .long 0xb5a0, 0xb580, 0x1b5a0, 0x1b580
  .long 0xb5a8, 0xb588, 0x1b5a8, 0x1b588
  .long 0xb5b0, 0xb590, 0x1b5b0, 0x1b590
  .long 0xb5b8, 0xb598, 0x1b5b8, 0x1b598
  .long 0x8080, 0x80a0, 0x18080, 0x180a0
  .long 0x8088, 0x80a8, 0x18088, 0x180a8
  .long 0x8090, 0x80b0, 0x18090, 0x180b0
  .long 0x8098, 0x80b8, 0x18098, 0x180b8
  .long 0x81a0, 0x8180, 0x181a0, 0x18180
  .long 0x81a8, 0x8188, 0x181a8, 0x18188
  .long 0x81b0, 0x8190, 0x181b0, 0x18190
  .long 0x81b8, 0x8198, 0x181b8, 0x18198
  .long 0xa000, 0xa020, 0x1a000, 0x1a020
  .long 0xa008, 0xa028, 0x1a008, 0x1a028
  .long 0xa010, 0xa030, 0x1a010, 0x1a030
  .long 0xa018, 0xa038, 0x1a018, 0x1a038
  .long 0xa120, 0xa100, 0x1a120, 0x1a100
  .long 0xa128, 0xa108, 0x1a128, 0x1a108
  .long 0xa130, 0xa110, 0x1a130, 0x1a110
  .long 0xa138, 0xa118, 0x1a138, 0x1a118
  .long 0x90c0, 0x90e0, 0x190c0, 0x190e0
  .long 0x90c8, 0x90e8, 0x190c8, 0x190e8
  .long 0x90d0, 0x90f0, 0x190d0, 0x190f0
  .long 0x90d8, 0x90f8, 0x190d8, 0x190f8
  .long 0x91e0, 0x91c0, 0x191e0, 0x191c0
  .long 0x91e8, 0x91c8, 0x191e8, 0x191c8
  .long 0x91f0, 0x91d0, 0x191f0, 0x191d0
  .long 0x91f8, 0x91d8, 0x191f8, 0x191d8
  .long 0xb040, 0xb060, 0x1b040, 0x1b060
  .long 0xb048, 0xb068, 0x1b048, 0x1b068
  .long 0xb050, 0xb070, 0x1b050, 0x1b070
  .long 0xb058, 0xb078, 0x1b058, 0x1b078
  .long 0xb160, 0xb140, 0x1b160, 0x1b140
  .long 0xb168, 0xb148, 0x1b168, 0x1b148
  .long 0xb170, 0xb150, 0x1b170, 0x1b150
  .long 0xb178, 0xb158, 0x1b178, 0x1b158
  .long 0x8480, 0x84a0, 0x18480, 0x184a0
  .long 0x8488, 0x84a8, 0x18488, 0x184a8
  .long 0x8490, 0x84b0, 0x18490, 0x184b0
  .long 0x8498, 0x84b8, 0x18498, 0x184b8
  .long 0x85a0, 0x8580, 0x185a0, 0x18580
  .long 0x85a8, 0x8588, 0x185a8, 0x18588
  .long 0x85b0, 0x8590, 0x185b0, 0x18590
  .long 0x85b8, 0x8598, 0x185b8, 0x18598
  .long 0xa400, 0xa420, 0x1a400, 0x1a420
  .long 0xa408, 0xa428, 0x1a408, 0x1a428
  .long 0xa410, 0xa430, 0x1a410, 0x1a430
  .long 0xa418, 0xa438, 0x1a418, 0x1a438
  .long 0xa520, 0xa500, 0x1a520, 0x1a500
  .long 0xa528, 0xa508, 0x1a528, 0x1a508
  .long 0xa530, 0xa510, 0x1a530, 0x1a510
  .long 0xa538, 0xa518, 0x1a538, 0x1a518
  .long 0x94c0, 0x94e0, 0x194c0, 0x194e0
  .long 0x94c8, 0x94e8, 0x194c8, 0x194e8
  .long 0x94d0, 0x94f0, 0x194d0, 0x194f0
  .long 0x94d8, 0x94f8, 0x194d8, 0x194f8
  .long 0x95e0, 0x95c0, 0x195e0, 0x195c0
  .long 0x95e8, 0x95c8, 0x195e8, 0x195c8
  .long 0x95f0, 0x95d0, 0x195f0, 0x195d0
  .long 0x95f8, 0x95d8, 0x195f8, 0x195d8
  .long 0xb440, 0xb460, 0x1b440, 0x1b460
  .long 0xb448, 0xb468, 0x1b448, 0x1b468
  .long 0xb450, 0xb470, 0x1b450, 0x1b470
  .long 0xb458, 0xb478, 0x1b458, 0x1b478
  .long 0xb560, 0xb540, 0x1b560, 0x1b540
  .long 0xb568, 0xb548, 0x1b568, 0x1b548
  .long 0xb570, 0xb550, 0x1b570, 0x1b550
  .long 0xb578, 0xb558, 0x1b578, 0x1b558
  .long 0x80c0, 0x80e0, 0x180c0, 0x180e0
  .long 0x80c8, 0x80e8, 0x180c8, 0x180e8
  .long 0x80d0, 0x80f0, 0x180d0, 0x180f0
  .long 0x80d8, 0x80f8, 0x180d8, 0x180f8
  .long 0x81e0, 0x81c0, 0x181e0, 0x181c0
  .long 0x81e8, 0x81c8, 0x181e8, 0x181c8
  .long 0x81f0, 0x81d0, 0x181f0, 0x181d0
  .long 0x81f8, 0x81d8, 0x181f8, 0x181d8
  .long 0xa040, 0xa060, 0x1a040, 0x1a060
  .long 0xa048, 0xa068, 0x1a048, 0x1a068
  .long 0xa050, 0xa070, 0x1a050, 0x1a070
  .long 0xa058, 0xa078, 0x1a058, 0x1a078
  .long 0xa160, 0xa140, 0x1a160, 0x1a140
  .long 0xa168, 0xa148, 0x1a168, 0x1a148
  .long 0xa170, 0xa150, 0x1a170, 0x1a150
  .long 0xa178, 0xa158, 0x1a178, 0x1a158
  .long 0x9080, 0x90a0, 0x19080, 0x190a0
  .long 0x9088, 0x90a8, 0x19088, 0x190a8
  .long 0x9090, 0x90b0, 0x19090, 0x190b0
  .long 0x9098, 0x90b8, 0x19098, 0x190b8
  .long 0x91a0, 0x9180, 0x191a0, 0x19180
  .long 0x91a8, 0x9188, 0x191a8, 0x19188
  .long 0x91b0, 0x9190, 0x191b0, 0x19190
  .long 0x91b8, 0x9198, 0x191b8, 0x19198
  .long 0xb000, 0xb020, 0x1b000, 0x1b020
  .long 0xb008, 0xb028, 0x1b008, 0x1b028
  .long 0xb010, 0xb030, 0x1b010, 0x1b030
  .long 0xb018, 0xb038, 0x1b018, 0x1b038
  .long 0xb120, 0xb100, 0x1b120, 0x1b100
  .long 0xb128, 0xb108, 0x1b128, 0x1b108
  .long 0xb130, 0xb110, 0x1b130, 0x1b110
  .long 0xb138, 0xb118, 0x1b138, 0x1b118
  .long 0x84c0, 0x84e0, 0x184c0, 0x184e0
  .long 0x84c8, 0x84e8, 0x184c8, 0x184e8
  .long 0x84d0, 0x84f0, 0x184d0, 0x184f0
  .long 0x84d8, 0x84f8, 0x184d8, 0x184f8
  .long 0x85e0, 0x85c0, 0x185e0, 0x185c0
  .long 0x85e8, 0x85c8, 0x185e8, 0x185c8
  .long 0x85f0, 0x85d0, 0x185f0, 0x185d0
  .long 0x85f8, 0x85d8, 0x185f8, 0x185d8
  .long 0xa440, 0xa460, 0x1a440, 0x1a460
  .long 0xa448, 0xa468, 0x1a448, 0x1a468
  .long 0xa450, 0xa470, 0x1a450, 0x1a470
  .long 0xa458, 0xa478, 0x1a458, 0x1a478
  .long 0xa560, 0xa540, 0x1a560, 0x1a540
  .long 0xa568, 0xa548, 0x1a568, 0x1a548
  .long 0xa570, 0xa550, 0x1a570, 0x1a550
  .long 0xa578, 0xa558, 0x1a578, 0x1a558
  .long 0x9480, 0x94a0, 0x19480, 0x194a0
  .long 0x9488, 0x94a8, 0x19488, 0x194a8
  .long 0x9490, 0x94b0, 0x19490, 0x194b0
  .long 0x9498, 0x94b8, 0x19498, 0x194b8
  .long 0x95a0, 0x9580, 0x195a0, 0x19580
  .long 0x95a8, 0x9588, 0x195a8, 0x19588
  .long 0x95b0, 0x9590, 0x195b0, 0x19590
  .long 0x95b8, 0x9598, 0x195b8, 0x19598
  .long 0xb400, 0xb420, 0x1b400, 0x1b420
  .long 0xb408, 0xb428, 0x1b408, 0x1b428
  .long 0xb410, 0xb430, 0x1b410, 0x1b430
  .long 0xb418, 0xb438, 0x1b418, 0x1b438
  .long 0xb520, 0xb500, 0x1b520, 0x1b500
  .long 0xb528, 0xb508, 0x1b528, 0x1b508
  .long 0xb530, 0xb510, 0x1b530, 0x1b510
  .long 0xb538, 0xb518, 0x1b538, 0x1b518
  .long 0x8000, 0x0, 0x0, 0x2000
  .long 0x8008, 0x4, 0x4, 0x2010
  .long 0x8010, 0x20, 0x8, 0x2020
  .long 0x8018, 0x24, 0xc, 0x2030
  .long 0x8120, 0x400, 0x10, 0x2040
  .long 0x8128, 0x404, 0x14, 0x2050
  .long 0x8130, 0x420, 0x18, 0x2060
  .long 0x8138, 0x424, 0x1c, 0x2070
  .long 0xc080, 0x40, 0x20, 0x2080
  .long 0xc088, 0x44, 0x24, 0x2090
  .long 0xc090, 0x60, 0x28, 0x20a0
  .long 0xc098, 0x64, 0x2c, 0x20b0
  .long 0xc1a0, 0x440, 0x30, 0x20c0
  .long 0xc1a8, 0x444, 0x34, 0x20d0
  .long 0xc1b0, 0x460, 0x38, 0x20e0
  .long 0xc1b8, 0x464, 0x3c, 0x20f0
  .long 0x8440, 0x800, 0x40, 0x2100
  .long 0x8448, 0x804, 0x44, 0x2110
  .long 0x8450, 0x820, 0x48, 0x2120
  .long 0x8458, 0x824, 0x4c, 0x2130
  .long 0x8560, 0xc00, 0x50, 0x2140
  .long 0x8568, 0xc04, 0x54, 0x2150
  .long 0x8570, 0xc20, 0x58, 0x2160
  .long 0x8578, 0xc24, 0x5c, 0x2170
  .long 0xc4c0, 0x840, 0x60, 0x2180
  .long 0xc4c8, 0x844, 0x64, 0x2190
  .long 0xc4d0, 0x860, 0x68, 0x21a0
  .long 0xc4d8, 0x864, 0x6c, 0x21b0
  .long 0xc5e0, 0xc40, 0x70, 0x21c0
  .long 0xc5e8, 0xc44, 0x74, 0x21d0
  .long 0xc5f0, 0xc60, 0x78, 0x21e0
  .long 0xc5f8, 0xc64, 0x7c, 0x21f0
  .long 0x8800, 0x1000, 0x80, 0x2200
  .long 0x8808, 0x1004, 0x84, 0x2210
  .long 0x8810, 0x1020, 0x88, 0x2220
  .long 0x8818, 0x1024, 0x8c, 0x2230
  .long 0x8920, 0x1400, 0x90, 0x2240
  .long 0x8928, 0x1404, 0x94, 0x2250
  .long 0x8930, 0x1420, 0x98, 0x2260
  .long 0x8938, 0x1424, 0x9c, 0x2270
  .long 0xc880, 0x1040, 0xa0, 0x2280
  .long 0xc888, 0x1044, 0xa4, 0x2290
  .long 0xc890, 0x1060, 0xa8, 0x22a0
  .long 0xc898, 0x1064, 0xac, 0x22b0
  .long 0xc9a0, 0x1440, 0xb0, 0x22c0
  .long 0xc9a8, 0x1444, 0xb4, 0x22d0
  .long 0xc9b0, 0x1460, 0xb8, 0x22e0
  .long 0xc9b8, 0x1464, 0xbc, 0x22f0
  .long 0x8c40, 0x1800, 0xc0, 0x2300
  .long 0x8c48, 0x1804, 0xc4, 0x2310
  .long 0x8c50, 0x1820, 0xc8, 0x2320
  .long 0x8c58, 0x1824, 0xcc, 0x2330
  .long 0x8d60, 0x1c00, 0xd0, 0x2340
  .long 0x8d68, 0x1c04, 0xd4, 0x2350
  .long 0x8d70, 0x1c20, 0xd8, 0x2360
  .long 0x8d78, 0x1c24, 0xdc, 0x2370
  .long 0xccc0, 0x1840, 0xe0, 0x2380
  .long 0xccc8, 0x1844, 0xe4, 0x2390
  .long 0xccd0, 0x1860, 0xe8, 0x23a0
  .long 0xccd8, 0x1864, 0xec, 0x23b0
  .long 0xcde0, 0x1c40, 0xf0, 0x23c0
  .long 0xcde8, 0x1c44, 0xf4, 0x23d0
  .long 0xcdf0, 0x1c60, 0xf8, 0x23e0
  .long 0xcdf8, 0x1c64, 0xfc, 0x23f0
  .long 0x10000, 0x8, 0x100, 0x3800
  .long 0x10008, 0xc, 0x104, 0x3810
  .long 0x10010, 0x28, 0x108, 0x3820
  .long 0x10018, 0x2c, 0x10c, 0x3830
  .long 0x10120, 0x408, 0x110, 0x3840
  .long 0x10128, 0x40c, 0x114, 0x3850
  .long 0x10130, 0x428, 0x118, 0x3860
  .long 0x10138, 0x42c, 0x11c, 0x3870
  .long 0x14080, 0x48, 0x120, 0x3880
  .long 0x14088, 0x4c, 0x124, 0x3890
  .long 0x14090, 0x68, 0x128, 0x38a0
  .long 0x14098, 0x6c, 0x12c, 0x38b0
  .long 0x141a0, 0x448, 0x130, 0x38c0
  .long 0x141a8, 0x44c, 0x134, 0x38d0
  .long 0x141b0, 0x468, 0x138, 0x38e0
  .long 0x141b8, 0x46c, 0x13c, 0x38f0
  .long 0x10440, 0x808, 0x140, 0x3900
  .long 0x10448, 0x80c, 0x144, 0x3910
  .long 0x10450, 0x828, 0x148, 0x3920
  .long 0x10458, 0x82c, 0x14c, 0x3930
  .long 0x10560, 0xc08, 0x150, 0x3940
  .long 0x10568, 0xc0c, 0x154, 0x3950
  .long 0x10570, 0xc28, 0x158, 0x3960
  .long 0x10578, 0xc2c, 0x15c, 0x3970
  .long 0x144c0, 0x848, 0x160, 0x3980
  .long 0x144c8, 0x84c, 0x164, 0x3990
  .long 0x144d0, 0x868, 0x168, 0x39a0
  .long 0x144d8, 0x86c, 0x16c, 0x39b0
  .long 0x145e0, 0xc48, 0x170, 0x39c0
  .long 0x145e8, 0xc4c, 0x174, 0x39d0
  .long 0x145f0, 0xc68, 0x178, 0x39e0
  .long 0x145f8, 0xc6c, 0x17c, 0x39f0
  .long 0x10800, 0x1008, 0x180, 0x3a00
  .long 0x10808, 0x100c, 0x184, 0x3a10
  .long 0x10810, 0x1028, 0x188, 0x3a20
  .long 0x10818, 0x102c, 0x18c, 0x3a30
  .long 0x10920, 0x1408, 0x190, 0x3a40
  .long 0x10928, 0x140c, 0x194, 0x3a50
  .long 0x10930, 0x1428, 0x198, 0x3a60
  .long 0x10938, 0x142c, 0x19c, 0x3a70
  .long 0x14880, 0x1048, 0x1a0, 0x3a80
  .long 0x14888, 0x104c, 0x1a4, 0x3a90
  .long 0x14890, 0x1068, 0x1a8, 0x3aa0
  .long 0x14898, 0x106c, 0x1ac, 0x3ab0
  .long 0x149a0, 0x1448, 0x1b0, 0x3ac0
  .long 0x149a8, 0x144c, 0x1b4, 0x3ad0
  .long 0x149b0, 0x1468, 0x1b8, 0x3ae0
  .long 0x149b8, 0x146c, 0x1bc, 0x3af0
  .long 0x10c40, 0x1808, 0x1c0, 0x3b00
  .long 0x10c48, 0x180c, 0x1c4, 0x3b10
  .long 0x10c50, 0x1828, 0x1c8, 0x3b20
  .long 0x10c58, 0x182c, 0x1cc, 0x3b30
  .long 0x10d60, 0x1c08, 0x1d0, 0x3b40
  .long 0x10d68, 0x1c0c, 0x1d4, 0x3b50
  .long 0x10d70, 0x1c28, 0x1d8, 0x3b60
  .long 0x10d78, 0x1c2c, 0x1dc, 0x3b70
  .long 0x14cc0, 0x1848, 0x1e0, 0x3b80
  .long 0x14cc8, 0x184c, 0x1e4, 0x3b90
  .long 0x14cd0, 0x1868, 0x1e8, 0x3ba0
  .long 0x14cd8, 0x186c, 0x1ec, 0x3bb0
  .long 0x14de0, 0x1c48, 0x1f0, 0x3bc0
  .long 0x14de8, 0x1c4c, 0x1f4, 0x3bd0
  .long 0x14df0, 0x1c68, 0x1f8, 0x3be0
  .long 0x14df8, 0x1c6c, 0x1fc, 0x3bf0
  .long 0x18000, 0x10, 0x200, 0x5000
  .long 0x18008, 0x14, 0x204, 0x5010
  .long 0x18010, 0x30, 0x208, 0x5020
  .long 0x18018, 0x34, 0x20c, 0x5030
  .long 0x18120, 0x410, 0x210, 0x5040
  .long 0x18128, 0x414, 0x214, 0x5050
  .long 0x18130, 0x430, 0x218, 0x5060
  .long 0x18138, 0x434, 0x21c, 0x5070
  .long 0x1c080, 0x50, 0x220, 0x5080
  .long 0x1c088, 0x54, 0x224, 0x5090
  .long 0x1c090, 0x70, 0x228, 0x50a0
  .long 0x1c098, 0x74, 0x22c, 0x50b0
  .long 0x1c1a0, 0x450, 0x230, 0x50c0
  .long 0x1c1a8, 0x454, 0x234, 0x50d0
  .long 0x1c1b0, 0x470, 0x238, 0x50e0
  .long 0x1c1b8, 0x474, 0x23c, 0x50f0
  .long 0x18440, 0x810, 0x240, 0x5100
  .long 0x18448, 0x814, 0x244, 0x5110
  .long 0x18450, 0x830, 0x248, 0x5120
  .long 0x18458, 0x834, 0x24c, 0x5130
  .long 0x18560, 0xc10, 0x250, 0x5140
  .long 0x18568, 0xc14, 0x254, 0x5150
  .long 0x18570, 0xc30, 0x258, 0x5160
  .long 0x18578, 0xc34, 0x25c, 0x5170
  .long 0x1c4c0, 0x850, 0x260, 0x5180
  .long 0x1c4c8, 0x854, 0x264, 0x5190
  .long 0x1c4d0, 0x870, 0x268, 0x51a0
  .long 0x1c4d8, 0x874, 0x26c, 0x51b0
  .long 0x1c5e0, 0xc50, 0x270, 0x51c0
  .long 0x1c5e8, 0xc54, 0x274, 0x51d0
  .long 0x1c5f0, 0xc70, 0x278, 0x51e0
  .long 0x1c5f8, 0xc74, 0x27c, 0x51f0
  .long 0x18800, 0x1010, 0x280, 0x5200
  .long 0x18808, 0x1014, 0x284, 0x5210
  .long 0x18810, 0x1030, 0x288, 0x5220
  .long 0x18818, 0x1034, 0x28c, 0x5230
  .long 0x18920, 0x1410, 0x290, 0x5240
  .long 0x18928, 0x1414, 0x294, 0x5250
  .long 0x18930, 0x1430, 0x298, 0x5260
  .long 0x18938, 0x1434, 0x29c, 0x5270
  .long 0x1c880, 0x1050, 0x2a0, 0x5280
  .long 0x1c888, 0x1054, 0x2a4, 0x5290
  .long 0x1c890, 0x1070, 0x2a8, 0x52a0
  .long 0x1c898, 0x1074, 0x2ac, 0x52b0
  .long 0x1c9a0, 0x1450, 0x2b0, 0x52c0
  .long 0x1c9a8, 0x1454, 0x2b4, 0x52d0
  .long 0x1c9b0, 0x1470, 0x2b8, 0x52e0
  .long 0x1c9b8, 0x1474, 0x2bc, 0x52f0
  .long 0x18c40, 0x1810, 0x2c0, 0x5300
  .long 0x18c48, 0x1814, 0x2c4, 0x5310
  .long 0x18c50, 0x1830, 0x2c8, 0x5320
  .long 0x18c58, 0x1834, 0x2cc, 0x5330
  .long 0x18d60, 0x1c10, 0x2d0, 0x5340
  .long 0x18d68, 0x1c14, 0x2d4, 0x5350
  .long 0x18d70, 0x1c30, 0x2d8, 0x5360
  .long 0x18d78, 0x1c34, 0x2dc, 0x5370
  .long 0x1ccc0, 0x1850, 0x2e0, 0x5380
  .long 0x1ccc8, 0x1854, 0x2e4, 0x5390
  .long 0x1ccd0, 0x1870, 0x2e8, 0x53a0
  .long 0x1ccd8, 0x1874, 0x2ec, 0x53b0
  .long 0x1cde0, 0x1c50, 0x2f0, 0x53c0
  .long 0x1cde8, 0x1c54, 0x2f4, 0x53d0
  .long 0x1cdf0, 0x1c70, 0x2f8, 0x53e0
  .long 0x1cdf8, 0x1c74, 0x2fc, 0x53f0
  .long 0x20000, 0x18, 0x300, 0x6800
  .long 0x20008, 0x1c, 0x304, 0x6810
  .long 0x20010, 0x38, 0x308, 0x6820
  .long 0x20018, 0x3c, 0x30c, 0x6830
  .long 0x20120, 0x418, 0x310, 0x6840
  .long 0x20128, 0x41c, 0x314, 0x6850
  .long 0x20130, 0x438, 0x318, 0x6860
  .long 0x20138, 0x43c, 0x31c, 0x6870
  .long 0x24080, 0x58, 0x320, 0x6880
  .long 0x24088, 0x5c, 0x324, 0x6890
  .long 0x24090, 0x78, 0x328, 0x68a0
  .long 0x24098, 0x7c, 0x32c, 0x68b0
  .long 0x241a0, 0x458, 0x330, 0x68c0
  .long 0x241a8, 0x45c, 0x334, 0x68d0
  .long 0x241b0, 0x478, 0x338, 0x68e0
  .long 0x241b8, 0x47c, 0x33c, 0x68f0
  .long 0x20440, 0x818, 0x340, 0x6900
  .long 0x20448, 0x81c, 0x344, 0x6910
  .long 0x20450, 0x838, 0x348, 0x6920
  .long 0x20458, 0x83c, 0x34c, 0x6930
  .long 0x20560, 0xc18, 0x350, 0x6940
  .long 0x20568, 0xc1c, 0x354, 0x6950
  .long 0x20570, 0xc38, 0x358, 0x6960
  .long 0x20578, 0xc3c, 0x35c, 0x6970
  .long 0x244c0, 0x858, 0x360, 0x6980
  .long 0x244c8, 0x85c, 0x364, 0x6990
  .long 0x244d0, 0x878, 0x368, 0x69a0
  .long 0x244d8, 0x87c, 0x36c, 0x69b0
  .long 0x245e0, 0xc58, 0x370, 0x69c0
  .long 0x245e8, 0xc5c, 0x374, 0x69d0
  .long 0x245f0, 0xc78, 0x378, 0x69e0
  .long 0x245f8, 0xc7c, 0x37c, 0x69f0
  .long 0x20800, 0x1018, 0x380, 0x6a00
  .long 0x20808, 0x101c, 0x384, 0x6a10
  .long 0x20810, 0x1038, 0x388, 0x6a20
  .long 0x20818, 0x103c, 0x38c, 0x6a30
  .long 0x20920, 0x1418, 0x390, 0x6a40
  .long 0x20928, 0x141c, 0x394, 0x6a50
  .long 0x20930, 0x1438, 0x398, 0x6a60
  .long 0x20938, 0x143c, 0x39c, 0x6a70
  .long 0x24880, 0x1058, 0x3a0, 0x6a80
  .long 0x24888, 0x105c, 0x3a4, 0x6a90
  .long 0x24890, 0x1078, 0x3a8, 0x6aa0
  .long 0x24898, 0x107c, 0x3ac, 0x6ab0
  .long 0x249a0, 0x1458, 0x3b0, 0x6ac0
  .long 0x249a8, 0x145c, 0x3b4, 0x6ad0
  .long 0x249b0, 0x1478, 0x3b8, 0x6ae0
  .long 0x249b8, 0x147c, 0x3bc, 0x6af0
  .long 0x20c40, 0x1818, 0x3c0, 0x6b00
  .long 0x20c48, 0x181c, 0x3c4, 0x6b10
  .long 0x20c50, 0x1838, 0x3c8, 0x6b20
  .long 0x20c58, 0x183c, 0x3cc, 0x6b30
  .long 0x20d60, 0x1c18, 0x3d0, 0x6b40
  .long 0x20d68, 0x1c1c, 0x3d4, 0x6b50
  .long 0x20d70, 0x1c38, 0x3d8, 0x6b60
  .long 0x20d78, 0x1c3c, 0x3dc, 0x6b70
  .long 0x24cc0, 0x1858, 0x3e0, 0x6b80
  .long 0x24cc8, 0x185c, 0x3e4, 0x6b90
  .long 0x24cd0, 0x1878, 0x3e8, 0x6ba0
  .long 0x24cd8, 0x187c, 0x3ec, 0x6bb0
  .long 0x24de0, 0x1c58, 0x3f0, 0x6bc0
  .long 0x24de8, 0x1c5c, 0x3f4, 0x6bd0
  .long 0x24df0, 0x1c78, 0x3f8, 0x6be0
  .long 0x24df8, 0x1c7c, 0x3fc, 0x6bf0
.section .rodata,"a"
.p2align 6
.amdhsa_kernel gated_mix__memory_aug_recurrent_mem_tr__moe_arch_mod__prompt_kernel
  .amdhsa_next_free_vgpr 512
  .amdhsa_next_free_sgpr 102
  .amdhsa_accum_offset 256
  .amdhsa_group_segment_fixed_size 0
  .amdhsa_kernarg_size 128
  .amdhsa_user_sgpr_count 2
  .amdhsa_user_sgpr_kernarg_segment_ptr 1
  .amdhsa_system_sgpr_workgroup_id_x 1
.end_amdhsa_kernel
```
